```python
import torch

def _softmax(x, axis=-1):
    return torch.softmax(x, dim=axis)
def _gelu(x):
    return torch.nn.functional.gelu(x, approximate="tanh")
def _silu(x):
    return torch.nn.functional.silu(x)
def _sigmoid(x):
    return torch.sigmoid(x)
def _layernorm(x, axis=-1, eps=1e-5):
    m = x.mean(dim=axis, keepdim=True)
    v = x.var(dim=axis, keepdim=True, unbiased=False)
    return (x - m) / torch.sqrt(v + eps)
def _scatter_add(tgt, idx, src, axis=0):
    return tgt.clone().index_add_(axis, idx, src)
def _segment_sum(src, seg, n):
    out = torch.zeros((n,) + src.shape[1:], dtype=src.dtype)
    return out.index_add_(0, seg, src)
def _pad(x, pw):
    flat = tuple(v for pair in reversed(pw) for v in pair)
    return torch.nn.functional.pad(x, flat)

kernel_name = 'gated_mix__compressed_kv_cla__linear_kernel_hedgehog__prompt'

def setup_inputs():

    _w = (lambda a: (lambda t: t.to(torch.bfloat16) if t.is_floating_point() else t)(torch.as_tensor(a)))
    def _A_setup():
        B, H, Sq, Sk, D, M = 1, 32, 2048, 2048, 128, 576
        Dc = 4 * D
        return {
            "x": _w((lambda *s: torch.randn(*s, dtype=torch.bfloat16) * 0.05)(B, Sq, M)),
            "c_kv": _w((lambda *s: torch.randn(*s, dtype=torch.bfloat16) * 0.4)(B, Sk, Dc)),
            "w_q": _w((lambda *s: torch.randn(*s, dtype=torch.bfloat16) * 6.4)(M, H, D) * (M ** -0.5)),
            "w_uk": _w((lambda *s: torch.randn(*s, dtype=torch.bfloat16) * 6.4)(Dc, H, D) * (Dc ** -0.5)),
            "w_uv": _w((lambda *s: torch.randn(*s, dtype=torch.bfloat16) * 0.4)(Dc, H, D) * (Dc ** -0.5)),
            "w_o": _w((lambda *s: torch.randn(*s, dtype=torch.bfloat16) * 0.4)(H, D, M) * ((H * D) ** -0.5)),
        }
    _A_in = _A_setup()

    def _B_setup():
        B, S, D, H = 1, 2048, 576, 32
        Dh = D // H
        return {
            "x": _w((lambda *s: torch.randn(*s, dtype=torch.bfloat16) * 0.05)(B, S, D)),
            "wqkv": _w((lambda *s: torch.randn(*s, dtype=torch.bfloat16) * 0.8)(D, 3 * D)),
            "w_phi": _w((lambda *s: torch.randn(*s, dtype=torch.bfloat16) * 0.8)(H, Dh, Dh) * (Dh ** -0.5)),
            "wo": _w((lambda *s: torch.randn(*s, dtype=torch.bfloat16) * 0.05)(D, D)),
        }
    _B_in = _B_setup()

    return {
        "A_x": _A_in["x"],
        "A_c_kv": _A_in["c_kv"],
        "A_w_q": _A_in["w_q"],
        "A_w_uk": _A_in["w_uk"],
        "A_w_uv": _A_in["w_uv"],
        "A_w_o": _A_in["w_o"],
        "B_x": _B_in["x"],
        "B_wqkv": _B_in["wqkv"],
        "B_w_phi": _B_in["w_phi"],
        "B_wo": _B_in["wo"],
        "gate_w": _w((lambda *s: torch.randn(*s, dtype=torch.bfloat16) * 0.05)(576) * 16.0),
    }

def reference(A_x, A_c_kv, A_w_q, A_w_uk, A_w_uv, A_w_o, B_x, B_wqkv, B_w_phi, B_wo, gate_w):
    def _A_ref(x, c_kv, w_q, w_uk, w_uv, w_o):
        B, Sq, M = x.shape[0], x.shape[1], x.shape[2]
        Sk = c_kv.shape[1]
        H, D = w_q.shape[1], w_q.shape[2]
        q = torch.einsum("bqm,mhd->bhqd", x, w_q)
        k = torch.einsum("bkc,chd->bhkd", c_kv, w_uk)
        v = torch.einsum("bkc,chd->bhkd", c_kv, w_uv)
        scores = torch.einsum("bhqd,bhkd->bhqk", q, k) * (D ** -0.5)
        off = Sk - Sq
        qi = torch.arange(Sq)[:, None]
        kj = torch.arange(Sk)[None, :]
        cmask = kj <= (qi + off)
        scores = torch.where(cmask[None, None], scores, -1e9)
        p = _softmax(scores, axis=-1)
        ctx = torch.einsum("bhqk,bhkd->bhqd", p, v)
        return torch.einsum("bhqd,hdm->bqm", ctx, w_o)

    def _B_ref(x, wqkv, w_phi, wo):
        B, S, D = x.shape
        H = 32; Dh = D // H
        qkv = (lambda x, *d: x.permute(*d))((x @ wqkv).reshape(B, S, 3, H, Dh), 2, 0, 3, 1, 4)
        q, k, v = qkv[0], qkv[1], qkv[2]
        pq = torch.einsum("bhsd,hdf->bhsf", q, w_phi)
        pk = torch.einsum("bhsd,hdf->bhsf", k, w_phi)
        phi_q = torch.concatenate([_softmax(pq, axis=-1), _softmax(-pq, axis=-1)], axis=-1)
        phi_k = torch.concatenate([_softmax(pk, axis=-1), _softmax(-pk, axis=-1)], axis=-1)
        kv = torch.einsum("bhsf,bhsd->bhfd", phi_k, v)
        z  = torch.einsum("bhsf->bhf", phi_k)
        num = torch.einsum("bhqf,bhfd->bhqd", phi_q, kv)
        den = torch.einsum("bhqf,bhf->bhq", phi_q, z)[..., None] + 1e-6
        o = num / den
        return (lambda x, *d: x.permute(*d))(o, 0, 2, 1, 3).reshape(B, S, D) @ wo

    x = A_x
    g = _sigmoid((x * gate_w).sum(-1, keepdims=True))
    a = _A_ref(x, A_c_kv, A_w_q, A_w_uk, A_w_uv, A_w_o)
    b = _B_ref(x, B_wqkv, B_w_phi, B_wo)
    return g * a + (1 - g) * b
```

```asm
; @launch grid=(256,1,1) block=(256,1,1) lds=163840
.amdgcn_target "amdgcn-amd-amdhsa--gfx950"
.text
.globl gated_mix__compressed_kv_cla__linear_kernel_hedgehog__prompt_kernel
.p2align 8
.type gated_mix__compressed_kv_cla__linear_kernel_hedgehog__prompt_kernel,@function
gated_mix__compressed_kv_cla__linear_kernel_hedgehog__prompt_kernel:
    s_cmp_ge_u32 s2, 256
    s_cbranch_scc1 f1_end
    s_load_dwordx4 s[4:7], s[0:1], 0
    s_load_dwordx4 s[8:11], s[0:1], 24
    s_load_dwordx4 s[12:15], s[0:1], 56
    s_load_dwordx2 s[16:17], s[0:1], 80
    s_load_dwordx2 s[18:19], s[0:1], 104
    s_load_dwordx2 s[64:65], s[0:1], 16
    s_load_dwordx2 s[66:67], s[0:1], 40
    s_load_dwordx2 s[68:69], s[0:1], 72
    s_load_dwordx2 s[70:71], s[0:1], 96
    v_lshrrev_b32 v2, 6, v0
    v_and_b32 v1, 63, v0
    v_readfirstlane_b32 s22, v2
    s_getpc_b64 s[60:61]
f1_pc0:
    s_mov_b32 s62, f1_last-f1_pc0
    s_mov_b32 s63, 0x00020000
    s_lshr_b32 s23, s2, 3
    s_lshl_b32 s23, s23, 2
    s_add_u32 s23, s23, s22
    s_lshl_b32 s23, s23, 10
    v_lshlrev_b32 v29, 4, v1
    buffer_load_dwordx4 a[248:251], v29, s[60:63], s23 offen
    s_and_b32 s20, s2, 7
    s_lshl_b32 s20, s20, 2
    s_bfe_u32 s23, s2, 131075
    s_add_u32 s20, s20, s23
    s_bfe_u32 s21, s2, 196613
    v_and_b32 v2, 15, v1
    v_lshrrev_b32 v3, 4, v1
    v_and_b32 v4, 7, v1
    v_lshrrev_b32 v5, 3, v1
    v_and_b32 v6, 3, v1
    v_bfe_u32 v7, v1, 2, 2
    v_xor_b32 v24, v4, v3
    v_lshlrev_b32 v24, 4, v24
    v_lshl_add_u32 v8, v5, 10, v24
    v_xor_b32 v9, 64, v8
    v_lshlrev_b32 v24, 1, v3
    v_xor_b32 v24, v2, v24
    v_lshlrev_b32 v24, 4, v24
    v_lshl_add_u32 v24, v3, 13, v24
    s_and_b32 s23, s22, 2
    s_add_u32 s23, s23, s20
    s_and_b32 s24, s20, 28
    s_lshl_b32 s24, s24, 8
    v_bfe_u32 v25, v24, 7, 1
    v_add_u32 v10, s23, v25
    v_sub_u32 v11, s23, v25
    v_add_u32 v11, 1, v11
    v_and_b32 v10, 3, v10
    v_and_b32 v11, 3, v11
    v_add_u32 v24, s24, v24
    v_lshl_add_u32 v10, v10, 8, v24
    v_xor_b32 v24, 128, v24
    v_lshl_add_u32 v11, v11, 8, v24
    s_lshl_b32 s27, s21, 18
    s_lshl_b32 s23, s22, 16
    s_add_u32 s27, s27, s23
    s_lshl_b32 s28, s22, 13
    s_and_b32 s23, s22, 1
    s_lshl_b32 s29, s23, 17
    s_lshl_b32 s30, s22, 12
    s_waitcnt lgkmcnt(0)
    s_mov_b32 s32, s6
    s_mov_b32 s33, s7
    s_mov_b32 s34, 2097152
    s_mov_b32 s35, 0x00020000
    s_cmp_lt_u32 s22, 2
    s_cselect_b32 s36, s8, s10
    s_cselect_b32 s37, s9, s11
    s_mov_b32 s38, 4194304
    s_mov_b32 s39, 0x00020000
    s_add_u32 m0, s30, 98304
    s_add_u32 s23, s29, 0
    buffer_load_dwordx4 v10, s[36:39], s23 offen lds
    s_add_u32 m0, s30, 99328
    s_add_u32 s23, s29, 32768
    buffer_load_dwordx4 v10, s[36:39], s23 offen lds
    s_add_u32 m0, s30, 100352
    s_add_u32 s23, s29, 65536
    buffer_load_dwordx4 v11, s[36:39], s23 offen lds
    s_add_u32 m0, s30, 101376
    s_add_u32 s23, s29, 98304
    buffer_load_dwordx4 v11, s[36:39], s23 offen lds
    s_add_u32 m0, s28, 0
    s_add_u32 s23, s27, 0
    buffer_load_dwordx4 v8, s[32:35], s23 offen lds
    s_add_u32 m0, s28, 1024
    s_add_u32 s23, s27, 8192
    buffer_load_dwordx4 v9, s[32:35], s23 offen lds
    s_add_u32 m0, s28, 2048
    s_add_u32 s23, s27, 16384
    buffer_load_dwordx4 v8, s[32:35], s23 offen lds
    s_add_u32 m0, s28, 3072
    s_add_u32 s23, s27, 24576
    buffer_load_dwordx4 v9, s[32:35], s23 offen lds
    s_add_u32 m0, s28, 4096
    s_add_u32 s23, s27, 32768
    buffer_load_dwordx4 v8, s[32:35], s23 offen lds
    s_add_u32 m0, s28, 5120
    s_add_u32 s23, s27, 40960
    buffer_load_dwordx4 v9, s[32:35], s23 offen lds
    s_add_u32 m0, s28, 6144
    s_add_u32 s23, s27, 49152
    buffer_load_dwordx4 v8, s[32:35], s23 offen lds
    s_add_u32 m0, s28, 7168
    s_add_u32 s23, s27, 57344
    buffer_load_dwordx4 v9, s[32:35], s23 offen lds
    s_add_u32 m0, s30, 114688
    s_add_u32 s23, s29, 262144
    buffer_load_dwordx4 v10, s[36:39], s23 offen lds
    s_add_u32 m0, s30, 115712
    s_add_u32 s23, s29, 294912
    buffer_load_dwordx4 v10, s[36:39], s23 offen lds
    s_add_u32 m0, s30, 116736
    s_add_u32 s23, s29, 327680
    buffer_load_dwordx4 v11, s[36:39], s23 offen lds
    s_add_u32 m0, s30, 117760
    s_add_u32 s23, s29, 360448
    buffer_load_dwordx4 v11, s[36:39], s23 offen lds
    v_lshrrev_b32 v24, 1, v2
    v_xor_b32 v24, v24, v3
    v_lshlrev_b32 v24, 4, v24
    v_lshl_add_u32 v24, v2, 7, v24
    s_and_b32 s23, s22, 1
    s_lshl_b32 s23, s23, 14
    v_add_u32 v12, s23, v24
    v_xor_b32 v13, 64, v12
    v_add_u32 v14, 0x8000, v12
    v_add_u32 v15, 0x8000, v13
    v_add_u32 v16, 0x10000, v12
    v_add_u32 v17, 0x10000, v13
    v_lshl_add_u32 v24, v3, 3, v7
    v_lshlrev_b32 v24, 8, v24
    v_lshl_add_u32 v24, v6, 3, v24
    v_add_u32 v24, 98304, v24
    v_and_b32 v25, 1, v3
    v_lshl_or_b32 v25, v25, 2, v7
    s_lshr_b32 s23, s22, 1
    s_lshl_b32 s23, s23, 2
    v_xor_b32 v58, s23, v25
    v_xor_b32 v18, 0, v58
    v_lshl_add_u32 v18, v18, 5, v24
    v_xor_b32 v19, 1, v58
    v_lshl_add_u32 v19, v19, 5, v24
    v_xor_b32 v20, 2, v58
    v_lshl_add_u32 v20, v20, 5, v24
    v_xor_b32 v21, 3, v58
    v_lshl_add_u32 v21, v21, 5, v24
    v_lshlrev_b32 v29, 4, v1
    v_xor_b32 v36, 0, v25
    v_lshl_add_u32 v36, v36, 5, v24
    v_xor_b32 v37, 1, v25
    v_lshl_add_u32 v37, v37, 5, v24
    v_xor_b32 v38, 2, v25
    v_lshl_add_u32 v38, v38, 5, v24
    v_xor_b32 v39, 3, v25
    v_lshl_add_u32 v39, v39, 5, v24
    v_xor_b32 v40, 4, v25
    v_lshl_add_u32 v40, v40, 5, v24
    v_xor_b32 v41, 5, v25
    v_lshl_add_u32 v41, v41, 5, v24
    v_xor_b32 v42, 6, v25
    v_lshl_add_u32 v42, v42, 5, v24
    v_xor_b32 v43, 7, v25
    v_lshl_add_u32 v43, v43, 5, v24
    s_mov_b32 s44, s4
    s_mov_b32 s45, s5
    s_mov_b32 s46, 2359296
    s_mov_b32 s47, 0x00020000
    s_mov_b32 s48, s12
    s_mov_b32 s49, s13
    s_mov_b32 s50, 1990656
    s_mov_b32 s51, 0x00020000
    s_mov_b32 s52, s64
    s_mov_b32 s53, s65
    s_mov_b32 s54, 4718592
    s_mov_b32 s55, 0x00020000
    s_mov_b32 s56, s70
    s_mov_b32 s57, s71
    s_mov_b32 s58, 256
    s_mov_b32 s59, 0x00020000
    s_getreg_b32 s70, hwreg(HW_REG_XCC_ID, 0, 3)
    s_and_b32 s83, s70, 4
    s_and_b32 s25, s20, 28
    s_lshl_b32 s25, s25, 1
    s_add_u32 s83, s83, s25
    s_and_b32 s70, s70, 3
    s_lshl_b32 s70, s70, 3
    s_lshl_b32 s25, 1, s70
    s_mov_b32 s9, 1152
    s_mov_b32 s40, s18
    s_mov_b32 s41, s19
    s_mov_b32 s42, 33554432
    s_mov_b32 s43, 0x00020000
    s_lshl_b32 s25, s21, 2
    s_and_b32 s26, s22, 1
    s_lshl_b32 s26, s26, 1
    s_add_u32 s25, s25, s26
    s_lshl_b32 s25, s25, 15
    s_and_b32 s26, s20, 28
    s_lshl_b32 s26, s26, 20
    s_add_u32 s25, s25, s26
    s_lshr_b32 s26, s22, 1
    s_add_u32 s31, s26, s20
    s_add_u32 s6, s31, 2
    s_and_b32 s31, s31, 3
    s_and_b32 s6, s6, 3
    s_lshl_b32 s31, s31, 20
    s_lshl_b32 s6, s6, 20
    s_add_u32 s31, s31, s25
    s_add_u32 s6, s6, s25
    s_lshl_b32 s25, s26, 11
    s_add_u32 s31, s31, s25
    s_lshl_b32 s25, s26, 13
    s_add_u32 s6, s6, s25
    s_add_u32 s25, s20, s21
    s_mul_i32 s80, s25, 57
    s_lshr_b32 s80, s80, 9
    s_mul_i32 s80, s80, 9
    s_sub_u32 s80, s25, s80
    s_lshl_b32 s75, s80, 7
    s_mul_i32 s78, s80, 9216
    s_lshl_b32 s79, s80, 19
    s_and_b32 s81, s20, 1
    s_lshl_b32 s81, s81, 1
    v_xor_b32 v56, v4, v3
    v_lshlrev_b32 v56, 4, v56
    v_mad_u32_u24 v30, v5, s9, v56
    v_xor_b32 v56, 64, v56
    v_mad_u32_u24 v31, v5, s9, v56
    s_lshl_b32 s25, s22, 4
    s_lshl_b32 s72, s21, 7
    s_sub_u32 s73, 1920, s72
    s_add_u32 s64, s72, s25
    s_add_u32 s65, s73, s25
    s_mul_i32 s72, s64, 1152
    s_mul_i32 s73, s65, 1152
    s_lshl_b32 s74, s22, 13
    v_lshrrev_b32 v56, 1, v2
    v_xor_b32 v56, v56, v3
    v_lshlrev_b32 v56, 4, v56
    v_lshl_add_u32 v56, v2, 7, v56
    v_add_u32 v56, s74, v56
    v_add_u32 v32, 65536, v56
    v_xor_b32 v33, 64, v32
    v_add_u32 v34, 32768, v56
    v_xor_b32 v35, 64, v34
    v_lshlrev_b32 v56, 1, v7
    v_lshl_add_u32 v56, v3, 3, v56
    v_mul_u32_u24 v56, 144, v56
    v_lshlrev_b32 v57, 3, v6
    v_add_u32 v57, 0, v57
    v_add_u32 v44, v56, v57
    v_lshlrev_b32 v57, 3, v6
    v_add_u32 v57, 32, v57
    v_cmp_lt_u32 vcc, 0, v6
    s_nop 1
    v_cndmask_b32_e64 v58, 0, 8, vcc
    v_add_u32 v57, v57, v58
    v_add_u32 v45, v56, v57
    v_lshlrev_b32 v57, 3, v6
    v_add_u32 v57, 64, v57
    v_cmp_lt_u32 vcc, 1, v6
    s_nop 1
    v_cndmask_b32_e64 v58, 8, 16, vcc
    v_add_u32 v57, v57, v58
    v_add_u32 v46, v56, v57
    v_lshlrev_b32 v57, 3, v6
    v_add_u32 v57, 96, v57
    v_add_u32 v57, 16, v57
    v_cmp_eq_u32 vcc, 3, v6
    s_nop 1
    v_cndmask_b32_e64 v57, v57, 40, vcc
    v_add_u32 v47, v56, v57
    s_add_u32 m0, s30, 131072
    s_add_u32 s23, s29, 524288
    buffer_load_dwordx4 v10, s[36:39], s23 offen lds
    s_add_u32 m0, s30, 132096
    s_add_u32 s23, s29, 557056
    buffer_load_dwordx4 v10, s[36:39], s23 offen lds
    s_add_u32 m0, s30, 133120
    s_add_u32 s23, s29, 589824
    buffer_load_dwordx4 v11, s[36:39], s23 offen lds
    s_add_u32 m0, s30, 134144
    s_add_u32 s23, s29, 622592
    buffer_load_dwordx4 v11, s[36:39], s23 offen lds
    s_add_u32 m0, s28, 32768
    s_add_u32 s23, s27, 128
    buffer_load_dwordx4 v8, s[32:35], s23 offen lds
    s_add_u32 m0, s28, 33792
    s_add_u32 s23, s27, 8320
    buffer_load_dwordx4 v9, s[32:35], s23 offen lds
    s_add_u32 m0, s28, 34816
    s_add_u32 s23, s27, 16512
    buffer_load_dwordx4 v8, s[32:35], s23 offen lds
    s_add_u32 m0, s28, 35840
    s_add_u32 s23, s27, 24704
    buffer_load_dwordx4 v9, s[32:35], s23 offen lds
    s_add_u32 m0, s28, 36864
    s_add_u32 s23, s27, 32896
    buffer_load_dwordx4 v8, s[32:35], s23 offen lds
    s_add_u32 m0, s28, 37888
    s_add_u32 s23, s27, 41088
    buffer_load_dwordx4 v9, s[32:35], s23 offen lds
    s_add_u32 m0, s28, 38912
    s_add_u32 s23, s27, 49280
    buffer_load_dwordx4 v8, s[32:35], s23 offen lds
    s_add_u32 m0, s28, 39936
    s_add_u32 s23, s27, 57472
    buffer_load_dwordx4 v9, s[32:35], s23 offen lds
    s_cmp_lg_u32 s22, 0
    s_cbranch_scc1 f1_sgx
    s_lshl_b32 s25, 1, s70
    s_mov_b64 exec, 1
    v_mov_b32 v56, s25
    buffer_atomic_add v56, off, s[56:59], s83 sc1
    s_add_u32 s60, s18, 66125824
    s_addc_u32 s61, s19, 0
    s_mov_b32 s62, 163840
    s_mov_b32 s63, 0x00020000
    s_lshl_b32 s25, s21, 5
    s_add_u32 s25, s25, s20
    s_lshl_b32 s25, s25, 7
    v_mov_b32 v57, 0
    buffer_store_dword v57, off, s[60:63], s25 sc1
    s_mov_b64 exec, 15
    v_mov_b32 v57, 0
    v_lshlrev_b32 v58, 9, v1
    s_and_b32 s25, s2, 1
    s_mul_i32 s25, s25, 60
    s_lshr_b32 s26, s2, 3
    s_xor_b32 s25, s25, s26
    s_lshl_b32 s25, s25, 4
    s_bfe_u32 s26, s2, 0x20001
    s_add_u32 s25, s25, s26
    s_add_u32 s25, s25, 256
    s_lshl_b32 s25, s25, 7
    buffer_store_dword v57, v58, s[60:63], s25 offen sc1
    s_mov_b64 exec, -1
f1_sgx:
    s_mov_b32 s60, s16
    s_mov_b32 s61, s17
    s_mov_b32 s62, 1152
    s_mov_b32 s63, 0x00020000
    s_mov_b32 s8, 7282
    s_mov_b32 s9, 1152
    s_mul_i32 s10, s20, 9
    s_lshr_b32 s10, s10, 1
    s_lshl_b32 s10, s10, 3
    s_lshl_b32 s12, s21, 7
    s_cmp_eq_u32 s22, 1
    s_cselect_b32 s16, s21, 8
    s_cmp_eq_u32 s22, 0
    s_cselect_b32 s17, s21, 8
    s_lshl_b32 s13, s22, 3
    s_add_u32 s13, s13, s21
    s_cmp_le_u32 s13, 16
    s_cselect_b32 s13, 0, 0x40000000
    s_lshl_b32 s25, s22, 6
    s_add_u32 s25, s25, 0
    v_add_u32 v56, s25, v1
    v_mul_u32_u24 v57, s8, v56
    v_lshrrev_b32 v57, 16, v57
    v_mul_u32_u24 v58, 9, v57
    v_sub_u32 v58, v56, v58
    v_bfe_u32 v59, v57, 1, 2
    v_and_b32 v60, 1, v57
    v_lshl_or_b32 v59, v60, 2, v59
    v_and_b32 v60, 0x78, v57
    v_or_b32 v59, v59, v60
    v_lshlrev_b32 v57, 1, v59
    v_cmp_eq_u32 vcc, 2, v58
    v_mov_b32 v56, 0xffff
    buffer_load_ushort v48, v57, s[60:63], s12 offen
    v_cndmask_b32 v61, 0, v56, vcc
    v_mul_u32_u24 v59, 3, v59
    v_mul_u32_u24 v60, 0x5556, v58
    v_lshrrev_b32 v60, 16, v60
    v_add_u32 v59, v59, v60
    v_mul_u32_u24 v60, 3, v60
    v_sub_u32 v58, v58, v60
    v_lshlrev_b32 v58, 4, v58
    v_mad_u32_u24 v26, v59, s9, v58
    v_add_u32 v26, s10, v26
    s_lshl_b32 s25, s22, 6
    s_add_u32 s25, s25, 256
    v_add_u32 v56, s25, v1
    v_mul_u32_u24 v57, s8, v56
    v_lshrrev_b32 v57, 16, v57
    v_mul_u32_u24 v58, 9, v57
    v_sub_u32 v58, v56, v58
    v_bfe_u32 v59, v57, 1, 2
    v_and_b32 v60, 1, v57
    v_lshl_or_b32 v59, v60, 2, v59
    v_and_b32 v60, 0x78, v57
    v_or_b32 v59, v59, v60
    v_lshlrev_b32 v57, 1, v59
    v_cmp_eq_u32 vcc, 2, v58
    v_mov_b32 v56, 0xffff
    buffer_load_ushort v49, v57, s[60:63], s12 offen
    v_cndmask_b32 v62, 0, v56, vcc
    v_mul_u32_u24 v59, 3, v59
    v_mul_u32_u24 v60, 0x5556, v58
    v_lshrrev_b32 v60, 16, v60
    v_add_u32 v59, v59, v60
    v_mul_u32_u24 v60, 3, v60
    v_sub_u32 v58, v58, v60
    v_lshlrev_b32 v58, 4, v58
    v_mad_u32_u24 v27, v59, s9, v58
    v_add_u32 v27, s10, v27
    s_lshl_b32 s25, s16, 6
    v_add_u32 v56, s25, v1
    s_lshl_b32 s12, s17, 7
    v_mul_u32_u24 v57, s8, v56
    v_lshrrev_b32 v57, 16, v57
    v_mul_u32_u24 v58, 9, v57
    v_sub_u32 v58, v56, v58
    v_bfe_u32 v59, v57, 1, 2
    v_and_b32 v60, 1, v57
    v_lshl_or_b32 v59, v60, 2, v59
    v_and_b32 v60, 0x78, v57
    v_or_b32 v59, v59, v60
    v_lshlrev_b32 v57, 1, v59
    v_cmp_eq_u32 vcc, 2, v58
    v_mov_b32 v56, 0xffff
    buffer_load_ushort v50, v57, s[60:63], s12 offen
    v_cndmask_b32 v63, 0, v56, vcc
    v_mul_u32_u24 v59, 3, v59
    v_mul_u32_u24 v60, 0x5556, v58
    v_lshrrev_b32 v60, 16, v60
    v_add_u32 v59, v59, v60
    v_mul_u32_u24 v60, 3, v60
    v_sub_u32 v58, v58, v60
    v_lshlrev_b32 v58, 4, v58
    v_mad_u32_u24 v28, v59, s9, v58
    v_add_u32 v28, s10, v28
    s_mov_b32 s60, s14
    s_mov_b32 s61, s15
    s_mov_b32 s62, 20736
    s_mov_b32 s63, 0x00020000
    s_mul_i32 s25, s20, 648
    v_lshlrev_b32 v56, 2, v0
    buffer_load_dword v52, v56, s[60:63], s25 offen
    v_mul_u32_u24 v56, 7282, v0
    v_lshrrev_b32 v56, 16, v56
    v_mul_u32_u24 v57, 9, v56
    v_sub_u32 v57, v0, v57
    v_mul_u32_u24 v56, 48, v56
    v_lshl_add_u32 v56, v57, 2, v56
    v_add_u32 v53, 27744, v56
    v_mov_b32 v57, 30016
    v_cmp_gt_u32 vcc, 162, v0
    s_nop 1
    v_cndmask_b32 v53, v57, v53, vcc
    v_lshlrev_b32 v56, 2, v0
    v_cmp_lt_u32 vcc, 23, v0
    s_nop 1
    v_cndmask_b32_e64 v58, 0, 1, vcc
    v_mul_u32_u24 v58, 864, v58
    v_add3_u32 v54, v56, v58, 0
    v_add_u32 v54, 27648, v54
    v_cmp_gt_u32 vcc, 72, v0
    s_nop 1
    v_cndmask_b32 v54, v57, v54, vcc
    s_lshl_b32 s11, s22, 17
    s_waitcnt vmcnt(20)
    s_barrier
    ds_read_b64_tr_b16 a[96:97], v18 offset:0
    ds_read_b64_tr_b16 a[98:99], v18 offset:1024
    ds_read_b64_tr_b16 a[112:113], v18 offset:8192
    ds_read_b64_tr_b16 a[114:115], v18 offset:9216
    ds_read_b128 a[64:67], v12 offset:0
    ds_read_b128 a[68:71], v12 offset:2048
    ds_read_b64_tr_b16 a[100:101], v19 offset:0
    ds_read_b64_tr_b16 a[102:103], v19 offset:1024
    ds_read_b64_tr_b16 a[116:117], v19 offset:8192
    ds_read_b64_tr_b16 a[118:119], v19 offset:9216
    ds_read_b128 a[72:75], v12 offset:4096
    ds_read_b128 a[76:79], v12 offset:6144
    ds_read_b64_tr_b16 a[104:105], v20 offset:0
    ds_read_b64_tr_b16 a[106:107], v20 offset:1024
    ds_read_b64_tr_b16 a[120:121], v20 offset:8192
    ds_read_b64_tr_b16 a[122:123], v20 offset:9216
    ds_read_b128 a[80:83], v12 offset:8192
    ds_read_b128 a[84:87], v12 offset:10240
    ds_read_b64_tr_b16 a[108:109], v21 offset:0
    ds_read_b64_tr_b16 a[110:111], v21 offset:1024
    ds_read_b64_tr_b16 a[124:125], v21 offset:8192
    ds_read_b64_tr_b16 a[126:127], v21 offset:9216
    ds_read_b128 a[88:91], v12 offset:12288
    ds_read_b128 a[92:95], v12 offset:14336
    s_waitcnt vmcnt(16) lgkmcnt(0)
    v_mfma_f32_16x16x32_bf16 v[64:67], a[96:99], a[64:67], 0
    s_barrier
    v_mfma_f32_16x16x32_bf16 v[96:99], a[100:103], a[64:67], 0
    v_mfma_f32_16x16x32_bf16 v[128:131], a[104:107], a[64:67], 0
    ds_read_b64_tr_b16 a[160:161], v18 offset:16384
    v_mfma_f32_16x16x32_bf16 v[160:163], a[108:111], a[64:67], 0
    s_add_u32 m0, s30, 147456
    v_mfma_f32_16x16x32_bf16 v[192:195], a[64:67], a[112:115], 0
    ds_read_b64_tr_b16 a[162:163], v18 offset:17408
    s_add_u32 s23, s29, 786432
    v_mfma_f32_16x16x32_bf16 v[196:199], a[64:67], a[116:119], 0
    buffer_load_dwordx4 v10, s[36:39], s23 offen lds
    v_mfma_f32_16x16x32_bf16 v[200:203], a[64:67], a[120:123], 0
    ds_read_b64_tr_b16 a[176:177], v18 offset:24576
    v_mfma_f32_16x16x32_bf16 v[204:207], a[64:67], a[124:127], 0
    s_add_u32 m0, s30, 148480
    v_mfma_f32_16x16x32_bf16 v[68:71], a[96:99], a[68:71], 0
    ds_read_b64_tr_b16 a[178:179], v18 offset:25600
    s_add_u32 s23, s29, 819200
    v_mfma_f32_16x16x32_bf16 v[100:103], a[100:103], a[68:71], 0
    buffer_load_dwordx4 v10, s[36:39], s23 offen lds
    v_mfma_f32_16x16x32_bf16 v[132:135], a[104:107], a[68:71], 0
    ds_read_b128 a[128:131], v13 offset:0
    v_mfma_f32_16x16x32_bf16 v[164:167], a[108:111], a[68:71], 0
    s_add_u32 m0, s30, 149504
    v_mfma_f32_16x16x32_bf16 v[208:211], a[68:71], a[112:115], 0
    ds_read_b128 a[132:135], v13 offset:2048
    s_add_u32 s23, s29, 851968
    v_mfma_f32_16x16x32_bf16 v[212:215], a[68:71], a[116:119], 0
    buffer_load_dwordx4 v11, s[36:39], s23 offen lds
    v_mfma_f32_16x16x32_bf16 v[216:219], a[68:71], a[120:123], 0
    ds_read_b64_tr_b16 a[164:165], v19 offset:16384
    v_mfma_f32_16x16x32_bf16 v[220:223], a[68:71], a[124:127], 0
    s_add_u32 m0, s30, 150528
    v_mfma_f32_16x16x32_bf16 v[72:75], a[96:99], a[72:75], 0
    ds_read_b64_tr_b16 a[166:167], v19 offset:17408
    s_add_u32 s23, s29, 884736
    v_mfma_f32_16x16x32_bf16 v[104:107], a[100:103], a[72:75], 0
    buffer_load_dwordx4 v11, s[36:39], s23 offen lds
    v_mfma_f32_16x16x32_bf16 v[136:139], a[104:107], a[72:75], 0
    ds_read_b64_tr_b16 a[180:181], v19 offset:24576
    v_mfma_f32_16x16x32_bf16 v[168:171], a[108:111], a[72:75], 0
    s_add_u32 m0, s28, 65536
    v_mfma_f32_16x16x32_bf16 v[224:227], a[72:75], a[112:115], 0
    ds_read_b64_tr_b16 a[182:183], v19 offset:25600
    s_add_u32 s23, s27, 256
    v_mfma_f32_16x16x32_bf16 v[228:231], a[72:75], a[116:119], 0
    buffer_load_dwordx4 v8, s[32:35], s23 offen lds
    v_mfma_f32_16x16x32_bf16 v[232:235], a[72:75], a[120:123], 0
    ds_read_b128 a[136:139], v13 offset:4096
    v_mfma_f32_16x16x32_bf16 v[236:239], a[72:75], a[124:127], 0
    s_add_u32 m0, s28, 66560
    v_mfma_f32_16x16x32_bf16 v[76:79], a[96:99], a[76:79], 0
    ds_read_b128 a[140:143], v13 offset:6144
    s_add_u32 s23, s27, 8448
    v_mfma_f32_16x16x32_bf16 v[108:111], a[100:103], a[76:79], 0
    buffer_load_dwordx4 v9, s[32:35], s23 offen lds
    v_mfma_f32_16x16x32_bf16 v[140:143], a[104:107], a[76:79], 0
    s_add_u32 m0, s28, 67584
    v_mfma_f32_16x16x32_bf16 v[172:175], a[108:111], a[76:79], 0
    ds_read_b64_tr_b16 a[168:169], v20 offset:16384
    v_mfma_f32_16x16x32_bf16 v[240:243], a[76:79], a[112:115], 0
    s_add_u32 s23, s27, 16640
    v_mfma_f32_16x16x32_bf16 v[244:247], a[76:79], a[116:119], 0
    ds_read_b64_tr_b16 a[170:171], v20 offset:17408
    buffer_load_dwordx4 v8, s[32:35], s23 offen lds
    v_mfma_f32_16x16x32_bf16 v[248:251], a[76:79], a[120:123], 0
    s_add_u32 m0, s28, 68608
    v_mfma_f32_16x16x32_bf16 v[252:255], a[76:79], a[124:127], 0
    ds_read_b64_tr_b16 a[184:185], v20 offset:24576
    v_mfma_f32_16x16x32_bf16 v[80:83], a[96:99], a[80:83], 0
    s_add_u32 s23, s27, 24832
    v_mfma_f32_16x16x32_bf16 v[112:115], a[100:103], a[80:83], 0
    ds_read_b64_tr_b16 a[186:187], v20 offset:25600
    buffer_load_dwordx4 v9, s[32:35], s23 offen lds
    v_mfma_f32_16x16x32_bf16 v[144:147], a[104:107], a[80:83], 0
    v_mfma_f32_16x16x32_bf16 v[176:179], a[108:111], a[80:83], 0
    ds_read_b128 a[144:147], v13 offset:8192
    s_add_u32 m0, s28, 69632
    v_mfma_f32_16x16x32_bf16 a[0:3], a[80:83], a[112:115], 0
    s_add_u32 s23, s27, 33024
    v_mfma_f32_16x16x32_bf16 a[4:7], a[80:83], a[116:119], 0
    ds_read_b128 a[148:151], v13 offset:10240
    v_mfma_f32_16x16x32_bf16 a[8:11], a[80:83], a[120:123], 0
    buffer_load_dwordx4 v8, s[32:35], s23 offen lds
    v_mfma_f32_16x16x32_bf16 a[12:15], a[80:83], a[124:127], 0
    ds_read_b64_tr_b16 a[172:173], v21 offset:16384
    s_add_u32 m0, s28, 70656
    v_mfma_f32_16x16x32_bf16 v[84:87], a[96:99], a[84:87], 0
    s_add_u32 s23, s27, 41216
    v_mfma_f32_16x16x32_bf16 v[116:119], a[100:103], a[84:87], 0
    ds_read_b64_tr_b16 a[174:175], v21 offset:17408
    v_mfma_f32_16x16x32_bf16 v[148:151], a[104:107], a[84:87], 0
    buffer_load_dwordx4 v9, s[32:35], s23 offen lds
    v_mfma_f32_16x16x32_bf16 v[180:183], a[108:111], a[84:87], 0
    ds_read_b64_tr_b16 a[188:189], v21 offset:24576
    s_add_u32 m0, s28, 71680
    v_mfma_f32_16x16x32_bf16 a[16:19], a[84:87], a[112:115], 0
    s_add_u32 s23, s27, 49408
    v_mfma_f32_16x16x32_bf16 a[20:23], a[84:87], a[116:119], 0
    ds_read_b64_tr_b16 a[190:191], v21 offset:25600
    v_mfma_f32_16x16x32_bf16 a[24:27], a[84:87], a[120:123], 0
    buffer_load_dwordx4 v8, s[32:35], s23 offen lds
    v_mfma_f32_16x16x32_bf16 a[28:31], a[84:87], a[124:127], 0
    ds_read_b128 a[152:155], v13 offset:12288
    s_add_u32 m0, s28, 72704
    v_mfma_f32_16x16x32_bf16 v[88:91], a[96:99], a[88:91], 0
    s_add_u32 s23, s27, 57600
    v_mfma_f32_16x16x32_bf16 v[120:123], a[100:103], a[88:91], 0
    ds_read_b128 a[156:159], v13 offset:14336
    v_mfma_f32_16x16x32_bf16 v[152:155], a[104:107], a[88:91], 0
    buffer_load_dwordx4 v9, s[32:35], s23 offen lds
    v_mfma_f32_16x16x32_bf16 v[184:187], a[108:111], a[88:91], 0
    s_add_u32 m0, s30, 98304
    v_mfma_f32_16x16x32_bf16 a[32:35], a[88:91], a[112:115], 0
    s_add_u32 s23, s29, 1048576
    v_mfma_f32_16x16x32_bf16 a[36:39], a[88:91], a[116:119], 0
    buffer_load_dwordx4 v10, s[36:39], s23 offen lds
    v_mfma_f32_16x16x32_bf16 a[40:43], a[88:91], a[120:123], 0
    s_add_u32 m0, s30, 99328
    v_mfma_f32_16x16x32_bf16 a[44:47], a[88:91], a[124:127], 0
    s_add_u32 s23, s29, 1081344
    v_mfma_f32_16x16x32_bf16 v[92:95], a[96:99], a[92:95], 0
    buffer_load_dwordx4 v10, s[36:39], s23 offen lds
    v_mfma_f32_16x16x32_bf16 v[124:127], a[100:103], a[92:95], 0
    s_add_u32 m0, s30, 100352
    v_mfma_f32_16x16x32_bf16 v[156:159], a[104:107], a[92:95], 0
    s_add_u32 s23, s29, 1114112
    v_mfma_f32_16x16x32_bf16 v[188:191], a[108:111], a[92:95], 0
    buffer_load_dwordx4 v11, s[36:39], s23 offen lds
    v_mfma_f32_16x16x32_bf16 a[48:51], a[92:95], a[112:115], 0
    s_add_u32 m0, s30, 101376
    v_mfma_f32_16x16x32_bf16 a[52:55], a[92:95], a[116:119], 0
    s_add_u32 s23, s29, 1146880
    v_mfma_f32_16x16x32_bf16 a[56:59], a[92:95], a[120:123], 0
    buffer_load_dwordx4 v11, s[36:39], s23 offen lds
    v_mfma_f32_16x16x32_bf16 a[60:63], a[92:95], a[124:127], 0
    s_waitcnt vmcnt(20) lgkmcnt(0)
    v_mfma_f32_16x16x32_bf16 v[64:67], a[160:163], a[128:131], v[64:67]
    s_barrier
    v_mfma_f32_16x16x32_bf16 v[96:99], a[164:167], a[128:131], v[96:99]
    v_mfma_f32_16x16x32_bf16 v[128:131], a[168:171], a[128:131], v[128:131]
    ds_read_b64_tr_b16 a[96:97], v18 offset:32768
    v_mfma_f32_16x16x32_bf16 v[160:163], a[172:175], a[128:131], v[160:163]
    s_add_u32 m0, s30, 114688
    v_mfma_f32_16x16x32_bf16 v[192:195], a[128:131], a[176:179], v[192:195]
    ds_read_b64_tr_b16 a[98:99], v18 offset:33792
    v_mfma_f32_16x16x32_bf16 v[196:199], a[128:131], a[180:183], v[196:199]
    v_mfma_f32_16x16x32_bf16 v[200:203], a[128:131], a[184:187], v[200:203]
    ds_read_b64_tr_b16 a[112:113], v18 offset:40960
    s_add_u32 s23, s29, 1310720
    v_mfma_f32_16x16x32_bf16 v[204:207], a[128:131], a[188:191], v[204:207]
    v_mfma_f32_16x16x32_bf16 v[68:71], a[160:163], a[132:135], v[68:71]
    ds_read_b64_tr_b16 a[114:115], v18 offset:41984
    v_mfma_f32_16x16x32_bf16 v[100:103], a[164:167], a[132:135], v[100:103]
    buffer_load_dwordx4 v10, s[36:39], s23 offen lds
    v_mfma_f32_16x16x32_bf16 v[132:135], a[168:171], a[132:135], v[132:135]
    ds_read_b128 a[64:67], v14 offset:0
    v_mfma_f32_16x16x32_bf16 v[164:167], a[172:175], a[132:135], v[164:167]
    s_add_u32 m0, s30, 115712
    v_mfma_f32_16x16x32_bf16 v[208:211], a[132:135], a[176:179], v[208:211]
    ds_read_b128 a[68:71], v14 offset:2048
    v_mfma_f32_16x16x32_bf16 v[212:215], a[132:135], a[180:183], v[212:215]
    v_mfma_f32_16x16x32_bf16 v[216:219], a[132:135], a[184:187], v[216:219]
    ds_read_b64_tr_b16 a[100:101], v19 offset:32768
    s_add_u32 s23, s29, 1343488
    v_mfma_f32_16x16x32_bf16 v[220:223], a[132:135], a[188:191], v[220:223]
    v_mfma_f32_16x16x32_bf16 v[72:75], a[160:163], a[136:139], v[72:75]
    ds_read_b64_tr_b16 a[102:103], v19 offset:33792
    v_mfma_f32_16x16x32_bf16 v[104:107], a[164:167], a[136:139], v[104:107]
    buffer_load_dwordx4 v10, s[36:39], s23 offen lds
    v_mfma_f32_16x16x32_bf16 v[136:139], a[168:171], a[136:139], v[136:139]
    ds_read_b64_tr_b16 a[116:117], v19 offset:40960
    v_mfma_f32_16x16x32_bf16 v[168:171], a[172:175], a[136:139], v[168:171]
    s_add_u32 m0, s30, 116736
    v_mfma_f32_16x16x32_bf16 v[224:227], a[136:139], a[176:179], v[224:227]
    ds_read_b64_tr_b16 a[118:119], v19 offset:41984
    v_mfma_f32_16x16x32_bf16 v[228:231], a[136:139], a[180:183], v[228:231]
    v_mfma_f32_16x16x32_bf16 v[232:235], a[136:139], a[184:187], v[232:235]
    ds_read_b128 a[72:75], v14 offset:4096
    s_add_u32 s23, s29, 1376256
    v_mfma_f32_16x16x32_bf16 v[236:239], a[136:139], a[188:191], v[236:239]
    v_mfma_f32_16x16x32_bf16 v[76:79], a[160:163], a[140:143], v[76:79]
    ds_read_b128 a[76:79], v14 offset:6144
    v_mfma_f32_16x16x32_bf16 v[108:111], a[164:167], a[140:143], v[108:111]
    buffer_load_dwordx4 v11, s[36:39], s23 offen lds
    v_mfma_f32_16x16x32_bf16 v[140:143], a[168:171], a[140:143], v[140:143]
    v_mfma_f32_16x16x32_bf16 v[172:175], a[172:175], a[140:143], v[172:175]
    ds_read_b64_tr_b16 a[104:105], v20 offset:32768
    s_add_u32 m0, s30, 117760
    v_mfma_f32_16x16x32_bf16 v[240:243], a[140:143], a[176:179], v[240:243]
    v_mfma_f32_16x16x32_bf16 v[244:247], a[140:143], a[180:183], v[244:247]
    ds_read_b64_tr_b16 a[106:107], v20 offset:33792
    v_mfma_f32_16x16x32_bf16 v[248:251], a[140:143], a[184:187], v[248:251]
    s_add_u32 s23, s29, 1409024
    v_mfma_f32_16x16x32_bf16 v[252:255], a[140:143], a[188:191], v[252:255]
    ds_read_b64_tr_b16 a[120:121], v20 offset:40960
    v_mfma_f32_16x16x32_bf16 v[80:83], a[160:163], a[144:147], v[80:83]
    buffer_load_dwordx4 v11, s[36:39], s23 offen lds
    v_mfma_f32_16x16x32_bf16 v[112:115], a[164:167], a[144:147], v[112:115]
    ds_read_b64_tr_b16 a[122:123], v20 offset:41984
    v_mfma_f32_16x16x32_bf16 v[144:147], a[168:171], a[144:147], v[144:147]
    v_mfma_f32_16x16x32_bf16 v[176:179], a[172:175], a[144:147], v[176:179]
    ds_read_b128 a[80:83], v14 offset:8192
    v_mfma_f32_16x16x32_bf16 a[0:3], a[144:147], a[176:179], a[0:3]
    s_add_u32 m0, s28, 0
    v_mfma_f32_16x16x32_bf16 a[4:7], a[144:147], a[180:183], a[4:7]
    ds_read_b128 a[84:87], v14 offset:10240
    v_mfma_f32_16x16x32_bf16 a[8:11], a[144:147], a[184:187], a[8:11]
    s_add_u32 s23, s27, 384
    v_mfma_f32_16x16x32_bf16 a[12:15], a[144:147], a[188:191], a[12:15]
    ds_read_b64_tr_b16 a[108:109], v21 offset:32768
    v_mfma_f32_16x16x32_bf16 v[84:87], a[160:163], a[148:151], v[84:87]
    v_mfma_f32_16x16x32_bf16 v[116:119], a[164:167], a[148:151], v[116:119]
    ds_read_b64_tr_b16 a[110:111], v21 offset:33792
    buffer_load_dwordx4 v8, s[32:35], s23 offen lds
    v_mfma_f32_16x16x32_bf16 v[148:151], a[168:171], a[148:151], v[148:151]
    v_mfma_f32_16x16x32_bf16 v[180:183], a[172:175], a[148:151], v[180:183]
    ds_read_b64_tr_b16 a[124:125], v21 offset:40960
    v_mfma_f32_16x16x32_bf16 a[16:19], a[148:151], a[176:179], a[16:19]
    s_add_u32 m0, s28, 1024
    v_mfma_f32_16x16x32_bf16 a[20:23], a[148:151], a[180:183], a[20:23]
    ds_read_b64_tr_b16 a[126:127], v21 offset:41984
    v_mfma_f32_16x16x32_bf16 a[24:27], a[148:151], a[184:187], a[24:27]
    s_add_u32 s23, s27, 8576
    v_mfma_f32_16x16x32_bf16 a[28:31], a[148:151], a[188:191], a[28:31]
    ds_read_b128 a[88:91], v14 offset:12288
    v_mfma_f32_16x16x32_bf16 v[88:91], a[160:163], a[152:155], v[88:91]
    v_mfma_f32_16x16x32_bf16 v[120:123], a[164:167], a[152:155], v[120:123]
    ds_read_b128 a[92:95], v14 offset:14336
    buffer_load_dwordx4 v9, s[32:35], s23 offen lds
    v_mfma_f32_16x16x32_bf16 v[152:155], a[168:171], a[152:155], v[152:155]
    v_mfma_f32_16x16x32_bf16 v[184:187], a[172:175], a[152:155], v[184:187]
    s_add_u32 m0, s28, 2048
    v_mfma_f32_16x16x32_bf16 a[32:35], a[152:155], a[176:179], a[32:35]
    v_mfma_f32_16x16x32_bf16 a[36:39], a[152:155], a[180:183], a[36:39]
    s_add_u32 s23, s27, 16768
    v_mfma_f32_16x16x32_bf16 a[40:43], a[152:155], a[184:187], a[40:43]
    v_mfma_f32_16x16x32_bf16 a[44:47], a[152:155], a[188:191], a[44:47]
    buffer_load_dwordx4 v8, s[32:35], s23 offen lds
    v_mfma_f32_16x16x32_bf16 v[92:95], a[160:163], a[156:159], v[92:95]
    v_mfma_f32_16x16x32_bf16 v[124:127], a[164:167], a[156:159], v[124:127]
    s_add_u32 m0, s28, 3072
    v_mfma_f32_16x16x32_bf16 v[156:159], a[168:171], a[156:159], v[156:159]
    v_mfma_f32_16x16x32_bf16 v[188:191], a[172:175], a[156:159], v[188:191]
    s_add_u32 s23, s27, 24960
    v_mfma_f32_16x16x32_bf16 a[48:51], a[156:159], a[176:179], a[48:51]
    v_mfma_f32_16x16x32_bf16 a[52:55], a[156:159], a[180:183], a[52:55]
    buffer_load_dwordx4 v9, s[32:35], s23 offen lds
    v_mfma_f32_16x16x32_bf16 a[56:59], a[156:159], a[184:187], a[56:59]
    v_mfma_f32_16x16x32_bf16 a[60:63], a[156:159], a[188:191], a[60:63]
    s_waitcnt vmcnt(20) lgkmcnt(0)
    v_mfma_f32_16x16x32_bf16 v[64:67], a[96:99], a[64:67], v[64:67]
    s_barrier
    v_mfma_f32_16x16x32_bf16 v[96:99], a[100:103], a[64:67], v[96:99]
    v_mfma_f32_16x16x32_bf16 v[128:131], a[104:107], a[64:67], v[128:131]
    ds_read_b64_tr_b16 a[160:161], v18 offset:49152
    v_mfma_f32_16x16x32_bf16 v[160:163], a[108:111], a[64:67], v[160:163]
    s_add_u32 m0, s30, 131072
    v_mfma_f32_16x16x32_bf16 v[192:195], a[64:67], a[112:115], v[192:195]
    ds_read_b64_tr_b16 a[162:163], v18 offset:50176
    v_mfma_f32_16x16x32_bf16 v[196:199], a[64:67], a[116:119], v[196:199]
    v_mfma_f32_16x16x32_bf16 v[200:203], a[64:67], a[120:123], v[200:203]
    ds_read_b64_tr_b16 a[176:177], v18 offset:57344
    s_add_u32 s23, s29, 1572864
    v_mfma_f32_16x16x32_bf16 v[204:207], a[64:67], a[124:127], v[204:207]
    v_mfma_f32_16x16x32_bf16 v[68:71], a[96:99], a[68:71], v[68:71]
    ds_read_b64_tr_b16 a[178:179], v18 offset:58368
    v_mfma_f32_16x16x32_bf16 v[100:103], a[100:103], a[68:71], v[100:103]
    buffer_load_dwordx4 v10, s[36:39], s23 offen lds
    v_mfma_f32_16x16x32_bf16 v[132:135], a[104:107], a[68:71], v[132:135]
    ds_read_b128 a[128:131], v15 offset:0
    v_mfma_f32_16x16x32_bf16 v[164:167], a[108:111], a[68:71], v[164:167]
    s_add_u32 m0, s30, 132096
    v_mfma_f32_16x16x32_bf16 v[208:211], a[68:71], a[112:115], v[208:211]
    ds_read_b128 a[132:135], v15 offset:2048
    v_mfma_f32_16x16x32_bf16 v[212:215], a[68:71], a[116:119], v[212:215]
    v_mfma_f32_16x16x32_bf16 v[216:219], a[68:71], a[120:123], v[216:219]
    ds_read_b64_tr_b16 a[164:165], v19 offset:49152
    s_add_u32 s23, s29, 1605632
    v_mfma_f32_16x16x32_bf16 v[220:223], a[68:71], a[124:127], v[220:223]
    v_mfma_f32_16x16x32_bf16 v[72:75], a[96:99], a[72:75], v[72:75]
    ds_read_b64_tr_b16 a[166:167], v19 offset:50176
    v_mfma_f32_16x16x32_bf16 v[104:107], a[100:103], a[72:75], v[104:107]
    buffer_load_dwordx4 v10, s[36:39], s23 offen lds
    v_mfma_f32_16x16x32_bf16 v[136:139], a[104:107], a[72:75], v[136:139]
    ds_read_b64_tr_b16 a[180:181], v19 offset:57344
    v_mfma_f32_16x16x32_bf16 v[168:171], a[108:111], a[72:75], v[168:171]
    s_add_u32 m0, s30, 133120
    v_mfma_f32_16x16x32_bf16 v[224:227], a[72:75], a[112:115], v[224:227]
    ds_read_b64_tr_b16 a[182:183], v19 offset:58368
    v_mfma_f32_16x16x32_bf16 v[228:231], a[72:75], a[116:119], v[228:231]
    v_mfma_f32_16x16x32_bf16 v[232:235], a[72:75], a[120:123], v[232:235]
    ds_read_b128 a[136:139], v15 offset:4096
    s_add_u32 s23, s29, 1638400
    v_mfma_f32_16x16x32_bf16 v[236:239], a[72:75], a[124:127], v[236:239]
    v_mfma_f32_16x16x32_bf16 v[76:79], a[96:99], a[76:79], v[76:79]
    ds_read_b128 a[140:143], v15 offset:6144
    v_mfma_f32_16x16x32_bf16 v[108:111], a[100:103], a[76:79], v[108:111]
    buffer_load_dwordx4 v11, s[36:39], s23 offen lds
    v_mfma_f32_16x16x32_bf16 v[140:143], a[104:107], a[76:79], v[140:143]
    v_mfma_f32_16x16x32_bf16 v[172:175], a[108:111], a[76:79], v[172:175]
    ds_read_b64_tr_b16 a[168:169], v20 offset:49152
    s_add_u32 m0, s30, 134144
    v_mfma_f32_16x16x32_bf16 v[240:243], a[76:79], a[112:115], v[240:243]
    v_mfma_f32_16x16x32_bf16 v[244:247], a[76:79], a[116:119], v[244:247]
    ds_read_b64_tr_b16 a[170:171], v20 offset:50176
    v_mfma_f32_16x16x32_bf16 v[248:251], a[76:79], a[120:123], v[248:251]
    s_add_u32 s23, s29, 1671168
    v_mfma_f32_16x16x32_bf16 v[252:255], a[76:79], a[124:127], v[252:255]
    ds_read_b64_tr_b16 a[184:185], v20 offset:57344
    v_mfma_f32_16x16x32_bf16 v[80:83], a[96:99], a[80:83], v[80:83]
    buffer_load_dwordx4 v11, s[36:39], s23 offen lds
    v_mfma_f32_16x16x32_bf16 v[112:115], a[100:103], a[80:83], v[112:115]
    ds_read_b64_tr_b16 a[186:187], v20 offset:58368
    v_mfma_f32_16x16x32_bf16 v[144:147], a[104:107], a[80:83], v[144:147]
    s_cmp_lg_u32 s22, 0
    s_cbranch_scc1 f1_w0_1
    buffer_load_dword v55, off, s[56:59], s83 sc1
f1_w0_1:
    v_mfma_f32_16x16x32_bf16 v[176:179], a[108:111], a[80:83], v[176:179]
    ds_read_b128 a[144:147], v15 offset:8192
    v_mfma_f32_16x16x32_bf16 a[0:3], a[80:83], a[112:115], a[0:3]
    s_add_u32 m0, s28, 4096
    v_mfma_f32_16x16x32_bf16 a[4:7], a[80:83], a[116:119], a[4:7]
    ds_read_b128 a[148:151], v15 offset:10240
    v_mfma_f32_16x16x32_bf16 a[8:11], a[80:83], a[120:123], a[8:11]
    s_add_u32 s23, s27, 33152
    v_mfma_f32_16x16x32_bf16 a[12:15], a[80:83], a[124:127], a[12:15]
    ds_read_b64_tr_b16 a[172:173], v21 offset:49152
    v_mfma_f32_16x16x32_bf16 v[84:87], a[96:99], a[84:87], v[84:87]
    v_mfma_f32_16x16x32_bf16 v[116:119], a[100:103], a[84:87], v[116:119]
    ds_read_b64_tr_b16 a[174:175], v21 offset:50176
    buffer_load_dwordx4 v8, s[32:35], s23 offen lds
    v_mfma_f32_16x16x32_bf16 v[148:151], a[104:107], a[84:87], v[148:151]
    v_mfma_f32_16x16x32_bf16 v[180:183], a[108:111], a[84:87], v[180:183]
    ds_read_b64_tr_b16 a[188:189], v21 offset:57344
    v_mfma_f32_16x16x32_bf16 a[16:19], a[84:87], a[112:115], a[16:19]
    s_add_u32 m0, s28, 5120
    v_mfma_f32_16x16x32_bf16 a[20:23], a[84:87], a[116:119], a[20:23]
    ds_read_b64_tr_b16 a[190:191], v21 offset:58368
    v_mfma_f32_16x16x32_bf16 a[24:27], a[84:87], a[120:123], a[24:27]
    s_add_u32 s23, s27, 41344
    v_mfma_f32_16x16x32_bf16 a[28:31], a[84:87], a[124:127], a[28:31]
    ds_read_b128 a[152:155], v15 offset:12288
    v_mfma_f32_16x16x32_bf16 v[88:91], a[96:99], a[88:91], v[88:91]
    v_mfma_f32_16x16x32_bf16 v[120:123], a[100:103], a[88:91], v[120:123]
    ds_read_b128 a[156:159], v15 offset:14336
    buffer_load_dwordx4 v9, s[32:35], s23 offen lds
    v_mfma_f32_16x16x32_bf16 v[152:155], a[104:107], a[88:91], v[152:155]
    v_mfma_f32_16x16x32_bf16 v[184:187], a[108:111], a[88:91], v[184:187]
    s_add_u32 m0, s28, 6144
    v_mfma_f32_16x16x32_bf16 a[32:35], a[88:91], a[112:115], a[32:35]
    v_mfma_f32_16x16x32_bf16 a[36:39], a[88:91], a[116:119], a[36:39]
    s_add_u32 s23, s27, 49536
    v_mfma_f32_16x16x32_bf16 a[40:43], a[88:91], a[120:123], a[40:43]
    v_mfma_f32_16x16x32_bf16 a[44:47], a[88:91], a[124:127], a[44:47]
    buffer_load_dwordx4 v8, s[32:35], s23 offen lds
    v_mfma_f32_16x16x32_bf16 v[92:95], a[96:99], a[92:95], v[92:95]
    v_mfma_f32_16x16x32_bf16 v[124:127], a[100:103], a[92:95], v[124:127]
    s_add_u32 m0, s28, 7168
    v_mfma_f32_16x16x32_bf16 v[156:159], a[104:107], a[92:95], v[156:159]
    v_mfma_f32_16x16x32_bf16 v[188:191], a[108:111], a[92:95], v[188:191]
    s_add_u32 s23, s27, 57728
    v_mfma_f32_16x16x32_bf16 a[48:51], a[92:95], a[112:115], a[48:51]
    v_mfma_f32_16x16x32_bf16 a[52:55], a[92:95], a[116:119], a[52:55]
    buffer_load_dwordx4 v9, s[32:35], s23 offen lds
    v_mfma_f32_16x16x32_bf16 a[56:59], a[92:95], a[120:123], a[56:59]
    v_mfma_f32_16x16x32_bf16 a[60:63], a[92:95], a[124:127], a[60:63]
    s_waitcnt vmcnt(16) lgkmcnt(0)
    v_mfma_f32_16x16x32_bf16 v[64:67], a[160:163], a[128:131], v[64:67]
    s_barrier
    v_mfma_f32_16x16x32_bf16 v[96:99], a[164:167], a[128:131], v[96:99]
    v_mfma_f32_16x16x32_bf16 v[128:131], a[168:171], a[128:131], v[128:131]
    ds_read_b64_tr_b16 a[96:97], v18 offset:0
    v_mfma_f32_16x16x32_bf16 v[160:163], a[172:175], a[128:131], v[160:163]
    s_add_u32 m0, s30, 147456
    v_mfma_f32_16x16x32_bf16 v[192:195], a[128:131], a[176:179], v[192:195]
    ds_read_b64_tr_b16 a[98:99], v18 offset:1024
    v_mfma_f32_16x16x32_bf16 v[196:199], a[128:131], a[180:183], v[196:199]
    v_mfma_f32_16x16x32_bf16 v[200:203], a[128:131], a[184:187], v[200:203]
    ds_read_b64_tr_b16 a[112:113], v18 offset:8192
    s_add_u32 s23, s29, 1835008
    v_mfma_f32_16x16x32_bf16 v[204:207], a[128:131], a[188:191], v[204:207]
    v_mfma_f32_16x16x32_bf16 v[68:71], a[160:163], a[132:135], v[68:71]
    ds_read_b64_tr_b16 a[114:115], v18 offset:9216
    v_mfma_f32_16x16x32_bf16 v[100:103], a[164:167], a[132:135], v[100:103]
    buffer_load_dwordx4 v10, s[36:39], s23 offen lds
    v_mfma_f32_16x16x32_bf16 v[132:135], a[168:171], a[132:135], v[132:135]
    ds_read_b128 a[64:67], v16 offset:0
    v_mfma_f32_16x16x32_bf16 v[164:167], a[172:175], a[132:135], v[164:167]
    s_add_u32 m0, s30, 148480
    v_mfma_f32_16x16x32_bf16 v[208:211], a[132:135], a[176:179], v[208:211]
    ds_read_b128 a[68:71], v16 offset:2048
    v_mfma_f32_16x16x32_bf16 v[212:215], a[132:135], a[180:183], v[212:215]
    v_mfma_f32_16x16x32_bf16 v[216:219], a[132:135], a[184:187], v[216:219]
    ds_read_b64_tr_b16 a[100:101], v19 offset:0
    s_add_u32 s23, s29, 1867776
    v_mfma_f32_16x16x32_bf16 v[220:223], a[132:135], a[188:191], v[220:223]
    v_mfma_f32_16x16x32_bf16 v[72:75], a[160:163], a[136:139], v[72:75]
    ds_read_b64_tr_b16 a[102:103], v19 offset:1024
    v_mfma_f32_16x16x32_bf16 v[104:107], a[164:167], a[136:139], v[104:107]
    buffer_load_dwordx4 v10, s[36:39], s23 offen lds
    v_mfma_f32_16x16x32_bf16 v[136:139], a[168:171], a[136:139], v[136:139]
    ds_read_b64_tr_b16 a[116:117], v19 offset:8192
    v_mfma_f32_16x16x32_bf16 v[168:171], a[172:175], a[136:139], v[168:171]
    s_add_u32 m0, s30, 149504
    v_mfma_f32_16x16x32_bf16 v[224:227], a[136:139], a[176:179], v[224:227]
    ds_read_b64_tr_b16 a[118:119], v19 offset:9216
    v_mfma_f32_16x16x32_bf16 v[228:231], a[136:139], a[180:183], v[228:231]
    v_mfma_f32_16x16x32_bf16 v[232:235], a[136:139], a[184:187], v[232:235]
    ds_read_b128 a[72:75], v16 offset:4096
    s_add_u32 s23, s29, 1900544
    v_mfma_f32_16x16x32_bf16 v[236:239], a[136:139], a[188:191], v[236:239]
    v_mfma_f32_16x16x32_bf16 v[76:79], a[160:163], a[140:143], v[76:79]
    ds_read_b128 a[76:79], v16 offset:6144
    v_mfma_f32_16x16x32_bf16 v[108:111], a[164:167], a[140:143], v[108:111]
    buffer_load_dwordx4 v11, s[36:39], s23 offen lds
    v_mfma_f32_16x16x32_bf16 v[140:143], a[168:171], a[140:143], v[140:143]
    v_mfma_f32_16x16x32_bf16 v[172:175], a[172:175], a[140:143], v[172:175]
    ds_read_b64_tr_b16 a[104:105], v20 offset:0
    s_add_u32 m0, s30, 150528
    v_mfma_f32_16x16x32_bf16 v[240:243], a[140:143], a[176:179], v[240:243]
    v_mfma_f32_16x16x32_bf16 v[244:247], a[140:143], a[180:183], v[244:247]
    ds_read_b64_tr_b16 a[106:107], v20 offset:1024
    v_mfma_f32_16x16x32_bf16 v[248:251], a[140:143], a[184:187], v[248:251]
    s_add_u32 s23, s29, 1933312
    v_mfma_f32_16x16x32_bf16 v[252:255], a[140:143], a[188:191], v[252:255]
    ds_read_b64_tr_b16 a[120:121], v20 offset:8192
    v_mfma_f32_16x16x32_bf16 v[80:83], a[160:163], a[144:147], v[80:83]
    buffer_load_dwordx4 v11, s[36:39], s23 offen lds
    v_mfma_f32_16x16x32_bf16 v[112:115], a[164:167], a[144:147], v[112:115]
    ds_read_b64_tr_b16 a[122:123], v20 offset:9216
    v_mfma_f32_16x16x32_bf16 v[144:147], a[168:171], a[144:147], v[144:147]
    v_mfma_f32_16x16x32_bf16 v[176:179], a[172:175], a[144:147], v[176:179]
    ds_read_b128 a[80:83], v16 offset:8192
    v_mfma_f32_16x16x32_bf16 a[0:3], a[144:147], a[176:179], a[0:3]
    s_add_u32 m0, s28, 32768
    v_mfma_f32_16x16x32_bf16 a[4:7], a[144:147], a[180:183], a[4:7]
    ds_read_b128 a[84:87], v16 offset:10240
    v_mfma_f32_16x16x32_bf16 a[8:11], a[144:147], a[184:187], a[8:11]
    s_add_u32 s23, s27, 512
    v_mfma_f32_16x16x32_bf16 a[12:15], a[144:147], a[188:191], a[12:15]
    ds_read_b64_tr_b16 a[108:109], v21 offset:0
    v_mfma_f32_16x16x32_bf16 v[84:87], a[160:163], a[148:151], v[84:87]
    v_mfma_f32_16x16x32_bf16 v[116:119], a[164:167], a[148:151], v[116:119]
    ds_read_b64_tr_b16 a[110:111], v21 offset:1024
    buffer_load_dwordx4 v8, s[32:35], s23 offen lds
    v_mfma_f32_16x16x32_bf16 v[148:151], a[168:171], a[148:151], v[148:151]
    v_mfma_f32_16x16x32_bf16 v[180:183], a[172:175], a[148:151], v[180:183]
    ds_read_b64_tr_b16 a[124:125], v21 offset:8192
    v_mfma_f32_16x16x32_bf16 a[16:19], a[148:151], a[176:179], a[16:19]
    s_add_u32 m0, s28, 33792
    v_mfma_f32_16x16x32_bf16 a[20:23], a[148:151], a[180:183], a[20:23]
    ds_read_b64_tr_b16 a[126:127], v21 offset:9216
    v_mfma_f32_16x16x32_bf16 a[24:27], a[148:151], a[184:187], a[24:27]
    s_add_u32 s23, s27, 8704
    v_mfma_f32_16x16x32_bf16 a[28:31], a[148:151], a[188:191], a[28:31]
    ds_read_b128 a[88:91], v16 offset:12288
    v_mfma_f32_16x16x32_bf16 v[88:91], a[160:163], a[152:155], v[88:91]
    v_mfma_f32_16x16x32_bf16 v[120:123], a[164:167], a[152:155], v[120:123]
    ds_read_b128 a[92:95], v16 offset:14336
    buffer_load_dwordx4 v9, s[32:35], s23 offen lds
    v_mfma_f32_16x16x32_bf16 v[152:155], a[168:171], a[152:155], v[152:155]
    v_mfma_f32_16x16x32_bf16 v[184:187], a[172:175], a[152:155], v[184:187]
    s_add_u32 m0, s28, 34816
    v_mfma_f32_16x16x32_bf16 a[32:35], a[152:155], a[176:179], a[32:35]
    v_mfma_f32_16x16x32_bf16 a[36:39], a[152:155], a[180:183], a[36:39]
    s_add_u32 s23, s27, 16896
    v_mfma_f32_16x16x32_bf16 a[40:43], a[152:155], a[184:187], a[40:43]
    v_mfma_f32_16x16x32_bf16 a[44:47], a[152:155], a[188:191], a[44:47]
    buffer_load_dwordx4 v8, s[32:35], s23 offen lds
    v_mfma_f32_16x16x32_bf16 v[92:95], a[160:163], a[156:159], v[92:95]
    v_mfma_f32_16x16x32_bf16 v[124:127], a[164:167], a[156:159], v[124:127]
    s_add_u32 m0, s28, 35840
    v_mfma_f32_16x16x32_bf16 v[156:159], a[168:171], a[156:159], v[156:159]
    v_mfma_f32_16x16x32_bf16 v[188:191], a[172:175], a[156:159], v[188:191]
    s_add_u32 s23, s27, 25088
    v_mfma_f32_16x16x32_bf16 a[48:51], a[156:159], a[176:179], a[48:51]
    v_mfma_f32_16x16x32_bf16 a[52:55], a[156:159], a[180:183], a[52:55]
    buffer_load_dwordx4 v9, s[32:35], s23 offen lds
    v_mfma_f32_16x16x32_bf16 a[56:59], a[156:159], a[184:187], a[56:59]
    v_mfma_f32_16x16x32_bf16 a[60:63], a[156:159], a[188:191], a[60:63]
    s_waitcnt vmcnt(20) lgkmcnt(0)
    v_mfma_f32_16x16x32_bf16 v[64:67], a[96:99], a[64:67], v[64:67]
    s_barrier
    v_mfma_f32_16x16x32_bf16 v[96:99], a[100:103], a[64:67], v[96:99]
    v_mfma_f32_16x16x32_bf16 v[128:131], a[104:107], a[64:67], v[128:131]
    ds_read_b64_tr_b16 a[160:161], v18 offset:16384
    v_mfma_f32_16x16x32_bf16 v[160:163], a[108:111], a[64:67], v[160:163]
    s_add_u32 m0, s30, 98304
    v_mfma_f32_16x16x32_bf16 v[192:195], a[64:67], a[112:115], v[192:195]
    ds_read_b64_tr_b16 a[162:163], v18 offset:17408
    v_mfma_f32_16x16x32_bf16 v[196:199], a[64:67], a[116:119], v[196:199]
    v_mfma_f32_16x16x32_bf16 v[200:203], a[64:67], a[120:123], v[200:203]
    ds_read_b64_tr_b16 a[176:177], v18 offset:24576
    s_add_u32 s23, s29, 2097152
    v_mfma_f32_16x16x32_bf16 v[204:207], a[64:67], a[124:127], v[204:207]
    v_mfma_f32_16x16x32_bf16 v[68:71], a[96:99], a[68:71], v[68:71]
    ds_read_b64_tr_b16 a[178:179], v18 offset:25600
    v_mfma_f32_16x16x32_bf16 v[100:103], a[100:103], a[68:71], v[100:103]
    buffer_load_dwordx4 v10, s[36:39], s23 offen lds
    v_mfma_f32_16x16x32_bf16 v[132:135], a[104:107], a[68:71], v[132:135]
    ds_read_b128 a[128:131], v17 offset:0
    v_mfma_f32_16x16x32_bf16 v[164:167], a[108:111], a[68:71], v[164:167]
    s_add_u32 m0, s30, 99328
    v_mfma_f32_16x16x32_bf16 v[208:211], a[68:71], a[112:115], v[208:211]
    ds_read_b128 a[132:135], v17 offset:2048
    v_mfma_f32_16x16x32_bf16 v[212:215], a[68:71], a[116:119], v[212:215]
    s_cmp_lg_u32 s22, 0
    s_cbranch_scc1 f1_w0_2
    s_waitcnt vmcnt(13)
    v_readfirstlane_b32 s14, v55
    s_nop 0
    s_lshr_b32 s14, s14, s70
    s_and_b32 s14, s14, 255
f1_w0_2:
    v_mfma_f32_16x16x32_bf16 v[216:219], a[68:71], a[120:123], v[216:219]
    ds_read_b64_tr_b16 a[164:165], v19 offset:16384
    s_add_u32 s23, s29, 2129920
    v_mfma_f32_16x16x32_bf16 v[220:223], a[68:71], a[124:127], v[220:223]
    v_mfma_f32_16x16x32_bf16 v[72:75], a[96:99], a[72:75], v[72:75]
    ds_read_b64_tr_b16 a[166:167], v19 offset:17408
    v_mfma_f32_16x16x32_bf16 v[104:107], a[100:103], a[72:75], v[104:107]
    buffer_load_dwordx4 v10, s[36:39], s23 offen lds
    v_mfma_f32_16x16x32_bf16 v[136:139], a[104:107], a[72:75], v[136:139]
    ds_read_b64_tr_b16 a[180:181], v19 offset:24576
    v_mfma_f32_16x16x32_bf16 v[168:171], a[108:111], a[72:75], v[168:171]
    s_add_u32 m0, s30, 100352
    v_mfma_f32_16x16x32_bf16 v[224:227], a[72:75], a[112:115], v[224:227]
    ds_read_b64_tr_b16 a[182:183], v19 offset:25600
    v_mfma_f32_16x16x32_bf16 v[228:231], a[72:75], a[116:119], v[228:231]
    v_mfma_f32_16x16x32_bf16 v[232:235], a[72:75], a[120:123], v[232:235]
    ds_read_b128 a[136:139], v17 offset:4096
    s_add_u32 s23, s29, 2162688
    v_mfma_f32_16x16x32_bf16 v[236:239], a[72:75], a[124:127], v[236:239]
    v_mfma_f32_16x16x32_bf16 v[76:79], a[96:99], a[76:79], v[76:79]
    ds_read_b128 a[140:143], v17 offset:6144
    v_mfma_f32_16x16x32_bf16 v[108:111], a[100:103], a[76:79], v[108:111]
    buffer_load_dwordx4 v11, s[36:39], s23 offen lds
    v_mfma_f32_16x16x32_bf16 v[140:143], a[104:107], a[76:79], v[140:143]
    v_mfma_f32_16x16x32_bf16 v[172:175], a[108:111], a[76:79], v[172:175]
    ds_read_b64_tr_b16 a[168:169], v20 offset:16384
    s_add_u32 m0, s30, 101376
    v_mfma_f32_16x16x32_bf16 v[240:243], a[76:79], a[112:115], v[240:243]
    s_lshr_b32 s83, s20, 1
    v_mfma_f32_16x16x32_bf16 v[244:247], a[76:79], a[116:119], v[244:247]
    ds_read_b64_tr_b16 a[170:171], v20 offset:17408
    v_mfma_f32_16x16x32_bf16 v[248:251], a[76:79], a[120:123], v[248:251]
    s_add_u32 s23, s29, 2195456
    v_mfma_f32_16x16x32_bf16 v[252:255], a[76:79], a[124:127], v[252:255]
    ds_read_b64_tr_b16 a[184:185], v20 offset:24576
    s_lshl_b32 s83, s83, 2
    v_mfma_f32_16x16x32_bf16 v[80:83], a[96:99], a[80:83], v[80:83]
    buffer_load_dwordx4 v11, s[36:39], s23 offen lds
    v_mfma_f32_16x16x32_bf16 v[112:115], a[100:103], a[80:83], v[112:115]
    ds_read_b64_tr_b16 a[186:187], v20 offset:25600
    v_mfma_f32_16x16x32_bf16 v[144:147], a[104:107], a[80:83], v[144:147]
    v_mfma_f32_16x16x32_bf16 v[176:179], a[108:111], a[80:83], v[176:179]
    ds_read_b128 a[144:147], v17 offset:8192
    s_add_u32 s83, s83, 96
    v_mfma_f32_16x16x32_bf16 a[0:3], a[80:83], a[112:115], a[0:3]
    s_add_u32 m0, s28, 36864
    v_mfma_f32_16x16x32_bf16 a[4:7], a[80:83], a[116:119], a[4:7]
    ds_read_b128 a[148:151], v17 offset:10240
    v_mfma_f32_16x16x32_bf16 a[8:11], a[80:83], a[120:123], a[8:11]
    s_add_u32 s23, s27, 33280
    v_mfma_f32_16x16x32_bf16 a[12:15], a[80:83], a[124:127], a[12:15]
    ds_read_b64_tr_b16 a[172:173], v21 offset:16384
    s_and_b32 s15, s20, 1
    v_mfma_f32_16x16x32_bf16 v[84:87], a[96:99], a[84:87], v[84:87]
    v_mfma_f32_16x16x32_bf16 v[116:119], a[100:103], a[84:87], v[116:119]
    ds_read_b64_tr_b16 a[174:175], v21 offset:17408
    buffer_load_dwordx4 v8, s[32:35], s23 offen lds
    v_mfma_f32_16x16x32_bf16 v[148:151], a[104:107], a[84:87], v[148:151]
    s_lshl_b32 s15, s15, 4
    v_mfma_f32_16x16x32_bf16 v[180:183], a[108:111], a[84:87], v[180:183]
    ds_read_b64_tr_b16 a[188:189], v21 offset:24576
    v_mfma_f32_16x16x32_bf16 a[16:19], a[84:87], a[112:115], a[16:19]
    s_add_u32 m0, s28, 37888
    v_mfma_f32_16x16x32_bf16 a[20:23], a[84:87], a[116:119], a[20:23]
    ds_read_b64_tr_b16 a[190:191], v21 offset:25600
    v_mfma_f32_16x16x32_bf16 a[24:27], a[84:87], a[120:123], a[24:27]
    s_add_u32 s23, s27, 41472
    s_mul_i32 s12, s21, 221184
    v_mfma_f32_16x16x32_bf16 a[28:31], a[84:87], a[124:127], a[28:31]
    ds_read_b128 a[152:155], v17 offset:12288
    v_mfma_f32_16x16x32_bf16 v[88:91], a[96:99], a[88:91], v[88:91]
    v_mfma_f32_16x16x32_bf16 v[120:123], a[100:103], a[88:91], v[120:123]
    ds_read_b128 a[156:159], v17 offset:14336
    buffer_load_dwordx4 v9, s[32:35], s23 offen lds
    v_mfma_f32_16x16x32_bf16 v[152:155], a[104:107], a[88:91], v[152:155]
    buffer_load_dwordx4 a[192:195], v26, s[48:51], s12 offen
    v_mfma_f32_16x16x32_bf16 v[184:187], a[108:111], a[88:91], v[184:187]
    s_add_u32 m0, s28, 38912
    v_mfma_f32_16x16x32_bf16 a[32:35], a[88:91], a[112:115], a[32:35]
    v_mfma_f32_16x16x32_bf16 a[36:39], a[88:91], a[116:119], a[36:39]
    s_add_u32 s23, s27, 49664
    buffer_load_dwordx4 a[196:199], v27, s[48:51], s12 offen
    v_mfma_f32_16x16x32_bf16 a[40:43], a[88:91], a[120:123], a[40:43]
    v_mfma_f32_16x16x32_bf16 a[44:47], a[88:91], a[124:127], a[44:47]
    buffer_load_dwordx4 v8, s[32:35], s23 offen lds
    v_mfma_f32_16x16x32_bf16 v[92:95], a[96:99], a[92:95], v[92:95]
    s_mul_i32 s12, s17, 221184
    v_mfma_f32_16x16x32_bf16 v[124:127], a[100:103], a[92:95], v[124:127]
    s_add_u32 m0, s28, 39936
    v_mfma_f32_16x16x32_bf16 v[156:159], a[104:107], a[92:95], v[156:159]
    s_add_u32 s12, s12, s13
    v_mfma_f32_16x16x32_bf16 v[188:191], a[108:111], a[92:95], v[188:191]
    s_add_u32 s23, s27, 57856
    v_mfma_f32_16x16x32_bf16 a[48:51], a[92:95], a[112:115], a[48:51]
    v_mfma_f32_16x16x32_bf16 a[52:55], a[92:95], a[116:119], a[52:55]
    buffer_load_dwordx4 v9, s[32:35], s23 offen lds
    buffer_load_dwordx4 a[200:203], v28, s[48:51], s12 offen
    v_mfma_f32_16x16x32_bf16 a[56:59], a[92:95], a[120:123], a[56:59]
    v_mfma_f32_16x16x32_bf16 a[60:63], a[92:95], a[124:127], a[60:63]
    s_waitcnt vmcnt(19) lgkmcnt(0)
    v_mfma_f32_16x16x32_bf16 v[64:67], a[160:163], a[128:131], v[64:67]
    s_barrier
    v_mfma_f32_16x16x32_bf16 v[96:99], a[164:167], a[128:131], v[96:99]
    v_mfma_f32_16x16x32_bf16 v[128:131], a[168:171], a[128:131], v[128:131]
    ds_read_b64_tr_b16 a[96:97], v18 offset:32768
    v_mfma_f32_16x16x32_bf16 v[160:163], a[172:175], a[128:131], v[160:163]
    s_add_u32 m0, s30, 114688
    v_mfma_f32_16x16x32_bf16 v[192:195], a[128:131], a[176:179], v[192:195]
    ds_read_b64_tr_b16 a[98:99], v18 offset:33792
    v_mfma_f32_16x16x32_bf16 v[196:199], a[128:131], a[180:183], v[196:199]
    v_mfma_f32_16x16x32_bf16 v[200:203], a[128:131], a[184:187], v[200:203]
    ds_read_b64_tr_b16 a[112:113], v18 offset:40960
    s_add_u32 s23, s29, 2359296
    v_mfma_f32_16x16x32_bf16 v[204:207], a[128:131], a[188:191], v[204:207]
    v_mfma_f32_16x16x32_bf16 v[68:71], a[160:163], a[132:135], v[68:71]
    ds_read_b64_tr_b16 a[114:115], v18 offset:41984
    v_mfma_f32_16x16x32_bf16 v[100:103], a[164:167], a[132:135], v[100:103]
    buffer_load_dwordx4 v10, s[36:39], s23 offen lds
    v_mfma_f32_16x16x32_bf16 v[132:135], a[168:171], a[132:135], v[132:135]
    ds_read_b128 a[64:67], v12 offset:0
    v_mfma_f32_16x16x32_bf16 v[164:167], a[172:175], a[132:135], v[164:167]
    s_add_u32 m0, s30, 115712
    v_mfma_f32_16x16x32_bf16 v[208:211], a[132:135], a[176:179], v[208:211]
    ds_read_b128 a[68:71], v12 offset:2048
    v_mfma_f32_16x16x32_bf16 v[212:215], a[132:135], a[180:183], v[212:215]
    v_mfma_f32_16x16x32_bf16 v[216:219], a[132:135], a[184:187], v[216:219]
    ds_read_b64_tr_b16 a[100:101], v19 offset:32768
    s_add_u32 s23, s29, 2392064
    v_mfma_f32_16x16x32_bf16 v[220:223], a[132:135], a[188:191], v[220:223]
    v_mfma_f32_16x16x32_bf16 v[72:75], a[160:163], a[136:139], v[72:75]
    ds_read_b64_tr_b16 a[102:103], v19 offset:33792
    v_mfma_f32_16x16x32_bf16 v[104:107], a[164:167], a[136:139], v[104:107]
    buffer_load_dwordx4 v10, s[36:39], s23 offen lds
    v_mfma_f32_16x16x32_bf16 v[136:139], a[168:171], a[136:139], v[136:139]
    ds_read_b64_tr_b16 a[116:117], v19 offset:40960
    v_mfma_f32_16x16x32_bf16 v[168:171], a[172:175], a[136:139], v[168:171]
    s_add_u32 m0, s30, 116736
    v_mfma_f32_16x16x32_bf16 v[224:227], a[136:139], a[176:179], v[224:227]
    ds_read_b64_tr_b16 a[118:119], v19 offset:41984
    v_mfma_f32_16x16x32_bf16 v[228:231], a[136:139], a[180:183], v[228:231]
    v_mfma_f32_16x16x32_bf16 v[232:235], a[136:139], a[184:187], v[232:235]
    ds_read_b128 a[72:75], v12 offset:4096
    s_add_u32 s23, s29, 2424832
    v_mfma_f32_16x16x32_bf16 v[236:239], a[136:139], a[188:191], v[236:239]
    v_mfma_f32_16x16x32_bf16 v[76:79], a[160:163], a[140:143], v[76:79]
    ds_read_b128 a[76:79], v12 offset:6144
    v_mfma_f32_16x16x32_bf16 v[108:111], a[164:167], a[140:143], v[108:111]
    buffer_load_dwordx4 v11, s[36:39], s23 offen lds
    v_mfma_f32_16x16x32_bf16 v[140:143], a[168:171], a[140:143], v[140:143]
    v_mfma_f32_16x16x32_bf16 v[172:175], a[172:175], a[140:143], v[172:175]
    ds_read_b64_tr_b16 a[104:105], v20 offset:32768
    s_add_u32 m0, s30, 117760
    v_mfma_f32_16x16x32_bf16 v[240:243], a[140:143], a[176:179], v[240:243]
    v_mfma_f32_16x16x32_bf16 v[244:247], a[140:143], a[180:183], v[244:247]
    ds_read_b64_tr_b16 a[106:107], v20 offset:33792
    v_mfma_f32_16x16x32_bf16 v[248:251], a[140:143], a[184:187], v[248:251]
    s_add_u32 s23, s29, 2457600
    v_mfma_f32_16x16x32_bf16 v[252:255], a[140:143], a[188:191], v[252:255]
    ds_read_b64_tr_b16 a[120:121], v20 offset:40960
    v_mfma_f32_16x16x32_bf16 v[80:83], a[160:163], a[144:147], v[80:83]
    buffer_load_dwordx4 v11, s[36:39], s23 offen lds
    v_mfma_f32_16x16x32_bf16 v[112:115], a[164:167], a[144:147], v[112:115]
    ds_read_b64_tr_b16 a[122:123], v20 offset:41984
    v_mfma_f32_16x16x32_bf16 v[144:147], a[168:171], a[144:147], v[144:147]
    v_mfma_f32_16x16x32_bf16 v[176:179], a[172:175], a[144:147], v[176:179]
    ds_read_b128 a[80:83], v12 offset:8192
    v_mfma_f32_16x16x32_bf16 a[0:3], a[144:147], a[176:179], a[0:3]
    s_add_u32 m0, s28, 65536
    v_mfma_f32_16x16x32_bf16 a[4:7], a[144:147], a[180:183], a[4:7]
    ds_read_b128 a[84:87], v12 offset:10240
    v_mfma_f32_16x16x32_bf16 a[8:11], a[144:147], a[184:187], a[8:11]
    s_add_u32 s23, s27, 640
    v_mfma_f32_16x16x32_bf16 a[12:15], a[144:147], a[188:191], a[12:15]
    ds_read_b64_tr_b16 a[108:109], v21 offset:32768
    v_mfma_f32_16x16x32_bf16 v[84:87], a[160:163], a[148:151], v[84:87]
    v_mfma_f32_16x16x32_bf16 v[116:119], a[164:167], a[148:151], v[116:119]
    ds_read_b64_tr_b16 a[110:111], v21 offset:33792
    buffer_load_dwordx4 v8, s[32:35], s23 offen lds
    v_mfma_f32_16x16x32_bf16 v[148:151], a[168:171], a[148:151], v[148:151]
    v_mfma_f32_16x16x32_bf16 v[180:183], a[172:175], a[148:151], v[180:183]
    ds_read_b64_tr_b16 a[124:125], v21 offset:40960
    v_mfma_f32_16x16x32_bf16 a[16:19], a[148:151], a[176:179], a[16:19]
    s_add_u32 m0, s28, 66560
    v_mfma_f32_16x16x32_bf16 a[20:23], a[148:151], a[180:183], a[20:23]
    ds_read_b64_tr_b16 a[126:127], v21 offset:41984
    v_mfma_f32_16x16x32_bf16 a[24:27], a[148:151], a[184:187], a[24:27]
    s_add_u32 s23, s27, 8832
    v_mfma_f32_16x16x32_bf16 a[28:31], a[148:151], a[188:191], a[28:31]
    ds_read_b128 a[88:91], v12 offset:12288
    v_mfma_f32_16x16x32_bf16 v[88:91], a[160:163], a[152:155], v[88:91]
    v_mfma_f32_16x16x32_bf16 v[120:123], a[164:167], a[152:155], v[120:123]
    ds_read_b128 a[92:95], v12 offset:14336
    buffer_load_dwordx4 v9, s[32:35], s23 offen lds
    v_mfma_f32_16x16x32_bf16 v[152:155], a[168:171], a[152:155], v[152:155]
    v_mfma_f32_16x16x32_bf16 v[184:187], a[172:175], a[152:155], v[184:187]
    s_add_u32 m0, s28, 67584
    v_mfma_f32_16x16x32_bf16 a[32:35], a[152:155], a[176:179], a[32:35]
    v_mfma_f32_16x16x32_bf16 a[36:39], a[152:155], a[180:183], a[36:39]
    s_add_u32 s23, s27, 17024
    v_mfma_f32_16x16x32_bf16 a[40:43], a[152:155], a[184:187], a[40:43]
    v_mfma_f32_16x16x32_bf16 a[44:47], a[152:155], a[188:191], a[44:47]
    buffer_load_dwordx4 v8, s[32:35], s23 offen lds
    v_mfma_f32_16x16x32_bf16 v[92:95], a[160:163], a[156:159], v[92:95]
    v_mfma_f32_16x16x32_bf16 v[124:127], a[164:167], a[156:159], v[124:127]
    s_add_u32 m0, s28, 68608
    v_mfma_f32_16x16x32_bf16 v[156:159], a[168:171], a[156:159], v[156:159]
    v_mfma_f32_16x16x32_bf16 v[188:191], a[172:175], a[156:159], v[188:191]
    s_add_u32 s23, s27, 25216
    v_mfma_f32_16x16x32_bf16 a[48:51], a[156:159], a[176:179], a[48:51]
    v_mfma_f32_16x16x32_bf16 a[52:55], a[156:159], a[180:183], a[52:55]
    buffer_load_dwordx4 v9, s[32:35], s23 offen lds
    v_mfma_f32_16x16x32_bf16 a[56:59], a[156:159], a[184:187], a[56:59]
    v_mfma_f32_16x16x32_bf16 a[60:63], a[156:159], a[188:191], a[60:63]
    s_waitcnt vmcnt(23) lgkmcnt(0)
    v_mfma_f32_16x16x32_bf16 v[64:67], a[96:99], a[64:67], v[64:67]
    s_barrier
    v_mfma_f32_16x16x32_bf16 v[96:99], a[100:103], a[64:67], v[96:99]
    v_mfma_f32_16x16x32_bf16 v[128:131], a[104:107], a[64:67], v[128:131]
    ds_read_b64_tr_b16 a[160:161], v18 offset:49152
    v_mfma_f32_16x16x32_bf16 v[160:163], a[108:111], a[64:67], v[160:163]
    s_add_u32 m0, s30, 131072
    v_mfma_f32_16x16x32_bf16 v[192:195], a[64:67], a[112:115], v[192:195]
    ds_read_b64_tr_b16 a[162:163], v18 offset:50176
    v_mfma_f32_16x16x32_bf16 v[196:199], a[64:67], a[116:119], v[196:199]
    v_mfma_f32_16x16x32_bf16 v[200:203], a[64:67], a[120:123], v[200:203]
    ds_read_b64_tr_b16 a[176:177], v18 offset:57344
    s_add_u32 s23, s29, 2621440
    v_mfma_f32_16x16x32_bf16 v[204:207], a[64:67], a[124:127], v[204:207]
    v_mfma_f32_16x16x32_bf16 v[68:71], a[96:99], a[68:71], v[68:71]
    ds_read_b64_tr_b16 a[178:179], v18 offset:58368
    v_mfma_f32_16x16x32_bf16 v[100:103], a[100:103], a[68:71], v[100:103]
    buffer_load_dwordx4 v10, s[36:39], s23 offen lds
    v_mfma_f32_16x16x32_bf16 v[132:135], a[104:107], a[68:71], v[132:135]
    ds_read_b128 a[128:131], v13 offset:0
    v_mfma_f32_16x16x32_bf16 v[164:167], a[108:111], a[68:71], v[164:167]
    s_add_u32 m0, s30, 132096
    v_mfma_f32_16x16x32_bf16 v[208:211], a[68:71], a[112:115], v[208:211]
    ds_read_b128 a[132:135], v13 offset:2048
    v_mfma_f32_16x16x32_bf16 v[212:215], a[68:71], a[116:119], v[212:215]
    v_mfma_f32_16x16x32_bf16 v[216:219], a[68:71], a[120:123], v[216:219]
    ds_read_b64_tr_b16 a[164:165], v19 offset:49152
    s_add_u32 s23, s29, 2654208
    v_mfma_f32_16x16x32_bf16 v[220:223], a[68:71], a[124:127], v[220:223]
    v_mfma_f32_16x16x32_bf16 v[72:75], a[96:99], a[72:75], v[72:75]
    ds_read_b64_tr_b16 a[166:167], v19 offset:50176
    v_mfma_f32_16x16x32_bf16 v[104:107], a[100:103], a[72:75], v[104:107]
    buffer_load_dwordx4 v10, s[36:39], s23 offen lds
    v_mfma_f32_16x16x32_bf16 v[136:139], a[104:107], a[72:75], v[136:139]
    ds_read_b64_tr_b16 a[180:181], v19 offset:57344
    v_mfma_f32_16x16x32_bf16 v[168:171], a[108:111], a[72:75], v[168:171]
    s_add_u32 m0, s30, 133120
    v_mfma_f32_16x16x32_bf16 v[224:227], a[72:75], a[112:115], v[224:227]
    ds_read_b64_tr_b16 a[182:183], v19 offset:58368
    v_mfma_f32_16x16x32_bf16 v[228:231], a[72:75], a[116:119], v[228:231]
    v_mfma_f32_16x16x32_bf16 v[232:235], a[72:75], a[120:123], v[232:235]
    ds_read_b128 a[136:139], v13 offset:4096
    s_add_u32 s23, s29, 2686976
    v_mfma_f32_16x16x32_bf16 v[236:239], a[72:75], a[124:127], v[236:239]
    v_mfma_f32_16x16x32_bf16 v[76:79], a[96:99], a[76:79], v[76:79]
    ds_read_b128 a[140:143], v13 offset:6144
    v_mfma_f32_16x16x32_bf16 v[108:111], a[100:103], a[76:79], v[108:111]
    buffer_load_dwordx4 v11, s[36:39], s23 offen lds
    v_mfma_f32_16x16x32_bf16 v[140:143], a[104:107], a[76:79], v[140:143]
    v_mfma_f32_16x16x32_bf16 v[172:175], a[108:111], a[76:79], v[172:175]
    ds_read_b64_tr_b16 a[168:169], v20 offset:49152
    s_add_u32 m0, s30, 134144
    v_mfma_f32_16x16x32_bf16 v[240:243], a[76:79], a[112:115], v[240:243]
    v_mfma_f32_16x16x32_bf16 v[244:247], a[76:79], a[116:119], v[244:247]
    ds_read_b64_tr_b16 a[170:171], v20 offset:50176
    v_mfma_f32_16x16x32_bf16 v[248:251], a[76:79], a[120:123], v[248:251]
    s_add_u32 s23, s29, 2719744
    v_mfma_f32_16x16x32_bf16 v[252:255], a[76:79], a[124:127], v[252:255]
    ds_read_b64_tr_b16 a[184:185], v20 offset:57344
    v_mfma_f32_16x16x32_bf16 v[80:83], a[96:99], a[80:83], v[80:83]
    buffer_load_dwordx4 v11, s[36:39], s23 offen lds
    v_mfma_f32_16x16x32_bf16 v[112:115], a[100:103], a[80:83], v[112:115]
    ds_read_b64_tr_b16 a[186:187], v20 offset:58368
    v_mfma_f32_16x16x32_bf16 v[144:147], a[104:107], a[80:83], v[144:147]
    v_mfma_f32_16x16x32_bf16 v[176:179], a[108:111], a[80:83], v[176:179]
    ds_read_b128 a[144:147], v13 offset:8192
    v_mfma_f32_16x16x32_bf16 a[0:3], a[80:83], a[112:115], a[0:3]
    s_add_u32 m0, s28, 69632
    v_mfma_f32_16x16x32_bf16 a[4:7], a[80:83], a[116:119], a[4:7]
    ds_read_b128 a[148:151], v13 offset:10240
    v_mfma_f32_16x16x32_bf16 a[8:11], a[80:83], a[120:123], a[8:11]
    s_add_u32 s23, s27, 33408
    v_mfma_f32_16x16x32_bf16 a[12:15], a[80:83], a[124:127], a[12:15]
    ds_read_b64_tr_b16 a[172:173], v21 offset:49152
    v_mfma_f32_16x16x32_bf16 v[84:87], a[96:99], a[84:87], v[84:87]
    v_mfma_f32_16x16x32_bf16 v[116:119], a[100:103], a[84:87], v[116:119]
    ds_read_b64_tr_b16 a[174:175], v21 offset:50176
    buffer_load_dwordx4 v8, s[32:35], s23 offen lds
    v_mfma_f32_16x16x32_bf16 v[148:151], a[104:107], a[84:87], v[148:151]
    v_mfma_f32_16x16x32_bf16 v[180:183], a[108:111], a[84:87], v[180:183]
    ds_read_b64_tr_b16 a[188:189], v21 offset:57344
    v_mfma_f32_16x16x32_bf16 a[16:19], a[84:87], a[112:115], a[16:19]
    s_add_u32 m0, s28, 70656
    v_mfma_f32_16x16x32_bf16 a[20:23], a[84:87], a[116:119], a[20:23]
    ds_read_b64_tr_b16 a[190:191], v21 offset:58368
    v_mfma_f32_16x16x32_bf16 a[24:27], a[84:87], a[120:123], a[24:27]
    s_add_u32 s23, s27, 41600
    v_mfma_f32_16x16x32_bf16 a[28:31], a[84:87], a[124:127], a[28:31]
    ds_read_b128 a[152:155], v13 offset:12288
    v_mfma_f32_16x16x32_bf16 v[88:91], a[96:99], a[88:91], v[88:91]
    v_mfma_f32_16x16x32_bf16 v[120:123], a[100:103], a[88:91], v[120:123]
    ds_read_b128 a[156:159], v13 offset:14336
    buffer_load_dwordx4 v9, s[32:35], s23 offen lds
    v_mfma_f32_16x16x32_bf16 v[152:155], a[104:107], a[88:91], v[152:155]
    v_mfma_f32_16x16x32_bf16 v[184:187], a[108:111], a[88:91], v[184:187]
    s_add_u32 m0, s28, 71680
    v_mfma_f32_16x16x32_bf16 a[32:35], a[88:91], a[112:115], a[32:35]
    v_mfma_f32_16x16x32_bf16 a[36:39], a[88:91], a[116:119], a[36:39]
    s_add_u32 s23, s27, 49792
    v_mfma_f32_16x16x32_bf16 a[40:43], a[88:91], a[120:123], a[40:43]
    v_mfma_f32_16x16x32_bf16 a[44:47], a[88:91], a[124:127], a[44:47]
    buffer_load_dwordx4 v8, s[32:35], s23 offen lds
    v_mfma_f32_16x16x32_bf16 v[92:95], a[96:99], a[92:95], v[92:95]
    v_mfma_f32_16x16x32_bf16 v[124:127], a[100:103], a[92:95], v[124:127]
    s_add_u32 m0, s28, 72704
    v_mfma_f32_16x16x32_bf16 v[156:159], a[104:107], a[92:95], v[156:159]
    v_mfma_f32_16x16x32_bf16 v[188:191], a[108:111], a[92:95], v[188:191]
    s_add_u32 s23, s27, 57984
    v_mfma_f32_16x16x32_bf16 a[48:51], a[92:95], a[112:115], a[48:51]
    v_mfma_f32_16x16x32_bf16 a[52:55], a[92:95], a[116:119], a[52:55]
    buffer_load_dwordx4 v9, s[32:35], s23 offen lds
    v_mfma_f32_16x16x32_bf16 a[56:59], a[92:95], a[120:123], a[56:59]
    v_mfma_f32_16x16x32_bf16 a[60:63], a[92:95], a[124:127], a[60:63]
    s_waitcnt vmcnt(17) lgkmcnt(0)
    v_mfma_f32_16x16x32_bf16 v[64:67], a[160:163], a[128:131], v[64:67]
    s_barrier
    v_mfma_f32_16x16x32_bf16 v[96:99], a[164:167], a[128:131], v[96:99]
    s_mul_i32 s12, s20, 82944
    v_mfma_f32_16x16x32_bf16 v[128:131], a[168:171], a[128:131], v[128:131]
    ds_read_b64_tr_b16 a[96:97], v18 offset:0
    v_mfma_f32_16x16x32_bf16 v[160:163], a[172:175], a[128:131], v[160:163]
    s_add_u32 m0, s30, 147456
    v_mfma_f32_16x16x32_bf16 v[192:195], a[128:131], a[176:179], v[192:195]
    ds_read_b64_tr_b16 a[98:99], v18 offset:1024
    v_mfma_f32_16x16x32_bf16 v[196:199], a[128:131], a[180:183], v[196:199]
    s_add_u32 s48, s18, s12
    s_addc_u32 s49, s19, 0
    v_mfma_f32_16x16x32_bf16 v[200:203], a[128:131], a[184:187], v[200:203]
    ds_read_b64_tr_b16 a[112:113], v18 offset:8192
    s_add_u32 s23, s29, 2883584
    v_mfma_f32_16x16x32_bf16 v[204:207], a[128:131], a[188:191], v[204:207]
    v_mfma_f32_16x16x32_bf16 v[68:71], a[160:163], a[132:135], v[68:71]
    ds_read_b64_tr_b16 a[114:115], v18 offset:9216
    v_mfma_f32_16x16x32_bf16 v[100:103], a[164:167], a[132:135], v[100:103]
    buffer_load_dwordx4 v10, s[36:39], s23 offen lds
    v_mfma_f32_16x16x32_bf16 v[132:135], a[168:171], a[132:135], v[132:135]
    ds_read_b128 a[64:67], v14 offset:0
    v_mfma_f32_16x16x32_bf16 v[164:167], a[172:175], a[132:135], v[164:167]
    s_add_u32 m0, s30, 148480
    v_mfma_f32_16x16x32_bf16 v[208:211], a[132:135], a[176:179], v[208:211]
    ds_read_b128 a[68:71], v14 offset:2048
    v_mfma_f32_16x16x32_bf16 v[212:215], a[132:135], a[180:183], v[212:215]
    s_add_u32 s48, s48, 79691776
    s_addc_u32 s49, s49, 0
    v_mfma_f32_16x16x32_bf16 v[216:219], a[132:135], a[184:187], v[216:219]
    ds_read_b64_tr_b16 a[100:101], v19 offset:0
    s_add_u32 s23, s29, 2916352
    v_mfma_f32_16x16x32_bf16 v[220:223], a[132:135], a[188:191], v[220:223]
    s_mov_b32 s50, 82944
    s_mul_i32 s12, s21, 9216
    v_mfma_f32_16x16x32_bf16 v[72:75], a[160:163], a[136:139], v[72:75]
    ds_read_b64_tr_b16 a[102:103], v19 offset:1024
    v_mfma_f32_16x16x32_bf16 v[104:107], a[164:167], a[136:139], v[104:107]
    buffer_load_dwordx4 v10, s[36:39], s23 offen lds
    s_lshl_b32 s10, s22, 10
    v_mfma_f32_16x16x32_bf16 v[136:139], a[168:171], a[136:139], v[136:139]
    ds_read_b64_tr_b16 a[116:117], v19 offset:8192
    v_mfma_f32_16x16x32_bf16 v[168:171], a[172:175], a[136:139], v[168:171]
    s_add_u32 m0, s30, 149504
    v_mfma_f32_16x16x32_bf16 v[224:227], a[136:139], a[176:179], v[224:227]
    ds_read_b64_tr_b16 a[118:119], v19 offset:9216
    s_add_u32 s12, s12, s10
    v_mfma_f32_16x16x32_bf16 v[228:231], a[136:139], a[180:183], v[228:231]
    s_waitcnt vmcnt(18)
    v_mfma_f32_16x16x32_bf16 v[232:235], a[136:139], a[184:187], v[232:235]
    ds_read_b128 a[72:75], v14 offset:4096
    s_add_u32 s23, s29, 2949120
    v_mfma_f32_16x16x32_bf16 v[236:239], a[136:139], a[188:191], v[236:239]
    v_mfma_f32_16x16x32_bf16 v[76:79], a[160:163], a[140:143], v[76:79]
    ds_read_b128 a[76:79], v14 offset:6144
    v_accvgpr_read_b32 v60, a194
    v_mfma_f32_16x16x32_bf16 v[108:111], a[164:167], a[140:143], v[108:111]
    buffer_load_dwordx4 v11, s[36:39], s23 offen lds
    v_mfma_f32_16x16x32_bf16 v[140:143], a[168:171], a[140:143], v[140:143]
    v_bfi_b32 v60, v61, v48, v60
    v_mfma_f32_16x16x32_bf16 v[172:175], a[172:175], a[140:143], v[172:175]
    ds_read_b64_tr_b16 a[104:105], v20 offset:0
    s_add_u32 m0, s30, 150528
    v_mfma_f32_16x16x32_bf16 v[240:243], a[140:143], a[176:179], v[240:243]
    v_accvgpr_write_b32 a194, v60
    v_mfma_f32_16x16x32_bf16 v[244:247], a[140:143], a[180:183], v[244:247]
    ds_read_b64_tr_b16 a[106:107], v20 offset:1024
    v_mfma_f32_16x16x32_bf16 v[248:251], a[140:143], a[184:187], v[248:251]
    s_add_u32 s23, s29, 2981888
    v_mfma_f32_16x16x32_bf16 v[252:255], a[140:143], a[188:191], v[252:255]
    ds_read_b64_tr_b16 a[120:121], v20 offset:8192
    buffer_store_dwordx4 a[192:195], v29, s[48:51], s12 offen
    v_mfma_f32_16x16x32_bf16 v[80:83], a[160:163], a[144:147], v[80:83]
    buffer_load_dwordx4 v11, s[36:39], s23 offen lds
    v_mfma_f32_16x16x32_bf16 v[112:115], a[164:167], a[144:147], v[112:115]
    ds_read_b64_tr_b16 a[122:123], v20 offset:9216
    v_accvgpr_read_b32 v60, a198
    v_mfma_f32_16x16x32_bf16 v[144:147], a[168:171], a[144:147], v[144:147]
    v_mfma_f32_16x16x32_bf16 v[176:179], a[172:175], a[144:147], v[176:179]
    ds_read_b128 a[80:83], v14 offset:8192
    v_bfi_b32 v60, v62, v49, v60
    v_mfma_f32_16x16x32_bf16 a[0:3], a[144:147], a[176:179], a[0:3]
    s_add_u32 m0, s28, 0
    v_mfma_f32_16x16x32_bf16 a[4:7], a[144:147], a[180:183], a[4:7]
    ds_read_b128 a[84:87], v14 offset:10240
    v_mfma_f32_16x16x32_bf16 a[8:11], a[144:147], a[184:187], a[8:11]
    s_add_u32 s23, s27, 768
    v_accvgpr_write_b32 a198, v60
    v_mfma_f32_16x16x32_bf16 a[12:15], a[144:147], a[188:191], a[12:15]
    ds_read_b64_tr_b16 a[108:109], v21 offset:0
    v_mfma_f32_16x16x32_bf16 v[84:87], a[160:163], a[148:151], v[84:87]
    s_add_u32 s12, s12, 4096
    v_mfma_f32_16x16x32_bf16 v[116:119], a[164:167], a[148:151], v[116:119]
    ds_read_b64_tr_b16 a[110:111], v21 offset:1024
    buffer_load_dwordx4 v8, s[32:35], s23 offen lds
    v_mfma_f32_16x16x32_bf16 v[148:151], a[168:171], a[148:151], v[148:151]
    buffer_store_dwordx4 a[196:199], v29, s[48:51], s12 offen
    v_mfma_f32_16x16x32_bf16 v[180:183], a[172:175], a[148:151], v[180:183]
    ds_read_b64_tr_b16 a[124:125], v21 offset:8192
    v_mfma_f32_16x16x32_bf16 a[16:19], a[148:151], a[176:179], a[16:19]
    s_add_u32 m0, s28, 1024
    v_mfma_f32_16x16x32_bf16 a[20:23], a[148:151], a[180:183], a[20:23]
    ds_read_b64_tr_b16 a[126:127], v21 offset:9216
    v_accvgpr_read_b32 v60, a202
    v_mfma_f32_16x16x32_bf16 a[24:27], a[148:151], a[184:187], a[24:27]
    s_add_u32 s23, s27, 8960
    v_mfma_f32_16x16x32_bf16 a[28:31], a[148:151], a[188:191], a[28:31]
    ds_read_b128 a[88:91], v14 offset:12288
    v_bfi_b32 v60, v63, v50, v60
    v_mfma_f32_16x16x32_bf16 v[88:91], a[160:163], a[152:155], v[88:91]
    v_mfma_f32_16x16x32_bf16 v[120:123], a[164:167], a[152:155], v[120:123]
    ds_read_b128 a[92:95], v14 offset:14336
    buffer_load_dwordx4 v9, s[32:35], s23 offen lds
    v_mfma_f32_16x16x32_bf16 v[152:155], a[168:171], a[152:155], v[152:155]
    v_accvgpr_write_b32 a202, v60
    v_mfma_f32_16x16x32_bf16 v[184:187], a[172:175], a[152:155], v[184:187]
    s_add_u32 m0, s28, 2048
    s_mul_i32 s12, s17, 9216
    v_mfma_f32_16x16x32_bf16 a[32:35], a[152:155], a[176:179], a[32:35]
    v_mfma_f32_16x16x32_bf16 a[36:39], a[152:155], a[180:183], a[36:39]
    s_add_u32 s23, s27, 17152
    s_lshl_b32 s16, s16, 10
    v_mfma_f32_16x16x32_bf16 a[40:43], a[152:155], a[184:187], a[40:43]
    v_mfma_f32_16x16x32_bf16 a[44:47], a[152:155], a[188:191], a[44:47]
    buffer_load_dwordx4 v8, s[32:35], s23 offen lds
    s_add_u32 s12, s12, s16
    v_mfma_f32_16x16x32_bf16 v[92:95], a[160:163], a[156:159], v[92:95]
    s_add_u32 s12, s12, s13
    v_mfma_f32_16x16x32_bf16 v[124:127], a[164:167], a[156:159], v[124:127]
    s_add_u32 m0, s28, 3072
    v_mfma_f32_16x16x32_bf16 v[156:159], a[168:171], a[156:159], v[156:159]
    buffer_store_dwordx4 a[200:203], v29, s[48:51], s12 offen
    v_mfma_f32_16x16x32_bf16 v[188:191], a[172:175], a[156:159], v[188:191]
    s_add_u32 s23, s27, 25344
    v_mfma_f32_16x16x32_bf16 a[48:51], a[156:159], a[176:179], a[48:51]
    s_and_b32 s17, s20, 28
    v_mfma_f32_16x16x32_bf16 a[52:55], a[156:159], a[180:183], a[52:55]
    buffer_load_dwordx4 v9, s[32:35], s23 offen lds
    v_mfma_f32_16x16x32_bf16 a[56:59], a[156:159], a[184:187], a[56:59]
    s_add_u32 s17, s17, 64
    v_mfma_f32_16x16x32_bf16 a[60:63], a[156:159], a[188:191], a[60:63]
    s_waitcnt vmcnt(1) lgkmcnt(0)
    v_mfma_f32_16x16x32_bf16 v[64:67], a[96:99], a[64:67], v[64:67]
    s_barrier
    v_mfma_f32_16x16x32_bf16 v[96:99], a[100:103], a[64:67], v[96:99]
    v_mfma_f32_16x16x32_bf16 v[128:131], a[104:107], a[64:67], v[128:131]
    ds_read_b64_tr_b16 a[160:161], v18 offset:16384
    v_mfma_f32_16x16x32_bf16 v[160:163], a[108:111], a[64:67], v[160:163]
    s_add_u32 m0, s30, 98304
    v_mfma_f32_16x16x32_bf16 v[192:195], a[64:67], a[112:115], v[192:195]
    ds_read_b64_tr_b16 a[162:163], v18 offset:17408
    v_mfma_f32_16x16x32_bf16 v[196:199], a[64:67], a[116:119], v[196:199]
    v_mfma_f32_16x16x32_bf16 v[200:203], a[64:67], a[120:123], v[200:203]
    ds_read_b64_tr_b16 a[176:177], v18 offset:24576
    s_add_u32 s23, s29, 3145728
    v_mfma_f32_16x16x32_bf16 v[204:207], a[64:67], a[124:127], v[204:207]
    v_mfma_f32_16x16x32_bf16 v[68:71], a[96:99], a[68:71], v[68:71]
    ds_read_b64_tr_b16 a[178:179], v18 offset:25600
    v_mfma_f32_16x16x32_bf16 v[100:103], a[100:103], a[68:71], v[100:103]
    buffer_load_dwordx4 v10, s[36:39], s23 offen lds
    v_mfma_f32_16x16x32_bf16 v[132:135], a[104:107], a[68:71], v[132:135]
    ds_read_b128 a[128:131], v15 offset:0
    v_mfma_f32_16x16x32_bf16 v[164:167], a[108:111], a[68:71], v[164:167]
    s_add_u32 m0, s30, 99328
    v_mfma_f32_16x16x32_bf16 v[208:211], a[68:71], a[112:115], v[208:211]
    ds_read_b128 a[132:135], v15 offset:2048
    v_mfma_f32_16x16x32_bf16 v[212:215], a[68:71], a[116:119], v[212:215]
    v_mfma_f32_16x16x32_bf16 v[216:219], a[68:71], a[120:123], v[216:219]
    ds_read_b64_tr_b16 a[164:165], v19 offset:16384
    s_add_u32 s23, s29, 3178496
    v_mfma_f32_16x16x32_bf16 v[220:223], a[68:71], a[124:127], v[220:223]
    v_mfma_f32_16x16x32_bf16 v[72:75], a[96:99], a[72:75], v[72:75]
    ds_read_b64_tr_b16 a[166:167], v19 offset:17408
    v_mfma_f32_16x16x32_bf16 v[104:107], a[100:103], a[72:75], v[104:107]
    buffer_load_dwordx4 v10, s[36:39], s23 offen lds
    v_mfma_f32_16x16x32_bf16 v[136:139], a[104:107], a[72:75], v[136:139]
    ds_read_b64_tr_b16 a[180:181], v19 offset:24576
    v_mfma_f32_16x16x32_bf16 v[168:171], a[108:111], a[72:75], v[168:171]
    s_add_u32 m0, s30, 100352
    v_mfma_f32_16x16x32_bf16 v[224:227], a[72:75], a[112:115], v[224:227]
    ds_read_b64_tr_b16 a[182:183], v19 offset:25600
    v_mfma_f32_16x16x32_bf16 v[228:231], a[72:75], a[116:119], v[228:231]
    v_mfma_f32_16x16x32_bf16 v[232:235], a[72:75], a[120:123], v[232:235]
    ds_read_b128 a[136:139], v15 offset:4096
    s_add_u32 s23, s29, 3211264
    v_mfma_f32_16x16x32_bf16 v[236:239], a[72:75], a[124:127], v[236:239]
    v_mfma_f32_16x16x32_bf16 v[76:79], a[96:99], a[76:79], v[76:79]
    ds_read_b128 a[140:143], v15 offset:6144
    v_mfma_f32_16x16x32_bf16 v[108:111], a[100:103], a[76:79], v[108:111]
    buffer_load_dwordx4 v11, s[36:39], s23 offen lds
    v_mfma_f32_16x16x32_bf16 v[140:143], a[104:107], a[76:79], v[140:143]
    v_mfma_f32_16x16x32_bf16 v[172:175], a[108:111], a[76:79], v[172:175]
    ds_read_b64_tr_b16 a[168:169], v20 offset:16384
    s_add_u32 m0, s30, 101376
    v_mfma_f32_16x16x32_bf16 v[240:243], a[76:79], a[112:115], v[240:243]
    v_mfma_f32_16x16x32_bf16 v[244:247], a[76:79], a[116:119], v[244:247]
    ds_read_b64_tr_b16 a[170:171], v20 offset:17408
    v_mfma_f32_16x16x32_bf16 v[248:251], a[76:79], a[120:123], v[248:251]
    s_add_u32 s23, s29, 3244032
    v_mfma_f32_16x16x32_bf16 v[252:255], a[76:79], a[124:127], v[252:255]
    ds_read_b64_tr_b16 a[184:185], v20 offset:24576
    v_mfma_f32_16x16x32_bf16 v[80:83], a[96:99], a[80:83], v[80:83]
    buffer_load_dwordx4 v11, s[36:39], s23 offen lds
    v_mfma_f32_16x16x32_bf16 v[112:115], a[100:103], a[80:83], v[112:115]
    ds_read_b64_tr_b16 a[186:187], v20 offset:25600
    v_mfma_f32_16x16x32_bf16 v[144:147], a[104:107], a[80:83], v[144:147]
    s_cmp_lg_u32 s22, 0
    s_cbranch_scc1 f1_sgw2
    s_cmp_lg_u32 s14, 32
    s_cbranch_scc1 f1_sgw2_wb
f1_sgw2_wb_r:
    s_lshl_b32 s24, 256, s15
    s_mov_b64 exec, 1
    v_mov_b32 v24, s24
    buffer_atomic_add v24, off, s[56:59], s83 sc1
    s_mov_b64 exec, -1
f1_sgw2:
    v_mfma_f32_16x16x32_bf16 v[176:179], a[108:111], a[80:83], v[176:179]
    ds_read_b128 a[144:147], v15 offset:8192
    v_mfma_f32_16x16x32_bf16 a[0:3], a[80:83], a[112:115], a[0:3]
    s_add_u32 m0, s28, 4096
    v_mfma_f32_16x16x32_bf16 a[4:7], a[80:83], a[116:119], a[4:7]
    ds_read_b128 a[148:151], v15 offset:10240
    v_mfma_f32_16x16x32_bf16 a[8:11], a[80:83], a[120:123], a[8:11]
    s_add_u32 s23, s27, 33536
    v_mfma_f32_16x16x32_bf16 a[12:15], a[80:83], a[124:127], a[12:15]
    ds_read_b64_tr_b16 a[172:173], v21 offset:16384
    v_mfma_f32_16x16x32_bf16 v[84:87], a[96:99], a[84:87], v[84:87]
    v_mfma_f32_16x16x32_bf16 v[116:119], a[100:103], a[84:87], v[116:119]
    ds_read_b64_tr_b16 a[174:175], v21 offset:17408
    buffer_load_dwordx4 v8, s[32:35], s23 offen lds
    v_mfma_f32_16x16x32_bf16 v[148:151], a[104:107], a[84:87], v[148:151]
    v_mfma_f32_16x16x32_bf16 v[180:183], a[108:111], a[84:87], v[180:183]
    ds_read_b64_tr_b16 a[188:189], v21 offset:24576
    v_mfma_f32_16x16x32_bf16 a[16:19], a[84:87], a[112:115], a[16:19]
    s_add_u32 m0, s28, 5120
    v_mfma_f32_16x16x32_bf16 a[20:23], a[84:87], a[116:119], a[20:23]
    ds_read_b64_tr_b16 a[190:191], v21 offset:25600
    v_mfma_f32_16x16x32_bf16 a[24:27], a[84:87], a[120:123], a[24:27]
    s_add_u32 s23, s27, 41728
    v_mfma_f32_16x16x32_bf16 a[28:31], a[84:87], a[124:127], a[28:31]
    ds_read_b128 a[152:155], v15 offset:12288
    v_mfma_f32_16x16x32_bf16 v[88:91], a[96:99], a[88:91], v[88:91]
    v_mfma_f32_16x16x32_bf16 v[120:123], a[100:103], a[88:91], v[120:123]
    ds_read_b128 a[156:159], v15 offset:14336
    buffer_load_dwordx4 v9, s[32:35], s23 offen lds
    v_mfma_f32_16x16x32_bf16 v[152:155], a[104:107], a[88:91], v[152:155]
    v_mfma_f32_16x16x32_bf16 v[184:187], a[108:111], a[88:91], v[184:187]
    s_add_u32 m0, s28, 6144
    v_mfma_f32_16x16x32_bf16 a[32:35], a[88:91], a[112:115], a[32:35]
    v_mfma_f32_16x16x32_bf16 a[36:39], a[88:91], a[116:119], a[36:39]
    s_add_u32 s23, s27, 49920
    v_mfma_f32_16x16x32_bf16 a[40:43], a[88:91], a[120:123], a[40:43]
    v_mfma_f32_16x16x32_bf16 a[44:47], a[88:91], a[124:127], a[44:47]
    buffer_load_dwordx4 v8, s[32:35], s23 offen lds
    v_mfma_f32_16x16x32_bf16 v[92:95], a[96:99], a[92:95], v[92:95]
    v_mfma_f32_16x16x32_bf16 v[124:127], a[100:103], a[92:95], v[124:127]
    s_add_u32 m0, s28, 7168
    v_mfma_f32_16x16x32_bf16 v[156:159], a[104:107], a[92:95], v[156:159]
    v_mfma_f32_16x16x32_bf16 v[188:191], a[108:111], a[92:95], v[188:191]
    s_add_u32 s23, s27, 58112
    v_mfma_f32_16x16x32_bf16 a[48:51], a[92:95], a[112:115], a[48:51]
    v_mfma_f32_16x16x32_bf16 a[52:55], a[92:95], a[116:119], a[52:55]
    buffer_load_dwordx4 v9, s[32:35], s23 offen lds
    v_mfma_f32_16x16x32_bf16 a[56:59], a[92:95], a[120:123], a[56:59]
    v_mfma_f32_16x16x32_bf16 a[60:63], a[92:95], a[124:127], a[60:63]
    s_waitcnt lgkmcnt(0)
    v_mfma_f32_16x16x32_bf16 v[64:67], a[160:163], a[128:131], v[64:67]
    s_barrier
    v_mfma_f32_16x16x32_bf16 v[96:99], a[164:167], a[128:131], v[96:99]
    v_mfma_f32_16x16x32_bf16 v[128:131], a[168:171], a[128:131], v[128:131]
    ds_read_b64_tr_b16 a[96:97], v18 offset:32768
    s_getpc_b64 s[60:61]
    v_mfma_f32_16x16x32_bf16 v[160:163], a[172:175], a[128:131], v[160:163]
    s_add_u32 m0, s30, 114688
    v_mfma_f32_16x16x32_bf16 v[192:195], a[128:131], a[176:179], v[192:195]
    ds_read_b64_tr_b16 a[98:99], v18 offset:33792
    v_mfma_f32_16x16x32_bf16 v[196:199], a[128:131], a[180:183], v[196:199]
f1_pcr1:
    v_mfma_f32_16x16x32_bf16 v[200:203], a[128:131], a[184:187], v[200:203]
    ds_read_b64_tr_b16 a[112:113], v18 offset:40960
    s_add_u32 s23, s29, 3407872
    v_mfma_f32_16x16x32_bf16 v[204:207], a[128:131], a[188:191], v[204:207]
    s_mov_b32 s62, f1_last-f1_pcr1
    v_mfma_f32_16x16x32_bf16 v[68:71], a[160:163], a[132:135], v[68:71]
    ds_read_b64_tr_b16 a[114:115], v18 offset:41984
    v_mfma_f32_16x16x32_bf16 v[100:103], a[164:167], a[132:135], v[100:103]
    buffer_load_dwordx4 v10, s[36:39], s23 offen lds
    v_mfma_f32_16x16x32_bf16 v[132:135], a[168:171], a[132:135], v[132:135]
    ds_read_b128 a[64:67], v16 offset:0
    v_mfma_f32_16x16x32_bf16 v[164:167], a[172:175], a[132:135], v[164:167]
    s_add_u32 m0, s30, 115712
    s_mov_b32 s63, 0x00020000
    v_mfma_f32_16x16x32_bf16 v[208:211], a[132:135], a[176:179], v[208:211]
    ds_read_b128 a[68:71], v16 offset:2048
    v_mfma_f32_16x16x32_bf16 v[212:215], a[132:135], a[180:183], v[212:215]
    v_mfma_f32_16x16x32_bf16 v[216:219], a[132:135], a[184:187], v[216:219]
    ds_read_b64_tr_b16 a[100:101], v19 offset:32768
    s_add_u32 s23, s29, 3440640
    v_mfma_f32_16x16x32_bf16 v[220:223], a[132:135], a[188:191], v[220:223]
    s_lshr_b32 s25, s2, 3
    v_mfma_f32_16x16x32_bf16 v[72:75], a[160:163], a[136:139], v[72:75]
    ds_read_b64_tr_b16 a[102:103], v19 offset:33792
    v_mfma_f32_16x16x32_bf16 v[104:107], a[164:167], a[136:139], v[104:107]
    buffer_load_dwordx4 v10, s[36:39], s23 offen lds
    v_mfma_f32_16x16x32_bf16 v[136:139], a[168:171], a[136:139], v[136:139]
    ds_read_b64_tr_b16 a[116:117], v19 offset:40960
    v_mfma_f32_16x16x32_bf16 v[168:171], a[172:175], a[136:139], v[168:171]
    s_add_u32 m0, s30, 116736
    v_mfma_f32_16x16x32_bf16 v[224:227], a[136:139], a[176:179], v[224:227]
    ds_read_b64_tr_b16 a[118:119], v19 offset:41984
    s_lshl_b32 s25, s25, 2
    v_mfma_f32_16x16x32_bf16 v[228:231], a[136:139], a[180:183], v[228:231]
    v_mfma_f32_16x16x32_bf16 v[232:235], a[136:139], a[184:187], v[232:235]
    ds_read_b128 a[72:75], v16 offset:4096
    s_add_u32 s23, s29, 3473408
    v_mfma_f32_16x16x32_bf16 v[236:239], a[136:139], a[188:191], v[236:239]
    v_mfma_f32_16x16x32_bf16 v[76:79], a[160:163], a[140:143], v[76:79]
    ds_read_b128 a[76:79], v16 offset:6144
    s_add_u32 s25, s25, s22
    v_mfma_f32_16x16x32_bf16 v[108:111], a[164:167], a[140:143], v[108:111]
    buffer_load_dwordx4 v11, s[36:39], s23 offen lds
    v_mfma_f32_16x16x32_bf16 v[140:143], a[168:171], a[140:143], v[140:143]
    v_mfma_f32_16x16x32_bf16 v[172:175], a[172:175], a[140:143], v[172:175]
    ds_read_b64_tr_b16 a[104:105], v20 offset:32768
    s_add_u32 m0, s30, 117760
    v_mfma_f32_16x16x32_bf16 v[240:243], a[140:143], a[176:179], v[240:243]
    s_lshl_b32 s25, s25, 10
    v_mfma_f32_16x16x32_bf16 v[244:247], a[140:143], a[180:183], v[244:247]
    ds_read_b64_tr_b16 a[106:107], v20 offset:33792
    v_mfma_f32_16x16x32_bf16 v[248:251], a[140:143], a[184:187], v[248:251]
    s_add_u32 s23, s29, 3506176
    v_mfma_f32_16x16x32_bf16 v[252:255], a[140:143], a[188:191], v[252:255]
    ds_read_b64_tr_b16 a[120:121], v20 offset:40960
    v_mfma_f32_16x16x32_bf16 v[80:83], a[160:163], a[144:147], v[80:83]
    buffer_load_dwordx4 v11, s[36:39], s23 offen lds
    v_mfma_f32_16x16x32_bf16 v[112:115], a[164:167], a[144:147], v[112:115]
    ds_read_b64_tr_b16 a[122:123], v20 offset:41984
    buffer_load_dwordx4 a[248:251], v29, s[60:63], s25 offen
    v_mfma_f32_16x16x32_bf16 v[144:147], a[168:171], a[144:147], v[144:147]
    v_mfma_f32_16x16x32_bf16 v[176:179], a[172:175], a[144:147], v[176:179]
    ds_read_b128 a[80:83], v16 offset:8192
    v_mfma_f32_16x16x32_bf16 a[0:3], a[144:147], a[176:179], a[0:3]
    s_add_u32 m0, s28, 32768
    v_mfma_f32_16x16x32_bf16 a[4:7], a[144:147], a[180:183], a[4:7]
    ds_read_b128 a[84:87], v16 offset:10240
    v_mfma_f32_16x16x32_bf16 a[8:11], a[144:147], a[184:187], a[8:11]
    s_add_u32 s23, s27, 896
    v_lshlrev_b32 v56, 1, v3
    v_mfma_f32_16x16x32_bf16 a[12:15], a[144:147], a[188:191], a[12:15]
    ds_read_b64_tr_b16 a[108:109], v21 offset:32768
    v_mfma_f32_16x16x32_bf16 v[84:87], a[160:163], a[148:151], v[84:87]
    v_mfma_f32_16x16x32_bf16 v[116:119], a[164:167], a[148:151], v[116:119]
    ds_read_b64_tr_b16 a[110:111], v21 offset:33792
    buffer_load_dwordx4 v8, s[32:35], s23 offen lds
    v_mfma_f32_16x16x32_bf16 v[148:151], a[168:171], a[148:151], v[148:151]
    v_xor_b32 v56, v2, v56
    v_mfma_f32_16x16x32_bf16 v[180:183], a[172:175], a[148:151], v[180:183]
    ds_read_b64_tr_b16 a[124:125], v21 offset:40960
    v_mfma_f32_16x16x32_bf16 a[16:19], a[148:151], a[176:179], a[16:19]
    s_add_u32 m0, s28, 33792
    v_mfma_f32_16x16x32_bf16 a[20:23], a[148:151], a[180:183], a[20:23]
    ds_read_b64_tr_b16 a[126:127], v21 offset:41984
    v_mfma_f32_16x16x32_bf16 a[24:27], a[148:151], a[184:187], a[24:27]
    s_add_u32 s23, s27, 9088
    v_mfma_f32_16x16x32_bf16 a[28:31], a[148:151], a[188:191], a[28:31]
    ds_read_b128 a[88:91], v16 offset:12288
    v_lshlrev_b32 v56, 4, v56
    v_mfma_f32_16x16x32_bf16 v[88:91], a[160:163], a[152:155], v[88:91]
    v_mfma_f32_16x16x32_bf16 v[120:123], a[164:167], a[152:155], v[120:123]
    ds_read_b128 a[92:95], v16 offset:14336
    buffer_load_dwordx4 v9, s[32:35], s23 offen lds
    v_mfma_f32_16x16x32_bf16 v[152:155], a[168:171], a[152:155], v[152:155]
    v_mfma_f32_16x16x32_bf16 v[184:187], a[172:175], a[152:155], v[184:187]
    s_add_u32 m0, s28, 34816
    v_lshl_add_u32 v26, v3, 13, v56
    v_mfma_f32_16x16x32_bf16 a[32:35], a[152:155], a[176:179], a[32:35]
    v_mfma_f32_16x16x32_bf16 a[36:39], a[152:155], a[180:183], a[36:39]
    s_add_u32 s23, s27, 17280
    v_mfma_f32_16x16x32_bf16 a[40:43], a[152:155], a[184:187], a[40:43]
    s_lshl_b32 s25, s20, 8
    v_mfma_f32_16x16x32_bf16 a[44:47], a[152:155], a[188:191], a[44:47]
    buffer_load_dwordx4 v8, s[32:35], s23 offen lds
    v_mfma_f32_16x16x32_bf16 v[92:95], a[160:163], a[156:159], v[92:95]
    v_mfma_f32_16x16x32_bf16 v[124:127], a[164:167], a[156:159], v[124:127]
    s_add_u32 m0, s28, 35840
    v_mfma_f32_16x16x32_bf16 v[156:159], a[168:171], a[156:159], v[156:159]
    v_add_u32 v26, s25, v26
    v_mfma_f32_16x16x32_bf16 v[188:191], a[172:175], a[156:159], v[188:191]
    s_add_u32 s23, s27, 25472
    v_mfma_f32_16x16x32_bf16 a[48:51], a[156:159], a[176:179], a[48:51]
    v_mfma_f32_16x16x32_bf16 a[52:55], a[156:159], a[180:183], a[52:55]
    buffer_load_dwordx4 v9, s[32:35], s23 offen lds
    v_xor_b32 v27, 128, v26
    v_mfma_f32_16x16x32_bf16 a[56:59], a[156:159], a[184:187], a[56:59]
    v_mfma_f32_16x16x32_bf16 a[60:63], a[156:159], a[188:191], a[60:63]
    s_waitcnt lgkmcnt(0)
    v_mfma_f32_16x16x32_bf16 v[64:67], a[96:99], a[64:67], v[64:67]
    s_barrier
    v_mfma_f32_16x16x32_bf16 v[96:99], a[100:103], a[64:67], v[96:99]
    v_mfma_f32_16x16x32_bf16 v[128:131], a[104:107], a[64:67], v[128:131]
    ds_read_b64_tr_b16 a[160:161], v18 offset:49152
    v_mfma_f32_16x16x32_bf16 v[160:163], a[108:111], a[64:67], v[160:163]
    s_add_u32 m0, s30, 131072
    v_mfma_f32_16x16x32_bf16 v[192:195], a[64:67], a[112:115], v[192:195]
    ds_read_b64_tr_b16 a[162:163], v18 offset:50176
    v_mfma_f32_16x16x32_bf16 v[196:199], a[64:67], a[116:119], v[196:199]
    v_mfma_f32_16x16x32_bf16 v[200:203], a[64:67], a[120:123], v[200:203]
    ds_read_b64_tr_b16 a[176:177], v18 offset:57344
    s_add_u32 s23, s29, 3670016
    v_mfma_f32_16x16x32_bf16 v[204:207], a[64:67], a[124:127], v[204:207]
    v_mfma_f32_16x16x32_bf16 v[68:71], a[96:99], a[68:71], v[68:71]
    ds_read_b64_tr_b16 a[178:179], v18 offset:58368
    v_mfma_f32_16x16x32_bf16 v[100:103], a[100:103], a[68:71], v[100:103]
    buffer_load_dwordx4 v10, s[36:39], s23 offen lds
    v_mfma_f32_16x16x32_bf16 v[132:135], a[104:107], a[68:71], v[132:135]
    ds_read_b128 a[128:131], v17 offset:0
    v_mfma_f32_16x16x32_bf16 v[164:167], a[108:111], a[68:71], v[164:167]
    s_add_u32 m0, s30, 132096
    v_mfma_f32_16x16x32_bf16 v[208:211], a[68:71], a[112:115], v[208:211]
    ds_read_b128 a[132:135], v17 offset:2048
    v_mfma_f32_16x16x32_bf16 v[212:215], a[68:71], a[116:119], v[212:215]
    v_mfma_f32_16x16x32_bf16 v[216:219], a[68:71], a[120:123], v[216:219]
    ds_read_b64_tr_b16 a[164:165], v19 offset:49152
    s_add_u32 s23, s29, 3702784
    v_mfma_f32_16x16x32_bf16 v[220:223], a[68:71], a[124:127], v[220:223]
    v_mfma_f32_16x16x32_bf16 v[72:75], a[96:99], a[72:75], v[72:75]
    ds_read_b64_tr_b16 a[166:167], v19 offset:50176
    v_mfma_f32_16x16x32_bf16 v[104:107], a[100:103], a[72:75], v[104:107]
    buffer_load_dwordx4 v10, s[36:39], s23 offen lds
    v_mfma_f32_16x16x32_bf16 v[136:139], a[104:107], a[72:75], v[136:139]
    ds_read_b64_tr_b16 a[180:181], v19 offset:57344
    v_mfma_f32_16x16x32_bf16 v[168:171], a[108:111], a[72:75], v[168:171]
    s_add_u32 m0, s30, 133120
    v_mfma_f32_16x16x32_bf16 v[224:227], a[72:75], a[112:115], v[224:227]
    ds_read_b64_tr_b16 a[182:183], v19 offset:58368
    v_mfma_f32_16x16x32_bf16 v[228:231], a[72:75], a[116:119], v[228:231]
    v_mfma_f32_16x16x32_bf16 v[232:235], a[72:75], a[120:123], v[232:235]
    ds_read_b128 a[136:139], v17 offset:4096
    s_add_u32 s23, s29, 3735552
    v_mfma_f32_16x16x32_bf16 v[236:239], a[72:75], a[124:127], v[236:239]
    v_mfma_f32_16x16x32_bf16 v[76:79], a[96:99], a[76:79], v[76:79]
    ds_read_b128 a[140:143], v17 offset:6144
    v_mfma_f32_16x16x32_bf16 v[108:111], a[100:103], a[76:79], v[108:111]
    buffer_load_dwordx4 v11, s[36:39], s23 offen lds
    v_mfma_f32_16x16x32_bf16 v[140:143], a[104:107], a[76:79], v[140:143]
    v_mfma_f32_16x16x32_bf16 v[172:175], a[108:111], a[76:79], v[172:175]
    ds_read_b64_tr_b16 a[168:169], v20 offset:49152
    s_add_u32 m0, s30, 134144
    v_mfma_f32_16x16x32_bf16 v[240:243], a[76:79], a[112:115], v[240:243]
    v_mfma_f32_16x16x32_bf16 v[244:247], a[76:79], a[116:119], v[244:247]
    ds_read_b64_tr_b16 a[170:171], v20 offset:50176
    v_mfma_f32_16x16x32_bf16 v[248:251], a[76:79], a[120:123], v[248:251]
    s_add_u32 s23, s29, 3768320
    v_mfma_f32_16x16x32_bf16 v[252:255], a[76:79], a[124:127], v[252:255]
    ds_read_b64_tr_b16 a[184:185], v20 offset:57344
    v_mfma_f32_16x16x32_bf16 v[80:83], a[96:99], a[80:83], v[80:83]
    buffer_load_dwordx4 v11, s[36:39], s23 offen lds
    v_mfma_f32_16x16x32_bf16 v[112:115], a[100:103], a[80:83], v[112:115]
    ds_read_b64_tr_b16 a[186:187], v20 offset:58368
    v_mfma_f32_16x16x32_bf16 v[144:147], a[104:107], a[80:83], v[144:147]
    v_mfma_f32_16x16x32_bf16 v[176:179], a[108:111], a[80:83], v[176:179]
    ds_read_b128 a[144:147], v17 offset:8192
    v_mfma_f32_16x16x32_bf16 a[0:3], a[80:83], a[112:115], a[0:3]
    s_add_u32 m0, s28, 36864
    v_mfma_f32_16x16x32_bf16 a[4:7], a[80:83], a[116:119], a[4:7]
    ds_read_b128 a[148:151], v17 offset:10240
    v_mfma_f32_16x16x32_bf16 a[8:11], a[80:83], a[120:123], a[8:11]
    s_add_u32 s23, s27, 33664
    v_mfma_f32_16x16x32_bf16 a[12:15], a[80:83], a[124:127], a[12:15]
    ds_read_b64_tr_b16 a[172:173], v21 offset:49152
    v_mfma_f32_16x16x32_bf16 v[84:87], a[96:99], a[84:87], v[84:87]
    v_mfma_f32_16x16x32_bf16 v[116:119], a[100:103], a[84:87], v[116:119]
    ds_read_b64_tr_b16 a[174:175], v21 offset:50176
    buffer_load_dwordx4 v8, s[32:35], s23 offen lds
    v_mfma_f32_16x16x32_bf16 v[148:151], a[104:107], a[84:87], v[148:151]
    v_mfma_f32_16x16x32_bf16 v[180:183], a[108:111], a[84:87], v[180:183]
    ds_read_b64_tr_b16 a[188:189], v21 offset:57344
    v_mfma_f32_16x16x32_bf16 a[16:19], a[84:87], a[112:115], a[16:19]
    s_add_u32 m0, s28, 37888
    v_mfma_f32_16x16x32_bf16 a[20:23], a[84:87], a[116:119], a[20:23]
    ds_read_b64_tr_b16 a[190:191], v21 offset:58368
    v_mfma_f32_16x16x32_bf16 a[24:27], a[84:87], a[120:123], a[24:27]
    s_add_u32 s23, s27, 41856
    v_mfma_f32_16x16x32_bf16 a[28:31], a[84:87], a[124:127], a[28:31]
    ds_read_b128 a[152:155], v17 offset:12288
    v_mfma_f32_16x16x32_bf16 v[88:91], a[96:99], a[88:91], v[88:91]
    v_mfma_f32_16x16x32_bf16 v[120:123], a[100:103], a[88:91], v[120:123]
    ds_read_b128 a[156:159], v17 offset:14336
    buffer_load_dwordx4 v9, s[32:35], s23 offen lds
    v_mfma_f32_16x16x32_bf16 v[152:155], a[104:107], a[88:91], v[152:155]
    v_mfma_f32_16x16x32_bf16 v[184:187], a[108:111], a[88:91], v[184:187]
    s_add_u32 m0, s28, 38912
    v_mfma_f32_16x16x32_bf16 a[32:35], a[88:91], a[112:115], a[32:35]
    v_mfma_f32_16x16x32_bf16 a[36:39], a[88:91], a[116:119], a[36:39]
    s_add_u32 s23, s27, 50048
    v_mfma_f32_16x16x32_bf16 a[40:43], a[88:91], a[120:123], a[40:43]
    v_mfma_f32_16x16x32_bf16 a[44:47], a[88:91], a[124:127], a[44:47]
    buffer_load_dwordx4 v8, s[32:35], s23 offen lds
    v_mfma_f32_16x16x32_bf16 v[92:95], a[96:99], a[92:95], v[92:95]
    v_mfma_f32_16x16x32_bf16 v[124:127], a[100:103], a[92:95], v[124:127]
    s_add_u32 m0, s28, 39936
    v_mfma_f32_16x16x32_bf16 v[156:159], a[104:107], a[92:95], v[156:159]
    v_mfma_f32_16x16x32_bf16 v[188:191], a[108:111], a[92:95], v[188:191]
    s_add_u32 s23, s27, 58240
    v_mfma_f32_16x16x32_bf16 a[48:51], a[92:95], a[112:115], a[48:51]
    v_mfma_f32_16x16x32_bf16 a[52:55], a[92:95], a[116:119], a[52:55]
    buffer_load_dwordx4 v9, s[32:35], s23 offen lds
    v_mfma_f32_16x16x32_bf16 a[56:59], a[92:95], a[120:123], a[56:59]
    v_mfma_f32_16x16x32_bf16 a[60:63], a[92:95], a[124:127], a[60:63]
    s_waitcnt vmcnt(17) lgkmcnt(0)
    v_mfma_f32_16x16x32_bf16 v[64:67], a[160:163], a[128:131], v[64:67]
    s_barrier
    v_mfma_f32_16x16x32_bf16 v[96:99], a[164:167], a[128:131], v[96:99]
    v_mfma_f32_16x16x32_bf16 v[128:131], a[168:171], a[128:131], v[128:131]
    ds_read_b64_tr_b16 a[96:97], v18 offset:0
    v_mfma_f32_16x16x32_bf16 v[160:163], a[172:175], a[128:131], v[160:163]
    s_add_u32 m0, s30, 147456
    v_mfma_f32_16x16x32_bf16 v[192:195], a[128:131], a[176:179], v[192:195]
    ds_read_b64_tr_b16 a[98:99], v18 offset:1024
    s_add_u32 s23, s29, 3932160
    v_mfma_f32_16x16x32_bf16 v[196:199], a[128:131], a[180:183], v[196:199]
    buffer_load_dwordx4 v10, s[36:39], s23 offen lds
    v_mfma_f32_16x16x32_bf16 v[200:203], a[128:131], a[184:187], v[200:203]
    ds_read_b64_tr_b16 a[112:113], v18 offset:8192
    v_mfma_f32_16x16x32_bf16 v[204:207], a[128:131], a[188:191], v[204:207]
    s_add_u32 m0, s30, 148480
    v_mfma_f32_16x16x32_bf16 v[68:71], a[160:163], a[132:135], v[68:71]
    ds_read_b64_tr_b16 a[114:115], v18 offset:9216
    v_mfma_f32_16x16x32_bf16 v[100:103], a[164:167], a[132:135], v[100:103]
    s_add_u32 s23, s29, 3964928
    v_mfma_f32_16x16x32_bf16 v[132:135], a[168:171], a[132:135], v[132:135]
    ds_read_b128 a[64:67], v12 offset:0
    v_mfma_f32_16x16x32_bf16 v[164:167], a[172:175], a[132:135], v[164:167]
    buffer_load_dwordx4 v10, s[36:39], s23 offen lds
    v_mfma_f32_16x16x32_bf16 v[208:211], a[132:135], a[176:179], v[208:211]
    ds_read_b128 a[68:71], v12 offset:2048
    s_add_u32 m0, s30, 149504
    v_mfma_f32_16x16x32_bf16 v[212:215], a[132:135], a[180:183], v[212:215]
    s_add_u32 s23, s29, 3997696
    v_mfma_f32_16x16x32_bf16 v[216:219], a[132:135], a[184:187], v[216:219]
    ds_read_b64_tr_b16 a[100:101], v19 offset:0
    v_mfma_f32_16x16x32_bf16 v[220:223], a[132:135], a[188:191], v[220:223]
    buffer_load_dwordx4 v11, s[36:39], s23 offen lds
    v_mfma_f32_16x16x32_bf16 v[72:75], a[160:163], a[136:139], v[72:75]
    ds_read_b64_tr_b16 a[102:103], v19 offset:1024
    v_mfma_f32_16x16x32_bf16 v[104:107], a[164:167], a[136:139], v[104:107]
    s_add_u32 m0, s30, 150528
    v_mfma_f32_16x16x32_bf16 v[136:139], a[168:171], a[136:139], v[136:139]
    ds_read_b64_tr_b16 a[116:117], v19 offset:8192
    v_mfma_f32_16x16x32_bf16 v[168:171], a[172:175], a[136:139], v[168:171]
    s_add_u32 s23, s29, 4030464
    v_mfma_f32_16x16x32_bf16 v[224:227], a[136:139], a[176:179], v[224:227]
    ds_read_b64_tr_b16 a[118:119], v19 offset:9216
    buffer_load_dwordx4 v11, s[36:39], s23 offen lds
    v_mfma_f32_16x16x32_bf16 v[228:231], a[136:139], a[180:183], v[228:231]
    s_add_u32 s76, s72, s75
    v_mfma_f32_16x16x32_bf16 v[232:235], a[136:139], a[184:187], v[232:235]
    ds_read_b128 a[72:75], v12 offset:4096
    v_mfma_f32_16x16x32_bf16 v[236:239], a[136:139], a[188:191], v[236:239]
    s_add_u32 s77, s73, s75
    v_mfma_f32_16x16x32_bf16 v[76:79], a[160:163], a[140:143], v[76:79]
    ds_read_b128 a[76:79], v12 offset:6144
    v_mfma_f32_16x16x32_bf16 v[108:111], a[164:167], a[140:143], v[108:111]
    s_add_u32 s75, s75, 128
    v_mfma_f32_16x16x32_bf16 v[140:143], a[168:171], a[140:143], v[140:143]
    v_mfma_f32_16x16x32_bf16 v[172:175], a[172:175], a[140:143], v[172:175]
    ds_read_b64_tr_b16 a[104:105], v20 offset:0
    v_mfma_f32_16x16x32_bf16 v[240:243], a[140:143], a[176:179], v[240:243]
    s_cmp_eq_u32 s75, 1152
    s_cselect_b32 s75, 0, s75
    v_mfma_f32_16x16x32_bf16 v[244:247], a[140:143], a[180:183], v[244:247]
    ds_read_b64_tr_b16 a[106:107], v20 offset:1024
    s_add_u32 m0, s74, 65536
    v_mfma_f32_16x16x32_bf16 v[248:251], a[140:143], a[184:187], v[248:251]
    v_mfma_f32_16x16x32_bf16 v[252:255], a[140:143], a[188:191], v[252:255]
    ds_read_b64_tr_b16 a[120:121], v20 offset:8192
    s_add_u32 s23, s76, 0
    v_mfma_f32_16x16x32_bf16 v[80:83], a[160:163], a[144:147], v[80:83]
    buffer_load_dwordx4 v30, s[44:47], s23 offen lds
    v_mfma_f32_16x16x32_bf16 v[112:115], a[164:167], a[144:147], v[112:115]
    ds_read_b64_tr_b16 a[122:123], v20 offset:9216
    v_mfma_f32_16x16x32_bf16 v[144:147], a[168:171], a[144:147], v[144:147]
    s_add_u32 m0, s74, 66560
    v_mfma_f32_16x16x32_bf16 v[176:179], a[172:175], a[144:147], v[176:179]
    ds_read_b128 a[80:83], v12 offset:8192
    v_mfma_f32_16x16x32_bf16 a[0:3], a[144:147], a[176:179], a[0:3]
    s_add_u32 s23, s76, 9216
    v_mfma_f32_16x16x32_bf16 a[4:7], a[144:147], a[180:183], a[4:7]
    ds_read_b128 a[84:87], v12 offset:10240
    buffer_load_dwordx4 v31, s[44:47], s23 offen lds
    v_mfma_f32_16x16x32_bf16 a[8:11], a[144:147], a[184:187], a[8:11]
    s_cmp_lg_u32 s22, 0
    s_cbranch_scc1 f1_w0_3
    buffer_load_dword v55, off, s[56:59], s83 sc1
f1_w0_3:
    v_mfma_f32_16x16x32_bf16 a[12:15], a[144:147], a[188:191], a[12:15]
    ds_read_b64_tr_b16 a[108:109], v21 offset:0
    s_add_u32 m0, s74, 67584
    v_mfma_f32_16x16x32_bf16 v[84:87], a[160:163], a[148:151], v[84:87]
    s_add_u32 s23, s76, 73728
    v_mfma_f32_16x16x32_bf16 v[116:119], a[164:167], a[148:151], v[116:119]
    ds_read_b64_tr_b16 a[110:111], v21 offset:1024
    v_mfma_f32_16x16x32_bf16 v[148:151], a[168:171], a[148:151], v[148:151]
    buffer_load_dwordx4 v30, s[44:47], s23 offen lds
    v_mfma_f32_16x16x32_bf16 v[180:183], a[172:175], a[148:151], v[180:183]
    ds_read_b64_tr_b16 a[124:125], v21 offset:8192
    v_mfma_f32_16x16x32_bf16 a[16:19], a[148:151], a[176:179], a[16:19]
    s_add_u32 m0, s74, 68608
    v_mfma_f32_16x16x32_bf16 a[20:23], a[148:151], a[180:183], a[20:23]
    ds_read_b64_tr_b16 a[126:127], v21 offset:9216
    s_add_u32 s23, s76, 82944
    v_mfma_f32_16x16x32_bf16 a[24:27], a[148:151], a[184:187], a[24:27]
    v_mfma_f32_16x16x32_bf16 a[28:31], a[148:151], a[188:191], a[28:31]
    ds_read_b128 a[88:91], v12 offset:12288
    buffer_load_dwordx4 v31, s[44:47], s23 offen lds
    v_mfma_f32_16x16x32_bf16 v[88:91], a[160:163], a[152:155], v[88:91]
    s_add_u32 m0, s74, 69632
    v_mfma_f32_16x16x32_bf16 v[120:123], a[164:167], a[152:155], v[120:123]
    ds_read_b128 a[92:95], v12 offset:14336
    v_mfma_f32_16x16x32_bf16 v[152:155], a[168:171], a[152:155], v[152:155]
    s_add_u32 s23, s77, 0
    v_mfma_f32_16x16x32_bf16 v[184:187], a[172:175], a[152:155], v[184:187]
    buffer_load_dwordx4 v30, s[44:47], s23 offen lds
    v_mfma_f32_16x16x32_bf16 a[32:35], a[152:155], a[176:179], a[32:35]
    s_add_u32 m0, s74, 70656
    v_mfma_f32_16x16x32_bf16 a[36:39], a[152:155], a[180:183], a[36:39]
    v_mfma_f32_16x16x32_bf16 a[40:43], a[152:155], a[184:187], a[40:43]
    s_add_u32 s23, s77, 9216
    v_mfma_f32_16x16x32_bf16 a[44:47], a[152:155], a[188:191], a[44:47]
    buffer_load_dwordx4 v31, s[44:47], s23 offen lds
    v_mfma_f32_16x16x32_bf16 v[92:95], a[160:163], a[156:159], v[92:95]
    s_add_u32 m0, s74, 71680
    v_mfma_f32_16x16x32_bf16 v[124:127], a[164:167], a[156:159], v[124:127]
    s_add_u32 s23, s77, 73728
    v_mfma_f32_16x16x32_bf16 v[156:159], a[168:171], a[156:159], v[156:159]
    buffer_load_dwordx4 v30, s[44:47], s23 offen lds
    v_mfma_f32_16x16x32_bf16 v[188:191], a[172:175], a[156:159], v[188:191]
    v_mfma_f32_16x16x32_bf16 a[48:51], a[156:159], a[176:179], a[48:51]
    s_add_u32 m0, s74, 72704
    v_mfma_f32_16x16x32_bf16 a[52:55], a[156:159], a[180:183], a[52:55]
    s_add_u32 s23, s77, 82944
    v_mfma_f32_16x16x32_bf16 a[56:59], a[156:159], a[184:187], a[56:59]
    buffer_load_dwordx4 v31, s[44:47], s23 offen lds
    v_mfma_f32_16x16x32_bf16 a[60:63], a[156:159], a[188:191], a[60:63]
    s_waitcnt vmcnt(25) lgkmcnt(0)
    v_mfma_f32_16x16x32_bf16 v[64:67], a[96:99], a[64:67], v[64:67]
    s_barrier
    v_mfma_f32_16x16x32_bf16 v[96:99], a[100:103], a[64:67], v[96:99]
    v_mfma_f32_16x16x32_bf16 v[128:131], a[104:107], a[64:67], v[128:131]
    ds_read_b64_tr_b16 a[160:161], v18 offset:16384
    v_mfma_f32_16x16x32_bf16 v[160:163], a[108:111], a[64:67], v[160:163]
    s_add_u32 s82, s11, s79
    v_mfma_f32_16x16x32_bf16 v[192:195], a[64:67], a[112:115], v[192:195]
    ds_read_b64_tr_b16 a[162:163], v18 offset:17408
    v_mfma_f32_16x16x32_bf16 v[196:199], a[64:67], a[116:119], v[196:199]
    s_add_u32 s79, s79, 0x80000
    v_mfma_f32_16x16x32_bf16 v[200:203], a[64:67], a[120:123], v[200:203]
    ds_read_b64_tr_b16 a[176:177], v18 offset:24576
    v_mfma_f32_16x16x32_bf16 v[204:207], a[64:67], a[124:127], v[204:207]
    v_mfma_f32_16x16x32_bf16 v[68:71], a[96:99], a[68:71], v[68:71]
    ds_read_b64_tr_b16 a[178:179], v18 offset:25600
    v_mfma_f32_16x16x32_bf16 v[100:103], a[100:103], a[68:71], v[100:103]
    s_cmp_eq_u32 s79, 4718592
    s_cselect_b32 s79, 0, s79
    v_mfma_f32_16x16x32_bf16 v[132:135], a[104:107], a[68:71], v[132:135]
    ds_read_b128 a[128:131], v13 offset:0
    v_mfma_f32_16x16x32_bf16 v[164:167], a[108:111], a[68:71], v[164:167]
    v_mfma_f32_16x16x32_bf16 v[208:211], a[68:71], a[112:115], v[208:211]
    ds_read_b128 a[132:135], v13 offset:2048
    v_mfma_f32_16x16x32_bf16 v[212:215], a[68:71], a[116:119], v[212:215]
    s_add_u32 m0, s30, 98304
    v_mfma_f32_16x16x32_bf16 v[216:219], a[68:71], a[120:123], v[216:219]
    ds_read_b64_tr_b16 a[164:165], v19 offset:16384
    v_mfma_f32_16x16x32_bf16 v[220:223], a[68:71], a[124:127], v[220:223]
    v_mfma_f32_16x16x32_bf16 v[72:75], a[96:99], a[72:75], v[72:75]
    ds_read_b64_tr_b16 a[166:167], v19 offset:17408
    s_add_u32 s23, s82, 0
    v_mfma_f32_16x16x32_bf16 v[104:107], a[100:103], a[72:75], v[104:107]
    v_mfma_f32_16x16x32_bf16 v[136:139], a[104:107], a[72:75], v[136:139]
    ds_read_b64_tr_b16 a[180:181], v19 offset:24576
    v_mfma_f32_16x16x32_bf16 v[168:171], a[108:111], a[72:75], v[168:171]
    buffer_load_dwordx4 v26, s[52:55], s23 offen lds
    v_mfma_f32_16x16x32_bf16 v[224:227], a[72:75], a[112:115], v[224:227]
    ds_read_b64_tr_b16 a[182:183], v19 offset:25600
    v_mfma_f32_16x16x32_bf16 v[228:231], a[72:75], a[116:119], v[228:231]
    s_add_u32 m0, s30, 99328
    v_mfma_f32_16x16x32_bf16 v[232:235], a[72:75], a[120:123], v[232:235]
    ds_read_b128 a[136:139], v13 offset:4096
    v_mfma_f32_16x16x32_bf16 v[236:239], a[72:75], a[124:127], v[236:239]
    v_mfma_f32_16x16x32_bf16 v[76:79], a[96:99], a[76:79], v[76:79]
    ds_read_b128 a[140:143], v13 offset:6144
    s_add_u32 s23, s82, 32768
    v_mfma_f32_16x16x32_bf16 v[108:111], a[100:103], a[76:79], v[108:111]
    v_mfma_f32_16x16x32_bf16 v[140:143], a[104:107], a[76:79], v[140:143]
    buffer_load_dwordx4 v26, s[52:55], s23 offen lds
    v_mfma_f32_16x16x32_bf16 v[172:175], a[108:111], a[76:79], v[172:175]
    ds_read_b64_tr_b16 a[168:169], v20 offset:16384
    v_mfma_f32_16x16x32_bf16 v[240:243], a[76:79], a[112:115], v[240:243]
    v_mfma_f32_16x16x32_bf16 v[244:247], a[76:79], a[116:119], v[244:247]
    ds_read_b64_tr_b16 a[170:171], v20 offset:17408
    s_add_u32 m0, s30, 100352
    v_mfma_f32_16x16x32_bf16 v[248:251], a[76:79], a[120:123], v[248:251]
    v_mfma_f32_16x16x32_bf16 v[252:255], a[76:79], a[124:127], v[252:255]
    ds_read_b64_tr_b16 a[184:185], v20 offset:24576
    v_mfma_f32_16x16x32_bf16 v[80:83], a[96:99], a[80:83], v[80:83]
    s_add_u32 s23, s82, 65536
    v_mfma_f32_16x16x32_bf16 v[112:115], a[100:103], a[80:83], v[112:115]
    ds_read_b64_tr_b16 a[186:187], v20 offset:25600
    v_mfma_f32_16x16x32_bf16 v[144:147], a[104:107], a[80:83], v[144:147]
    buffer_load_dwordx4 v27, s[52:55], s23 offen lds
    v_mfma_f32_16x16x32_bf16 v[176:179], a[108:111], a[80:83], v[176:179]
    ds_read_b128 a[144:147], v13 offset:8192
    v_mfma_f32_16x16x32_bf16 a[0:3], a[80:83], a[112:115], a[0:3]
    s_add_u32 m0, s30, 101376
    v_mfma_f32_16x16x32_bf16 a[4:7], a[80:83], a[116:119], a[4:7]
    ds_read_b128 a[148:151], v13 offset:10240
    v_mfma_f32_16x16x32_bf16 a[8:11], a[80:83], a[120:123], a[8:11]
    v_mfma_f32_16x16x32_bf16 a[12:15], a[80:83], a[124:127], a[12:15]
    ds_read_b64_tr_b16 a[172:173], v21 offset:16384
    s_add_u32 s23, s82, 98304
    v_mfma_f32_16x16x32_bf16 v[84:87], a[96:99], a[84:87], v[84:87]
    v_mfma_f32_16x16x32_bf16 v[116:119], a[100:103], a[84:87], v[116:119]
    ds_read_b64_tr_b16 a[174:175], v21 offset:17408
    v_mfma_f32_16x16x32_bf16 v[148:151], a[104:107], a[84:87], v[148:151]
    buffer_load_dwordx4 v27, s[52:55], s23 offen lds
    v_mfma_f32_16x16x32_bf16 v[180:183], a[108:111], a[84:87], v[180:183]
    ds_read_b64_tr_b16 a[188:189], v21 offset:24576
    v_mfma_f32_16x16x32_bf16 a[16:19], a[84:87], a[112:115], a[16:19]
    v_mfma_f32_16x16x32_bf16 a[20:23], a[84:87], a[116:119], a[20:23]
    ds_read_b64_tr_b16 a[190:191], v21 offset:25600
    v_mfma_f32_16x16x32_bf16 a[24:27], a[84:87], a[120:123], a[24:27]
    v_mfma_f32_16x16x32_bf16 a[28:31], a[84:87], a[124:127], a[28:31]
    ds_read_b128 a[152:155], v13 offset:12288
    v_mfma_f32_16x16x32_bf16 v[88:91], a[96:99], a[88:91], v[88:91]
    v_mfma_f32_16x16x32_bf16 v[120:123], a[100:103], a[88:91], v[120:123]
    ds_read_b128 a[156:159], v13 offset:14336
    v_mfma_f32_16x16x32_bf16 v[152:155], a[104:107], a[88:91], v[152:155]
    v_mfma_f32_16x16x32_bf16 v[184:187], a[108:111], a[88:91], v[184:187]
    v_mfma_f32_16x16x32_bf16 a[32:35], a[88:91], a[112:115], a[32:35]
    v_mfma_f32_16x16x32_bf16 a[36:39], a[88:91], a[116:119], a[36:39]
    v_mfma_f32_16x16x32_bf16 a[40:43], a[88:91], a[120:123], a[40:43]
    s_cmp_lg_u32 s22, 0
    s_cbranch_scc1 f1_w0_4
    s_waitcnt vmcnt(10)
    v_readfirstlane_b32 s25, v55
    s_nop 0
    s_lshr_b32 s25, s25, s15
    s_bfe_u32 s25, s25, 262152
    s_cmp_ge_u32 s25, 8
    s_cbranch_scc0 f1_pwb
f1_pwb_r:
f1_w0_4:
    v_mfma_f32_16x16x32_bf16 a[44:47], a[88:91], a[124:127], a[44:47]
    v_mfma_f32_16x16x32_bf16 v[92:95], a[96:99], a[92:95], v[92:95]
    v_mfma_f32_16x16x32_bf16 v[124:127], a[100:103], a[92:95], v[124:127]
    v_mfma_f32_16x16x32_bf16 v[156:159], a[104:107], a[92:95], v[156:159]
    v_mfma_f32_16x16x32_bf16 v[188:191], a[108:111], a[92:95], v[188:191]
    v_mfma_f32_16x16x32_bf16 a[48:51], a[92:95], a[112:115], a[48:51]
    v_mfma_f32_16x16x32_bf16 a[52:55], a[92:95], a[116:119], a[52:55]
    v_mfma_f32_16x16x32_bf16 a[56:59], a[92:95], a[120:123], a[56:59]
    v_mfma_f32_16x16x32_bf16 a[60:63], a[92:95], a[124:127], a[60:63]
    s_waitcnt vmcnt(16) lgkmcnt(0)
    v_mfma_f32_16x16x32_bf16 v[64:67], a[160:163], a[128:131], v[64:67]
    s_barrier
    v_mfma_f32_16x16x32_bf16 v[96:99], a[164:167], a[128:131], v[96:99]
    v_mfma_f32_16x16x32_bf16 v[128:131], a[168:171], a[128:131], v[128:131]
    ds_read_b64_tr_b16 a[96:97], v18 offset:32768
    v_mfma_f32_16x16x32_bf16 v[160:163], a[172:175], a[128:131], v[160:163]
    s_add_u32 m0, s10, 0
    v_mfma_f32_16x16x32_bf16 v[192:195], a[128:131], a[176:179], v[192:195]
    ds_read_b64_tr_b16 a[98:99], v18 offset:33792
    s_add_u32 s23, s78, s10
    v_mfma_f32_16x16x32_bf16 v[196:199], a[128:131], a[180:183], v[196:199]
    buffer_load_dwordx4 v29, s[48:51], s23 offen sc1 lds
    v_mfma_f32_16x16x32_bf16 v[200:203], a[128:131], a[184:187], v[200:203]
    ds_read_b64_tr_b16 a[112:113], v18 offset:40960
    v_mfma_f32_16x16x32_bf16 v[204:207], a[128:131], a[188:191], v[204:207]
    s_add_u32 m0, s10, 4096
    v_mfma_f32_16x16x32_bf16 v[68:71], a[160:163], a[132:135], v[68:71]
    ds_read_b64_tr_b16 a[114:115], v18 offset:41984
    v_mfma_f32_16x16x32_bf16 v[100:103], a[164:167], a[132:135], v[100:103]
    s_add_u32 s23, s23, 4096
    v_mfma_f32_16x16x32_bf16 v[132:135], a[168:171], a[132:135], v[132:135]
    ds_read_b128 a[64:67], v14 offset:0
    buffer_load_dwordx4 v29, s[48:51], s23 offen sc1 lds
    v_mfma_f32_16x16x32_bf16 v[164:167], a[172:175], a[132:135], v[164:167]
    s_add_u32 s78, s78, 9216
    v_mfma_f32_16x16x32_bf16 v[208:211], a[132:135], a[176:179], v[208:211]
    ds_read_b128 a[68:71], v14 offset:2048
    v_mfma_f32_16x16x32_bf16 v[212:215], a[132:135], a[180:183], v[212:215]
    s_cmp_eq_u32 s78, 82944
    s_cselect_b32 s78, 0, s78
    v_mfma_f32_16x16x32_bf16 v[216:219], a[132:135], a[184:187], v[216:219]
    ds_read_b64_tr_b16 a[100:101], v19 offset:32768
    v_mfma_f32_16x16x32_bf16 v[220:223], a[132:135], a[188:191], v[220:223]
    v_mfma_f32_16x16x32_bf16 v[72:75], a[160:163], a[136:139], v[72:75]
    ds_read_b64_tr_b16 a[102:103], v19 offset:33792
    v_mfma_f32_16x16x32_bf16 v[104:107], a[164:167], a[136:139], v[104:107]
    v_mfma_f32_16x16x32_bf16 v[136:139], a[168:171], a[136:139], v[136:139]
    ds_read_b64_tr_b16 a[116:117], v19 offset:40960
    v_mfma_f32_16x16x32_bf16 v[168:171], a[172:175], a[136:139], v[168:171]
    s_cmp_lg_u32 s22, 0
    s_cbranch_scc1 f1_wb0
    s_mov_b32 m0, 8192
    s_add_u32 s23, s23, 4096
    buffer_load_dwordx4 v29, s[48:51], s23 offen sc1 lds
f1_wb0:
    v_mfma_f32_16x16x32_bf16 v[224:227], a[136:139], a[176:179], v[224:227]
    ds_read_b64_tr_b16 a[118:119], v19 offset:41984
    v_mfma_f32_16x16x32_bf16 v[228:231], a[136:139], a[180:183], v[228:231]
    v_mfma_f32_16x16x32_bf16 v[232:235], a[136:139], a[184:187], v[232:235]
    ds_read_b128 a[72:75], v14 offset:4096
    v_mfma_f32_16x16x32_bf16 v[236:239], a[136:139], a[188:191], v[236:239]
    s_add_u32 s82, s11, s79
    v_mfma_f32_16x16x32_bf16 v[76:79], a[160:163], a[140:143], v[76:79]
    ds_read_b128 a[76:79], v14 offset:6144
    v_mfma_f32_16x16x32_bf16 v[108:111], a[164:167], a[140:143], v[108:111]
    s_add_u32 s79, s79, 0x80000
    v_mfma_f32_16x16x32_bf16 v[140:143], a[168:171], a[140:143], v[140:143]
    s_cmp_eq_u32 s79, 4718592
    s_cselect_b32 s79, 0, s79
    v_mfma_f32_16x16x32_bf16 v[172:175], a[172:175], a[140:143], v[172:175]
    ds_read_b64_tr_b16 a[104:105], v20 offset:32768
    v_mfma_f32_16x16x32_bf16 v[240:243], a[140:143], a[176:179], v[240:243]
    v_mfma_f32_16x16x32_bf16 v[244:247], a[140:143], a[180:183], v[244:247]
    ds_read_b64_tr_b16 a[106:107], v20 offset:33792
    s_add_u32 m0, s30, 114688
    v_mfma_f32_16x16x32_bf16 v[248:251], a[140:143], a[184:187], v[248:251]
    s_add_u32 s23, s82, 0
    v_mfma_f32_16x16x32_bf16 v[252:255], a[140:143], a[188:191], v[252:255]
    ds_read_b64_tr_b16 a[120:121], v20 offset:40960
    v_mfma_f32_16x16x32_bf16 v[80:83], a[160:163], a[144:147], v[80:83]
    buffer_load_dwordx4 v26, s[52:55], s23 offen lds
    v_mfma_f32_16x16x32_bf16 v[112:115], a[164:167], a[144:147], v[112:115]
    ds_read_b64_tr_b16 a[122:123], v20 offset:41984
    s_add_u32 m0, s30, 115712
    v_mfma_f32_16x16x32_bf16 v[144:147], a[168:171], a[144:147], v[144:147]
    v_mfma_f32_16x16x32_bf16 v[176:179], a[172:175], a[144:147], v[176:179]
    ds_read_b128 a[80:83], v14 offset:8192
    s_add_u32 s23, s82, 32768
    v_mfma_f32_16x16x32_bf16 a[0:3], a[144:147], a[176:179], a[0:3]
    buffer_load_dwordx4 v26, s[52:55], s23 offen lds
    v_mfma_f32_16x16x32_bf16 a[4:7], a[144:147], a[180:183], a[4:7]
    ds_read_b128 a[84:87], v14 offset:10240
    v_mfma_f32_16x16x32_bf16 a[8:11], a[144:147], a[184:187], a[8:11]
    s_add_u32 m0, s30, 116736
    v_mfma_f32_16x16x32_bf16 a[12:15], a[144:147], a[188:191], a[12:15]
    ds_read_b64_tr_b16 a[108:109], v21 offset:32768
    s_add_u32 s23, s82, 65536
    v_mfma_f32_16x16x32_bf16 v[84:87], a[160:163], a[148:151], v[84:87]
    v_mfma_f32_16x16x32_bf16 v[116:119], a[164:167], a[148:151], v[116:119]
    ds_read_b64_tr_b16 a[110:111], v21 offset:33792
    buffer_load_dwordx4 v27, s[52:55], s23 offen lds
    v_mfma_f32_16x16x32_bf16 v[148:151], a[168:171], a[148:151], v[148:151]
    s_add_u32 m0, s30, 117760
    v_mfma_f32_16x16x32_bf16 v[180:183], a[172:175], a[148:151], v[180:183]
    ds_read_b64_tr_b16 a[124:125], v21 offset:40960
    v_mfma_f32_16x16x32_bf16 a[16:19], a[148:151], a[176:179], a[16:19]
    s_add_u32 s23, s82, 98304
    v_mfma_f32_16x16x32_bf16 a[20:23], a[148:151], a[180:183], a[20:23]
    ds_read_b64_tr_b16 a[126:127], v21 offset:41984
    buffer_load_dwordx4 v27, s[52:55], s23 offen lds
    v_mfma_f32_16x16x32_bf16 a[24:27], a[148:151], a[184:187], a[24:27]
    s_add_u32 m0, s10, 9216
    v_mfma_f32_16x16x32_bf16 a[28:31], a[148:151], a[188:191], a[28:31]
    ds_read_b128 a[88:91], v14 offset:12288
    v_mfma_f32_16x16x32_bf16 v[88:91], a[160:163], a[152:155], v[88:91]
    s_add_u32 s23, s78, s10
    v_mfma_f32_16x16x32_bf16 v[120:123], a[164:167], a[152:155], v[120:123]
    ds_read_b128 a[92:95], v14 offset:14336
    v_mfma_f32_16x16x32_bf16 v[152:155], a[168:171], a[152:155], v[152:155]
    buffer_load_dwordx4 v29, s[48:51], s23 offen sc1 lds
    v_mfma_f32_16x16x32_bf16 v[184:187], a[172:175], a[152:155], v[184:187]
    s_add_u32 m0, s10, 13312
    v_mfma_f32_16x16x32_bf16 a[32:35], a[152:155], a[176:179], a[32:35]
    s_add_u32 s23, s23, 4096
    v_mfma_f32_16x16x32_bf16 a[36:39], a[152:155], a[180:183], a[36:39]
    buffer_load_dwordx4 v29, s[48:51], s23 offen sc1 lds
    v_mfma_f32_16x16x32_bf16 a[40:43], a[152:155], a[184:187], a[40:43]
    s_add_u32 s78, s78, 9216
    v_mfma_f32_16x16x32_bf16 a[44:47], a[152:155], a[188:191], a[44:47]
    v_mfma_f32_16x16x32_bf16 v[92:95], a[160:163], a[156:159], v[92:95]
    s_cmp_eq_u32 s78, 82944
    s_cselect_b32 s78, 0, s78
    v_mfma_f32_16x16x32_bf16 v[124:127], a[164:167], a[156:159], v[124:127]
    v_mfma_f32_16x16x32_bf16 v[156:159], a[168:171], a[156:159], v[156:159]
    v_mfma_f32_16x16x32_bf16 v[188:191], a[172:175], a[156:159], v[188:191]
    v_mfma_f32_16x16x32_bf16 a[48:51], a[156:159], a[176:179], a[48:51]
    s_cmp_lg_u32 s22, 0
    s_cbranch_scc1 f1_wb1
    s_mov_b32 m0, 17408
    s_add_u32 s23, s23, 4096
    buffer_load_dwordx4 v29, s[48:51], s23 offen sc1 lds
f1_wb1:
    v_mfma_f32_16x16x32_bf16 a[52:55], a[156:159], a[180:183], a[52:55]
    v_mfma_f32_16x16x32_bf16 a[56:59], a[156:159], a[184:187], a[56:59]
    v_mfma_f32_16x16x32_bf16 a[60:63], a[156:159], a[188:191], a[60:63]
    s_waitcnt vmcnt(20) lgkmcnt(0)
    v_mfma_f32_16x16x32_bf16 v[64:67], a[96:99], a[64:67], v[64:67]
    s_barrier
    v_mfma_f32_16x16x32_bf16 v[96:99], a[100:103], a[64:67], v[96:99]
    v_mfma_f32_16x16x32_bf16 v[128:131], a[104:107], a[64:67], v[128:131]
    ds_read_b64_tr_b16 a[160:161], v18 offset:49152
    s_waitcnt vmcnt(12)
    v_mfma_f32_16x16x32_bf16 v[160:163], a[108:111], a[64:67], v[160:163]
    ds_read_b128 a[192:195], v32 offset:0
    v_mfma_f32_16x16x32_bf16 v[192:195], a[64:67], a[112:115], v[192:195]
    ds_read_b64_tr_b16 a[162:163], v18 offset:50176
    ds_read_b128 a[196:199], v32 offset:2048
    v_mfma_f32_16x16x32_bf16 v[196:199], a[64:67], a[116:119], v[196:199]
    ds_read_b128 a[200:203], v32 offset:4096
    v_mfma_f32_16x16x32_bf16 v[200:203], a[64:67], a[120:123], v[200:203]
    ds_read_b64_tr_b16 a[176:177], v18 offset:57344
    ds_read_b128 a[204:207], v32 offset:6144
    v_mfma_f32_16x16x32_bf16 v[204:207], a[64:67], a[124:127], v[204:207]
    ds_read_b128 a[208:211], v33 offset:0
    v_mfma_f32_16x16x32_bf16 v[68:71], a[96:99], a[68:71], v[68:71]
    ds_read_b64_tr_b16 a[178:179], v18 offset:58368
    ds_read_b128 a[212:215], v33 offset:2048
    v_mfma_f32_16x16x32_bf16 v[100:103], a[100:103], a[68:71], v[100:103]
    ds_read_b128 a[216:219], v33 offset:4096
    v_mfma_f32_16x16x32_bf16 v[132:135], a[104:107], a[68:71], v[132:135]
    ds_read_b128 a[128:131], v15 offset:0
    ds_read_b128 a[220:223], v33 offset:6144
    v_mfma_f32_16x16x32_bf16 v[164:167], a[108:111], a[68:71], v[164:167]
    s_waitcnt lgkmcnt(0)
    s_add_u32 s76, s72, s75
    v_mfma_f32_16x16x32_bf16 v[208:211], a[68:71], a[112:115], v[208:211]
    ds_read_b128 a[132:135], v15 offset:2048
    v_mfma_f32_16x16x32_bf16 v[212:215], a[68:71], a[116:119], v[212:215]
    s_add_u32 s77, s73, s75
    s_add_u32 s75, s75, 128
    v_mfma_f32_16x16x32_bf16 v[216:219], a[68:71], a[120:123], v[216:219]
    ds_read_b64_tr_b16 a[164:165], v19 offset:49152
    v_mfma_f32_16x16x32_bf16 v[220:223], a[68:71], a[124:127], v[220:223]
    s_cmp_eq_u32 s75, 1152
    s_cselect_b32 s75, 0, s75
    v_mfma_f32_16x16x32_bf16 v[72:75], a[96:99], a[72:75], v[72:75]
    ds_read_b64_tr_b16 a[166:167], v19 offset:50176
    v_mfma_f32_16x16x32_bf16 v[104:107], a[100:103], a[72:75], v[104:107]
    s_add_u32 m0, s74, 65536
    s_add_u32 s23, s76, 0
    v_mfma_f32_16x16x32_bf16 v[136:139], a[104:107], a[72:75], v[136:139]
    ds_read_b64_tr_b16 a[180:181], v19 offset:57344
    buffer_load_dwordx4 v30, s[44:47], s23 offen lds
    v_mfma_f32_16x16x32_bf16 v[168:171], a[108:111], a[72:75], v[168:171]
    s_add_u32 m0, s74, 66560
    v_mfma_f32_16x16x32_bf16 v[224:227], a[72:75], a[112:115], v[224:227]
    ds_read_b64_tr_b16 a[182:183], v19 offset:58368
    s_add_u32 s23, s76, 9216
    v_mfma_f32_16x16x32_bf16 v[228:231], a[72:75], a[116:119], v[228:231]
    buffer_load_dwordx4 v31, s[44:47], s23 offen lds
    v_mfma_f32_16x16x32_bf16 v[232:235], a[72:75], a[120:123], v[232:235]
    ds_read_b128 a[136:139], v15 offset:4096
    s_add_u32 m0, s74, 67584
    v_mfma_f32_16x16x32_bf16 v[236:239], a[72:75], a[124:127], v[236:239]
    s_add_u32 s23, s76, 73728
    v_mfma_f32_16x16x32_bf16 v[76:79], a[96:99], a[76:79], v[76:79]
    ds_read_b128 a[140:143], v15 offset:6144
    buffer_load_dwordx4 v30, s[44:47], s23 offen lds
    v_mfma_f32_16x16x32_bf16 v[108:111], a[100:103], a[76:79], v[108:111]
    s_add_u32 m0, s74, 68608
    v_mfma_f32_16x16x32_bf16 v[140:143], a[104:107], a[76:79], v[140:143]
    s_add_u32 s23, s76, 82944
    buffer_load_dwordx4 v31, s[44:47], s23 offen lds
    v_mfma_f32_16x16x32_bf16 v[172:175], a[108:111], a[76:79], v[172:175]
    ds_read_b64_tr_b16 a[168:169], v20 offset:49152
    v_mfma_f32_16x16x32_bf16 v[240:243], a[76:79], a[112:115], v[240:243]
    s_add_u32 m0, s74, 69632
    s_add_u32 s23, s77, 0
    v_mfma_f32_16x16x32_bf16 v[244:247], a[76:79], a[116:119], v[244:247]
    ds_read_b64_tr_b16 a[170:171], v20 offset:50176
    buffer_load_dwordx4 v30, s[44:47], s23 offen lds
    v_mfma_f32_16x16x32_bf16 v[248:251], a[76:79], a[120:123], v[248:251]
    s_add_u32 m0, s74, 70656
    v_mfma_f32_16x16x32_bf16 v[252:255], a[76:79], a[124:127], v[252:255]
    ds_read_b64_tr_b16 a[184:185], v20 offset:57344
    s_add_u32 s23, s77, 9216
    v_mfma_f32_16x16x32_bf16 v[80:83], a[96:99], a[80:83], v[80:83]
    buffer_load_dwordx4 v31, s[44:47], s23 offen lds
    v_mfma_f32_16x16x32_bf16 v[112:115], a[100:103], a[80:83], v[112:115]
    ds_read_b64_tr_b16 a[186:187], v20 offset:58368
    s_add_u32 m0, s74, 71680
    v_mfma_f32_16x16x32_bf16 v[144:147], a[104:107], a[80:83], v[144:147]
    s_add_u32 s23, s77, 73728
    v_mfma_f32_16x16x32_bf16 v[176:179], a[108:111], a[80:83], v[176:179]
    ds_read_b128 a[144:147], v15 offset:8192
    buffer_load_dwordx4 v30, s[44:47], s23 offen lds
    v_mfma_f32_16x16x32_bf16 a[0:3], a[80:83], a[112:115], a[0:3]
    s_add_u32 m0, s74, 72704
    v_mfma_f32_16x16x32_bf16 a[4:7], a[80:83], a[116:119], a[4:7]
    ds_read_b128 a[148:151], v15 offset:10240
    s_add_u32 s23, s77, 82944
    v_mfma_f32_16x16x32_bf16 a[8:11], a[80:83], a[120:123], a[8:11]
    buffer_load_dwordx4 v31, s[44:47], s23 offen lds
    v_mfma_f32_16x16x32_bf16 a[12:15], a[80:83], a[124:127], a[12:15]
    ds_read_b64_tr_b16 a[172:173], v21 offset:49152
    s_add_u32 s82, s11, s79
    v_mfma_f32_16x16x32_bf16 v[84:87], a[96:99], a[84:87], v[84:87]
    s_add_u32 s79, s79, 0x80000
    v_mfma_f32_16x16x32_bf16 v[116:119], a[100:103], a[84:87], v[116:119]
    ds_read_b64_tr_b16 a[174:175], v21 offset:50176
    v_mfma_f32_16x16x32_bf16 v[148:151], a[104:107], a[84:87], v[148:151]
    s_cmp_eq_u32 s79, 4718592
    s_cselect_b32 s79, 0, s79
    v_mfma_f32_16x16x32_bf16 v[180:183], a[108:111], a[84:87], v[180:183]
    ds_read_b64_tr_b16 a[188:189], v21 offset:57344
    s_add_u32 m0, s30, 131072
    v_mfma_f32_16x16x32_bf16 a[16:19], a[84:87], a[112:115], a[16:19]
    s_add_u32 s23, s82, 0
    buffer_load_dwordx4 v26, s[52:55], s23 offen lds
    v_mfma_f32_16x16x32_bf16 a[20:23], a[84:87], a[116:119], a[20:23]
    ds_read_b64_tr_b16 a[190:191], v21 offset:58368
    v_mfma_f32_16x16x32_bf16 a[24:27], a[84:87], a[120:123], a[24:27]
    s_add_u32 m0, s30, 132096
    s_add_u32 s23, s82, 32768
    v_mfma_f32_16x16x32_bf16 a[28:31], a[84:87], a[124:127], a[28:31]
    ds_read_b128 a[152:155], v15 offset:12288
    buffer_load_dwordx4 v26, s[52:55], s23 offen lds
    v_mfma_f32_16x16x32_bf16 v[88:91], a[96:99], a[88:91], v[88:91]
    s_add_u32 m0, s30, 133120
    v_mfma_f32_16x16x32_bf16 v[120:123], a[100:103], a[88:91], v[120:123]
    ds_read_b128 a[156:159], v15 offset:14336
    s_add_u32 s23, s82, 65536
    v_mfma_f32_16x16x32_bf16 v[152:155], a[104:107], a[88:91], v[152:155]
    buffer_load_dwordx4 v27, s[52:55], s23 offen lds
    v_mfma_f32_16x16x32_bf16 v[184:187], a[108:111], a[88:91], v[184:187]
    s_add_u32 m0, s30, 134144
    s_add_u32 s23, s82, 98304
    v_mfma_f32_16x16x32_bf16 a[32:35], a[88:91], a[112:115], a[32:35]
    buffer_load_dwordx4 v27, s[52:55], s23 offen lds
    v_mfma_f32_16x16x32_bf16 a[36:39], a[88:91], a[116:119], a[36:39]
    s_add_u32 m0, s10, 18432
    v_mfma_f32_16x16x32_bf16 a[40:43], a[88:91], a[120:123], a[40:43]
    s_add_u32 s23, s78, s10
    buffer_load_dwordx4 v29, s[48:51], s23 offen sc1 lds
    v_mfma_f32_16x16x32_bf16 a[44:47], a[88:91], a[124:127], a[44:47]
    s_add_u32 m0, s10, 22528
    v_mfma_f32_16x16x32_bf16 v[92:95], a[96:99], a[92:95], v[92:95]
    s_add_u32 s23, s23, 4096
    buffer_load_dwordx4 v29, s[48:51], s23 offen sc1 lds
    v_mfma_f32_16x16x32_bf16 v[124:127], a[100:103], a[92:95], v[124:127]
    s_add_u32 s78, s78, 9216
    v_mfma_f32_16x16x32_bf16 v[156:159], a[104:107], a[92:95], v[156:159]
    s_cmp_eq_u32 s78, 82944
    s_cselect_b32 s78, 0, s78
    v_mfma_f32_16x16x32_bf16 v[188:191], a[108:111], a[92:95], v[188:191]
    v_mfma_f32_16x16x32_bf16 a[48:51], a[92:95], a[112:115], a[48:51]
    v_mfma_f32_16x16x32_bf16 a[52:55], a[92:95], a[116:119], a[52:55]
    s_cmp_lg_u32 s22, 0
    s_cbranch_scc1 f1_wb2
    s_mov_b32 m0, 26624
    s_add_u32 s23, s23, 4096
    buffer_load_dwordx4 v29, s[48:51], s23 offen sc1 lds
f1_wb2:
    v_mfma_f32_16x16x32_bf16 a[56:59], a[92:95], a[120:123], a[56:59]
    v_mfma_f32_16x16x32_bf16 a[60:63], a[92:95], a[124:127], a[60:63]
    s_waitcnt lgkmcnt(0)
    v_mfma_f32_16x16x32_bf16 v[64:67], a[160:163], a[128:131], v[64:67]
    s_barrier
    v_mfma_f32_16x16x32_bf16 v[96:99], a[164:167], a[128:131], v[96:99]
    v_mfma_f32_16x16x32_bf16 v[68:71], a[160:163], a[132:135], v[68:71]
    ds_write_b32 v53, v52
    v_mfma_f32_16x16x32_bf16 v[100:103], a[164:167], a[132:135], v[100:103]
    v_mfma_f32_16x16x32_bf16 v[72:75], a[160:163], a[136:139], v[72:75]
    v_xor_b32 v25, 0x80008000, v52
    v_mfma_f32_16x16x32_bf16 v[104:107], a[164:167], a[136:139], v[104:107]
    v_mfma_f32_16x16x32_bf16 v[76:79], a[160:163], a[140:143], v[76:79]
    v_mov_b32 v24, 0
    v_mfma_f32_16x16x32_bf16 v[108:111], a[164:167], a[140:143], v[108:111]
    v_mfma_f32_16x16x32_bf16 v[80:83], a[160:163], a[144:147], v[80:83]
    ds_write_b32 v53, v25 offset:1152
    v_mfma_f32_16x16x32_bf16 v[112:115], a[164:167], a[144:147], v[112:115]
    ds_write_b32 v54, v24
    v_mfma_f32_16x16x32_bf16 v[84:87], a[160:163], a[148:151], v[84:87]
    v_mfma_f32_16x16x32_bf16 v[116:119], a[164:167], a[148:151], v[116:119]
    ds_write_b32 v54, v24 offset:1152
    v_mfma_f32_16x16x32_bf16 v[88:91], a[160:163], a[152:155], v[88:91]
    v_cvt_pk_bf16_f32 v64, v64, v65
    v_cvt_pk_bf16_f32 v65, v66, v67
    v_mfma_f32_16x16x32_bf16 v[120:123], a[164:167], a[152:155], v[120:123]
    s_add_u32 s76, s72, s75
    v_cvt_pk_bf16_f32 v66, v96, v97
    v_cvt_pk_bf16_f32 v67, v98, v99
    v_mfma_f32_16x16x32_bf16 v[92:95], a[160:163], a[156:159], v[92:95]
    v_cvt_pk_bf16_f32 v68, v68, v69
    v_cvt_pk_bf16_f32 v69, v70, v71
    v_mfma_f32_16x16x32_bf16 v[124:127], a[164:167], a[156:159], v[124:127]
    s_add_u32 s77, s73, s75
    v_cvt_pk_bf16_f32 v70, v100, v101
    v_mfma_f32_16x16x32_bf16 v[128:131], a[168:171], a[128:131], v[128:131]
    s_add_u32 s75, s75, 128
    v_cvt_pk_bf16_f32 v71, v102, v103
    v_cvt_pk_bf16_f32 v72, v72, v73
    v_mfma_f32_16x16x32_bf16 v[160:163], a[172:175], a[128:131], v[160:163]
    v_cvt_pk_bf16_f32 v73, v74, v75
    v_cvt_pk_bf16_f32 v74, v104, v105
    v_mfma_f32_16x16x32_bf16 v[132:135], a[168:171], a[132:135], v[132:135]
    v_cvt_pk_bf16_f32 v75, v106, v107
    v_cvt_pk_bf16_f32 v76, v76, v77
    v_mfma_f32_16x16x32_bf16 v[164:167], a[172:175], a[132:135], v[164:167]
    s_cmp_eq_u32 s75, 1152
    s_cselect_b32 s75, 0, s75
    v_cvt_pk_bf16_f32 v77, v78, v79
    v_mfma_f32_16x16x32_bf16 v[136:139], a[168:171], a[136:139], v[136:139]
    v_cvt_pk_bf16_f32 v78, v108, v109
    v_cvt_pk_bf16_f32 v79, v110, v111
    v_mfma_f32_16x16x32_bf16 v[168:171], a[172:175], a[136:139], v[168:171]
    v_cvt_pk_bf16_f32 v80, v80, v81
    v_cvt_pk_bf16_f32 v81, v82, v83
    v_mfma_f32_16x16x32_bf16 v[140:143], a[168:171], a[140:143], v[140:143]
    s_add_u32 m0, s74, 32768
    v_cvt_pk_bf16_f32 v82, v112, v113
    v_cvt_pk_bf16_f32 v83, v114, v115
    v_mfma_f32_16x16x32_bf16 v[172:175], a[172:175], a[140:143], v[172:175]
    s_add_u32 s23, s76, 0
    v_cvt_pk_bf16_f32 v84, v84, v85
    v_mfma_f32_16x16x32_bf16 v[144:147], a[168:171], a[144:147], v[144:147]
    v_cvt_pk_bf16_f32 v85, v86, v87
    v_cvt_pk_bf16_f32 v86, v116, v117
    v_mfma_f32_16x16x32_bf16 v[176:179], a[172:175], a[144:147], v[176:179]
    buffer_load_dwordx4 v30, s[44:47], s23 offen lds
    v_cvt_pk_bf16_f32 v87, v118, v119
    v_cvt_pk_bf16_f32 v88, v88, v89
    v_mfma_f32_16x16x32_bf16 v[148:151], a[168:171], a[148:151], v[148:151]
    v_cvt_pk_bf16_f32 v89, v90, v91
    v_cvt_pk_bf16_f32 v90, v120, v121
    v_mfma_f32_16x16x32_bf16 v[180:183], a[172:175], a[148:151], v[180:183]
    s_add_u32 m0, s74, 33792
    v_cvt_pk_bf16_f32 v91, v122, v123
    v_mfma_f32_16x16x32_bf16 v[152:155], a[168:171], a[152:155], v[152:155]
    v_cvt_pk_bf16_f32 v92, v92, v93
    v_cvt_pk_bf16_f32 v93, v94, v95
    v_mfma_f32_16x16x32_bf16 v[184:187], a[172:175], a[152:155], v[184:187]
    s_add_u32 s23, s76, 9216
    v_cvt_pk_bf16_f32 v94, v124, v125
    v_cvt_pk_bf16_f32 v95, v126, v127
    v_mfma_f32_16x16x32_bf16 v[156:159], a[168:171], a[156:159], v[156:159]
    buffer_load_dwordx4 v31, s[44:47], s23 offen lds
    s_add_u32 s24, s31, 0
    v_mfma_f32_16x16x32_bf16 v[188:191], a[172:175], a[156:159], v[188:191]
    buffer_store_dwordx4 v[64:67], v29, s[40:43], s24 offen offset:0
    v_cvt_pk_bf16_f32 v128, v128, v129
    v_mfma_f32_16x16x32_bf16 a[0:3], a[144:147], a[176:179], a[0:3]
    s_add_u32 m0, s74, 34816
    v_cvt_pk_bf16_f32 v129, v130, v131
    v_cvt_pk_bf16_f32 v130, v160, v161
    v_mfma_f32_16x16x32_bf16 a[4:7], a[144:147], a[180:183], a[4:7]
    v_cvt_pk_bf16_f32 v131, v162, v163
    v_cvt_pk_bf16_f32 v132, v132, v133
    v_mfma_f32_16x16x32_bf16 a[8:11], a[144:147], a[184:187], a[8:11]
    s_add_u32 s23, s76, 73728
    v_cvt_pk_bf16_f32 v133, v134, v135
    v_cvt_pk_bf16_f32 v134, v164, v165
    v_mfma_f32_16x16x32_bf16 a[12:15], a[144:147], a[188:191], a[12:15]
    buffer_load_dwordx4 v30, s[44:47], s23 offen lds
    v_cvt_pk_bf16_f32 v135, v166, v167
    v_mfma_f32_16x16x32_bf16 a[16:19], a[148:151], a[176:179], a[16:19]
    v_cvt_pk_bf16_f32 v136, v136, v137
    v_cvt_pk_bf16_f32 v137, v138, v139
    v_mfma_f32_16x16x32_bf16 a[20:23], a[148:151], a[180:183], a[20:23]
    s_add_u32 m0, s74, 35840
    v_cvt_pk_bf16_f32 v138, v168, v169
    v_cvt_pk_bf16_f32 v139, v170, v171
    v_mfma_f32_16x16x32_bf16 a[24:27], a[148:151], a[184:187], a[24:27]
    v_cvt_pk_bf16_f32 v140, v140, v141
    v_cvt_pk_bf16_f32 v141, v142, v143
    v_mfma_f32_16x16x32_bf16 a[28:31], a[148:151], a[188:191], a[28:31]
    s_add_u32 s23, s76, 82944
    v_cvt_pk_bf16_f32 v142, v172, v173
    v_mfma_f32_16x16x32_bf16 a[32:35], a[152:155], a[176:179], a[32:35]
    v_cvt_pk_bf16_f32 v143, v174, v175
    v_cvt_pk_bf16_f32 v144, v144, v145
    v_mfma_f32_16x16x32_bf16 a[36:39], a[152:155], a[180:183], a[36:39]
    buffer_load_dwordx4 v31, s[44:47], s23 offen lds
    v_cvt_pk_bf16_f32 v145, v146, v147
    v_cvt_pk_bf16_f32 v146, v176, v177
    v_mfma_f32_16x16x32_bf16 a[40:43], a[152:155], a[184:187], a[40:43]
    s_add_u32 m0, s74, 36864
    v_cvt_pk_bf16_f32 v147, v178, v179
    v_mfma_f32_16x16x32_bf16 a[44:47], a[152:155], a[188:191], a[44:47]
    v_cvt_pk_bf16_f32 v148, v148, v149
    v_cvt_pk_bf16_f32 v149, v150, v151
    v_cvt_pk_bf16_f32 v150, v180, v181
    v_mfma_f32_16x16x32_bf16 a[48:51], a[156:159], a[176:179], a[48:51]
    s_add_u32 s23, s77, 0
    v_cvt_pk_bf16_f32 v151, v182, v183
    v_mfma_f32_16x16x32_bf16 a[52:55], a[156:159], a[180:183], a[52:55]
    v_cvt_pk_bf16_f32 v152, v152, v153
    v_cvt_pk_bf16_f32 v153, v154, v155
    v_mfma_f32_16x16x32_bf16 a[56:59], a[156:159], a[184:187], a[56:59]
    buffer_load_dwordx4 v30, s[44:47], s23 offen lds
    v_cvt_pk_bf16_f32 v154, v184, v185
    v_cvt_pk_bf16_f32 v155, v186, v187
    v_mfma_f32_16x16x32_bf16 a[60:63], a[156:159], a[188:191], a[60:63]
    v_cvt_pk_bf16_f32 v156, v156, v157
    v_cvt_pk_bf16_f32 v157, v158, v159
    v_mfma_f32_16x16x32_bf16 v[192:195], a[128:131], a[176:179], v[192:195]
    s_add_u32 m0, s74, 37888
    v_cvt_pk_bf16_f32 v158, v188, v189
    v_mfma_f32_16x16x32_bf16 v[196:199], a[128:131], a[180:183], v[196:199]
    s_add_u32 s23, s77, 9216
    v_cvt_pk_bf16_f32 v159, v190, v191
    s_add_u32 s24, s31, 4096
    v_mfma_f32_16x16x32_bf16 v[200:203], a[128:131], a[184:187], v[200:203]
    buffer_store_dwordx4 v[68:71], v29, s[40:43], s24 offen offset:0
    v_accvgpr_read_b32 v56, a0
    v_mfma_f32_16x16x32_bf16 v[204:207], a[128:131], a[188:191], v[204:207]
    buffer_load_dwordx4 v31, s[44:47], s23 offen lds
    v_accvgpr_read_b32 v57, a1
    v_mfma_f32_16x16x32_bf16 v[208:211], a[132:135], a[176:179], v[208:211]
    v_cvt_pk_bf16_f32 v96, v56, v57
    v_accvgpr_read_b32 v58, a2
    v_mfma_f32_16x16x32_bf16 v[212:215], a[132:135], a[180:183], v[212:215]
    s_add_u32 m0, s74, 38912
    v_accvgpr_read_b32 v59, a3
    v_cvt_pk_bf16_f32 v97, v58, v59
    v_mfma_f32_16x16x32_bf16 v[216:219], a[132:135], a[184:187], v[216:219]
    v_accvgpr_read_b32 v60, a16
    v_accvgpr_read_b32 v61, a17
    v_mfma_f32_16x16x32_bf16 v[220:223], a[132:135], a[188:191], v[220:223]
    s_add_u32 s23, s77, 73728
    v_cvt_pk_bf16_f32 v98, v60, v61
    v_accvgpr_read_b32 v62, a18
    v_mfma_f32_16x16x32_bf16 v[224:227], a[136:139], a[176:179], v[224:227]
    buffer_load_dwordx4 v30, s[44:47], s23 offen lds
    v_accvgpr_read_b32 v63, a19
    v_mfma_f32_16x16x32_bf16 v[228:231], a[136:139], a[180:183], v[228:231]
    v_cvt_pk_bf16_f32 v99, v62, v63
    v_accvgpr_read_b32 v56, a4
    v_mfma_f32_16x16x32_bf16 v[232:235], a[136:139], a[184:187], v[232:235]
    s_add_u32 m0, s74, 39936
    v_accvgpr_read_b32 v57, a5
    v_cvt_pk_bf16_f32 v100, v56, v57
    v_mfma_f32_16x16x32_bf16 v[236:239], a[136:139], a[188:191], v[236:239]
    v_accvgpr_read_b32 v58, a6
    v_accvgpr_read_b32 v59, a7
    v_mfma_f32_16x16x32_bf16 v[240:243], a[140:143], a[176:179], v[240:243]
    s_add_u32 s23, s77, 82944
    v_cvt_pk_bf16_f32 v101, v58, v59
    v_mfma_f32_16x16x32_bf16 v[244:247], a[140:143], a[180:183], v[244:247]
    v_accvgpr_read_b32 v60, a20
    v_accvgpr_read_b32 v61, a21
    v_mfma_f32_16x16x32_bf16 v[248:251], a[140:143], a[184:187], v[248:251]
    buffer_load_dwordx4 v31, s[44:47], s23 offen lds
    v_cvt_pk_bf16_f32 v102, v60, v61
    v_accvgpr_read_b32 v62, a22
    v_mfma_f32_16x16x32_bf16 v[252:255], a[140:143], a[188:191], v[252:255]
    v_accvgpr_read_b32 v63, a23
    v_cvt_pk_bf16_f32 v103, v62, v63
    s_waitcnt vmcnt(30) lgkmcnt(0)
    s_barrier
    ds_read_b64_tr_b16 a[64:65], v36 offset:0
    ds_read_b64_tr_b16 a[66:67], v36 offset:1024
    ds_read_b64_tr_b16 a[68:69], v37 offset:0
    ds_read_b64_tr_b16 a[70:71], v37 offset:1024
    ds_read_b64_tr_b16 a[72:73], v38 offset:0
    ds_read_b64_tr_b16 a[74:75], v38 offset:1024
    ds_read_b64_tr_b16 a[76:77], v39 offset:0
    ds_read_b64_tr_b16 a[78:79], v39 offset:1024
    ds_read_b64_tr_b16 a[80:81], v40 offset:0
    ds_read_b64_tr_b16 a[82:83], v40 offset:1024
    ds_read_b64_tr_b16 a[84:85], v41 offset:0
    ds_read_b64_tr_b16 a[86:87], v41 offset:1024
    ds_read_b64_tr_b16 a[88:89], v42 offset:0
    ds_read_b64_tr_b16 a[90:91], v42 offset:1024
    ds_read_b64_tr_b16 a[92:93], v43 offset:0
    ds_read_b64_tr_b16 a[94:95], v43 offset:1024
    ds_read_b64_tr_b16 a[96:97], v44 offset:0
    ds_read_b64_tr_b16 a[98:99], v44 offset:144
    ds_read_b64_tr_b16 a[100:101], v45 offset:0
    ds_read_b64_tr_b16 a[102:103], v45 offset:144
    ds_read_b64_tr_b16 a[104:105], v46 offset:0
    ds_read_b64_tr_b16 a[106:107], v46 offset:144
    ds_read_b64_tr_b16 a[108:109], v47 offset:0
    ds_read_b64_tr_b16 a[110:111], v47 offset:144
    v_accvgpr_read_b32 v56, a8
    v_accvgpr_read_b32 v57, a9
    v_cvt_pk_bf16_f32 v104, v56, v57
    v_accvgpr_read_b32 v58, a10
    v_accvgpr_read_b32 v59, a11
    v_cvt_pk_bf16_f32 v105, v58, v59
    v_accvgpr_read_b32 v60, a24
    v_accvgpr_read_b32 v61, a25
    v_cvt_pk_bf16_f32 v106, v60, v61
    v_accvgpr_read_b32 v62, a26
    v_accvgpr_read_b32 v63, a27
    v_cvt_pk_bf16_f32 v107, v62, v63
    v_accvgpr_read_b32 v56, a12
    v_accvgpr_read_b32 v57, a13
    v_cvt_pk_bf16_f32 v108, v56, v57
    v_accvgpr_read_b32 v58, a14
    v_accvgpr_read_b32 v59, a15
    v_cvt_pk_bf16_f32 v109, v58, v59
    v_accvgpr_read_b32 v60, a28
    v_accvgpr_read_b32 v61, a29
    v_cvt_pk_bf16_f32 v110, v60, v61
    v_accvgpr_read_b32 v62, a30
    v_accvgpr_read_b32 v63, a31
    v_cvt_pk_bf16_f32 v111, v62, v63
    v_accvgpr_read_b32 v56, a32
    v_accvgpr_read_b32 v57, a33
    v_cvt_pk_bf16_f32 v112, v56, v57
    v_accvgpr_read_b32 v58, a34
    v_accvgpr_read_b32 v59, a35
    v_cvt_pk_bf16_f32 v113, v58, v59
    v_accvgpr_read_b32 v60, a48
    v_accvgpr_read_b32 v61, a49
    s_waitcnt lgkmcnt(15)
    v_mfma_f32_16x16x32_bf16 a[112:115], a[64:67], a[192:195], 0
    v_cvt_pk_bf16_f32 v114, v60, v61
    v_accvgpr_read_b32 v62, a50
    v_accvgpr_read_b32 v63, a51
    v_mfma_f32_16x16x32_bf16 a[116:119], a[64:67], a[196:199], 0
    v_cvt_pk_bf16_f32 v115, v62, v63
    v_accvgpr_read_b32 v56, a36
    v_accvgpr_read_b32 v57, a37
    v_mfma_f32_16x16x32_bf16 a[120:123], a[68:71], a[192:195], 0
    v_cvt_pk_bf16_f32 v116, v56, v57
    v_accvgpr_read_b32 v58, a38
    v_accvgpr_read_b32 v59, a39
    v_mfma_f32_16x16x32_bf16 a[124:127], a[68:71], a[196:199], 0
    v_cvt_pk_bf16_f32 v117, v58, v59
    v_accvgpr_read_b32 v60, a52
    v_accvgpr_read_b32 v61, a53
    v_mfma_f32_16x16x32_bf16 a[128:131], a[72:75], a[192:195], 0
    v_cvt_pk_bf16_f32 v118, v60, v61
    v_accvgpr_read_b32 v62, a54
    v_accvgpr_read_b32 v63, a55
    v_mfma_f32_16x16x32_bf16 a[132:135], a[72:75], a[196:199], 0
    s_waitcnt lgkmcnt(12)
    v_cvt_pk_bf16_f32 v119, v62, v63
    v_accvgpr_read_b32 v56, a40
    v_mfma_f32_16x16x32_bf16 a[136:139], a[76:79], a[192:195], 0
    v_accvgpr_read_b32 v57, a41
    v_cvt_pk_bf16_f32 v120, v56, v57
    v_accvgpr_read_b32 v58, a42
    v_mfma_f32_16x16x32_bf16 a[140:143], a[76:79], a[196:199], 0
    s_waitcnt lgkmcnt(0)
    v_accvgpr_read_b32 v59, a43
    v_mfma_f32_16x16x32_bf16 a[144:147], a[80:83], a[192:195], 0
    s_barrier
    v_cvt_pk_bf16_f32 v121, v58, v59
    v_accvgpr_read_b32 v60, a56
    v_mfma_f32_16x16x32_bf16 a[148:151], a[80:83], a[196:199], 0
    v_accvgpr_read_b32 v61, a57
    v_cvt_pk_bf16_f32 v122, v60, v61
    v_accvgpr_read_b32 v62, a58
    v_mfma_f32_16x16x32_bf16 a[152:155], a[84:87], a[192:195], 0
    v_accvgpr_read_b32 v63, a59
    v_cvt_pk_bf16_f32 v123, v62, v63
    v_accvgpr_read_b32 v56, a44
    v_mfma_f32_16x16x32_bf16 a[156:159], a[84:87], a[196:199], 0
    v_accvgpr_read_b32 v57, a45
    v_cvt_pk_bf16_f32 v124, v56, v57
    v_mfma_f32_16x16x32_bf16 a[160:163], a[88:91], a[192:195], 0
    v_accvgpr_read_b32 v58, a46
    v_accvgpr_read_b32 v59, a47
    v_cvt_pk_bf16_f32 v125, v58, v59
    v_mfma_f32_16x16x32_bf16 a[164:167], a[88:91], a[196:199], 0
    v_accvgpr_read_b32 v60, a60
    v_accvgpr_read_b32 v61, a61
    v_cvt_pk_bf16_f32 v126, v60, v61
    v_mfma_f32_16x16x32_bf16 a[168:171], a[92:95], a[192:195], 0
    v_accvgpr_read_b32 v62, a62
    v_accvgpr_read_b32 v63, a63
    v_cvt_pk_bf16_f32 v127, v62, v63
    v_mfma_f32_16x16x32_bf16 a[172:175], a[92:95], a[196:199], 0
    s_waitcnt vmcnt(16)
    ds_read_b128 a[224:227], v32 offset:0
    v_mfma_f32_16x16x32_bf16 a[0:3], a[64:67], a[200:203], 0
    ds_read_b128 a[228:231], v32 offset:2048
    v_cvt_pk_bf16_f32 v192, v192, v193
    v_cvt_pk_bf16_f32 v193, v194, v195
    v_cvt_pk_bf16_f32 v194, v208, v209
    v_mfma_f32_16x16x32_bf16 a[4:7], a[64:67], a[204:207], 0
    ds_read_b64_tr_b16 a[64:65], v36 offset:8192
    ds_read_b128 a[232:235], v32 offset:4096
    v_cvt_pk_bf16_f32 v195, v210, v211
    v_cvt_pk_bf16_f32 v196, v196, v197
    v_mfma_f32_16x16x32_bf16 a[8:11], a[68:71], a[200:203], 0
    ds_read_b128 a[236:239], v32 offset:6144
    ds_read_b128 a[240:243], v33 offset:0
    v_cvt_pk_bf16_f32 v197, v198, v199
    v_mfma_f32_16x16x32_bf16 a[12:15], a[68:71], a[204:207], 0
    ds_read_b64_tr_b16 a[66:67], v36 offset:9216
    ds_read_b128 a[244:247], v33 offset:2048
    v_cvt_pk_bf16_f32 v198, v212, v213
    v_cvt_pk_bf16_f32 v199, v214, v215
    v_mfma_f32_16x16x32_bf16 a[16:19], a[72:75], a[200:203], 0
    ds_read_b128 a[248:251], v33 offset:4096
    v_cvt_pk_bf16_f32 v200, v200, v201
    v_cvt_pk_bf16_f32 v201, v202, v203
    v_cvt_pk_bf16_f32 v202, v216, v217
    v_mfma_f32_16x16x32_bf16 a[20:23], a[72:75], a[204:207], 0
    ds_read_b64_tr_b16 a[68:69], v37 offset:8192
    ds_read_b128 a[252:255], v33 offset:6144
    v_cvt_pk_bf16_f32 v203, v218, v219
    v_cvt_pk_bf16_f32 v204, v204, v205
    v_mfma_f32_16x16x32_bf16 a[24:27], a[76:79], a[200:203], 0
    s_waitcnt lgkmcnt(0)
    s_add_u32 s76, s72, s75
    v_cvt_pk_bf16_f32 v205, v206, v207
    v_cvt_pk_bf16_f32 v206, v220, v221
    v_mfma_f32_16x16x32_bf16 a[28:31], a[76:79], a[204:207], 0
    ds_read_b64_tr_b16 a[70:71], v37 offset:9216
    v_cvt_pk_bf16_f32 v207, v222, v223
    v_cvt_pk_bf16_f32 v224, v224, v225
    v_mfma_f32_16x16x32_bf16 a[32:35], a[80:83], a[200:203], 0
    s_add_u32 s77, s73, s75
    s_add_u32 s75, s75, 128
    v_cvt_pk_bf16_f32 v225, v226, v227
    v_cvt_pk_bf16_f32 v226, v240, v241
    v_mfma_f32_16x16x32_bf16 a[36:39], a[80:83], a[204:207], 0
    ds_read_b64_tr_b16 a[72:73], v38 offset:8192
    v_cvt_pk_bf16_f32 v227, v242, v243
    v_cvt_pk_bf16_f32 v228, v228, v229
    v_cvt_pk_bf16_f32 v229, v230, v231
    v_mfma_f32_16x16x32_bf16 a[40:43], a[84:87], a[200:203], 0
    s_cmp_eq_u32 s75, 1152
    s_cselect_b32 s75, 0, s75
    v_cvt_pk_bf16_f32 v230, v244, v245
    v_cvt_pk_bf16_f32 v231, v246, v247
    v_mfma_f32_16x16x32_bf16 a[44:47], a[84:87], a[204:207], 0
    ds_read_b64_tr_b16 a[74:75], v38 offset:9216
    s_add_u32 m0, s74, 65536
    v_cvt_pk_bf16_f32 v232, v232, v233
    v_cvt_pk_bf16_f32 v233, v234, v235
    v_mfma_f32_16x16x32_bf16 a[48:51], a[88:91], a[200:203], 0
    s_add_u32 s23, s76, 0
    buffer_load_dwordx4 v30, s[44:47], s23 offen lds
    v_cvt_pk_bf16_f32 v234, v248, v249
    v_mfma_f32_16x16x32_bf16 a[52:55], a[88:91], a[204:207], 0
    ds_read_b64_tr_b16 a[76:77], v39 offset:8192
    s_add_u32 m0, s74, 66560
    v_cvt_pk_bf16_f32 v235, v250, v251
    v_cvt_pk_bf16_f32 v236, v236, v237
    v_mfma_f32_16x16x32_bf16 a[56:59], a[92:95], a[200:203], 0
    s_add_u32 s23, s76, 9216
    v_cvt_pk_bf16_f32 v237, v238, v239
    v_cvt_pk_bf16_f32 v238, v252, v253
    v_cvt_pk_bf16_f32 v239, v254, v255
    v_mfma_f32_16x16x32_bf16 a[60:63], a[92:95], a[204:207], 0
    ds_read_b64_tr_b16 a[78:79], v39 offset:9216
    buffer_load_dwordx4 v31, s[44:47], s23 offen lds
    v_mfma_f32_16x16x32_bf16 v[160:163], a[96:99], a[192:195], 0
    s_add_u32 m0, s74, 67584
    s_add_u32 s23, s76, 73728
    s_add_u32 s24, s31, 8192
    v_mfma_f32_16x16x32_bf16 v[176:179], a[96:99], a[196:199], 0
    ds_read_b64_tr_b16 a[80:81], v40 offset:8192
    buffer_load_dwordx4 v30, s[44:47], s23 offen lds
    v_mfma_f32_16x16x32_bf16 v[208:211], a[96:99], a[200:203], 0
    s_add_u32 m0, s74, 68608
    buffer_store_dwordx4 v[72:75], v29, s[40:43], s24 offen offset:0
    v_mfma_f32_16x16x32_bf16 v[240:243], a[96:99], a[204:207], 0
    s_add_u32 s23, s76, 82944
    v_mfma_f32_16x16x32_bf16 v[164:167], a[100:103], a[192:195], 0
    ds_read_b64_tr_b16 a[82:83], v40 offset:9216
    buffer_load_dwordx4 v31, s[44:47], s23 offen lds
    v_mfma_f32_16x16x32_bf16 v[180:183], a[100:103], a[196:199], 0
    s_add_u32 m0, s74, 69632
    s_add_u32 s24, s31, 12288
    v_mfma_f32_16x16x32_bf16 v[212:215], a[100:103], a[200:203], 0
    ds_read_b64_tr_b16 a[84:85], v41 offset:8192
    s_add_u32 s23, s77, 0
    v_mfma_f32_16x16x32_bf16 v[244:247], a[100:103], a[204:207], 0
    buffer_load_dwordx4 v30, s[44:47], s23 offen lds
    s_add_u32 m0, s74, 70656
    v_mfma_f32_16x16x32_bf16 v[168:171], a[104:107], a[192:195], 0
    ds_read_b64_tr_b16 a[86:87], v41 offset:9216
    s_add_u32 s23, s77, 9216
    buffer_store_dwordx4 v[76:79], v29, s[40:43], s24 offen offset:0
    v_mfma_f32_16x16x32_bf16 v[184:187], a[104:107], a[196:199], 0
    buffer_load_dwordx4 v31, s[44:47], s23 offen lds
    v_mfma_f32_16x16x32_bf16 v[216:219], a[104:107], a[200:203], 0
    ds_read_b64_tr_b16 a[88:89], v42 offset:8192
    s_add_u32 m0, s74, 71680
    s_add_u32 s24, s31, 32768
    v_mfma_f32_16x16x32_bf16 v[248:251], a[104:107], a[204:207], 0
    s_add_u32 s23, s77, 73728
    buffer_load_dwordx4 v30, s[44:47], s23 offen lds
    v_mfma_f32_16x16x32_bf16 v[172:175], a[108:111], a[192:195], 0
    ds_read_b64_tr_b16 a[90:91], v42 offset:9216
    s_add_u32 m0, s74, 72704
    v_mfma_f32_16x16x32_bf16 v[188:191], a[108:111], a[196:199], 0
    s_add_u32 s23, s77, 82944
    buffer_store_dwordx4 v[80:83], v29, s[40:43], s24 offen offset:0
    v_mfma_f32_16x16x32_bf16 v[220:223], a[108:111], a[200:203], 0
    ds_read_b64_tr_b16 a[92:93], v43 offset:8192
    buffer_load_dwordx4 v31, s[44:47], s23 offen lds
    v_mfma_f32_16x16x32_bf16 v[252:255], a[108:111], a[204:207], 0
    ds_read_b64_tr_b16 a[94:95], v43 offset:9216
    ds_read_b64_tr_b16 a[96:97], v44 offset:4608
    ds_read_b64_tr_b16 a[98:99], v44 offset:4752
    ds_read_b64_tr_b16 a[100:101], v45 offset:4608
    ds_read_b64_tr_b16 a[102:103], v45 offset:4752
    ds_read_b64_tr_b16 a[104:105], v46 offset:4608
    ds_read_b64_tr_b16 a[106:107], v46 offset:4752
    ds_read_b64_tr_b16 a[108:109], v47 offset:4608
    ds_read_b64_tr_b16 a[110:111], v47 offset:4752
    s_waitcnt lgkmcnt(15)
    v_mfma_f32_16x16x32_bf16 a[112:115], a[64:67], a[208:211], a[112:115]
    v_mfma_f32_16x16x32_bf16 a[116:119], a[64:67], a[212:215], a[116:119]
    v_mfma_f32_16x16x32_bf16 a[0:3], a[64:67], a[216:219], a[0:3]
    s_add_u32 s24, s31, 36864
    v_mfma_f32_16x16x32_bf16 a[4:7], a[64:67], a[220:223], a[4:7]
    v_mfma_f32_16x16x32_bf16 a[120:123], a[68:71], a[208:211], a[120:123]
    v_mfma_f32_16x16x32_bf16 a[124:127], a[68:71], a[212:215], a[124:127]
    buffer_store_dwordx4 v[84:87], v29, s[40:43], s24 offen offset:0
    v_mfma_f32_16x16x32_bf16 a[8:11], a[68:71], a[216:219], a[8:11]
    v_mfma_f32_16x16x32_bf16 a[12:15], a[68:71], a[220:223], a[12:15]
    s_waitcnt lgkmcnt(0)
    v_mfma_f32_16x16x32_bf16 a[128:131], a[72:75], a[208:211], a[128:131]
    s_barrier
    v_mfma_f32_16x16x32_bf16 a[132:135], a[72:75], a[212:215], a[132:135]
    ds_read_b64_tr_b16 a[64:65], v36 offset:16384
    s_add_u32 s82, s11, s79
    v_mfma_f32_16x16x32_bf16 a[16:19], a[72:75], a[216:219], a[16:19]
    ds_read_b64_tr_b16 a[66:67], v36 offset:17408
    v_mfma_f32_16x16x32_bf16 a[20:23], a[72:75], a[220:223], a[20:23]
    s_add_u32 s79, s79, 0x80000
    v_mfma_f32_16x16x32_bf16 a[136:139], a[76:79], a[208:211], a[136:139]
    ds_read_b64_tr_b16 a[68:69], v37 offset:16384
    s_add_u32 s24, s31, 40960
    v_mfma_f32_16x16x32_bf16 a[140:143], a[76:79], a[212:215], a[140:143]
    ds_read_b64_tr_b16 a[70:71], v37 offset:17408
    v_mfma_f32_16x16x32_bf16 a[24:27], a[76:79], a[216:219], a[24:27]
    ds_read_b64_tr_b16 a[72:73], v38 offset:16384
    v_mfma_f32_16x16x32_bf16 a[28:31], a[76:79], a[220:223], a[28:31]
    ds_read_b64_tr_b16 a[74:75], v38 offset:17408
    v_mfma_f32_16x16x32_bf16 a[144:147], a[80:83], a[208:211], a[144:147]
    ds_read_b64_tr_b16 a[76:77], v39 offset:16384
    v_mfma_f32_16x16x32_bf16 a[148:151], a[80:83], a[212:215], a[148:151]
    s_cmp_eq_u32 s79, 4718592
    s_cselect_b32 s79, 0, s79
    v_mfma_f32_16x16x32_bf16 a[32:35], a[80:83], a[216:219], a[32:35]
    ds_read_b64_tr_b16 a[78:79], v39 offset:17408
    s_add_u32 m0, s30, 98304
    v_mfma_f32_16x16x32_bf16 a[36:39], a[80:83], a[220:223], a[36:39]
    s_add_u32 s23, s82, 0
    buffer_load_dwordx4 v26, s[52:55], s23 offen lds
    v_mfma_f32_16x16x32_bf16 a[152:155], a[84:87], a[208:211], a[152:155]
    ds_read_b64_tr_b16 a[80:81], v40 offset:16384
    s_add_u32 m0, s30, 99328
    v_mfma_f32_16x16x32_bf16 a[156:159], a[84:87], a[212:215], a[156:159]
    s_add_u32 s23, s82, 32768
    v_mfma_f32_16x16x32_bf16 a[40:43], a[84:87], a[216:219], a[40:43]
    ds_read_b64_tr_b16 a[82:83], v40 offset:17408
    buffer_load_dwordx4 v26, s[52:55], s23 offen lds
    v_mfma_f32_16x16x32_bf16 a[44:47], a[84:87], a[220:223], a[44:47]
    s_add_u32 m0, s30, 100352
    v_mfma_f32_16x16x32_bf16 a[160:163], a[88:91], a[208:211], a[160:163]
    ds_read_b64_tr_b16 a[84:85], v41 offset:16384
    v_mfma_f32_16x16x32_bf16 a[164:167], a[88:91], a[212:215], a[164:167]
    s_add_u32 s23, s82, 65536
    buffer_store_dwordx4 v[88:91], v29, s[40:43], s24 offen offset:0
    v_mfma_f32_16x16x32_bf16 a[48:51], a[88:91], a[216:219], a[48:51]
    ds_read_b64_tr_b16 a[86:87], v41 offset:17408
    buffer_load_dwordx4 v27, s[52:55], s23 offen lds
    v_mfma_f32_16x16x32_bf16 a[52:55], a[88:91], a[220:223], a[52:55]
    s_add_u32 m0, s30, 101376
    v_mfma_f32_16x16x32_bf16 a[168:171], a[92:95], a[208:211], a[168:171]
    ds_read_b64_tr_b16 a[88:89], v42 offset:16384
    s_add_u32 s23, s82, 98304
    v_mfma_f32_16x16x32_bf16 a[172:175], a[92:95], a[212:215], a[172:175]
    buffer_load_dwordx4 v27, s[52:55], s23 offen lds
    v_mfma_f32_16x16x32_bf16 a[56:59], a[92:95], a[216:219], a[56:59]
    ds_read_b64_tr_b16 a[90:91], v42 offset:17408
    v_mfma_f32_16x16x32_bf16 a[60:63], a[92:95], a[220:223], a[60:63]
    s_add_u32 m0, s10, 0
    s_add_u32 s23, s78, s10
    v_mfma_f32_16x16x32_bf16 v[160:163], a[96:99], a[208:211], v[160:163]
    ds_read_b64_tr_b16 a[92:93], v43 offset:16384
    v_mfma_f32_16x16x32_bf16 v[176:179], a[96:99], a[212:215], v[176:179]
    buffer_load_dwordx4 v29, s[48:51], s23 offen sc1 lds
    v_mfma_f32_16x16x32_bf16 v[208:211], a[96:99], a[216:219], v[208:211]
    ds_read_b64_tr_b16 a[94:95], v43 offset:17408
    s_add_u32 m0, s10, 4096
    v_mfma_f32_16x16x32_bf16 v[240:243], a[96:99], a[220:223], v[240:243]
    s_add_u32 s23, s23, 4096
    v_mfma_f32_16x16x32_bf16 v[164:167], a[100:103], a[208:211], v[164:167]
    ds_read_b64_tr_b16 a[96:97], v44 offset:9216
    s_add_u32 s24, s31, 45056
    v_mfma_f32_16x16x32_bf16 v[180:183], a[100:103], a[212:215], v[180:183]
    buffer_load_dwordx4 v29, s[48:51], s23 offen sc1 lds
    v_mfma_f32_16x16x32_bf16 v[212:215], a[100:103], a[216:219], v[212:215]
    ds_read_b64_tr_b16 a[98:99], v44 offset:9360
    s_add_u32 s78, s78, 9216
    v_mfma_f32_16x16x32_bf16 v[244:247], a[100:103], a[220:223], v[244:247]
    s_cmp_eq_u32 s78, 82944
    s_cselect_b32 s78, 0, s78
    v_mfma_f32_16x16x32_bf16 v[168:171], a[104:107], a[208:211], v[168:171]
    ds_read_b64_tr_b16 a[100:101], v45 offset:9216
    v_mfma_f32_16x16x32_bf16 v[184:187], a[104:107], a[212:215], v[184:187]
    v_mfma_f32_16x16x32_bf16 v[216:219], a[104:107], a[216:219], v[216:219]
    ds_read_b64_tr_b16 a[102:103], v45 offset:9360
    v_mfma_f32_16x16x32_bf16 v[248:251], a[104:107], a[220:223], v[248:251]
    s_cmp_lg_u32 s22, 0
    s_cbranch_scc1 f1_wb3
    s_mov_b32 m0, 8192
    s_add_u32 s23, s23, 4096
    buffer_load_dwordx4 v29, s[48:51], s23 offen sc1 lds
f1_wb3:
    v_mfma_f32_16x16x32_bf16 v[172:175], a[108:111], a[208:211], v[172:175]
    ds_read_b64_tr_b16 a[104:105], v46 offset:9216
    buffer_store_dwordx4 v[92:95], v29, s[40:43], s24 offen offset:0
    v_mfma_f32_16x16x32_bf16 v[188:191], a[108:111], a[212:215], v[188:191]
    v_mfma_f32_16x16x32_bf16 v[220:223], a[108:111], a[216:219], v[220:223]
    ds_read_b64_tr_b16 a[106:107], v46 offset:9360
    v_mfma_f32_16x16x32_bf16 v[252:255], a[108:111], a[220:223], v[252:255]
    ds_read_b64_tr_b16 a[108:109], v47 offset:9216
    ds_read_b64_tr_b16 a[110:111], v47 offset:9360
    s_waitcnt lgkmcnt(15)
    v_mfma_f32_16x16x32_bf16 a[112:115], a[64:67], a[224:227], a[112:115]
    v_mfma_f32_16x16x32_bf16 a[116:119], a[64:67], a[228:231], a[116:119]
    v_mfma_f32_16x16x32_bf16 a[0:3], a[64:67], a[232:235], a[0:3]
    s_add_u32 s24, s31, 0
    v_mfma_f32_16x16x32_bf16 a[4:7], a[64:67], a[236:239], a[4:7]
    v_mfma_f32_16x16x32_bf16 a[120:123], a[68:71], a[224:227], a[120:123]
    buffer_store_dwordx4 v[128:131], v29, s[40:43], s24 offen offset:1024
    v_mfma_f32_16x16x32_bf16 a[124:127], a[68:71], a[228:231], a[124:127]
    v_mfma_f32_16x16x32_bf16 a[8:11], a[68:71], a[232:235], a[8:11]
    s_add_u32 s24, s31, 4096
    v_mfma_f32_16x16x32_bf16 a[12:15], a[68:71], a[236:239], a[12:15]
    s_waitcnt lgkmcnt(0)
    v_mfma_f32_16x16x32_bf16 a[128:131], a[72:75], a[224:227], a[128:131]
    s_barrier
    v_mfma_f32_16x16x32_bf16 a[132:135], a[72:75], a[228:231], a[132:135]
    ds_read_b64_tr_b16 a[64:65], v36 offset:24576
    s_waitcnt vmcnt(21)
    v_mfma_f32_16x16x32_bf16 a[16:19], a[72:75], a[232:235], a[16:19]
    ds_read_b64_tr_b16 a[66:67], v36 offset:25600
    ds_read_b128 a[192:195], v34 offset:0
    v_mfma_f32_16x16x32_bf16 a[20:23], a[72:75], a[236:239], a[20:23]
    v_mfma_f32_16x16x32_bf16 a[136:139], a[76:79], a[224:227], a[136:139]
    ds_read_b64_tr_b16 a[68:69], v37 offset:24576
    ds_read_b128 a[196:199], v34 offset:2048
    v_mfma_f32_16x16x32_bf16 a[140:143], a[76:79], a[228:231], a[140:143]
    ds_read_b64_tr_b16 a[70:71], v37 offset:25600
    ds_read_b128 a[200:203], v34 offset:4096
    v_mfma_f32_16x16x32_bf16 a[24:27], a[76:79], a[232:235], a[24:27]
    ds_read_b64_tr_b16 a[72:73], v38 offset:24576
    ds_read_b128 a[204:207], v34 offset:6144
    v_mfma_f32_16x16x32_bf16 a[28:31], a[76:79], a[236:239], a[28:31]
    ds_read_b64_tr_b16 a[74:75], v38 offset:25600
    buffer_store_dwordx4 v[132:135], v29, s[40:43], s24 offen offset:1024
    v_mfma_f32_16x16x32_bf16 a[144:147], a[80:83], a[224:227], a[144:147]
    ds_read_b64_tr_b16 a[76:77], v39 offset:24576
    ds_read_b128 a[208:211], v35 offset:0
    v_mfma_f32_16x16x32_bf16 a[148:151], a[80:83], a[228:231], a[148:151]
    ds_read_b128 a[212:215], v35 offset:2048
    ds_read_b128 a[216:219], v35 offset:4096
    v_mfma_f32_16x16x32_bf16 a[32:35], a[80:83], a[232:235], a[32:35]
    ds_read_b64_tr_b16 a[78:79], v39 offset:25600
    v_mfma_f32_16x16x32_bf16 a[36:39], a[80:83], a[236:239], a[36:39]
    ds_read_b128 a[220:223], v35 offset:6144
    s_waitcnt lgkmcnt(0)
    v_mfma_f32_16x16x32_bf16 a[152:155], a[84:87], a[224:227], a[152:155]
    ds_read_b64_tr_b16 a[80:81], v40 offset:24576
    s_add_u32 s76, s72, s75
    v_mfma_f32_16x16x32_bf16 a[156:159], a[84:87], a[228:231], a[156:159]
    s_add_u32 s77, s73, s75
    v_mfma_f32_16x16x32_bf16 a[40:43], a[84:87], a[232:235], a[40:43]
    ds_read_b64_tr_b16 a[82:83], v40 offset:25600
    s_add_u32 s75, s75, 128
    v_mfma_f32_16x16x32_bf16 a[44:47], a[84:87], a[236:239], a[44:47]
    v_mfma_f32_16x16x32_bf16 a[160:163], a[88:91], a[224:227], a[160:163]
    ds_read_b64_tr_b16 a[84:85], v41 offset:24576
    s_add_u32 s24, s31, 8192
    v_mfma_f32_16x16x32_bf16 a[164:167], a[88:91], a[228:231], a[164:167]
    s_cmp_eq_u32 s75, 1152
    s_cselect_b32 s75, 0, s75
    v_mfma_f32_16x16x32_bf16 a[48:51], a[88:91], a[232:235], a[48:51]
    ds_read_b64_tr_b16 a[86:87], v41 offset:25600
    s_add_u32 m0, s74, 32768
    v_mfma_f32_16x16x32_bf16 a[52:55], a[88:91], a[236:239], a[52:55]
    s_add_u32 s23, s76, 0
    buffer_load_dwordx4 v30, s[44:47], s23 offen lds
    v_mfma_f32_16x16x32_bf16 a[168:171], a[92:95], a[224:227], a[168:171]
    ds_read_b64_tr_b16 a[88:89], v42 offset:24576
    s_add_u32 m0, s74, 33792
    v_mfma_f32_16x16x32_bf16 a[172:175], a[92:95], a[228:231], a[172:175]
    s_add_u32 s23, s76, 9216
    buffer_load_dwordx4 v31, s[44:47], s23 offen lds
    v_mfma_f32_16x16x32_bf16 a[56:59], a[92:95], a[232:235], a[56:59]
    ds_read_b64_tr_b16 a[90:91], v42 offset:25600
    v_mfma_f32_16x16x32_bf16 a[60:63], a[92:95], a[236:239], a[60:63]
    s_add_u32 m0, s74, 34816
    s_add_u32 s23, s76, 73728
    v_mfma_f32_16x16x32_bf16 v[160:163], a[96:99], a[224:227], v[160:163]
    ds_read_b64_tr_b16 a[92:93], v43 offset:24576
    buffer_load_dwordx4 v30, s[44:47], s23 offen lds
    v_mfma_f32_16x16x32_bf16 v[176:179], a[96:99], a[228:231], v[176:179]
    s_add_u32 m0, s74, 35840
    v_mfma_f32_16x16x32_bf16 v[208:211], a[96:99], a[232:235], v[208:211]
    ds_read_b64_tr_b16 a[94:95], v43 offset:25600
    s_add_u32 s23, s76, 82944
    v_mfma_f32_16x16x32_bf16 v[240:243], a[96:99], a[236:239], v[240:243]
    buffer_load_dwordx4 v31, s[44:47], s23 offen lds
    v_mfma_f32_16x16x32_bf16 v[164:167], a[100:103], a[224:227], v[164:167]
    ds_read_b64_tr_b16 a[96:97], v44 offset:13824
    s_add_u32 m0, s74, 36864
    v_mfma_f32_16x16x32_bf16 v[180:183], a[100:103], a[228:231], v[180:183]
    s_add_u32 s23, s77, 0
    v_mfma_f32_16x16x32_bf16 v[212:215], a[100:103], a[232:235], v[212:215]
    ds_read_b64_tr_b16 a[98:99], v44 offset:13968
    buffer_load_dwordx4 v30, s[44:47], s23 offen lds
    v_mfma_f32_16x16x32_bf16 v[244:247], a[100:103], a[236:239], v[244:247]
    s_add_u32 m0, s74, 37888
    buffer_store_dwordx4 v[136:139], v29, s[40:43], s24 offen offset:1024
    v_mfma_f32_16x16x32_bf16 v[168:171], a[104:107], a[224:227], v[168:171]
    ds_read_b64_tr_b16 a[100:101], v45 offset:13824
    s_add_u32 s23, s77, 9216
    v_mfma_f32_16x16x32_bf16 v[184:187], a[104:107], a[228:231], v[184:187]
    buffer_load_dwordx4 v31, s[44:47], s23 offen lds
    s_add_u32 m0, s74, 38912
    v_mfma_f32_16x16x32_bf16 v[216:219], a[104:107], a[232:235], v[216:219]
    ds_read_b64_tr_b16 a[102:103], v45 offset:13968
    v_mfma_f32_16x16x32_bf16 v[248:251], a[104:107], a[236:239], v[248:251]
    s_add_u32 s23, s77, 73728
    buffer_load_dwordx4 v30, s[44:47], s23 offen lds
    v_mfma_f32_16x16x32_bf16 v[172:175], a[108:111], a[224:227], v[172:175]
    ds_read_b64_tr_b16 a[104:105], v46 offset:13824
    s_add_u32 m0, s74, 39936
    v_mfma_f32_16x16x32_bf16 v[188:191], a[108:111], a[228:231], v[188:191]
    s_add_u32 s23, s77, 82944
    v_mfma_f32_16x16x32_bf16 v[220:223], a[108:111], a[232:235], v[220:223]
    ds_read_b64_tr_b16 a[106:107], v46 offset:13968
    buffer_load_dwordx4 v31, s[44:47], s23 offen lds
    v_mfma_f32_16x16x32_bf16 v[252:255], a[108:111], a[236:239], v[252:255]
    ds_read_b64_tr_b16 a[108:109], v47 offset:13824
    ds_read_b64_tr_b16 a[110:111], v47 offset:13968
    v_mfma_f32_16x16x32_bf16 a[112:115], a[64:67], a[240:243], a[112:115]
    v_lshrrev_b32 v56, 1, v6
    v_mul_u32_u24 v56, 5, v56
    v_mfma_f32_16x16x32_bf16 a[116:119], a[64:67], a[244:247], a[116:119]
    v_sub_u32 v56, v3, v56
    v_mfma_f32_16x16x32_bf16 a[0:3], a[64:67], a[248:251], a[0:3]
    s_add_u32 s24, s31, 12288
    v_and_b32 v57, 1, v6
    v_mfma_f32_16x16x32_bf16 a[4:7], a[64:67], a[252:255], a[4:7]
    v_mul_u32_u24 v57, 1152, v57
    v_mul_u32_u24 v58, 48, v7
    v_mfma_f32_16x16x32_bf16 a[120:123], a[68:71], a[240:243], a[120:123]
    v_add3_u32 v57, v57, v58, 0
    v_add_u32 v57, 27648, v57
    v_mfma_f32_16x16x32_bf16 a[124:127], a[68:71], a[244:247], a[124:127]
    buffer_store_dwordx4 v[140:143], v29, s[40:43], s24 offen offset:1024
    s_mul_i32 s25, s81, 48
    v_mfma_f32_16x16x32_bf16 a[8:11], a[68:71], a[248:251], a[8:11]
    s_sub_u32 s25, 96, s25
    v_mfma_f32_16x16x32_bf16 a[12:15], a[68:71], a[252:255], a[12:15]
    s_waitcnt lgkmcnt(0)
    v_add_u32 v58, 0, v56
    v_mfma_f32_16x16x32_bf16 a[128:131], a[72:75], a[240:243], a[128:131]
    s_barrier
    v_mul_u32_u24 v59, 192, v58
    v_mfma_f32_16x16x32_bf16 a[132:135], a[72:75], a[244:247], a[132:135]
    ds_read_b64_tr_b16 a[64:65], v36 offset:32768
    s_add_u32 s82, s11, s79
    v_mfma_f32_16x16x32_bf16 a[16:19], a[72:75], a[248:251], a[16:19]
    ds_read_b64_tr_b16 a[66:67], v36 offset:33792
    v_cmp_gt_u32 vcc, 5, v58
    v_mfma_f32_16x16x32_bf16 a[20:23], a[72:75], a[252:255], a[20:23]
    s_add_u32 s79, s79, 0x80000
    v_mfma_f32_16x16x32_bf16 a[136:139], a[76:79], a[240:243], a[136:139]
    ds_read_b64_tr_b16 a[68:69], v37 offset:32768
    s_add_u32 s24, s31, 32768
    v_mfma_f32_16x16x32_bf16 a[140:143], a[76:79], a[244:247], a[140:143]
    ds_read_b64_tr_b16 a[70:71], v37 offset:33792
    v_add_u32 v59, s25, v59
    v_mfma_f32_16x16x32_bf16 a[24:27], a[76:79], a[248:251], a[24:27]
    ds_read_b64_tr_b16 a[72:73], v38 offset:32768
    v_mov_b32 v60, 960
    v_mfma_f32_16x16x32_bf16 a[28:31], a[76:79], a[252:255], a[28:31]
    ds_read_b64_tr_b16 a[74:75], v38 offset:33792
    v_mfma_f32_16x16x32_bf16 a[144:147], a[80:83], a[240:243], a[144:147]
    ds_read_b64_tr_b16 a[76:77], v39 offset:32768
    v_cndmask_b32 v59, v60, v59, vcc
    v_mfma_f32_16x16x32_bf16 a[148:151], a[80:83], a[244:247], a[148:151]
    s_cmp_eq_u32 s79, 4718592
    s_cselect_b32 s79, 0, s79
    v_mfma_f32_16x16x32_bf16 a[32:35], a[80:83], a[248:251], a[32:35]
    ds_read_b64_tr_b16 a[78:79], v39 offset:33792
    s_add_u32 m0, s30, 114688
    v_mfma_f32_16x16x32_bf16 a[36:39], a[80:83], a[252:255], a[36:39]
    s_add_u32 s23, s82, 0
    buffer_load_dwordx4 v26, s[52:55], s23 offen lds
    v_mfma_f32_16x16x32_bf16 a[152:155], a[84:87], a[240:243], a[152:155]
    ds_read_b64_tr_b16 a[80:81], v40 offset:32768
    s_add_u32 m0, s30, 115712
    v_mfma_f32_16x16x32_bf16 a[156:159], a[84:87], a[244:247], a[156:159]
    s_add_u32 s23, s82, 32768
    v_add_u32 v61, v59, v57
    v_mfma_f32_16x16x32_bf16 a[40:43], a[84:87], a[248:251], a[40:43]
    ds_read_b64_tr_b16 a[82:83], v40 offset:33792
    buffer_load_dwordx4 v26, s[52:55], s23 offen lds
    v_mfma_f32_16x16x32_bf16 a[44:47], a[84:87], a[252:255], a[44:47]
    s_add_u32 m0, s30, 116736
    v_mfma_f32_16x16x32_bf16 a[160:163], a[88:91], a[240:243], a[160:163]
    ds_read_b64_tr_b16 a[84:85], v41 offset:32768
    ds_read_b64_tr_b16 v[64:65], v61 offset:0
    v_mfma_f32_16x16x32_bf16 a[164:167], a[88:91], a[244:247], a[164:167]
    s_add_u32 s23, s82, 65536
    buffer_store_dwordx4 v[144:147], v29, s[40:43], s24 offen offset:1024
    v_mfma_f32_16x16x32_bf16 a[48:51], a[88:91], a[248:251], a[48:51]
    ds_read_b64_tr_b16 a[86:87], v41 offset:33792
    buffer_load_dwordx4 v27, s[52:55], s23 offen lds
    v_mfma_f32_16x16x32_bf16 a[52:55], a[88:91], a[252:255], a[52:55]
    s_add_u32 m0, s30, 117760
    ds_read_b64_tr_b16 v[72:73], v61 offset:8
    v_mfma_f32_16x16x32_bf16 a[168:171], a[92:95], a[240:243], a[168:171]
    ds_read_b64_tr_b16 a[88:89], v42 offset:32768
    s_add_u32 s23, s82, 98304
    v_mfma_f32_16x16x32_bf16 a[172:175], a[92:95], a[244:247], a[172:175]
    buffer_load_dwordx4 v27, s[52:55], s23 offen lds
    ds_read_b64_tr_b16 v[80:81], v61 offset:16
    v_mfma_f32_16x16x32_bf16 a[56:59], a[92:95], a[248:251], a[56:59]
    ds_read_b64_tr_b16 a[90:91], v42 offset:33792
    v_mfma_f32_16x16x32_bf16 a[60:63], a[92:95], a[252:255], a[60:63]
    s_add_u32 m0, s10, 9216
    s_add_u32 s23, s78, s10
    v_mfma_f32_16x16x32_bf16 v[160:163], a[96:99], a[240:243], v[160:163]
    ds_read_b64_tr_b16 a[92:93], v43 offset:32768
    ds_read_b64_tr_b16 v[88:89], v61 offset:24
    v_mfma_f32_16x16x32_bf16 v[176:179], a[96:99], a[244:247], v[176:179]
    buffer_load_dwordx4 v29, s[48:51], s23 offen sc1 lds
    ds_read_b64_tr_b16 v[128:129], v61 offset:32
    v_mfma_f32_16x16x32_bf16 v[208:211], a[96:99], a[248:251], v[208:211]
    ds_read_b64_tr_b16 a[94:95], v43 offset:33792
    s_add_u32 m0, s10, 13312
    v_mfma_f32_16x16x32_bf16 v[240:243], a[96:99], a[252:255], v[240:243]
    s_add_u32 s23, s23, 4096
    v_mfma_f32_16x16x32_bf16 v[164:167], a[100:103], a[240:243], v[164:167]
    ds_read_b64_tr_b16 a[96:97], v44 offset:18432
    s_add_u32 s24, s31, 36864
    v_mfma_f32_16x16x32_bf16 v[180:183], a[100:103], a[244:247], v[180:183]
    buffer_load_dwordx4 v29, s[48:51], s23 offen sc1 lds
    v_add_u32 v58, 4, v56
    v_mfma_f32_16x16x32_bf16 v[212:215], a[100:103], a[248:251], v[212:215]
    ds_read_b64_tr_b16 a[98:99], v44 offset:18576
    s_add_u32 s78, s78, 9216
    v_mfma_f32_16x16x32_bf16 v[244:247], a[100:103], a[252:255], v[244:247]
    s_cmp_eq_u32 s78, 82944
    s_cselect_b32 s78, 0, s78
    v_mfma_f32_16x16x32_bf16 v[168:171], a[104:107], a[240:243], v[168:171]
    ds_read_b64_tr_b16 a[100:101], v45 offset:18432
    v_mul_u32_u24 v59, 192, v58
    v_mfma_f32_16x16x32_bf16 v[184:187], a[104:107], a[244:247], v[184:187]
    v_cmp_gt_u32 vcc, 5, v58
    v_add_u32 v59, s25, v59
    v_mfma_f32_16x16x32_bf16 v[216:219], a[104:107], a[248:251], v[216:219]
    ds_read_b64_tr_b16 a[102:103], v45 offset:18576
    v_mfma_f32_16x16x32_bf16 v[248:251], a[104:107], a[252:255], v[248:251]
    s_cmp_lg_u32 s22, 0
    s_cbranch_scc1 f1_wb4
    s_mov_b32 m0, 17408
    s_add_u32 s23, s23, 4096
    buffer_load_dwordx4 v29, s[48:51], s23 offen sc1 lds
f1_wb4:
    v_mfma_f32_16x16x32_bf16 v[172:175], a[108:111], a[240:243], v[172:175]
    ds_read_b64_tr_b16 a[104:105], v46 offset:18432
    buffer_store_dwordx4 v[148:151], v29, s[40:43], s24 offen offset:1024
    v_mfma_f32_16x16x32_bf16 v[188:191], a[108:111], a[244:247], v[188:191]
    v_mov_b32 v60, 960
    v_cndmask_b32 v59, v60, v59, vcc
    v_mfma_f32_16x16x32_bf16 v[220:223], a[108:111], a[248:251], v[220:223]
    ds_read_b64_tr_b16 a[106:107], v46 offset:18576
    v_add_u32 v62, v59, v57
    v_mfma_f32_16x16x32_bf16 v[252:255], a[108:111], a[252:255], v[252:255]
    ds_read_b64_tr_b16 a[108:109], v47 offset:18432
    ds_read_b64_tr_b16 a[110:111], v47 offset:18576
    s_waitcnt lgkmcnt(15)
    v_mfma_f32_16x16x32_bf16 a[112:115], a[64:67], a[192:195], a[112:115]
    ds_read_b64_tr_b16 v[66:67], v62 offset:0
    v_mfma_f32_16x16x32_bf16 a[116:119], a[64:67], a[196:199], a[116:119]
    ds_read_b64_tr_b16 v[74:75], v62 offset:8
    v_mfma_f32_16x16x32_bf16 a[0:3], a[64:67], a[200:203], a[0:3]
    s_add_u32 s24, s31, 40960
    ds_read_b64_tr_b16 v[82:83], v62 offset:16
    v_mfma_f32_16x16x32_bf16 a[4:7], a[64:67], a[204:207], a[4:7]
    ds_read_b64_tr_b16 v[90:91], v62 offset:24
    ds_read_b64_tr_b16 v[130:131], v62 offset:32
    v_mfma_f32_16x16x32_bf16 a[120:123], a[68:71], a[192:195], a[120:123]
    buffer_store_dwordx4 v[152:155], v29, s[40:43], s24 offen offset:1024
    v_mfma_f32_16x16x32_bf16 a[124:127], a[68:71], a[196:199], a[124:127]
    v_add_u32 v58, 8, v56
    v_mul_u32_u24 v59, 192, v58
    v_mfma_f32_16x16x32_bf16 a[8:11], a[68:71], a[200:203], a[8:11]
    s_add_u32 s24, s31, 45056
    v_mfma_f32_16x16x32_bf16 a[12:15], a[68:71], a[204:207], a[12:15]
    s_waitcnt lgkmcnt(5)
    v_cmp_gt_u32 vcc, 5, v58
    v_mfma_f32_16x16x32_bf16 a[128:131], a[72:75], a[192:195], a[128:131]
    s_barrier
    v_add_u32 v59, s25, v59
    v_mfma_f32_16x16x32_bf16 a[132:135], a[72:75], a[196:199], a[132:135]
    ds_read_b64_tr_b16 a[64:65], v36 offset:40960
    s_waitcnt vmcnt(30)
    v_mov_b32 v60, 960
    v_mfma_f32_16x16x32_bf16 a[16:19], a[72:75], a[200:203], a[16:19]
    ds_read_b64_tr_b16 a[66:67], v36 offset:41984
    ds_read_b128 a[224:227], v32 offset:0
    v_mfma_f32_16x16x32_bf16 a[20:23], a[72:75], a[204:207], a[20:23]
    v_cndmask_b32 v59, v60, v59, vcc
    v_mfma_f32_16x16x32_bf16 a[136:139], a[76:79], a[192:195], a[136:139]
    ds_read_b64_tr_b16 a[68:69], v37 offset:40960
    ds_read_b128 a[228:231], v32 offset:2048
    v_mfma_f32_16x16x32_bf16 a[140:143], a[76:79], a[196:199], a[140:143]
    ds_read_b64_tr_b16 a[70:71], v37 offset:41984
    ds_read_b128 a[232:235], v32 offset:4096
    v_add_u32 v61, v59, v57
    v_mfma_f32_16x16x32_bf16 a[24:27], a[76:79], a[200:203], a[24:27]
    ds_read_b64_tr_b16 a[72:73], v38 offset:40960
    ds_read_b128 a[236:239], v32 offset:6144
    v_mfma_f32_16x16x32_bf16 a[28:31], a[76:79], a[204:207], a[28:31]
    ds_read_b64_tr_b16 a[74:75], v38 offset:41984
    buffer_store_dwordx4 v[156:159], v29, s[40:43], s24 offen offset:1024
    v_mfma_f32_16x16x32_bf16 a[144:147], a[80:83], a[192:195], a[144:147]
    ds_read_b64_tr_b16 a[76:77], v39 offset:40960
    ds_read_b128 a[240:243], v33 offset:0
    ds_read_b64_tr_b16 v[68:69], v61 offset:0
    v_mfma_f32_16x16x32_bf16 a[148:151], a[80:83], a[196:199], a[148:151]
    ds_read_b128 a[244:247], v33 offset:2048
    ds_read_b128 a[248:251], v33 offset:4096
    v_mfma_f32_16x16x32_bf16 a[32:35], a[80:83], a[200:203], a[32:35]
    ds_read_b64_tr_b16 a[78:79], v39 offset:41984
    ds_read_b64_tr_b16 v[76:77], v61 offset:8
    v_mfma_f32_16x16x32_bf16 a[36:39], a[80:83], a[204:207], a[36:39]
    ds_read_b128 a[252:255], v33 offset:6144
    s_waitcnt lgkmcnt(0)
    ds_read_b64_tr_b16 v[84:85], v61 offset:16
    v_mfma_f32_16x16x32_bf16 a[152:155], a[84:87], a[192:195], a[152:155]
    ds_read_b64_tr_b16 a[80:81], v40 offset:40960
    s_add_u32 s76, s72, s75
    v_mfma_f32_16x16x32_bf16 a[156:159], a[84:87], a[196:199], a[156:159]
    s_add_u32 s77, s73, s75
    ds_read_b64_tr_b16 v[92:93], v61 offset:24
    v_mfma_f32_16x16x32_bf16 a[40:43], a[84:87], a[200:203], a[40:43]
    ds_read_b64_tr_b16 a[82:83], v40 offset:41984
    s_add_u32 s75, s75, 128
    v_mfma_f32_16x16x32_bf16 a[44:47], a[84:87], a[204:207], a[44:47]
    ds_read_b64_tr_b16 v[132:133], v61 offset:32
    v_mfma_f32_16x16x32_bf16 a[160:163], a[88:91], a[192:195], a[160:163]
    ds_read_b64_tr_b16 a[84:85], v41 offset:40960
    s_add_u32 s24, s6, 49152
    v_mfma_f32_16x16x32_bf16 a[164:167], a[88:91], a[196:199], a[164:167]
    s_cmp_eq_u32 s75, 1152
    s_cselect_b32 s75, 0, s75
    v_add_u32 v58, 12, v56
    v_mfma_f32_16x16x32_bf16 a[48:51], a[88:91], a[200:203], a[48:51]
    ds_read_b64_tr_b16 a[86:87], v41 offset:41984
    s_add_u32 m0, s74, 65536
    v_mfma_f32_16x16x32_bf16 a[52:55], a[88:91], a[204:207], a[52:55]
    s_add_u32 s23, s76, 0
    buffer_load_dwordx4 v30, s[44:47], s23 offen lds
    v_mul_u32_u24 v59, 192, v58
    v_mfma_f32_16x16x32_bf16 a[168:171], a[92:95], a[192:195], a[168:171]
    ds_read_b64_tr_b16 a[88:89], v42 offset:40960
    s_add_u32 m0, s74, 66560
    v_mfma_f32_16x16x32_bf16 a[172:175], a[92:95], a[196:199], a[172:175]
    s_add_u32 s23, s76, 9216
    buffer_load_dwordx4 v31, s[44:47], s23 offen lds
    v_mfma_f32_16x16x32_bf16 a[56:59], a[92:95], a[200:203], a[56:59]
    ds_read_b64_tr_b16 a[90:91], v42 offset:41984
    v_cmp_gt_u32 vcc, 5, v58
    v_mfma_f32_16x16x32_bf16 a[60:63], a[92:95], a[204:207], a[60:63]
    s_add_u32 m0, s74, 67584
    s_add_u32 s23, s76, 73728
    v_add_u32 v59, s25, v59
    v_mfma_f32_16x16x32_bf16 v[160:163], a[96:99], a[192:195], v[160:163]
    ds_read_b64_tr_b16 a[92:93], v43 offset:40960
    buffer_load_dwordx4 v30, s[44:47], s23 offen lds
    v_mfma_f32_16x16x32_bf16 v[176:179], a[96:99], a[196:199], v[176:179]
    s_add_u32 m0, s74, 68608
    v_mov_b32 v60, 960
    v_mfma_f32_16x16x32_bf16 v[208:211], a[96:99], a[200:203], v[208:211]
    ds_read_b64_tr_b16 a[94:95], v43 offset:41984
    s_add_u32 s23, s76, 82944
    v_mfma_f32_16x16x32_bf16 v[240:243], a[96:99], a[204:207], v[240:243]
    buffer_load_dwordx4 v31, s[44:47], s23 offen lds
    v_cndmask_b32 v59, v60, v59, vcc
    v_mfma_f32_16x16x32_bf16 v[164:167], a[100:103], a[192:195], v[164:167]
    ds_read_b64_tr_b16 a[96:97], v44 offset:23040
    s_add_u32 m0, s74, 69632
    v_mfma_f32_16x16x32_bf16 v[180:183], a[100:103], a[196:199], v[180:183]
    s_add_u32 s23, s77, 0
    v_add_u32 v62, v59, v57
    v_mfma_f32_16x16x32_bf16 v[212:215], a[100:103], a[200:203], v[212:215]
    ds_read_b64_tr_b16 a[98:99], v44 offset:23184
    buffer_load_dwordx4 v30, s[44:47], s23 offen lds
    v_mfma_f32_16x16x32_bf16 v[244:247], a[100:103], a[204:207], v[244:247]
    s_add_u32 m0, s74, 70656
    buffer_store_dwordx4 v[96:99], v29, s[40:43], s24 offen offset:0
    ds_read_b64_tr_b16 v[70:71], v62 offset:0
    v_mfma_f32_16x16x32_bf16 v[168:171], a[104:107], a[192:195], v[168:171]
    ds_read_b64_tr_b16 a[100:101], v45 offset:23040
    s_add_u32 s23, s77, 9216
    v_mfma_f32_16x16x32_bf16 v[184:187], a[104:107], a[196:199], v[184:187]
    buffer_load_dwordx4 v31, s[44:47], s23 offen lds
    s_add_u32 m0, s74, 71680
    ds_read_b64_tr_b16 v[78:79], v62 offset:8
    v_mfma_f32_16x16x32_bf16 v[216:219], a[104:107], a[200:203], v[216:219]
    ds_read_b64_tr_b16 a[102:103], v45 offset:23184
    ds_read_b64_tr_b16 v[86:87], v62 offset:16
    v_mfma_f32_16x16x32_bf16 v[248:251], a[104:107], a[204:207], v[248:251]
    s_add_u32 s23, s77, 73728
    buffer_load_dwordx4 v30, s[44:47], s23 offen lds
    v_mfma_f32_16x16x32_bf16 v[172:175], a[108:111], a[192:195], v[172:175]
    ds_read_b64_tr_b16 a[104:105], v46 offset:23040
    s_add_u32 m0, s74, 72704
    v_mfma_f32_16x16x32_bf16 v[188:191], a[108:111], a[196:199], v[188:191]
    s_add_u32 s23, s77, 82944
    ds_read_b64_tr_b16 v[94:95], v62 offset:24
    v_mfma_f32_16x16x32_bf16 v[220:223], a[108:111], a[200:203], v[220:223]
    ds_read_b64_tr_b16 a[106:107], v46 offset:23184
    buffer_load_dwordx4 v31, s[44:47], s23 offen lds
    ds_read_b64_tr_b16 v[134:135], v62 offset:32
    v_mfma_f32_16x16x32_bf16 v[252:255], a[108:111], a[204:207], v[252:255]
    ds_read_b64_tr_b16 a[108:109], v47 offset:23040
    ds_read_b64_tr_b16 a[110:111], v47 offset:23184
    v_mfma_f32_16x16x32_bf16 a[112:115], a[64:67], a[208:211], a[112:115]
    v_and_b32 v56, 1, v2
    v_mfma_f32_16x16x32_bf16 a[116:119], a[64:67], a[212:215], a[116:119]
    v_lshlrev_b32 v56, 4, v56
    v_mfma_f32_16x16x32_bf16 a[0:3], a[64:67], a[216:219], a[0:3]
    s_add_u32 s24, s6, 49152
    v_mov_b32 v57, 0x3f80
    v_mfma_f32_16x16x32_bf16 a[4:7], a[64:67], a[220:223], a[4:7]
    v_lshlrev_b32 v57, v56, v57
    v_mfma_f32_16x16x32_bf16 a[120:123], a[68:71], a[208:211], a[120:123]
    v_lshrrev_b32 v58, 3, v2
    v_mfma_f32_16x16x32_bf16 a[124:127], a[68:71], a[212:215], a[124:127]
    buffer_store_dwordx4 v[100:103], v29, s[40:43], s24 offen offset:2048
    v_add_u32 v58, 2, v58
    v_mfma_f32_16x16x32_bf16 a[8:11], a[68:71], a[216:219], a[8:11]
    v_cmp_eq_u32 vcc, v58, v3
    v_mfma_f32_16x16x32_bf16 a[12:15], a[68:71], a[220:223], a[12:15]
    s_waitcnt vmcnt(33) lgkmcnt(0)
    v_mfma_f32_16x16x32_bf16 a[128:131], a[72:75], a[208:211], a[128:131]
    s_barrier
    v_bfe_u32 v59, v2, 1, 2
    v_mfma_f32_16x16x32_bf16 a[132:135], a[72:75], a[212:215], a[132:135]
    ds_read_b64_tr_b16 a[64:65], v36 offset:0
    s_add_u32 s82, s11, s79
    v_mfma_f32_16x16x32_bf16 a[16:19], a[72:75], a[216:219], a[16:19]
    ds_read_b64_tr_b16 a[66:67], v36 offset:1024
    v_mfma_f32_16x16x32_bf16 a[20:23], a[72:75], a[220:223], a[20:23]
    s_add_u32 s79, s79, 0x80000
    v_mfma_f32_16x16x32_bf16 a[136:139], a[76:79], a[208:211], a[136:139]
    ds_read_b64_tr_b16 a[68:69], v37 offset:0
    s_add_u32 s24, s6, 53248
    v_mfma_f32_16x16x32_bf16 a[140:143], a[76:79], a[212:215], a[140:143]
    ds_read_b64_tr_b16 a[70:71], v37 offset:1024
    v_cndmask_b32 v58, 0, v57, vcc
    v_mfma_f32_16x16x32_bf16 a[24:27], a[76:79], a[216:219], a[24:27]
    ds_read_b64_tr_b16 a[72:73], v38 offset:0
    v_cmp_eq_u32 vcc, 0, v59
    v_mfma_f32_16x16x32_bf16 a[28:31], a[76:79], a[220:223], a[28:31]
    ds_read_b64_tr_b16 a[74:75], v38 offset:1024
    v_mfma_f32_16x16x32_bf16 a[144:147], a[80:83], a[208:211], a[144:147]
    ds_read_b64_tr_b16 a[76:77], v39 offset:0
    v_cndmask_b32 v136, 0, v58, vcc
    v_mfma_f32_16x16x32_bf16 a[148:151], a[80:83], a[212:215], a[148:151]
    s_cmp_eq_u32 s79, 4718592
    s_cselect_b32 s79, 0, s79
    v_mfma_f32_16x16x32_bf16 a[32:35], a[80:83], a[216:219], a[32:35]
    ds_read_b64_tr_b16 a[78:79], v39 offset:1024
    s_add_u32 m0, s30, 131072
    v_mfma_f32_16x16x32_bf16 a[36:39], a[80:83], a[220:223], a[36:39]
    s_add_u32 s23, s82, 0
    buffer_load_dwordx4 v26, s[52:55], s23 offen lds
    v_mfma_f32_16x16x32_bf16 a[152:155], a[84:87], a[208:211], a[152:155]
    ds_read_b64_tr_b16 a[80:81], v40 offset:0
    s_add_u32 m0, s30, 132096
    v_mfma_f32_16x16x32_bf16 a[156:159], a[84:87], a[212:215], a[156:159]
    s_add_u32 s23, s82, 32768
    v_mfma_f32_16x16x32_bf16 a[40:43], a[84:87], a[216:219], a[40:43]
    ds_read_b64_tr_b16 a[82:83], v40 offset:1024
    buffer_load_dwordx4 v26, s[52:55], s23 offen lds
    v_mfma_f32_16x16x32_bf16 a[44:47], a[84:87], a[220:223], a[44:47]
    s_add_u32 m0, s30, 133120
    v_mfma_f32_16x16x32_bf16 a[160:163], a[88:91], a[208:211], a[160:163]
    ds_read_b64_tr_b16 a[84:85], v41 offset:0
    v_cmp_eq_u32 vcc, 1, v59
    v_mfma_f32_16x16x32_bf16 a[164:167], a[88:91], a[212:215], a[164:167]
    s_add_u32 s23, s82, 65536
    buffer_store_dwordx4 v[104:107], v29, s[40:43], s24 offen offset:0
    v_mfma_f32_16x16x32_bf16 a[48:51], a[88:91], a[216:219], a[48:51]
    ds_read_b64_tr_b16 a[86:87], v41 offset:1024
    buffer_load_dwordx4 v27, s[52:55], s23 offen lds
    v_mfma_f32_16x16x32_bf16 a[52:55], a[88:91], a[220:223], a[52:55]
    s_add_u32 m0, s30, 134144
    v_mfma_f32_16x16x32_bf16 a[168:171], a[92:95], a[208:211], a[168:171]
    ds_read_b64_tr_b16 a[88:89], v42 offset:0
    s_add_u32 s23, s82, 98304
    v_mfma_f32_16x16x32_bf16 a[172:175], a[92:95], a[212:215], a[172:175]
    buffer_load_dwordx4 v27, s[52:55], s23 offen lds
    v_cndmask_b32 v137, 0, v58, vcc
    v_mfma_f32_16x16x32_bf16 a[56:59], a[92:95], a[216:219], a[56:59]
    ds_read_b64_tr_b16 a[90:91], v42 offset:1024
    v_mfma_f32_16x16x32_bf16 a[60:63], a[92:95], a[220:223], a[60:63]
    s_add_u32 m0, s10, 18432
    s_add_u32 s23, s78, s10
    v_mfma_f32_16x16x32_bf16 v[160:163], a[96:99], a[208:211], v[160:163]
    ds_read_b64_tr_b16 a[92:93], v43 offset:0
    v_cmp_eq_u32 vcc, 2, v59
    v_mfma_f32_16x16x32_bf16 v[176:179], a[96:99], a[212:215], v[176:179]
    buffer_load_dwordx4 v29, s[48:51], s23 offen sc1 lds
    v_cndmask_b32 v138, 0, v58, vcc
    v_mfma_f32_16x16x32_bf16 v[208:211], a[96:99], a[216:219], v[208:211]
    ds_read_b64_tr_b16 a[94:95], v43 offset:1024
    s_add_u32 m0, s10, 22528
    v_mfma_f32_16x16x32_bf16 v[240:243], a[96:99], a[220:223], v[240:243]
    s_add_u32 s23, s23, 4096
    v_mfma_f32_16x16x32_bf16 v[164:167], a[100:103], a[208:211], v[164:167]
    ds_read_b64_tr_b16 a[96:97], v44 offset:0
    s_add_u32 s24, s6, 53248
    v_mfma_f32_16x16x32_bf16 v[180:183], a[100:103], a[212:215], v[180:183]
    buffer_load_dwordx4 v29, s[48:51], s23 offen sc1 lds
    v_mfma_f32_16x16x32_bf16 v[212:215], a[100:103], a[216:219], v[212:215]
    ds_read_b64_tr_b16 a[98:99], v44 offset:144
    s_add_u32 s78, s78, 9216
    v_mfma_f32_16x16x32_bf16 v[244:247], a[100:103], a[220:223], v[244:247]
    s_cmp_eq_u32 s78, 82944
    s_cselect_b32 s78, 0, s78
    v_mfma_f32_16x16x32_bf16 v[168:171], a[104:107], a[208:211], v[168:171]
    ds_read_b64_tr_b16 a[100:101], v45 offset:0
    v_cmp_eq_u32 vcc, 3, v59
    v_mfma_f32_16x16x32_bf16 v[184:187], a[104:107], a[212:215], v[184:187]
    s_nop 0
    v_cndmask_b32 v139, 0, v58, vcc
    v_mfma_f32_16x16x32_bf16 v[216:219], a[104:107], a[216:219], v[216:219]
    ds_read_b64_tr_b16 a[102:103], v45 offset:144
    v_mfma_f32_16x16x32_bf16 v[248:251], a[104:107], a[220:223], v[248:251]
    s_cmp_lg_u32 s22, 0
    s_cbranch_scc1 f1_wb5
    s_mov_b32 m0, 26624
    s_add_u32 s23, s23, 4096
    buffer_load_dwordx4 v29, s[48:51], s23 offen sc1 lds
f1_wb5:
    v_mfma_f32_16x16x32_bf16 v[172:175], a[108:111], a[208:211], v[172:175]
    ds_read_b64_tr_b16 a[104:105], v46 offset:0
    buffer_store_dwordx4 v[108:111], v29, s[40:43], s24 offen offset:2048
    v_mfma_f32_16x16x32_bf16 v[188:191], a[108:111], a[212:215], v[188:191]
    v_lshlrev_b32 v56, 2, v3
    v_mfma_f32_16x16x32_bf16 v[220:223], a[108:111], a[216:219], v[220:223]
    ds_read_b64_tr_b16 a[106:107], v46 offset:144
    v_subrev_u32 v56, s81, v56
    v_mfma_f32_16x16x32_bf16 v[252:255], a[108:111], a[220:223], v[252:255]
    ds_read_b64_tr_b16 a[108:109], v47 offset:0
    ds_read_b64_tr_b16 a[110:111], v47 offset:144
    s_waitcnt lgkmcnt(15)
    v_mfma_f32_16x16x32_bf16 a[112:115], a[64:67], a[224:227], a[112:115]
    v_sub_u32 v56, v56, v2
    v_mov_b32 v57, 0x3f80
    v_mfma_f32_16x16x32_bf16 a[116:119], a[64:67], a[228:231], a[116:119]
    v_mov_b32 v58, 0x3f800000
    v_mfma_f32_16x16x32_bf16 a[0:3], a[64:67], a[232:235], a[0:3]
    s_add_u32 s24, s6, 49152
    v_cmp_eq_i32 vcc, 8, v56
    v_mfma_f32_16x16x32_bf16 a[4:7], a[64:67], a[236:239], a[4:7]
    s_nop 0
    v_cndmask_b32 v59, 0, v57, vcc
    v_cmp_eq_i32 vcc, 7, v56
    v_mfma_f32_16x16x32_bf16 a[120:123], a[68:71], a[224:227], a[120:123]
    buffer_store_dwordx4 v[112:115], v29, s[40:43], s24 offen offset:1024
    v_cndmask_b32 v60, 0, v58, vcc
    v_mfma_f32_16x16x32_bf16 a[124:127], a[68:71], a[228:231], a[124:127]
    v_or_b32 v140, v59, v60
    v_mfma_f32_16x16x32_bf16 a[8:11], a[68:71], a[232:235], a[8:11]
    s_add_u32 s24, s6, 49152
    v_cmp_eq_i32 vcc, 6, v56
    v_mfma_f32_16x16x32_bf16 a[12:15], a[68:71], a[236:239], a[12:15]
    s_waitcnt lgkmcnt(0)
    v_cndmask_b32 v59, 0, v57, vcc
    v_mfma_f32_16x16x32_bf16 a[128:131], a[72:75], a[224:227], a[128:131]
    s_barrier
    v_cmp_eq_i32 vcc, 5, v56
    v_mfma_f32_16x16x32_bf16 a[132:135], a[72:75], a[228:231], a[132:135]
    ds_read_b64_tr_b16 a[64:65], v36 offset:8192
    s_waitcnt vmcnt(30)
    v_mfma_f32_16x16x32_bf16 a[16:19], a[72:75], a[232:235], a[16:19]
    ds_read_b64_tr_b16 a[66:67], v36 offset:9216
    ds_read_b128 a[192:195], v34 offset:0
    v_mfma_f32_16x16x32_bf16 a[20:23], a[72:75], a[236:239], a[20:23]
    v_mfma_f32_16x16x32_bf16 a[136:139], a[76:79], a[224:227], a[136:139]
    ds_read_b64_tr_b16 a[68:69], v37 offset:8192
    ds_read_b128 a[196:199], v34 offset:2048
    v_mfma_f32_16x16x32_bf16 a[140:143], a[76:79], a[228:231], a[140:143]
    ds_read_b64_tr_b16 a[70:71], v37 offset:9216
    ds_read_b128 a[200:203], v34 offset:4096
    v_mfma_f32_16x16x32_bf16 a[24:27], a[76:79], a[232:235], a[24:27]
    ds_read_b64_tr_b16 a[72:73], v38 offset:8192
    ds_read_b128 a[204:207], v34 offset:6144
    v_mfma_f32_16x16x32_bf16 a[28:31], a[76:79], a[236:239], a[28:31]
    ds_read_b64_tr_b16 a[74:75], v38 offset:9216
    buffer_store_dwordx4 v[116:119], v29, s[40:43], s24 offen offset:3072
    v_mfma_f32_16x16x32_bf16 a[144:147], a[80:83], a[224:227], a[144:147]
    ds_read_b64_tr_b16 a[76:77], v39 offset:8192
    ds_read_b128 a[208:211], v35 offset:0
    v_mfma_f32_16x16x32_bf16 a[148:151], a[80:83], a[228:231], a[148:151]
    ds_read_b128 a[212:215], v35 offset:2048
    ds_read_b128 a[216:219], v35 offset:4096
    v_mfma_f32_16x16x32_bf16 a[32:35], a[80:83], a[232:235], a[32:35]
    ds_read_b64_tr_b16 a[78:79], v39 offset:9216
    v_cndmask_b32 v60, 0, v58, vcc
    v_mfma_f32_16x16x32_bf16 a[36:39], a[80:83], a[236:239], a[36:39]
    ds_read_b128 a[220:223], v35 offset:6144
    s_waitcnt lgkmcnt(0)
    v_mfma_f32_16x16x32_bf16 a[152:155], a[84:87], a[224:227], a[152:155]
    ds_read_b64_tr_b16 a[80:81], v40 offset:8192
    s_add_u32 s76, s72, s75
    v_mfma_f32_16x16x32_bf16 a[156:159], a[84:87], a[228:231], a[156:159]
    s_add_u32 s77, s73, s75
    v_or_b32 v141, v59, v60
    v_mfma_f32_16x16x32_bf16 a[40:43], a[84:87], a[232:235], a[40:43]
    ds_read_b64_tr_b16 a[82:83], v40 offset:9216
    s_add_u32 s75, s75, 128
    v_mfma_f32_16x16x32_bf16 a[44:47], a[84:87], a[236:239], a[44:47]
    v_cmp_eq_i32 vcc, -8, v56
    v_mfma_f32_16x16x32_bf16 a[160:163], a[88:91], a[224:227], a[160:163]
    ds_read_b64_tr_b16 a[84:85], v41 offset:8192
    s_add_u32 s24, s6, 53248
    v_mfma_f32_16x16x32_bf16 a[164:167], a[88:91], a[228:231], a[164:167]
    s_cmp_eq_u32 s75, 1152
    s_cselect_b32 s75, 0, s75
    v_mfma_f32_16x16x32_bf16 a[48:51], a[88:91], a[232:235], a[48:51]
    ds_read_b64_tr_b16 a[86:87], v41 offset:9216
    s_add_u32 m0, s74, 32768
    v_mfma_f32_16x16x32_bf16 a[52:55], a[88:91], a[236:239], a[52:55]
    s_add_u32 s23, s76, 0
    buffer_load_dwordx4 v30, s[44:47], s23 offen lds
    v_mfma_f32_16x16x32_bf16 a[168:171], a[92:95], a[224:227], a[168:171]
    ds_read_b64_tr_b16 a[88:89], v42 offset:8192
    s_add_u32 m0, s74, 33792
    v_mfma_f32_16x16x32_bf16 a[172:175], a[92:95], a[228:231], a[172:175]
    s_add_u32 s23, s76, 9216
    buffer_load_dwordx4 v31, s[44:47], s23 offen lds
    v_mfma_f32_16x16x32_bf16 a[56:59], a[92:95], a[232:235], a[56:59]
    ds_read_b64_tr_b16 a[90:91], v42 offset:9216
    v_cndmask_b32 v59, 0, v57, vcc
    v_mfma_f32_16x16x32_bf16 a[60:63], a[92:95], a[236:239], a[60:63]
    s_add_u32 m0, s74, 34816
    s_add_u32 s23, s76, 73728
    v_mfma_f32_16x16x32_bf16 v[160:163], a[96:99], a[224:227], v[160:163]
    ds_read_b64_tr_b16 a[92:93], v43 offset:8192
    buffer_load_dwordx4 v30, s[44:47], s23 offen lds
    v_mfma_f32_16x16x32_bf16 v[176:179], a[96:99], a[228:231], v[176:179]
    s_add_u32 m0, s74, 35840
    v_cmp_eq_i32 vcc, -9, v56
    v_mfma_f32_16x16x32_bf16 v[208:211], a[96:99], a[232:235], v[208:211]
    ds_read_b64_tr_b16 a[94:95], v43 offset:9216
    s_add_u32 s23, s76, 82944
    v_mfma_f32_16x16x32_bf16 v[240:243], a[96:99], a[236:239], v[240:243]
    buffer_load_dwordx4 v31, s[44:47], s23 offen lds
    v_mfma_f32_16x16x32_bf16 v[164:167], a[100:103], a[224:227], v[164:167]
    ds_read_b64_tr_b16 a[96:97], v44 offset:4608
    s_add_u32 m0, s74, 36864
    v_mfma_f32_16x16x32_bf16 v[180:183], a[100:103], a[228:231], v[180:183]
    s_add_u32 s23, s77, 0
    v_mfma_f32_16x16x32_bf16 v[212:215], a[100:103], a[232:235], v[212:215]
    ds_read_b64_tr_b16 a[98:99], v44 offset:4752
    buffer_load_dwordx4 v30, s[44:47], s23 offen lds
    v_mfma_f32_16x16x32_bf16 v[244:247], a[100:103], a[236:239], v[244:247]
    s_add_u32 m0, s74, 37888
    buffer_store_dwordx4 v[120:123], v29, s[40:43], s24 offen offset:1024
    v_mfma_f32_16x16x32_bf16 v[168:171], a[104:107], a[224:227], v[168:171]
    ds_read_b64_tr_b16 a[100:101], v45 offset:4608
    s_add_u32 s23, s77, 9216
    v_mfma_f32_16x16x32_bf16 v[184:187], a[104:107], a[228:231], v[184:187]
    buffer_load_dwordx4 v31, s[44:47], s23 offen lds
    s_add_u32 m0, s74, 38912
    v_mfma_f32_16x16x32_bf16 v[216:219], a[104:107], a[232:235], v[216:219]
    ds_read_b64_tr_b16 a[102:103], v45 offset:4752
    v_cndmask_b32 v60, 0, v58, vcc
    v_mfma_f32_16x16x32_bf16 v[248:251], a[104:107], a[236:239], v[248:251]
    s_add_u32 s23, s77, 73728
    buffer_load_dwordx4 v30, s[44:47], s23 offen lds
    v_mfma_f32_16x16x32_bf16 v[172:175], a[108:111], a[224:227], v[172:175]
    ds_read_b64_tr_b16 a[104:105], v46 offset:4608
    s_add_u32 m0, s74, 39936
    v_mfma_f32_16x16x32_bf16 v[188:191], a[108:111], a[228:231], v[188:191]
    s_add_u32 s23, s77, 82944
    v_or_b32 v142, v59, v60
    v_mfma_f32_16x16x32_bf16 v[220:223], a[108:111], a[232:235], v[220:223]
    ds_read_b64_tr_b16 a[106:107], v46 offset:4752
    buffer_load_dwordx4 v31, s[44:47], s23 offen lds
    v_mfma_f32_16x16x32_bf16 v[252:255], a[108:111], a[236:239], v[252:255]
    ds_read_b64_tr_b16 a[108:109], v47 offset:4608
    ds_read_b64_tr_b16 a[110:111], v47 offset:4752
    v_mfma_f32_16x16x32_bf16 a[112:115], a[64:67], a[240:243], a[112:115]
    v_cmp_eq_i32 vcc, -10, v56
    v_mfma_f32_16x16x32_bf16 a[116:119], a[64:67], a[244:247], a[116:119]
    s_nop 0
    v_cndmask_b32 v59, 0, v57, vcc
    v_mfma_f32_16x16x32_bf16 a[0:3], a[64:67], a[248:251], a[0:3]
    s_add_u32 s24, s6, 53248
    v_cmp_eq_i32 vcc, -11, v56
    v_mfma_f32_16x16x32_bf16 a[4:7], a[64:67], a[252:255], a[4:7]
    s_nop 0
    v_cndmask_b32 v60, 0, v58, vcc
    v_mfma_f32_16x16x32_bf16 a[120:123], a[68:71], a[240:243], a[120:123]
    v_or_b32 v143, v59, v60
    v_mfma_f32_16x16x32_bf16 a[124:127], a[68:71], a[244:247], a[124:127]
    buffer_store_dwordx4 v[124:127], v29, s[40:43], s24 offen offset:3072
    v_mfma_f32_16x16x32_bf16 a[8:11], a[68:71], a[248:251], a[8:11]
    v_cmp_eq_i32 vcc, 24, v56
    v_mfma_f32_16x16x32_bf16 a[12:15], a[68:71], a[252:255], a[12:15]
    s_waitcnt vmcnt(33) lgkmcnt(0)
    v_cndmask_b32 v59, 0, v57, vcc
    v_mfma_f32_16x16x32_bf16 a[128:131], a[72:75], a[240:243], a[128:131]
    s_barrier
    v_mfma_f32_16x16x32_bf16 a[132:135], a[72:75], a[244:247], a[132:135]
    ds_read_b64_tr_b16 a[64:65], v36 offset:16384
    s_add_u32 s82, s11, s79
    v_mfma_f32_16x16x32_bf16 a[16:19], a[72:75], a[248:251], a[16:19]
    ds_read_b64_tr_b16 a[66:67], v36 offset:17408
    v_cmp_eq_i32 vcc, 23, v56
    v_mfma_f32_16x16x32_bf16 a[20:23], a[72:75], a[252:255], a[20:23]
    s_add_u32 s79, s79, 0x80000
    v_mfma_f32_16x16x32_bf16 a[136:139], a[76:79], a[240:243], a[136:139]
    ds_read_b64_tr_b16 a[68:69], v37 offset:16384
    s_add_u32 s24, s6, 16384
    v_mfma_f32_16x16x32_bf16 a[140:143], a[76:79], a[244:247], a[140:143]
    ds_read_b64_tr_b16 a[70:71], v37 offset:17408
    v_mfma_f32_16x16x32_bf16 a[24:27], a[76:79], a[248:251], a[24:27]
    ds_read_b64_tr_b16 a[72:73], v38 offset:16384
    v_cndmask_b32 v60, 0, v58, vcc
    v_mfma_f32_16x16x32_bf16 a[28:31], a[76:79], a[252:255], a[28:31]
    ds_read_b64_tr_b16 a[74:75], v38 offset:17408
    v_or_b32 v144, v59, v60
    v_mfma_f32_16x16x32_bf16 a[144:147], a[80:83], a[240:243], a[144:147]
    ds_read_b64_tr_b16 a[76:77], v39 offset:16384
    v_mfma_f32_16x16x32_bf16 a[148:151], a[80:83], a[244:247], a[148:151]
    s_cmp_eq_u32 s79, 4718592
    s_cselect_b32 s79, 0, s79
    v_mfma_f32_16x16x32_bf16 a[32:35], a[80:83], a[248:251], a[32:35]
    ds_read_b64_tr_b16 a[78:79], v39 offset:17408
    s_add_u32 m0, s30, 98304
    v_mfma_f32_16x16x32_bf16 a[36:39], a[80:83], a[252:255], a[36:39]
    s_add_u32 s23, s82, 0
    buffer_load_dwordx4 v26, s[52:55], s23 offen lds
    v_mfma_f32_16x16x32_bf16 a[152:155], a[84:87], a[240:243], a[152:155]
    ds_read_b64_tr_b16 a[80:81], v40 offset:16384
    s_add_u32 m0, s30, 99328
    v_mfma_f32_16x16x32_bf16 a[156:159], a[84:87], a[244:247], a[156:159]
    s_add_u32 s23, s82, 32768
    v_cmp_eq_i32 vcc, 22, v56
    v_mfma_f32_16x16x32_bf16 a[40:43], a[84:87], a[248:251], a[40:43]
    ds_read_b64_tr_b16 a[82:83], v40 offset:17408
    buffer_load_dwordx4 v26, s[52:55], s23 offen lds
    v_mfma_f32_16x16x32_bf16 a[44:47], a[84:87], a[252:255], a[44:47]
    s_add_u32 m0, s30, 100352
    v_mfma_f32_16x16x32_bf16 a[160:163], a[88:91], a[240:243], a[160:163]
    ds_read_b64_tr_b16 a[84:85], v41 offset:16384
    v_mfma_f32_16x16x32_bf16 a[164:167], a[88:91], a[244:247], a[164:167]
    s_add_u32 s23, s82, 65536
    buffer_store_dwordx4 v[192:195], v29, s[40:43], s24 offen offset:0
    v_mfma_f32_16x16x32_bf16 a[48:51], a[88:91], a[248:251], a[48:51]
    ds_read_b64_tr_b16 a[86:87], v41 offset:17408
    buffer_load_dwordx4 v27, s[52:55], s23 offen lds
    v_mfma_f32_16x16x32_bf16 a[52:55], a[88:91], a[252:255], a[52:55]
    s_add_u32 m0, s30, 101376
    v_cndmask_b32 v59, 0, v57, vcc
    v_mfma_f32_16x16x32_bf16 a[168:171], a[92:95], a[240:243], a[168:171]
    ds_read_b64_tr_b16 a[88:89], v42 offset:16384
    s_add_u32 s23, s82, 98304
    v_mfma_f32_16x16x32_bf16 a[172:175], a[92:95], a[244:247], a[172:175]
    buffer_load_dwordx4 v27, s[52:55], s23 offen lds
    v_mfma_f32_16x16x32_bf16 a[56:59], a[92:95], a[248:251], a[56:59]
    ds_read_b64_tr_b16 a[90:91], v42 offset:17408
    v_cmp_eq_i32 vcc, 21, v56
    v_mfma_f32_16x16x32_bf16 a[60:63], a[92:95], a[252:255], a[60:63]
    s_add_u32 m0, s10, 0
    s_add_u32 s23, s78, s10
    v_mfma_f32_16x16x32_bf16 v[160:163], a[96:99], a[240:243], v[160:163]
    ds_read_b64_tr_b16 a[92:93], v43 offset:16384
    v_mfma_f32_16x16x32_bf16 v[176:179], a[96:99], a[244:247], v[176:179]
    buffer_load_dwordx4 v29, s[48:51], s23 offen sc1 lds
    v_cndmask_b32 v60, 0, v58, vcc
    v_mfma_f32_16x16x32_bf16 v[208:211], a[96:99], a[248:251], v[208:211]
    ds_read_b64_tr_b16 a[94:95], v43 offset:17408
    s_add_u32 m0, s10, 4096
    v_mfma_f32_16x16x32_bf16 v[240:243], a[96:99], a[252:255], v[240:243]
    s_add_u32 s23, s23, 4096
    v_mfma_f32_16x16x32_bf16 v[164:167], a[100:103], a[240:243], v[164:167]
    ds_read_b64_tr_b16 a[96:97], v44 offset:9216
    s_add_u32 s24, s6, 16384
    v_mfma_f32_16x16x32_bf16 v[180:183], a[100:103], a[244:247], v[180:183]
    buffer_load_dwordx4 v29, s[48:51], s23 offen sc1 lds
    v_mfma_f32_16x16x32_bf16 v[212:215], a[100:103], a[248:251], v[212:215]
    ds_read_b64_tr_b16 a[98:99], v44 offset:9360
    s_add_u32 s78, s78, 9216
    v_mfma_f32_16x16x32_bf16 v[244:247], a[100:103], a[252:255], v[244:247]
    s_cmp_eq_u32 s78, 82944
    s_cselect_b32 s78, 0, s78
    v_mfma_f32_16x16x32_bf16 v[168:171], a[104:107], a[240:243], v[168:171]
    ds_read_b64_tr_b16 a[100:101], v45 offset:9216
    v_or_b32 v145, v59, v60
    v_mfma_f32_16x16x32_bf16 v[184:187], a[104:107], a[244:247], v[184:187]
    v_cmp_eq_i32 vcc, 8, v56
    v_mfma_f32_16x16x32_bf16 v[216:219], a[104:107], a[248:251], v[216:219]
    ds_read_b64_tr_b16 a[102:103], v45 offset:9360
    v_mfma_f32_16x16x32_bf16 v[248:251], a[104:107], a[252:255], v[248:251]
    s_cmp_lg_u32 s22, 0
    s_cbranch_scc1 f1_wb6
    s_mov_b32 m0, 8192
    s_add_u32 s23, s23, 4096
    buffer_load_dwordx4 v29, s[48:51], s23 offen sc1 lds
f1_wb6:
    v_mfma_f32_16x16x32_bf16 v[172:175], a[108:111], a[240:243], v[172:175]
    ds_read_b64_tr_b16 a[104:105], v46 offset:9216
    buffer_store_dwordx4 v[196:199], v29, s[40:43], s24 offen offset:2048
    v_mfma_f32_16x16x32_bf16 v[188:191], a[108:111], a[244:247], v[188:191]
    v_cndmask_b32 v59, 0, v57, vcc
    v_mfma_f32_16x16x32_bf16 v[220:223], a[108:111], a[248:251], v[220:223]
    ds_read_b64_tr_b16 a[106:107], v46 offset:9360
    v_cmp_eq_i32 vcc, 7, v56
    v_mfma_f32_16x16x32_bf16 v[252:255], a[108:111], a[252:255], v[252:255]
    ds_read_b64_tr_b16 a[108:109], v47 offset:9216
    ds_read_b64_tr_b16 a[110:111], v47 offset:9360
    s_waitcnt lgkmcnt(15)
    v_mfma_f32_16x16x32_bf16 a[112:115], a[64:67], a[192:195], a[112:115]
    v_cndmask_b32 v60, 0, v58, vcc
    v_or_b32 v146, v59, v60
    v_mfma_f32_16x16x32_bf16 a[116:119], a[64:67], a[196:199], a[116:119]
    v_cmp_eq_i32 vcc, 6, v56
    v_mfma_f32_16x16x32_bf16 a[0:3], a[64:67], a[200:203], a[0:3]
    s_add_u32 s24, s6, 20480
    v_cndmask_b32 v59, 0, v57, vcc
    v_mfma_f32_16x16x32_bf16 a[4:7], a[64:67], a[204:207], a[4:7]
    v_cmp_eq_i32 vcc, 5, v56
    s_nop 1
    v_cndmask_b32 v60, 0, v58, vcc
    v_mfma_f32_16x16x32_bf16 a[120:123], a[68:71], a[192:195], a[120:123]
    buffer_store_dwordx4 v[200:203], v29, s[40:43], s24 offen offset:0
    v_or_b32 v147, v59, v60
    v_mfma_f32_16x16x32_bf16 a[124:127], a[68:71], a[196:199], a[124:127]
    v_cmp_gt_u32 vcc, 2, v2
    v_mfma_f32_16x16x32_bf16 a[8:11], a[68:71], a[200:203], a[8:11]
    s_add_u32 s24, s6, 20480
    v_cndmask_b32 v144, 0, v144, vcc
    v_mfma_f32_16x16x32_bf16 a[12:15], a[68:71], a[204:207], a[12:15]
    s_waitcnt lgkmcnt(0)
    v_cndmask_b32 v145, 0, v145, vcc
    v_mfma_f32_16x16x32_bf16 a[128:131], a[72:75], a[192:195], a[128:131]
    s_barrier
    v_cndmask_b32 v146, 0, v146, vcc
    v_mfma_f32_16x16x32_bf16 a[132:135], a[72:75], a[196:199], a[132:135]
    ds_read_b64_tr_b16 a[64:65], v36 offset:24576
    s_waitcnt vmcnt(30)
    v_mfma_f32_16x16x32_bf16 a[16:19], a[72:75], a[200:203], a[16:19]
    ds_read_b64_tr_b16 a[66:67], v36 offset:25600
    ds_read_b128 a[224:227], v32 offset:0
    v_mfma_f32_16x16x32_bf16 a[20:23], a[72:75], a[204:207], a[20:23]
    v_mfma_f32_16x16x32_bf16 a[136:139], a[76:79], a[192:195], a[136:139]
    ds_read_b64_tr_b16 a[68:69], v37 offset:24576
    ds_read_b128 a[228:231], v32 offset:2048
    v_mfma_f32_16x16x32_bf16 a[140:143], a[76:79], a[196:199], a[140:143]
    ds_read_b64_tr_b16 a[70:71], v37 offset:25600
    ds_read_b128 a[232:235], v32 offset:4096
    v_mfma_f32_16x16x32_bf16 a[24:27], a[76:79], a[200:203], a[24:27]
    ds_read_b64_tr_b16 a[72:73], v38 offset:24576
    ds_read_b128 a[236:239], v32 offset:6144
    v_mfma_f32_16x16x32_bf16 a[28:31], a[76:79], a[204:207], a[28:31]
    ds_read_b64_tr_b16 a[74:75], v38 offset:25600
    buffer_store_dwordx4 v[204:207], v29, s[40:43], s24 offen offset:2048
    v_mfma_f32_16x16x32_bf16 a[144:147], a[80:83], a[192:195], a[144:147]
    ds_read_b64_tr_b16 a[76:77], v39 offset:24576
    ds_read_b128 a[240:243], v33 offset:0
    v_mfma_f32_16x16x32_bf16 a[148:151], a[80:83], a[196:199], a[148:151]
    ds_read_b128 a[244:247], v33 offset:2048
    ds_read_b128 a[248:251], v33 offset:4096
    v_mfma_f32_16x16x32_bf16 a[32:35], a[80:83], a[200:203], a[32:35]
    ds_read_b64_tr_b16 a[78:79], v39 offset:25600
    v_cndmask_b32 v147, 0, v147, vcc
    v_mfma_f32_16x16x32_bf16 a[36:39], a[80:83], a[204:207], a[36:39]
    ds_read_b128 a[252:255], v33 offset:6144
    s_waitcnt lgkmcnt(0)
    v_mfma_f32_16x16x32_bf16 a[152:155], a[84:87], a[192:195], a[152:155]
    ds_read_b64_tr_b16 a[80:81], v40 offset:24576
    s_add_u32 s76, s72, s75
    v_mfma_f32_16x16x32_bf16 a[156:159], a[84:87], a[196:199], a[156:159]
    s_add_u32 s77, s73, s75
    v_cmp_eq_u32 vcc, 2, v2
    v_mfma_f32_16x16x32_bf16 a[40:43], a[84:87], a[200:203], a[40:43]
    ds_read_b64_tr_b16 a[82:83], v40 offset:25600
    s_add_u32 s75, s75, 128
    v_mfma_f32_16x16x32_bf16 a[44:47], a[84:87], a[204:207], a[44:47]
    v_mov_b32 v56, 1.0
    v_mfma_f32_16x16x32_bf16 a[160:163], a[88:91], a[192:195], a[160:163]
    ds_read_b64_tr_b16 a[84:85], v41 offset:24576
    s_add_u32 s24, s6, 16384
    v_mfma_f32_16x16x32_bf16 a[164:167], a[88:91], a[196:199], a[164:167]
    s_cmp_eq_u32 s75, 1152
    s_cselect_b32 s75, 0, s75
    v_mfma_f32_16x16x32_bf16 a[48:51], a[88:91], a[200:203], a[48:51]
    ds_read_b64_tr_b16 a[86:87], v41 offset:25600
    s_add_u32 m0, s74, 65536
    v_mfma_f32_16x16x32_bf16 a[52:55], a[88:91], a[204:207], a[52:55]
    s_add_u32 s23, s76, 0
    buffer_load_dwordx4 v30, s[44:47], s23 offen lds
    v_mfma_f32_16x16x32_bf16 a[168:171], a[92:95], a[192:195], a[168:171]
    ds_read_b64_tr_b16 a[88:89], v42 offset:24576
    s_add_u32 m0, s74, 66560
    v_mfma_f32_16x16x32_bf16 a[172:175], a[92:95], a[196:199], a[172:175]
    s_add_u32 s23, s76, 9216
    buffer_load_dwordx4 v31, s[44:47], s23 offen lds
    v_mfma_f32_16x16x32_bf16 a[56:59], a[92:95], a[200:203], a[56:59]
    ds_read_b64_tr_b16 a[90:91], v42 offset:25600
    v_cndmask_b32 v148, 0, v56, vcc
    v_mfma_f32_16x16x32_bf16 a[60:63], a[92:95], a[204:207], a[60:63]
    s_add_u32 m0, s74, 67584
    s_add_u32 s23, s76, 73728
    v_mfma_f32_16x16x32_bf16 v[160:163], a[96:99], a[192:195], v[160:163]
    ds_read_b64_tr_b16 a[92:93], v43 offset:24576
    buffer_load_dwordx4 v30, s[44:47], s23 offen lds
    v_mfma_f32_16x16x32_bf16 v[176:179], a[96:99], a[196:199], v[176:179]
    s_add_u32 m0, s74, 68608
    v_cndmask_b32 v149, 0, v56, vcc
    v_mfma_f32_16x16x32_bf16 v[208:211], a[96:99], a[200:203], v[208:211]
    ds_read_b64_tr_b16 a[94:95], v43 offset:25600
    s_add_u32 s23, s76, 82944
    v_mfma_f32_16x16x32_bf16 v[240:243], a[96:99], a[204:207], v[240:243]
    buffer_load_dwordx4 v31, s[44:47], s23 offen lds
    v_mfma_f32_16x16x32_bf16 v[164:167], a[100:103], a[192:195], v[164:167]
    ds_read_b64_tr_b16 a[96:97], v44 offset:13824
    s_add_u32 m0, s74, 69632
    v_mfma_f32_16x16x32_bf16 v[180:183], a[100:103], a[196:199], v[180:183]
    s_add_u32 s23, s77, 0
    v_mfma_f32_16x16x32_bf16 v[212:215], a[100:103], a[200:203], v[212:215]
    ds_read_b64_tr_b16 a[98:99], v44 offset:13968
    buffer_load_dwordx4 v30, s[44:47], s23 offen lds
    v_mfma_f32_16x16x32_bf16 v[244:247], a[100:103], a[204:207], v[244:247]
    s_add_u32 m0, s74, 70656
    buffer_store_dwordx4 v[224:227], v29, s[40:43], s24 offen offset:1024
    v_mfma_f32_16x16x32_bf16 v[168:171], a[104:107], a[192:195], v[168:171]
    ds_read_b64_tr_b16 a[100:101], v45 offset:13824
    s_add_u32 s23, s77, 9216
    v_mfma_f32_16x16x32_bf16 v[184:187], a[104:107], a[196:199], v[184:187]
    buffer_load_dwordx4 v31, s[44:47], s23 offen lds
    s_add_u32 m0, s74, 71680
    v_mfma_f32_16x16x32_bf16 v[216:219], a[104:107], a[200:203], v[216:219]
    ds_read_b64_tr_b16 a[102:103], v45 offset:13968
    v_cndmask_b32 v150, 0, v56, vcc
    v_mfma_f32_16x16x32_bf16 v[248:251], a[104:107], a[204:207], v[248:251]
    s_add_u32 s23, s77, 73728
    buffer_load_dwordx4 v30, s[44:47], s23 offen lds
    v_mfma_f32_16x16x32_bf16 v[172:175], a[108:111], a[192:195], v[172:175]
    ds_read_b64_tr_b16 a[104:105], v46 offset:13824
    s_add_u32 m0, s74, 72704
    v_mfma_f32_16x16x32_bf16 v[188:191], a[108:111], a[196:199], v[188:191]
    s_add_u32 s23, s77, 82944
    v_cndmask_b32 v151, 0, v56, vcc
    v_mfma_f32_16x16x32_bf16 v[220:223], a[108:111], a[200:203], v[220:223]
    ds_read_b64_tr_b16 a[106:107], v46 offset:13968
    buffer_load_dwordx4 v31, s[44:47], s23 offen lds
    v_mfma_f32_16x16x32_bf16 v[252:255], a[108:111], a[204:207], v[252:255]
    ds_read_b64_tr_b16 a[108:109], v47 offset:13824
    ds_read_b64_tr_b16 a[110:111], v47 offset:13968
    v_mfma_f32_16x16x32_bf16 a[112:115], a[64:67], a[208:211], a[112:115]
    s_and_b32 s4, s2, 3
    s_mul_i32 s7, s4, 288
    v_mfma_f32_16x16x32_bf16 a[116:119], a[64:67], a[212:215], a[116:119]
    s_mov_b32 s8, 3641
    v_mfma_f32_16x16x32_bf16 a[0:3], a[64:67], a[216:219], a[0:3]
    s_add_u32 s24, s6, 16384
    v_mfma_f32_16x16x32_bf16 a[4:7], a[64:67], a[220:223], a[4:7]
    s_lshr_b32 s5, s2, 2
    s_cmp_ge_u32 s5, 16
    s_cselect_b64 s[70:71], -1, 0
    v_mfma_f32_16x16x32_bf16 a[120:123], a[68:71], a[208:211], a[120:123]
    s_lshl_b32 s25, s22, 6
    s_add_u32 s25, s25, 0
    v_add_u32 v56, s25, v1
    v_mfma_f32_16x16x32_bf16 a[124:127], a[68:71], a[212:215], a[124:127]
    buffer_store_dwordx4 v[228:231], v29, s[40:43], s24 offen offset:3072
    v_mfma_f32_16x16x32_bf16 a[8:11], a[68:71], a[216:219], a[8:11]
    v_mul_u32_u24 v59, s8, v56
    v_lshrrev_b32 v59, 16, v59
    v_mfma_f32_16x16x32_bf16 a[12:15], a[68:71], a[220:223], a[12:15]
    s_waitcnt vmcnt(33) lgkmcnt(0)
    v_mfma_f32_16x16x32_bf16 a[128:131], a[72:75], a[208:211], a[128:131]
    s_barrier
    v_mul_u32_u24 v58, 18, v59
    v_mfma_f32_16x16x32_bf16 a[132:135], a[72:75], a[212:215], a[132:135]
    ds_read_b64_tr_b16 a[64:65], v36 offset:32768
    s_add_u32 s82, s11, s79
    v_mfma_f32_16x16x32_bf16 a[16:19], a[72:75], a[216:219], a[16:19]
    ds_read_b64_tr_b16 a[66:67], v36 offset:33792
    v_sub_u32 v58, v56, v58
    v_mfma_f32_16x16x32_bf16 a[20:23], a[72:75], a[220:223], a[20:23]
    s_add_u32 s79, s79, 0x80000
    v_mfma_f32_16x16x32_bf16 a[136:139], a[76:79], a[208:211], a[136:139]
    ds_read_b64_tr_b16 a[68:69], v37 offset:32768
    s_add_u32 s24, s6, 20480
    v_mfma_f32_16x16x32_bf16 a[140:143], a[76:79], a[212:215], a[140:143]
    ds_read_b64_tr_b16 a[70:71], v37 offset:33792
    v_lshlrev_b32 v61, 4, v58
    v_mfma_f32_16x16x32_bf16 a[24:27], a[76:79], a[216:219], a[24:27]
    ds_read_b64_tr_b16 a[72:73], v38 offset:32768
    v_add_u32 v61, s7, v61
    v_mfma_f32_16x16x32_bf16 a[28:31], a[76:79], a[220:223], a[28:31]
    ds_read_b64_tr_b16 a[74:75], v38 offset:33792
    v_mad_u32_u24 v12, v59, s9, v61
    v_mfma_f32_16x16x32_bf16 a[144:147], a[80:83], a[208:211], a[144:147]
    ds_read_b64_tr_b16 a[76:77], v39 offset:32768
    v_bfe_u32 v60, v59, 3, 1
    v_mfma_f32_16x16x32_bf16 a[148:151], a[80:83], a[212:215], a[148:151]
    s_cmp_eq_u32 s79, 4718592
    s_cselect_b32 s79, 0, s79
    v_mfma_f32_16x16x32_bf16 a[32:35], a[80:83], a[216:219], a[32:35]
    ds_read_b64_tr_b16 a[78:79], v39 offset:33792
    s_add_u32 m0, s30, 114688
    v_mfma_f32_16x16x32_bf16 a[36:39], a[80:83], a[220:223], a[36:39]
    s_add_u32 s23, s82, 0
    buffer_load_dwordx4 v26, s[52:55], s23 offen lds
    v_mfma_f32_16x16x32_bf16 a[152:155], a[84:87], a[208:211], a[152:155]
    ds_read_b64_tr_b16 a[80:81], v40 offset:32768
    s_add_u32 m0, s30, 115712
    v_mfma_f32_16x16x32_bf16 a[156:159], a[84:87], a[212:215], a[156:159]
    s_add_u32 s23, s82, 32768
    v_bfe_u32 v62, v59, 4, 1
    v_mfma_f32_16x16x32_bf16 a[40:43], a[84:87], a[216:219], a[40:43]
    ds_read_b64_tr_b16 a[82:83], v40 offset:33792
    buffer_load_dwordx4 v26, s[52:55], s23 offen lds
    v_mfma_f32_16x16x32_bf16 a[44:47], a[84:87], a[220:223], a[44:47]
    s_add_u32 m0, s30, 116736
    v_mfma_f32_16x16x32_bf16 a[160:163], a[88:91], a[208:211], a[160:163]
    ds_read_b64_tr_b16 a[84:85], v41 offset:32768
    v_and_b32 v59, 7, v59
    v_mfma_f32_16x16x32_bf16 a[164:167], a[88:91], a[212:215], a[164:167]
    s_add_u32 s23, s82, 65536
    buffer_store_dwordx4 v[232:235], v29, s[40:43], s24 offen offset:1024
    v_mfma_f32_16x16x32_bf16 a[48:51], a[88:91], a[216:219], a[48:51]
    ds_read_b64_tr_b16 a[86:87], v41 offset:33792
    buffer_load_dwordx4 v27, s[52:55], s23 offen lds
    v_mfma_f32_16x16x32_bf16 a[52:55], a[88:91], a[220:223], a[52:55]
    s_add_u32 m0, s30, 117760
    v_mfma_f32_16x16x32_bf16 a[168:171], a[92:95], a[208:211], a[168:171]
    ds_read_b64_tr_b16 a[88:89], v42 offset:32768
    s_add_u32 s23, s82, 98304
    v_mfma_f32_16x16x32_bf16 a[172:175], a[92:95], a[212:215], a[172:175]
    buffer_load_dwordx4 v27, s[52:55], s23 offen lds
    v_lshl_or_b32 v59, v60, 4, v59
    v_mfma_f32_16x16x32_bf16 a[56:59], a[92:95], a[216:219], a[56:59]
    ds_read_b64_tr_b16 a[90:91], v42 offset:33792
    v_lshl_or_b32 v59, v62, 3, v59
    v_mfma_f32_16x16x32_bf16 a[60:63], a[92:95], a[220:223], a[60:63]
    s_add_u32 m0, s10, 9216
    s_add_u32 s23, s78, s10
    v_mfma_f32_16x16x32_bf16 v[160:163], a[96:99], a[208:211], v[160:163]
    ds_read_b64_tr_b16 a[92:93], v43 offset:32768
    v_lshrrev_b32 v62, 4, v59
    v_mfma_f32_16x16x32_bf16 v[176:179], a[96:99], a[212:215], v[176:179]
    buffer_load_dwordx4 v29, s[48:51], s23 offen sc1 lds
    v_lshl_add_u32 v62, v62, 1, v59
    v_mfma_f32_16x16x32_bf16 v[208:211], a[96:99], a[216:219], v[208:211]
    ds_read_b64_tr_b16 a[94:95], v43 offset:33792
    s_add_u32 m0, s10, 13312
    v_mfma_f32_16x16x32_bf16 v[240:243], a[96:99], a[220:223], v[240:243]
    s_add_u32 s23, s23, 4096
    v_mfma_f32_16x16x32_bf16 v[164:167], a[100:103], a[208:211], v[164:167]
    ds_read_b64_tr_b16 a[96:97], v44 offset:18432
    s_add_u32 s24, s6, 20480
    v_mfma_f32_16x16x32_bf16 v[180:183], a[100:103], a[212:215], v[180:183]
    buffer_load_dwordx4 v29, s[48:51], s23 offen sc1 lds
    v_and_b32 v63, 0x10, v59
    v_mfma_f32_16x16x32_bf16 v[212:215], a[100:103], a[216:219], v[212:215]
    ds_read_b64_tr_b16 a[98:99], v44 offset:18576
    s_add_u32 s78, s78, 9216
    v_mfma_f32_16x16x32_bf16 v[244:247], a[100:103], a[220:223], v[244:247]
    s_cmp_eq_u32 s78, 82944
    s_cselect_b32 s78, 0, s78
    v_mfma_f32_16x16x32_bf16 v[168:171], a[104:107], a[208:211], v[168:171]
    ds_read_b64_tr_b16 a[100:101], v45 offset:18432
    v_lshrrev_b32 v63, 1, v63
    v_mfma_f32_16x16x32_bf16 v[184:187], a[104:107], a[212:215], v[184:187]
    v_and_b32 v60, 4, v59
    v_mfma_f32_16x16x32_bf16 v[216:219], a[104:107], a[216:219], v[216:219]
    ds_read_b64_tr_b16 a[102:103], v45 offset:18576
    v_or_b32 v63, v63, v60
    v_mfma_f32_16x16x32_bf16 v[248:251], a[104:107], a[220:223], v[248:251]
    s_cmp_lg_u32 s22, 0
    s_cbranch_scc1 f1_wb7
    s_mov_b32 m0, 17408
    s_add_u32 s23, s23, 4096
    buffer_load_dwordx4 v29, s[48:51], s23 offen sc1 lds
f1_wb7:
    v_mfma_f32_16x16x32_bf16 v[172:175], a[108:111], a[208:211], v[172:175]
    ds_read_b64_tr_b16 a[104:105], v46 offset:18432
    buffer_store_dwordx4 v[236:239], v29, s[40:43], s24 offen offset:3072
    v_mfma_f32_16x16x32_bf16 v[188:191], a[108:111], a[212:215], v[188:191]
    v_bfe_u32 v60, v59, 3, 1
    v_lshl_or_b32 v63, v60, 1, v63
    v_mfma_f32_16x16x32_bf16 v[220:223], a[108:111], a[216:219], v[220:223]
    ds_read_b64_tr_b16 a[106:107], v46 offset:18576
    v_bfe_u32 v60, v59, 1, 1
    v_mfma_f32_16x16x32_bf16 v[252:255], a[108:111], a[220:223], v[252:255]
    ds_read_b64_tr_b16 a[108:109], v47 offset:18432
    ds_read_b64_tr_b16 a[110:111], v47 offset:18576
    s_waitcnt lgkmcnt(15)
    v_mfma_f32_16x16x32_bf16 a[112:115], a[64:67], a[224:227], a[112:115]
    v_or_b32 v63, v63, v60
    v_mul_u32_u24 v63, 18, v63
    v_mfma_f32_16x16x32_bf16 a[116:119], a[64:67], a[228:231], a[116:119]
    v_and_b32 v60, 1, v59
    v_add3_u32 v63, v63, v60, 16
    v_mfma_f32_16x16x32_bf16 a[0:3], a[64:67], a[232:235], a[0:3]
    v_cndmask_b32 v62, v62, v63, s[70:71]
    v_mad_u32_u24 v15, v62, s9, v61
    v_mfma_f32_16x16x32_bf16 a[4:7], a[64:67], a[236:239], a[4:7]
    s_lshl_b32 s25, s22, 6
    s_add_u32 s25, s25, 256
    v_add_u32 v56, s25, v1
    v_mfma_f32_16x16x32_bf16 a[120:123], a[68:71], a[224:227], a[120:123]
    v_mul_u32_u24 v59, s8, v56
    v_mfma_f32_16x16x32_bf16 a[124:127], a[68:71], a[228:231], a[124:127]
    v_lshrrev_b32 v59, 16, v59
    v_mul_u32_u24 v58, 18, v59
    v_mfma_f32_16x16x32_bf16 a[8:11], a[68:71], a[232:235], a[8:11]
    v_sub_u32 v58, v56, v58
    v_lshlrev_b32 v61, 4, v58
    v_mfma_f32_16x16x32_bf16 a[12:15], a[68:71], a[236:239], a[12:15]
    s_waitcnt lgkmcnt(0)
    v_mfma_f32_16x16x32_bf16 a[128:131], a[72:75], a[224:227], a[128:131]
    s_barrier
    v_add_u32 v61, s7, v61
    v_mfma_f32_16x16x32_bf16 a[132:135], a[72:75], a[228:231], a[132:135]
    ds_read_b64_tr_b16 a[64:65], v36 offset:40960
    s_waitcnt vmcnt(29)
    v_mfma_f32_16x16x32_bf16 a[16:19], a[72:75], a[232:235], a[16:19]
    ds_read_b64_tr_b16 a[66:67], v36 offset:41984
    ds_read_b128 a[192:195], v34 offset:0
    v_mfma_f32_16x16x32_bf16 a[20:23], a[72:75], a[236:239], a[20:23]
    v_mad_u32_u24 v13, v59, s9, v61
    v_mfma_f32_16x16x32_bf16 a[136:139], a[76:79], a[224:227], a[136:139]
    ds_read_b64_tr_b16 a[68:69], v37 offset:40960
    ds_read_b128 a[196:199], v34 offset:2048
    v_mfma_f32_16x16x32_bf16 a[140:143], a[76:79], a[228:231], a[140:143]
    ds_read_b64_tr_b16 a[70:71], v37 offset:41984
    ds_read_b128 a[200:203], v34 offset:4096
    v_mfma_f32_16x16x32_bf16 a[24:27], a[76:79], a[232:235], a[24:27]
    ds_read_b64_tr_b16 a[72:73], v38 offset:40960
    ds_read_b128 a[204:207], v34 offset:6144
    v_mfma_f32_16x16x32_bf16 a[28:31], a[76:79], a[236:239], a[28:31]
    ds_read_b64_tr_b16 a[74:75], v38 offset:41984
    v_bfe_u32 v60, v59, 3, 1
    v_mfma_f32_16x16x32_bf16 a[144:147], a[80:83], a[224:227], a[144:147]
    ds_read_b64_tr_b16 a[76:77], v39 offset:40960
    ds_read_b128 a[208:211], v35 offset:0
    v_mfma_f32_16x16x32_bf16 a[148:151], a[80:83], a[228:231], a[148:151]
    ds_read_b128 a[212:215], v35 offset:2048
    ds_read_b128 a[216:219], v35 offset:4096
    v_mfma_f32_16x16x32_bf16 a[32:35], a[80:83], a[232:235], a[32:35]
    ds_read_b64_tr_b16 a[78:79], v39 offset:41984
    v_bfe_u32 v62, v59, 4, 1
    v_mfma_f32_16x16x32_bf16 a[36:39], a[80:83], a[236:239], a[36:39]
    ds_read_b128 a[220:223], v35 offset:6144
    s_waitcnt lgkmcnt(0)
    v_mfma_f32_16x16x32_bf16 a[152:155], a[84:87], a[224:227], a[152:155]
    ds_read_b64_tr_b16 a[80:81], v40 offset:40960
    s_add_u32 s76, s72, s75
    v_mfma_f32_16x16x32_bf16 a[156:159], a[84:87], a[228:231], a[156:159]
    s_add_u32 s77, s73, s75
    v_and_b32 v59, 7, v59
    v_mfma_f32_16x16x32_bf16 a[40:43], a[84:87], a[232:235], a[40:43]
    ds_read_b64_tr_b16 a[82:83], v40 offset:41984
    s_add_u32 s75, s75, 128
    v_mfma_f32_16x16x32_bf16 a[44:47], a[84:87], a[236:239], a[44:47]
    v_lshl_or_b32 v59, v60, 4, v59
    v_mfma_f32_16x16x32_bf16 a[160:163], a[88:91], a[224:227], a[160:163]
    ds_read_b64_tr_b16 a[84:85], v41 offset:40960
    v_lshl_or_b32 v59, v62, 3, v59
    v_mfma_f32_16x16x32_bf16 a[164:167], a[88:91], a[228:231], a[164:167]
    s_cmp_eq_u32 s75, 1152
    s_cselect_b32 s75, 0, s75
    v_mfma_f32_16x16x32_bf16 a[48:51], a[88:91], a[232:235], a[48:51]
    ds_read_b64_tr_b16 a[86:87], v41 offset:41984
    s_add_u32 m0, s74, 32768
    v_mfma_f32_16x16x32_bf16 a[52:55], a[88:91], a[236:239], a[52:55]
    s_add_u32 s23, s76, 0
    buffer_load_dwordx4 v30, s[44:47], s23 offen lds
    v_mfma_f32_16x16x32_bf16 a[168:171], a[92:95], a[224:227], a[168:171]
    ds_read_b64_tr_b16 a[88:89], v42 offset:40960
    s_add_u32 m0, s74, 33792
    v_mfma_f32_16x16x32_bf16 a[172:175], a[92:95], a[228:231], a[172:175]
    s_add_u32 s23, s76, 9216
    buffer_load_dwordx4 v31, s[44:47], s23 offen lds
    v_mfma_f32_16x16x32_bf16 a[56:59], a[92:95], a[232:235], a[56:59]
    ds_read_b64_tr_b16 a[90:91], v42 offset:41984
    v_lshrrev_b32 v62, 4, v59
    v_mfma_f32_16x16x32_bf16 a[60:63], a[92:95], a[236:239], a[60:63]
    s_add_u32 m0, s74, 34816
    s_add_u32 s23, s76, 73728
    v_mfma_f32_16x16x32_bf16 v[160:163], a[96:99], a[224:227], v[160:163]
    ds_read_b64_tr_b16 a[92:93], v43 offset:40960
    buffer_load_dwordx4 v30, s[44:47], s23 offen lds
    v_mfma_f32_16x16x32_bf16 v[176:179], a[96:99], a[228:231], v[176:179]
    s_add_u32 m0, s74, 35840
    v_lshl_add_u32 v62, v62, 1, v59
    v_mfma_f32_16x16x32_bf16 v[208:211], a[96:99], a[232:235], v[208:211]
    ds_read_b64_tr_b16 a[94:95], v43 offset:41984
    s_add_u32 s23, s76, 82944
    v_mfma_f32_16x16x32_bf16 v[240:243], a[96:99], a[236:239], v[240:243]
    buffer_load_dwordx4 v31, s[44:47], s23 offen lds
    v_mfma_f32_16x16x32_bf16 v[164:167], a[100:103], a[224:227], v[164:167]
    ds_read_b64_tr_b16 a[96:97], v44 offset:23040
    s_add_u32 m0, s74, 36864
    v_mfma_f32_16x16x32_bf16 v[180:183], a[100:103], a[228:231], v[180:183]
    s_add_u32 s23, s77, 0
    v_and_b32 v63, 0x10, v59
    v_mfma_f32_16x16x32_bf16 v[212:215], a[100:103], a[232:235], v[212:215]
    ds_read_b64_tr_b16 a[98:99], v44 offset:23184
    buffer_load_dwordx4 v30, s[44:47], s23 offen lds
    v_mfma_f32_16x16x32_bf16 v[244:247], a[100:103], a[236:239], v[244:247]
    s_add_u32 m0, s74, 37888
    v_lshrrev_b32 v63, 1, v63
    v_mfma_f32_16x16x32_bf16 v[168:171], a[104:107], a[224:227], v[168:171]
    ds_read_b64_tr_b16 a[100:101], v45 offset:23040
    s_add_u32 s23, s77, 9216
    v_mfma_f32_16x16x32_bf16 v[184:187], a[104:107], a[228:231], v[184:187]
    buffer_load_dwordx4 v31, s[44:47], s23 offen lds
    s_add_u32 m0, s74, 38912
    v_mfma_f32_16x16x32_bf16 v[216:219], a[104:107], a[232:235], v[216:219]
    ds_read_b64_tr_b16 a[102:103], v45 offset:23184
    v_and_b32 v60, 4, v59
    v_mfma_f32_16x16x32_bf16 v[248:251], a[104:107], a[236:239], v[248:251]
    s_add_u32 s23, s77, 73728
    buffer_load_dwordx4 v30, s[44:47], s23 offen lds
    v_mfma_f32_16x16x32_bf16 v[172:175], a[108:111], a[224:227], v[172:175]
    ds_read_b64_tr_b16 a[104:105], v46 offset:23040
    s_add_u32 m0, s74, 39936
    v_mfma_f32_16x16x32_bf16 v[188:191], a[108:111], a[228:231], v[188:191]
    s_add_u32 s23, s77, 82944
    v_or_b32 v63, v63, v60
    v_mfma_f32_16x16x32_bf16 v[220:223], a[108:111], a[232:235], v[220:223]
    ds_read_b64_tr_b16 a[106:107], v46 offset:23184
    buffer_load_dwordx4 v31, s[44:47], s23 offen lds
    v_mfma_f32_16x16x32_bf16 v[252:255], a[108:111], a[236:239], v[252:255]
    ds_read_b64_tr_b16 a[108:109], v47 offset:23040
    ds_read_b64_tr_b16 a[110:111], v47 offset:23184
    v_mfma_f32_16x16x32_bf16 a[112:115], a[64:67], a[240:243], a[112:115]
    v_bfe_u32 v60, v59, 3, 1
    v_mfma_f32_16x16x32_bf16 a[116:119], a[64:67], a[244:247], a[116:119]
    v_lshl_or_b32 v63, v60, 1, v63
    v_bfe_u32 v60, v59, 1, 1
    v_mfma_f32_16x16x32_bf16 a[0:3], a[64:67], a[248:251], a[0:3]
    v_or_b32 v63, v63, v60
    v_mfma_f32_16x16x32_bf16 a[4:7], a[64:67], a[252:255], a[4:7]
    v_mul_u32_u24 v63, 18, v63
    v_mfma_f32_16x16x32_bf16 a[120:123], a[68:71], a[240:243], a[120:123]
    v_and_b32 v60, 1, v59
    v_add3_u32 v63, v63, v60, 16
    v_mfma_f32_16x16x32_bf16 a[124:127], a[68:71], a[244:247], a[124:127]
    v_cndmask_b32 v62, v62, v63, s[70:71]
    v_mad_u32_u24 v16, v62, s9, v61
    v_mfma_f32_16x16x32_bf16 a[8:11], a[68:71], a[248:251], a[8:11]
    s_lshl_b32 s25, s22, 6
    s_add_u32 s25, s25, 512
    v_add_u32 v56, s25, v1
    v_mfma_f32_16x16x32_bf16 a[12:15], a[68:71], a[252:255], a[12:15]
    s_waitcnt vmcnt(29) lgkmcnt(0)
    v_mfma_f32_16x16x32_bf16 a[128:131], a[72:75], a[240:243], a[128:131]
    s_barrier
    v_mfma_f32_16x16x32_bf16 a[132:135], a[72:75], a[244:247], a[132:135]
    ds_read_b64_tr_b16 a[64:65], v36 offset:0
    s_add_u32 s82, s11, s79
    v_mfma_f32_16x16x32_bf16 a[16:19], a[72:75], a[248:251], a[16:19]
    ds_read_b64_tr_b16 a[66:67], v36 offset:1024
    v_mfma_f32_16x16x32_bf16 a[20:23], a[72:75], a[252:255], a[20:23]
    s_add_u32 s79, s79, 0x80000
    v_mfma_f32_16x16x32_bf16 a[136:139], a[76:79], a[240:243], a[136:139]
    ds_read_b64_tr_b16 a[68:69], v37 offset:0
    v_mfma_f32_16x16x32_bf16 a[140:143], a[76:79], a[244:247], a[140:143]
    ds_read_b64_tr_b16 a[70:71], v37 offset:1024
    v_mul_u32_u24 v59, s8, v56
    v_mfma_f32_16x16x32_bf16 a[24:27], a[76:79], a[248:251], a[24:27]
    ds_read_b64_tr_b16 a[72:73], v38 offset:0
    v_lshrrev_b32 v59, 16, v59
    v_mfma_f32_16x16x32_bf16 a[28:31], a[76:79], a[252:255], a[28:31]
    ds_read_b64_tr_b16 a[74:75], v38 offset:1024
    v_mfma_f32_16x16x32_bf16 a[144:147], a[80:83], a[240:243], a[144:147]
    ds_read_b64_tr_b16 a[76:77], v39 offset:0
    v_mul_u32_u24 v58, 18, v59
    v_mfma_f32_16x16x32_bf16 a[148:151], a[80:83], a[244:247], a[148:151]
    s_cmp_eq_u32 s79, 4718592
    s_cselect_b32 s79, 0, s79
    v_mfma_f32_16x16x32_bf16 a[32:35], a[80:83], a[248:251], a[32:35]
    ds_read_b64_tr_b16 a[78:79], v39 offset:1024
    s_add_u32 m0, s30, 131072
    v_mfma_f32_16x16x32_bf16 a[36:39], a[80:83], a[252:255], a[36:39]
    s_add_u32 s23, s82, 0
    buffer_load_dwordx4 v26, s[52:55], s23 offen lds
    v_mfma_f32_16x16x32_bf16 a[152:155], a[84:87], a[240:243], a[152:155]
    ds_read_b64_tr_b16 a[80:81], v40 offset:0
    s_add_u32 m0, s30, 132096
    v_mfma_f32_16x16x32_bf16 a[156:159], a[84:87], a[244:247], a[156:159]
    s_add_u32 s23, s82, 32768
    v_sub_u32 v58, v56, v58
    v_mfma_f32_16x16x32_bf16 a[40:43], a[84:87], a[248:251], a[40:43]
    ds_read_b64_tr_b16 a[82:83], v40 offset:1024
    buffer_load_dwordx4 v26, s[52:55], s23 offen lds
    v_mfma_f32_16x16x32_bf16 a[44:47], a[84:87], a[252:255], a[44:47]
    s_add_u32 m0, s30, 133120
    v_mfma_f32_16x16x32_bf16 a[160:163], a[88:91], a[240:243], a[160:163]
    ds_read_b64_tr_b16 a[84:85], v41 offset:0
    v_mfma_f32_16x16x32_bf16 a[164:167], a[88:91], a[244:247], a[164:167]
    s_add_u32 s23, s82, 65536
    v_lshlrev_b32 v61, 4, v58
    v_mfma_f32_16x16x32_bf16 a[48:51], a[88:91], a[248:251], a[48:51]
    ds_read_b64_tr_b16 a[86:87], v41 offset:1024
    buffer_load_dwordx4 v27, s[52:55], s23 offen lds
    v_mfma_f32_16x16x32_bf16 a[52:55], a[88:91], a[252:255], a[52:55]
    s_add_u32 m0, s30, 134144
    v_add_u32 v61, s7, v61
    v_mfma_f32_16x16x32_bf16 a[168:171], a[92:95], a[240:243], a[168:171]
    ds_read_b64_tr_b16 a[88:89], v42 offset:0
    s_add_u32 s23, s82, 98304
    v_mfma_f32_16x16x32_bf16 a[172:175], a[92:95], a[244:247], a[172:175]
    buffer_load_dwordx4 v27, s[52:55], s23 offen lds
    v_mfma_f32_16x16x32_bf16 a[56:59], a[92:95], a[248:251], a[56:59]
    ds_read_b64_tr_b16 a[90:91], v42 offset:1024
    v_mad_u32_u24 v14, v59, s9, v61
    v_mfma_f32_16x16x32_bf16 a[60:63], a[92:95], a[252:255], a[60:63]
    s_add_u32 m0, s10, 18432
    s_add_u32 s23, s78, s10
    v_mfma_f32_16x16x32_bf16 v[160:163], a[96:99], a[240:243], v[160:163]
    ds_read_b64_tr_b16 a[92:93], v43 offset:0
    v_bfe_u32 v60, v59, 3, 1
    v_mfma_f32_16x16x32_bf16 v[176:179], a[96:99], a[244:247], v[176:179]
    buffer_load_dwordx4 v29, s[48:51], s23 offen sc1 lds
    v_mfma_f32_16x16x32_bf16 v[208:211], a[96:99], a[248:251], v[208:211]
    ds_read_b64_tr_b16 a[94:95], v43 offset:1024
    s_add_u32 m0, s10, 22528
    v_mfma_f32_16x16x32_bf16 v[240:243], a[96:99], a[252:255], v[240:243]
    s_add_u32 s23, s23, 4096
    v_mfma_f32_16x16x32_bf16 v[164:167], a[100:103], a[240:243], v[164:167]
    ds_read_b64_tr_b16 a[96:97], v44 offset:0
    v_bfe_u32 v62, v59, 4, 1
    v_mfma_f32_16x16x32_bf16 v[180:183], a[100:103], a[244:247], v[180:183]
    buffer_load_dwordx4 v29, s[48:51], s23 offen sc1 lds
    v_and_b32 v59, 7, v59
    v_mfma_f32_16x16x32_bf16 v[212:215], a[100:103], a[248:251], v[212:215]
    ds_read_b64_tr_b16 a[98:99], v44 offset:144
    s_add_u32 s78, s78, 9216
    v_mfma_f32_16x16x32_bf16 v[244:247], a[100:103], a[252:255], v[244:247]
    s_cmp_eq_u32 s78, 82944
    s_cselect_b32 s78, 0, s78
    v_mfma_f32_16x16x32_bf16 v[168:171], a[104:107], a[240:243], v[168:171]
    ds_read_b64_tr_b16 a[100:101], v45 offset:0
    v_mfma_f32_16x16x32_bf16 v[184:187], a[104:107], a[244:247], v[184:187]
    v_lshl_or_b32 v59, v60, 4, v59
    v_lshl_or_b32 v59, v62, 3, v59
    v_mfma_f32_16x16x32_bf16 v[216:219], a[104:107], a[248:251], v[216:219]
    ds_read_b64_tr_b16 a[102:103], v45 offset:144
    v_mfma_f32_16x16x32_bf16 v[248:251], a[104:107], a[252:255], v[248:251]
    s_cmp_lg_u32 s22, 0
    s_cbranch_scc1 f1_wb8
    s_mov_b32 m0, 26624
    s_add_u32 s23, s23, 4096
    buffer_load_dwordx4 v29, s[48:51], s23 offen sc1 lds
f1_wb8:
    v_mfma_f32_16x16x32_bf16 v[172:175], a[108:111], a[240:243], v[172:175]
    ds_read_b64_tr_b16 a[104:105], v46 offset:0
    v_lshrrev_b32 v62, 4, v59
    v_mfma_f32_16x16x32_bf16 v[188:191], a[108:111], a[244:247], v[188:191]
    v_lshl_add_u32 v62, v62, 1, v59
    v_mfma_f32_16x16x32_bf16 v[220:223], a[108:111], a[248:251], v[220:223]
    ds_read_b64_tr_b16 a[106:107], v46 offset:144
    v_and_b32 v63, 0x10, v59
    v_mfma_f32_16x16x32_bf16 v[252:255], a[108:111], a[252:255], v[252:255]
    ds_read_b64_tr_b16 a[108:109], v47 offset:0
    ds_read_b64_tr_b16 a[110:111], v47 offset:144
    s_waitcnt lgkmcnt(15)
    v_mfma_f32_16x16x32_bf16 a[112:115], a[64:67], a[192:195], a[112:115]
    v_lshrrev_b32 v63, 1, v63
    v_mfma_f32_16x16x32_bf16 a[116:119], a[64:67], a[196:199], a[116:119]
    v_and_b32 v60, 4, v59
    v_mfma_f32_16x16x32_bf16 a[0:3], a[64:67], a[200:203], a[0:3]
    v_or_b32 v63, v63, v60
    v_mfma_f32_16x16x32_bf16 a[4:7], a[64:67], a[204:207], a[4:7]
    v_bfe_u32 v60, v59, 3, 1
    v_mfma_f32_16x16x32_bf16 a[120:123], a[68:71], a[192:195], a[120:123]
    v_lshl_or_b32 v63, v60, 1, v63
    v_mfma_f32_16x16x32_bf16 a[124:127], a[68:71], a[196:199], a[124:127]
    v_bfe_u32 v60, v59, 1, 1
    v_mfma_f32_16x16x32_bf16 a[8:11], a[68:71], a[200:203], a[8:11]
    v_or_b32 v63, v63, v60
    v_mfma_f32_16x16x32_bf16 a[12:15], a[68:71], a[204:207], a[12:15]
    s_waitcnt vmcnt(14) lgkmcnt(0)
    v_mul_u32_u24 v63, 18, v63
    v_mfma_f32_16x16x32_bf16 a[128:131], a[72:75], a[192:195], a[128:131]
    s_barrier
    v_mfma_f32_16x16x32_bf16 a[132:135], a[72:75], a[196:199], a[132:135]
    ds_read_b64_tr_b16 a[64:65], v36 offset:8192
    v_and_b32 v60, 1, v59
    v_mfma_f32_16x16x32_bf16 a[16:19], a[72:75], a[200:203], a[16:19]
    ds_read_b64_tr_b16 a[66:67], v36 offset:9216
    v_mfma_f32_16x16x32_bf16 a[20:23], a[72:75], a[204:207], a[20:23]
    v_add3_u32 v63, v63, v60, 16
    v_mfma_f32_16x16x32_bf16 a[136:139], a[76:79], a[192:195], a[136:139]
    ds_read_b64_tr_b16 a[68:69], v37 offset:8192
    v_mfma_f32_16x16x32_bf16 a[140:143], a[76:79], a[196:199], a[140:143]
    ds_read_b64_tr_b16 a[70:71], v37 offset:9216
    v_cndmask_b32 v62, v62, v63, s[70:71]
    v_mfma_f32_16x16x32_bf16 a[24:27], a[76:79], a[200:203], a[24:27]
    ds_read_b64_tr_b16 a[72:73], v38 offset:8192
    v_mfma_f32_16x16x32_bf16 a[28:31], a[76:79], a[204:207], a[28:31]
    ds_read_b64_tr_b16 a[74:75], v38 offset:9216
    v_mad_u32_u24 v17, v62, s9, v61
    v_mfma_f32_16x16x32_bf16 a[144:147], a[80:83], a[192:195], a[144:147]
    ds_read_b64_tr_b16 a[76:77], v39 offset:8192
    v_mfma_f32_16x16x32_bf16 a[148:151], a[80:83], a[196:199], a[148:151]
    s_mul_i32 s4, s4, 146
    s_add_u32 s4, s4, s5
    v_mfma_f32_16x16x32_bf16 a[32:35], a[80:83], a[200:203], a[32:35]
    ds_read_b64_tr_b16 a[78:79], v39 offset:9216
    s_mul_i32 s4, s4, 9216
    v_mfma_f32_16x16x32_bf16 a[36:39], a[80:83], a[204:207], a[36:39]
    s_cmp_lg_u32 s22, 0
    s_cbranch_scc1 f1_sg0
    s_cmp_lg_u32 s14, 32
    s_cbranch_scc1 f1_sg0_wb
f1_sg0_wb_r:
    s_mov_b32 s24, 1
    s_mov_b64 exec, 1
    v_mov_b32 v24, s24
    buffer_atomic_add v24, off, s[56:59], s17 sc1
    s_mov_b64 exec, -1
f1_sg0:
    v_mfma_f32_16x16x32_bf16 a[152:155], a[84:87], a[192:195], a[152:155]
    ds_read_b64_tr_b16 a[80:81], v40 offset:8192
    s_add_u32 s4, s4, s10
    v_mfma_f32_16x16x32_bf16 a[156:159], a[84:87], a[196:199], a[156:159]
    s_cmp_eq_u32 s22, 0
    s_cselect_b32 s6, 0, 0x40000000
    v_mfma_f32_16x16x32_bf16 a[40:43], a[84:87], a[200:203], a[40:43]
    ds_read_b64_tr_b16 a[82:83], v40 offset:9216
    v_mfma_f32_16x16x32_bf16 a[44:47], a[84:87], a[204:207], a[44:47]
    v_mfma_f32_16x16x32_bf16 a[160:163], a[88:91], a[192:195], a[160:163]
    ds_read_b64_tr_b16 a[84:85], v41 offset:8192
    v_mfma_f32_16x16x32_bf16 a[164:167], a[88:91], a[196:199], a[164:167]
    v_add_u32 v14, s6, v14
    v_mfma_f32_16x16x32_bf16 a[48:51], a[88:91], a[200:203], a[48:51]
    ds_read_b64_tr_b16 a[86:87], v41 offset:9216
    v_add_u32 v17, s6, v17
    v_mfma_f32_16x16x32_bf16 a[52:55], a[88:91], a[204:207], a[52:55]
    s_mov_b32 s40, s66
    s_mov_b32 s41, s67
    v_mfma_f32_16x16x32_bf16 a[168:171], a[92:95], a[192:195], a[168:171]
    ds_read_b64_tr_b16 a[88:89], v42 offset:8192
    v_mfma_f32_16x16x32_bf16 a[172:175], a[92:95], a[196:199], a[172:175]
    v_mfma_f32_16x16x32_bf16 a[56:59], a[92:95], a[200:203], a[56:59]
    ds_read_b64_tr_b16 a[90:91], v42 offset:9216
    v_mfma_f32_16x16x32_bf16 a[60:63], a[92:95], a[204:207], a[60:63]
    ds_read_b128 a[224:227], v32 offset:0
    v_mfma_f32_16x16x32_bf16 v[160:163], a[96:99], a[192:195], v[160:163]
    ds_read_b64_tr_b16 a[92:93], v43 offset:8192
    v_mfma_f32_16x16x32_bf16 v[176:179], a[96:99], a[196:199], v[176:179]
    ds_read_b128 a[228:231], v32 offset:2048
    v_mfma_f32_16x16x32_bf16 v[208:211], a[96:99], a[200:203], v[208:211]
    ds_read_b64_tr_b16 a[94:95], v43 offset:9216
    s_mov_b32 s42, 4718592
    v_mfma_f32_16x16x32_bf16 v[240:243], a[96:99], a[204:207], v[240:243]
    v_mfma_f32_16x16x32_bf16 v[164:167], a[100:103], a[192:195], v[164:167]
    ds_read_b64_tr_b16 a[96:97], v44 offset:4608
    ds_read_b128 a[232:235], v32 offset:4096
    v_mfma_f32_16x16x32_bf16 v[180:183], a[100:103], a[196:199], v[180:183]
    s_mov_b32 s43, 0x00020000
    v_mfma_f32_16x16x32_bf16 v[212:215], a[100:103], a[200:203], v[212:215]
    ds_read_b64_tr_b16 a[98:99], v44 offset:4752
    ds_read_b128 a[236:239], v32 offset:6144
    v_mfma_f32_16x16x32_bf16 v[244:247], a[100:103], a[204:207], v[244:247]
    s_mov_b32 s60, s68
    s_mov_b32 s61, s69
    v_mfma_f32_16x16x32_bf16 v[168:171], a[104:107], a[192:195], v[168:171]
    ds_read_b64_tr_b16 a[100:101], v45 offset:4608
    ds_read_b128 a[240:243], v33 offset:0
    v_mfma_f32_16x16x32_bf16 v[184:187], a[104:107], a[196:199], v[184:187]
    ds_read_b128 a[244:247], v33 offset:2048
    v_mfma_f32_16x16x32_bf16 v[216:219], a[104:107], a[200:203], v[216:219]
    ds_read_b64_tr_b16 a[102:103], v45 offset:4752
    v_mfma_f32_16x16x32_bf16 v[248:251], a[104:107], a[204:207], v[248:251]
    ds_read_b128 a[248:251], v33 offset:4096
    s_mov_b32 s62, 663552
    v_mfma_f32_16x16x32_bf16 v[172:175], a[108:111], a[192:195], v[172:175]
    ds_read_b64_tr_b16 a[104:105], v46 offset:4608
    v_mfma_f32_16x16x32_bf16 v[188:191], a[108:111], a[196:199], v[188:191]
    ds_read_b128 a[252:255], v33 offset:6144
    s_mov_b32 s63, 0x00020000
    v_mfma_f32_16x16x32_bf16 v[220:223], a[108:111], a[200:203], v[220:223]
    ds_read_b64_tr_b16 a[106:107], v46 offset:4752
    v_mfma_f32_16x16x32_bf16 v[252:255], a[108:111], a[204:207], v[252:255]
    ds_read_b64_tr_b16 a[108:109], v47 offset:4608
    ds_read_b64_tr_b16 a[110:111], v47 offset:4752
    s_waitcnt lgkmcnt(15)
    v_mfma_f32_16x16x32_bf16 a[112:115], a[64:67], a[208:211], a[112:115]
    v_mfma_f32_16x16x32_bf16 a[116:119], a[64:67], a[212:215], a[116:119]
    s_add_u32 s32, s18, 58720256
    s_addc_u32 s33, s19, 0
    v_mfma_f32_16x16x32_bf16 a[0:3], a[64:67], a[216:219], a[0:3]
    v_mfma_f32_16x16x32_bf16 a[4:7], a[64:67], a[220:223], a[4:7]
    s_mov_b32 s34, 4718592
    v_mfma_f32_16x16x32_bf16 a[120:123], a[68:71], a[208:211], a[120:123]
    s_mov_b32 s35, 0x00020000
    v_mfma_f32_16x16x32_bf16 a[124:127], a[68:71], a[212:215], a[124:127]
    v_mfma_f32_16x16x32_bf16 a[8:11], a[68:71], a[216:219], a[8:11]
    s_add_u32 s36, s18, 65011712
    s_addc_u32 s37, s19, 0
    v_mfma_f32_16x16x32_bf16 a[12:15], a[68:71], a[220:223], a[12:15]
    s_waitcnt lgkmcnt(0)
    v_mfma_f32_16x16x32_bf16 a[128:131], a[72:75], a[208:211], a[128:131]
    s_barrier
    v_mfma_f32_16x16x32_bf16 a[132:135], a[72:75], a[212:215], a[132:135]
    ds_read_b64_tr_b16 a[64:65], v36 offset:16384
    v_mfma_f32_16x16x32_bf16 a[16:19], a[72:75], a[216:219], a[16:19]
    ds_read_b64_tr_b16 a[66:67], v36 offset:17408
    v_mfma_f32_16x16x32_bf16 a[20:23], a[72:75], a[220:223], a[20:23]
    s_mov_b32 s38, 778240
    v_mfma_f32_16x16x32_bf16 a[136:139], a[76:79], a[208:211], a[136:139]
    ds_read_b64_tr_b16 a[68:69], v37 offset:16384
    v_mfma_f32_16x16x32_bf16 a[140:143], a[76:79], a[212:215], a[140:143]
    ds_read_b64_tr_b16 a[70:71], v37 offset:17408
    s_mov_b32 s39, 0x00020000
    v_mfma_f32_16x16x32_bf16 a[24:27], a[76:79], a[216:219], a[24:27]
    ds_read_b64_tr_b16 a[72:73], v38 offset:16384
    v_mfma_f32_16x16x32_bf16 a[28:31], a[76:79], a[220:223], a[28:31]
    ds_read_b64_tr_b16 a[74:75], v38 offset:17408
    v_mfma_f32_16x16x32_bf16 a[144:147], a[80:83], a[208:211], a[144:147]
    ds_read_b64_tr_b16 a[76:77], v39 offset:16384
    v_mfma_f32_16x16x32_bf16 a[148:151], a[80:83], a[212:215], a[148:151]
    s_add_u32 s52, s18, 33554432
    s_addc_u32 s53, s19, 0
    v_mfma_f32_16x16x32_bf16 a[32:35], a[80:83], a[216:219], a[32:35]
    ds_read_b64_tr_b16 a[78:79], v39 offset:17408
    v_mfma_f32_16x16x32_bf16 a[36:39], a[80:83], a[220:223], a[36:39]
    v_mfma_f32_16x16x32_bf16 a[152:155], a[84:87], a[208:211], a[152:155]
    ds_read_b64_tr_b16 a[80:81], v40 offset:16384
    s_mov_b32 s54, 19136512
    v_mfma_f32_16x16x32_bf16 a[156:159], a[84:87], a[212:215], a[156:159]
    v_mfma_f32_16x16x32_bf16 a[40:43], a[84:87], a[216:219], a[40:43]
    ds_read_b64_tr_b16 a[82:83], v40 offset:17408
    s_mov_b32 s55, 0x00020000
    v_mfma_f32_16x16x32_bf16 a[44:47], a[84:87], a[220:223], a[44:47]
    v_mfma_f32_16x16x32_bf16 a[160:163], a[88:91], a[208:211], a[160:163]
    ds_read_b64_tr_b16 a[84:85], v41 offset:16384
    v_mul_u32_u24 v20, 72, v2
    v_mfma_f32_16x16x32_bf16 a[164:167], a[88:91], a[212:215], a[164:167]
    v_mfma_f32_16x16x32_bf16 a[48:51], a[88:91], a[216:219], a[48:51]
    ds_read_b64_tr_b16 a[86:87], v41 offset:17408
    v_lshl_add_u32 v21, v3, 2, v20
    v_mfma_f32_16x16x32_bf16 a[52:55], a[88:91], a[220:223], a[52:55]
    v_mfma_f32_16x16x32_bf16 a[168:171], a[92:95], a[208:211], a[168:171]
    ds_read_b64_tr_b16 a[88:89], v42 offset:16384
    v_lshl_add_u32 v20, v3, 5, v20
    v_mfma_f32_16x16x32_bf16 a[172:175], a[92:95], a[212:215], a[172:175]
    v_mfma_f32_16x16x32_bf16 a[56:59], a[92:95], a[216:219], a[56:59]
    ds_read_b64_tr_b16 a[90:91], v42 offset:17408
    v_mov_b32 v57, 2147483392
    v_mfma_f32_16x16x32_bf16 a[60:63], a[92:95], a[220:223], a[60:63]
    v_mfma_f32_16x16x32_bf16 v[160:163], a[96:99], a[208:211], v[160:163]
    ds_read_b64_tr_b16 a[92:93], v43 offset:16384
    v_cmp_gt_u32 vcc, 2, v3
    v_mfma_f32_16x16x32_bf16 v[176:179], a[96:99], a[212:215], v[176:179]
    s_lshl_b32 s25, s20, 11
    v_mfma_f32_16x16x32_bf16 v[208:211], a[96:99], a[216:219], v[208:211]
    ds_read_b64_tr_b16 a[94:95], v43 offset:17408
    v_mfma_f32_16x16x32_bf16 v[240:243], a[96:99], a[220:223], v[240:243]
    v_mfma_f32_16x16x32_bf16 v[164:167], a[100:103], a[208:211], v[164:167]
    ds_read_b64_tr_b16 a[96:97], v44 offset:9216
    v_cndmask_b32 v20, v57, v20, vcc
    v_mfma_f32_16x16x32_bf16 v[180:183], a[100:103], a[212:215], v[180:183]
    v_mfma_f32_16x16x32_bf16 v[212:215], a[100:103], a[216:219], v[212:215]
    ds_read_b64_tr_b16 a[98:99], v44 offset:9360
    v_cndmask_b32 v21, v57, v21, vcc
    v_mfma_f32_16x16x32_bf16 v[244:247], a[100:103], a[220:223], v[244:247]
    v_mfma_f32_16x16x32_bf16 v[168:171], a[104:107], a[208:211], v[168:171]
    ds_read_b64_tr_b16 a[100:101], v45 offset:9216
    s_add_u32 s66, s25, s64
    v_mfma_f32_16x16x32_bf16 v[184:187], a[104:107], a[212:215], v[184:187]
    v_mfma_f32_16x16x32_bf16 v[216:219], a[104:107], a[216:219], v[216:219]
    ds_read_b64_tr_b16 a[102:103], v45 offset:9360
    s_add_u32 s67, s25, s65
    v_mfma_f32_16x16x32_bf16 v[248:251], a[104:107], a[220:223], v[248:251]
    s_mul_i32 s66, s66, 72
    v_mfma_f32_16x16x32_bf16 v[172:175], a[108:111], a[208:211], v[172:175]
    ds_read_b64_tr_b16 a[104:105], v46 offset:9216
    v_mfma_f32_16x16x32_bf16 v[188:191], a[108:111], a[212:215], v[188:191]
    s_mul_i32 s67, s67, 72
    v_mfma_f32_16x16x32_bf16 v[220:223], a[108:111], a[216:219], v[220:223]
    ds_read_b64_tr_b16 a[106:107], v46 offset:9360
    v_mfma_f32_16x16x32_bf16 v[252:255], a[108:111], a[220:223], v[252:255]
    ds_read_b64_tr_b16 a[108:109], v47 offset:9216
    ds_read_b64_tr_b16 a[110:111], v47 offset:9360
    s_waitcnt lgkmcnt(15)
    v_mfma_f32_16x16x32_bf16 a[112:115], a[64:67], a[224:227], a[112:115]
    s_mov_b32 s68, 0x3fb8aa3b
    v_mfma_f32_16x16x32_bf16 a[116:119], a[64:67], a[228:231], a[116:119]
    s_mov_b32 s69, 0xbfb8aa3b
    v_mfma_f32_16x16x32_bf16 a[0:3], a[64:67], a[232:235], a[0:3]
    v_mfma_f32_16x16x32_bf16 a[4:7], a[64:67], a[236:239], a[4:7]
    s_lshl_b32 s25, s20, 20
    v_mfma_f32_16x16x32_bf16 a[120:123], a[68:71], a[224:227], a[120:123]
    v_mfma_f32_16x16x32_bf16 a[124:127], a[68:71], a[228:231], a[124:127]
    s_add_u32 s44, s18, s25
    s_addc_u32 s45, s19, 0
    v_mfma_f32_16x16x32_bf16 a[8:11], a[68:71], a[232:235], a[8:11]
    v_mfma_f32_16x16x32_bf16 a[12:15], a[68:71], a[236:239], a[12:15]
    s_waitcnt lgkmcnt(0)
    s_lshl_b32 s25, s21, 16
    v_mfma_f32_16x16x32_bf16 a[128:131], a[72:75], a[224:227], a[128:131]
    s_barrier
    v_mfma_f32_16x16x32_bf16 a[132:135], a[72:75], a[228:231], a[132:135]
    ds_read_b64_tr_b16 a[64:65], v36 offset:24576
    v_mfma_f32_16x16x32_bf16 a[16:19], a[72:75], a[232:235], a[16:19]
    ds_read_b64_tr_b16 a[66:67], v36 offset:25600
    s_sub_u32 s46, 0x100000, s25
    v_mfma_f32_16x16x32_bf16 a[20:23], a[72:75], a[236:239], a[20:23]
    s_waitcnt vmcnt(6)
    v_mfma_f32_16x16x32_bf16 a[136:139], a[76:79], a[224:227], a[136:139]
    ds_read_b64_tr_b16 a[68:69], v37 offset:24576
    v_mfma_f32_16x16x32_bf16 a[140:143], a[76:79], a[228:231], a[140:143]
    ds_read_b64_tr_b16 a[70:71], v37 offset:25600
    s_mov_b32 s47, 0x00020000
    v_mfma_f32_16x16x32_bf16 a[24:27], a[76:79], a[232:235], a[24:27]
    ds_read_b64_tr_b16 a[72:73], v38 offset:24576
    v_mfma_f32_16x16x32_bf16 a[28:31], a[76:79], a[236:239], a[28:31]
    ds_read_b64_tr_b16 a[74:75], v38 offset:25600
    v_mfma_f32_16x16x32_bf16 a[144:147], a[80:83], a[224:227], a[144:147]
    ds_read_b64_tr_b16 a[76:77], v39 offset:24576
    v_mfma_f32_16x16x32_bf16 a[148:151], a[80:83], a[228:231], a[148:151]
    ds_read_b128 a[192:195], v34 offset:0
    v_mfma_f32_16x16x32_bf16 a[32:35], a[80:83], a[232:235], a[32:35]
    ds_read_b64_tr_b16 a[78:79], v39 offset:25600
    v_mfma_f32_16x16x32_bf16 a[36:39], a[80:83], a[236:239], a[36:39]
    s_sub_u32 s48, s44, 49152
    s_subb_u32 s49, s45, 0
    v_mfma_f32_16x16x32_bf16 a[152:155], a[84:87], a[224:227], a[152:155]
    ds_read_b64_tr_b16 a[80:81], v40 offset:24576
    s_add_u32 s50, s46, 49152
    v_mfma_f32_16x16x32_bf16 a[156:159], a[84:87], a[228:231], a[156:159]
    ds_read_b128 a[196:199], v34 offset:2048
    v_mfma_f32_16x16x32_bf16 a[40:43], a[84:87], a[232:235], a[40:43]
    ds_read_b64_tr_b16 a[82:83], v40 offset:25600
    v_mfma_f32_16x16x32_bf16 a[44:47], a[84:87], a[236:239], a[44:47]
    s_mov_b32 s51, 0x00020000
    v_mfma_f32_16x16x32_bf16 a[160:163], a[88:91], a[224:227], a[160:163]
    ds_read_b64_tr_b16 a[84:85], v41 offset:24576
    v_mfma_f32_16x16x32_bf16 a[164:167], a[88:91], a[228:231], a[164:167]
    ds_read_b128 a[200:203], v34 offset:4096
    s_add_u32 s28, s30, 16384
    v_mfma_f32_16x16x32_bf16 a[48:51], a[88:91], a[232:235], a[48:51]
    ds_read_b64_tr_b16 a[86:87], v41 offset:25600
    v_mfma_f32_16x16x32_bf16 a[52:55], a[88:91], a[236:239], a[52:55]
    s_lshr_b32 s25, s20, 1
    v_mfma_f32_16x16x32_bf16 a[168:171], a[92:95], a[224:227], a[168:171]
    ds_read_b64_tr_b16 a[88:89], v42 offset:24576
    v_mfma_f32_16x16x32_bf16 a[172:175], a[92:95], a[228:231], a[172:175]
    ds_read_b128 a[204:207], v34 offset:6144
    v_mfma_f32_16x16x32_bf16 a[56:59], a[92:95], a[232:235], a[56:59]
    ds_read_b64_tr_b16 a[90:91], v42 offset:25600
    s_lshl_b32 s25, s25, 10
    v_mfma_f32_16x16x32_bf16 a[60:63], a[92:95], a[236:239], a[60:63]
    s_and_b32 s26, s20, 1
    v_mfma_f32_16x16x32_bf16 v[160:163], a[96:99], a[224:227], v[160:163]
    ds_read_b64_tr_b16 a[92:93], v43 offset:24576
    v_mfma_f32_16x16x32_bf16 v[176:179], a[96:99], a[228:231], v[176:179]
    ds_read_b128 a[208:211], v35 offset:0
    v_mfma_f32_16x16x32_bf16 v[208:211], a[96:99], a[232:235], v[208:211]
    ds_read_b64_tr_b16 a[94:95], v43 offset:25600
    s_lshl_b32 s26, s26, 9
    v_mfma_f32_16x16x32_bf16 v[240:243], a[96:99], a[236:239], v[240:243]
    v_mfma_f32_16x16x32_bf16 v[164:167], a[100:103], a[224:227], v[164:167]
    ds_read_b64_tr_b16 a[96:97], v44 offset:13824
    v_mfma_f32_16x16x32_bf16 v[180:183], a[100:103], a[228:231], v[180:183]
    ds_read_b128 a[212:215], v35 offset:2048
    s_add_u32 s80, s25, s26
    v_mfma_f32_16x16x32_bf16 v[212:215], a[100:103], a[232:235], v[212:215]
    ds_read_b64_tr_b16 a[98:99], v44 offset:13968
    v_mfma_f32_16x16x32_bf16 v[244:247], a[100:103], a[236:239], v[244:247]
    s_add_u32 s80, s80, 131072
    v_mfma_f32_16x16x32_bf16 v[168:171], a[104:107], a[224:227], v[168:171]
    ds_read_b64_tr_b16 a[100:101], v45 offset:13824
    v_mfma_f32_16x16x32_bf16 v[184:187], a[104:107], a[228:231], v[184:187]
    ds_read_b128 a[216:219], v35 offset:4096
    s_lshr_b32 s25, s20, 4
    v_mfma_f32_16x16x32_bf16 v[216:219], a[104:107], a[232:235], v[216:219]
    ds_read_b64_tr_b16 a[102:103], v45 offset:13968
    v_mfma_f32_16x16x32_bf16 v[248:251], a[104:107], a[236:239], v[248:251]
    s_lshl_b32 s25, s25, 10
    v_mfma_f32_16x16x32_bf16 v[172:175], a[108:111], a[224:227], v[172:175]
    ds_read_b64_tr_b16 a[104:105], v46 offset:13824
    v_mfma_f32_16x16x32_bf16 v[188:191], a[108:111], a[228:231], v[188:191]
    ds_read_b128 a[220:223], v35 offset:6144
    s_bfe_u32 s26, s20, 0x20002
    v_mfma_f32_16x16x32_bf16 v[220:223], a[108:111], a[232:235], v[220:223]
    ds_read_b64_tr_b16 a[106:107], v46 offset:13968
    v_mfma_f32_16x16x32_bf16 v[252:255], a[108:111], a[236:239], v[252:255]
    ds_read_b64_tr_b16 a[108:109], v47 offset:13824
    ds_read_b64_tr_b16 a[110:111], v47 offset:13968
    s_waitcnt lgkmcnt(15)
    v_mfma_f32_16x16x32_bf16 a[112:115], a[64:67], a[240:243], a[112:115]
    s_lshl_b32 s26, s26, 8
    v_mfma_f32_16x16x32_bf16 a[116:119], a[64:67], a[244:247], a[116:119]
    v_mfma_f32_16x16x32_bf16 a[0:3], a[64:67], a[248:251], a[0:3]
    s_add_u32 s81, s25, s26
    v_mfma_f32_16x16x32_bf16 a[4:7], a[64:67], a[252:255], a[4:7]
    v_mfma_f32_16x16x32_bf16 a[120:123], a[68:71], a[240:243], a[120:123]
    s_and_b32 s26, s20, 3
    v_mfma_f32_16x16x32_bf16 a[124:127], a[68:71], a[244:247], a[124:127]
    s_lshl_b32 s26, s26, 2
    v_mfma_f32_16x16x32_bf16 a[8:11], a[68:71], a[248:251], a[8:11]
    v_mfma_f32_16x16x32_bf16 a[12:15], a[68:71], a[252:255], a[12:15]
    s_waitcnt vmcnt(0) lgkmcnt(0)
    v_mfma_f32_16x16x32_bf16 a[128:131], a[72:75], a[240:243], a[128:131]
    s_barrier
    s_add_u32 s81, s81, s26
    v_mfma_f32_16x16x32_bf16 a[132:135], a[72:75], a[244:247], a[132:135]
    ds_read_b64_tr_b16 a[64:65], v36 offset:32768
    v_mfma_f32_16x16x32_bf16 a[16:19], a[72:75], a[248:251], a[16:19]
    ds_read_b64_tr_b16 a[66:67], v36 offset:33792
    v_mfma_f32_16x16x32_bf16 a[20:23], a[72:75], a[252:255], a[20:23]
    s_add_u32 s81, s81, 147456
    v_mfma_f32_16x16x32_bf16 a[136:139], a[76:79], a[240:243], a[136:139]
    ds_read_b64_tr_b16 a[68:69], v37 offset:32768
    v_mfma_f32_16x16x32_bf16 a[140:143], a[76:79], a[244:247], a[140:143]
    ds_read_b64_tr_b16 a[70:71], v37 offset:33792
    v_mfma_f32_16x16x32_bf16 a[24:27], a[76:79], a[248:251], a[24:27]
    ds_read_b64_tr_b16 a[72:73], v38 offset:32768
    s_lshl_b32 s25, s20, 12
    v_mfma_f32_16x16x32_bf16 a[28:31], a[76:79], a[252:255], a[28:31]
    ds_read_b64_tr_b16 a[74:75], v38 offset:33792
    v_mfma_f32_16x16x32_bf16 a[144:147], a[80:83], a[240:243], a[144:147]
    ds_read_b64_tr_b16 a[76:77], v39 offset:32768
    v_mfma_f32_16x16x32_bf16 a[148:151], a[80:83], a[244:247], a[148:151]
    s_sub_u32 s80, s80, s25
    v_mfma_f32_16x16x32_bf16 a[32:35], a[80:83], a[248:251], a[32:35]
    ds_read_b64_tr_b16 a[78:79], v39 offset:33792
    v_mfma_f32_16x16x32_bf16 a[36:39], a[80:83], a[252:255], a[36:39]
    s_sub_u32 s81, s81, s25
    v_mfma_f32_16x16x32_bf16 a[152:155], a[84:87], a[240:243], a[152:155]
    ds_read_b64_tr_b16 a[80:81], v40 offset:32768
    v_mfma_f32_16x16x32_bf16 a[156:159], a[84:87], a[244:247], a[156:159]
    s_lshr_b32 s78, s64, 4
    v_mfma_f32_16x16x32_bf16 a[40:43], a[84:87], a[248:251], a[40:43]
    ds_read_b64_tr_b16 a[82:83], v40 offset:33792
    v_mfma_f32_16x16x32_bf16 a[44:47], a[84:87], a[252:255], a[44:47]
    v_mfma_f32_16x16x32_bf16 a[160:163], a[88:91], a[240:243], a[160:163]
    ds_read_b64_tr_b16 a[84:85], v41 offset:32768
    v_mfma_f32_16x16x32_bf16 a[164:167], a[88:91], a[244:247], a[164:167]
    s_mul_i32 s78, s78, 149504
    v_mfma_f32_16x16x32_bf16 a[48:51], a[88:91], a[248:251], a[48:51]
    ds_read_b64_tr_b16 a[86:87], v41 offset:33792
    v_mfma_f32_16x16x32_bf16 a[52:55], a[88:91], a[252:255], a[52:55]
    s_add_u32 s78, s78, s25
    v_mfma_f32_16x16x32_bf16 a[168:171], a[92:95], a[240:243], a[168:171]
    ds_read_b64_tr_b16 a[88:89], v42 offset:32768
    v_mfma_f32_16x16x32_bf16 a[172:175], a[92:95], a[244:247], a[172:175]
    s_lshr_b32 s79, s65, 4
    v_mfma_f32_16x16x32_bf16 a[56:59], a[92:95], a[248:251], a[56:59]
    ds_read_b64_tr_b16 a[90:91], v42 offset:33792
    v_mfma_f32_16x16x32_bf16 a[60:63], a[92:95], a[252:255], a[60:63]
    s_mul_i32 s79, s79, 149504
    v_mfma_f32_16x16x32_bf16 v[160:163], a[96:99], a[240:243], v[160:163]
    ds_read_b64_tr_b16 a[92:93], v43 offset:32768
    v_mfma_f32_16x16x32_bf16 v[176:179], a[96:99], a[244:247], v[176:179]
    s_add_u32 s79, s79, s25
    v_mfma_f32_16x16x32_bf16 v[208:211], a[96:99], a[248:251], v[208:211]
    ds_read_b64_tr_b16 a[94:95], v43 offset:33792
    v_mfma_f32_16x16x32_bf16 v[240:243], a[96:99], a[252:255], v[240:243]
    v_mfma_f32_16x16x32_bf16 v[164:167], a[100:103], a[240:243], v[164:167]
    ds_read_b64_tr_b16 a[96:97], v44 offset:18432
    s_mov_b32 s77, 0x4b800000
    v_mfma_f32_16x16x32_bf16 v[180:183], a[100:103], a[244:247], v[180:183]
    v_mfma_f32_16x16x32_bf16 v[212:215], a[100:103], a[248:251], v[212:215]
    ds_read_b64_tr_b16 a[98:99], v44 offset:18576
    v_mfma_f32_16x16x32_bf16 v[244:247], a[100:103], a[252:255], v[244:247]
    s_add_u32 s76, s21, 1
    v_mfma_f32_16x16x32_bf16 v[168:171], a[104:107], a[240:243], v[168:171]
    ds_read_b64_tr_b16 a[100:101], v45 offset:18432
    v_mfma_f32_16x16x32_bf16 v[184:187], a[104:107], a[244:247], v[184:187]
    s_mov_b32 s72, 0x8000
    v_mfma_f32_16x16x32_bf16 v[216:219], a[104:107], a[248:251], v[216:219]
    ds_read_b64_tr_b16 a[102:103], v45 offset:18576
    v_mfma_f32_16x16x32_bf16 v[248:251], a[104:107], a[252:255], v[248:251]
    s_mov_b32 s73, 0
    v_mfma_f32_16x16x32_bf16 v[172:175], a[108:111], a[240:243], v[172:175]
    ds_read_b64_tr_b16 a[104:105], v46 offset:18432
    v_mfma_f32_16x16x32_bf16 v[188:191], a[108:111], a[244:247], v[188:191]
    s_add_u32 s75, s30, 163840
    v_mfma_f32_16x16x32_bf16 v[220:223], a[108:111], a[248:251], v[220:223]
    ds_read_b64_tr_b16 a[106:107], v46 offset:18576
    v_mfma_f32_16x16x32_bf16 v[252:255], a[108:111], a[252:255], v[252:255]
    ds_read_b64_tr_b16 a[108:109], v47 offset:18432
    ds_read_b64_tr_b16 a[110:111], v47 offset:18576
    s_waitcnt lgkmcnt(15)
    v_mfma_f32_16x16x32_bf16 a[112:115], a[64:67], a[192:195], a[112:115]
    v_mfma_f32_16x16x32_bf16 a[116:119], a[64:67], a[196:199], a[116:119]
    v_mfma_f32_16x16x32_bf16 a[0:3], a[64:67], a[200:203], a[0:3]
    v_mfma_f32_16x16x32_bf16 a[4:7], a[64:67], a[204:207], a[4:7]
    v_mfma_f32_16x16x32_bf16 a[120:123], a[68:71], a[192:195], a[120:123]
    v_mfma_f32_16x16x32_bf16 a[124:127], a[68:71], a[196:199], a[124:127]
    v_mfma_f32_16x16x32_bf16 a[8:11], a[68:71], a[200:203], a[8:11]
    v_mfma_f32_16x16x32_bf16 a[12:15], a[68:71], a[204:207], a[12:15]
    s_waitcnt lgkmcnt(0)
    v_mfma_f32_16x16x32_bf16 a[128:131], a[72:75], a[192:195], a[128:131]
    s_barrier
    v_mfma_f32_16x16x32_bf16 a[132:135], a[72:75], a[196:199], a[132:135]
    ds_read_b64_tr_b16 a[64:65], v36 offset:40960
    v_mfma_f32_16x16x32_bf16 a[16:19], a[72:75], a[200:203], a[16:19]
    ds_read_b64_tr_b16 a[66:67], v36 offset:41984
    v_mfma_f32_16x16x32_bf16 a[20:23], a[72:75], a[204:207], a[20:23]
    v_mfma_f32_16x16x32_bf16 a[136:139], a[76:79], a[192:195], a[136:139]
    ds_read_b64_tr_b16 a[68:69], v37 offset:40960
    v_mfma_f32_16x16x32_bf16 a[140:143], a[76:79], a[196:199], a[140:143]
    ds_read_b64_tr_b16 a[70:71], v37 offset:41984
    v_mfma_f32_16x16x32_bf16 a[24:27], a[76:79], a[200:203], a[24:27]
    ds_read_b64_tr_b16 a[72:73], v38 offset:40960
    v_mfma_f32_16x16x32_bf16 a[28:31], a[76:79], a[204:207], a[28:31]
    ds_read_b64_tr_b16 a[74:75], v38 offset:41984
    v_mfma_f32_16x16x32_bf16 a[144:147], a[80:83], a[192:195], a[144:147]
    ds_read_b64_tr_b16 a[76:77], v39 offset:40960
    v_mfma_f32_16x16x32_bf16 a[148:151], a[80:83], a[196:199], a[148:151]
    v_mfma_f32_16x16x32_bf16 a[32:35], a[80:83], a[200:203], a[32:35]
    ds_read_b64_tr_b16 a[78:79], v39 offset:41984
    v_mfma_f32_16x16x32_bf16 a[36:39], a[80:83], a[204:207], a[36:39]
    v_mfma_f32_16x16x32_bf16 a[152:155], a[84:87], a[192:195], a[152:155]
    ds_read_b64_tr_b16 a[80:81], v40 offset:40960
    v_mfma_f32_16x16x32_bf16 a[156:159], a[84:87], a[196:199], a[156:159]
    v_mfma_f32_16x16x32_bf16 a[40:43], a[84:87], a[200:203], a[40:43]
    ds_read_b64_tr_b16 a[82:83], v40 offset:41984
    v_mfma_f32_16x16x32_bf16 a[44:47], a[84:87], a[204:207], a[44:47]
    v_mfma_f32_16x16x32_bf16 a[160:163], a[88:91], a[192:195], a[160:163]
    ds_read_b64_tr_b16 a[84:85], v41 offset:40960
    v_mfma_f32_16x16x32_bf16 a[164:167], a[88:91], a[196:199], a[164:167]
    v_mfma_f32_16x16x32_bf16 a[48:51], a[88:91], a[200:203], a[48:51]
    ds_read_b64_tr_b16 a[86:87], v41 offset:41984
    v_mfma_f32_16x16x32_bf16 a[52:55], a[88:91], a[204:207], a[52:55]
    v_mfma_f32_16x16x32_bf16 a[168:171], a[92:95], a[192:195], a[168:171]
    ds_read_b64_tr_b16 a[88:89], v42 offset:40960
    v_mfma_f32_16x16x32_bf16 a[172:175], a[92:95], a[196:199], a[172:175]
    v_mfma_f32_16x16x32_bf16 a[56:59], a[92:95], a[200:203], a[56:59]
    ds_read_b64_tr_b16 a[90:91], v42 offset:41984
    v_mfma_f32_16x16x32_bf16 a[60:63], a[92:95], a[204:207], a[60:63]
    v_mfma_f32_16x16x32_bf16 v[160:163], a[96:99], a[192:195], v[160:163]
    ds_read_b64_tr_b16 a[92:93], v43 offset:40960
    v_mfma_f32_16x16x32_bf16 v[176:179], a[96:99], a[196:199], v[176:179]
    v_mfma_f32_16x16x32_bf16 v[208:211], a[96:99], a[200:203], v[208:211]
    ds_read_b64_tr_b16 a[94:95], v43 offset:41984
    v_mfma_f32_16x16x32_bf16 v[240:243], a[96:99], a[204:207], v[240:243]
    v_mfma_f32_16x16x32_bf16 v[164:167], a[100:103], a[192:195], v[164:167]
    ds_read_b64_tr_b16 a[96:97], v44 offset:23040
    v_mfma_f32_16x16x32_bf16 v[180:183], a[100:103], a[196:199], v[180:183]
    v_mfma_f32_16x16x32_bf16 v[212:215], a[100:103], a[200:203], v[212:215]
    ds_read_b64_tr_b16 a[98:99], v44 offset:23184
    v_mfma_f32_16x16x32_bf16 v[244:247], a[100:103], a[204:207], v[244:247]
    v_mfma_f32_16x16x32_bf16 v[168:171], a[104:107], a[192:195], v[168:171]
    ds_read_b64_tr_b16 a[100:101], v45 offset:23040
    v_mfma_f32_16x16x32_bf16 v[184:187], a[104:107], a[196:199], v[184:187]
    v_mfma_f32_16x16x32_bf16 v[216:219], a[104:107], a[200:203], v[216:219]
    ds_read_b64_tr_b16 a[102:103], v45 offset:23184
    v_mfma_f32_16x16x32_bf16 v[248:251], a[104:107], a[204:207], v[248:251]
    v_mfma_f32_16x16x32_bf16 v[172:175], a[108:111], a[192:195], v[172:175]
    ds_read_b64_tr_b16 a[104:105], v46 offset:23040
    v_mfma_f32_16x16x32_bf16 v[188:191], a[108:111], a[196:199], v[188:191]
    v_mfma_f32_16x16x32_bf16 v[220:223], a[108:111], a[200:203], v[220:223]
    ds_read_b64_tr_b16 a[106:107], v46 offset:23184
    v_mfma_f32_16x16x32_bf16 v[252:255], a[108:111], a[204:207], v[252:255]
    ds_read_b64_tr_b16 a[108:109], v47 offset:23040
    ds_read_b64_tr_b16 a[110:111], v47 offset:23184
    s_waitcnt lgkmcnt(15)
    v_mfma_f32_16x16x32_bf16 a[112:115], a[64:67], a[208:211], a[112:115]
    v_mfma_f32_16x16x32_bf16 a[116:119], a[64:67], a[212:215], a[116:119]
    v_mfma_f32_16x16x32_bf16 a[0:3], a[64:67], a[216:219], a[0:3]
    v_mfma_f32_16x16x32_bf16 a[4:7], a[64:67], a[220:223], a[4:7]
    v_mfma_f32_16x16x32_bf16 a[120:123], a[68:71], a[208:211], a[120:123]
    v_mfma_f32_16x16x32_bf16 a[124:127], a[68:71], a[212:215], a[124:127]
    v_mfma_f32_16x16x32_bf16 a[8:11], a[68:71], a[216:219], a[8:11]
    v_mfma_f32_16x16x32_bf16 a[12:15], a[68:71], a[220:223], a[12:15]
    s_waitcnt lgkmcnt(0)
    v_mfma_f32_16x16x32_bf16 a[128:131], a[72:75], a[208:211], a[128:131]
    s_barrier
    v_mfma_f32_16x16x32_bf16 a[132:135], a[72:75], a[212:215], a[132:135]
    v_mfma_f32_16x16x32_bf16 a[16:19], a[72:75], a[216:219], a[16:19]
    v_mfma_f32_16x16x32_bf16 a[20:23], a[72:75], a[220:223], a[20:23]
    v_mfma_f32_16x16x32_bf16 a[136:139], a[76:79], a[208:211], a[136:139]
    v_mfma_f32_16x16x32_bf16 a[140:143], a[76:79], a[212:215], a[140:143]
    v_mfma_f32_16x16x32_bf16 a[24:27], a[76:79], a[216:219], a[24:27]
    v_mfma_f32_16x16x32_bf16 a[28:31], a[76:79], a[220:223], a[28:31]
    v_mfma_f32_16x16x32_bf16 a[144:147], a[80:83], a[208:211], a[144:147]
    v_mfma_f32_16x16x32_bf16 a[148:151], a[80:83], a[212:215], a[148:151]
    v_mfma_f32_16x16x32_bf16 a[32:35], a[80:83], a[216:219], a[32:35]
    v_mfma_f32_16x16x32_bf16 a[36:39], a[80:83], a[220:223], a[36:39]
    v_mfma_f32_16x16x32_bf16 a[152:155], a[84:87], a[208:211], a[152:155]
    v_mfma_f32_16x16x32_bf16 a[156:159], a[84:87], a[212:215], a[156:159]
    v_mfma_f32_16x16x32_bf16 a[40:43], a[84:87], a[216:219], a[40:43]
    v_mfma_f32_16x16x32_bf16 a[44:47], a[84:87], a[220:223], a[44:47]
    v_mfma_f32_16x16x32_bf16 a[160:163], a[88:91], a[208:211], a[160:163]
    v_mfma_f32_16x16x32_bf16 a[164:167], a[88:91], a[212:215], a[164:167]
    v_mfma_f32_16x16x32_bf16 a[48:51], a[88:91], a[216:219], a[48:51]
    v_mfma_f32_16x16x32_bf16 a[52:55], a[88:91], a[220:223], a[52:55]
    v_mfma_f32_16x16x32_bf16 a[168:171], a[92:95], a[208:211], a[168:171]
    s_cmp_lg_u32 s22, 0
    s_cbranch_scc1 f1_w0_5
    buffer_load_dword v22, off, s[56:59], s17 sc1
f1_w0_5:
    v_mfma_f32_16x16x32_bf16 a[172:175], a[92:95], a[212:215], a[172:175]
    v_mfma_f32_16x16x32_bf16 a[56:59], a[92:95], a[216:219], a[56:59]
    v_mfma_f32_16x16x32_bf16 a[60:63], a[92:95], a[220:223], a[60:63]
    v_mfma_f32_16x16x32_bf16 v[160:163], a[96:99], a[208:211], v[160:163]
    v_mfma_f32_16x16x32_bf16 v[176:179], a[96:99], a[212:215], v[176:179]
    v_mfma_f32_16x16x32_bf16 v[208:211], a[96:99], a[216:219], v[208:211]
    v_mfma_f32_16x16x32_bf16 v[240:243], a[96:99], a[220:223], v[240:243]
    v_mfma_f32_16x16x32_bf16 v[164:167], a[100:103], a[208:211], v[164:167]
    v_mfma_f32_16x16x32_bf16 v[180:183], a[100:103], a[212:215], v[180:183]
    v_mfma_f32_16x16x32_bf16 v[212:215], a[100:103], a[216:219], v[212:215]
    v_mfma_f32_16x16x32_bf16 v[244:247], a[100:103], a[220:223], v[244:247]
    v_mfma_f32_16x16x32_bf16 v[168:171], a[104:107], a[208:211], v[168:171]
    v_mfma_f32_16x16x32_bf16 v[184:187], a[104:107], a[212:215], v[184:187]
    v_mfma_f32_16x16x32_bf16 v[216:219], a[104:107], a[216:219], v[216:219]
    v_mfma_f32_16x16x32_bf16 v[248:251], a[104:107], a[220:223], v[248:251]
    v_mfma_f32_16x16x32_bf16 v[172:175], a[108:111], a[208:211], v[172:175]
    v_mfma_f32_16x16x32_bf16 v[188:191], a[108:111], a[212:215], v[188:191]
    v_mfma_f32_16x16x32_bf16 v[220:223], a[108:111], a[216:219], v[220:223]
    v_mfma_f32_16x16x32_bf16 v[252:255], a[108:111], a[220:223], v[252:255]
    s_add_u32 s7, s5, 0
    s_mul_i32 s7, s7, 36864
    buffer_load_dwordx4 a[224:227], v12, s[40:43], s7 offen
    buffer_load_dwordx4 a[228:231], v13, s[40:43], s7 offen
    buffer_load_dwordx4 a[232:235], v14, s[40:43], s7 offen
    s_add_u32 s7, s5, 64
    s_mul_i32 s7, s7, 36864
    buffer_load_dwordx4 a[236:239], v12, s[40:43], s7 offen
    buffer_load_dwordx4 a[240:243], v13, s[40:43], s7 offen
    buffer_load_dwordx4 a[244:247], v14, s[40:43], s7 offen
    s_mul_i32 s7, s5, 41472
    s_cmp_eq_u32 s5, 16
    s_cselect_b32 s7, 0, s7
    s_cmp_eq_u32 s5, 17
    s_cselect_b32 s7, 331776, s7
    s_cmp_gt_u32 s5, 17
    s_cselect_b32 s7, 0x40000000, s7
    buffer_load_dwordx4 a[248:251], v15, s[60:63], s7 offen
    buffer_load_dwordx4 a[252:255], v16, s[60:63], s7 offen
    buffer_load_dwordx4 a[176:179], v17, s[60:63], s7 offen
    v_mov_b32 v17, 0
    v_mov_b32 v18, 0
    v_mov_b32 v19, 0
    v_mov_b32 v125, 0
    v_mov_b32 v126, 0
    v_mov_b32 v127, 0
    v_cvt_pk_bf16_f32 v192, v160, v161
    v_cvt_pk_bf16_f32 v200, v176, v177
    v_cvt_pk_bf16_f32 v193, v162, v163
    v_cvt_pk_bf16_f32 v201, v178, v179
    v_cvt_pk_bf16_f32 v194, v164, v165
    v_cvt_pk_bf16_f32 v202, v180, v181
    v_cvt_pk_bf16_f32 v195, v166, v167
    v_cvt_pk_bf16_f32 v203, v182, v183
    v_cvt_pk_bf16_f32 v196, v168, v169
    v_cvt_pk_bf16_f32 v204, v184, v185
    v_cvt_pk_bf16_f32 v197, v170, v171
    v_cvt_pk_bf16_f32 v205, v186, v187
    v_cvt_pk_bf16_f32 v198, v172, v173
    v_cvt_pk_bf16_f32 v206, v188, v189
    v_cvt_pk_bf16_f32 v199, v174, v175
    v_cvt_pk_bf16_f32 v207, v190, v191
    v_mfma_f32_16x16x32_bf16 v[96:99], v[64:67], v[192:195], 0
    v_mfma_f32_16x16x32_bf16 v[224:227], v[64:67], v[200:203], 0
    v_mfma_f32_16x16x32_bf16 v[96:99], v[68:71], v[196:199], v[96:99]
    v_mfma_f32_16x16x32_bf16 v[224:227], v[68:71], v[204:207], v[224:227]
    v_mfma_f32_16x16x32_bf16 v[100:103], v[72:75], v[192:195], 0
    v_mfma_f32_16x16x32_bf16 v[228:231], v[72:75], v[200:203], 0
    v_mfma_f32_16x16x32_bf16 v[100:103], v[76:79], v[196:199], v[100:103]
    v_mfma_f32_16x16x32_bf16 v[228:231], v[76:79], v[204:207], v[228:231]
    v_mfma_f32_16x16x32_bf16 v[104:107], v[80:83], v[192:195], 0
    v_mfma_f32_16x16x32_bf16 v[232:235], v[80:83], v[200:203], 0
    v_mfma_f32_16x16x32_bf16 v[104:107], v[84:87], v[196:199], v[104:107]
    v_mfma_f32_16x16x32_bf16 v[232:235], v[84:87], v[204:207], v[232:235]
    v_mfma_f32_16x16x32_bf16 v[108:111], v[88:91], v[192:195], 0
    v_mfma_f32_16x16x32_bf16 v[236:239], v[88:91], v[200:203], 0
    v_mfma_f32_16x16x32_bf16 v[108:111], v[92:95], v[196:199], v[108:111]
    v_mfma_f32_16x16x32_bf16 v[236:239], v[92:95], v[204:207], v[236:239]
    v_mfma_f32_16x16x32_bf16 v[112:115], v[128:131], v[192:195], 0
    v_mfma_f32_16x16x32_bf16 v[44:47], v[128:131], v[200:203], 0
    v_mfma_f32_16x16x32_bf16 v[112:115], v[132:135], v[196:199], v[112:115]
    v_mfma_f32_16x16x32_bf16 v[44:47], v[132:135], v[204:207], v[44:47]
    v_lshlrev_b32 v56, 16, v198
    v_lshlrev_b32 v60, 16, v206
    v_mul_f32 v56, s69, v56
    v_mul_f32 v60, s69, v60
    v_exp_f32 v56, v56
    v_exp_f32 v60, v60
    s_nop 0
    s_nop 0
    v_add_f32 v56, 1.0, v56
    v_add_f32 v60, 1.0, v60
    v_rcp_f32 v56, v56
    v_rcp_f32 v60, v60
    s_nop 0
    s_nop 0
    v_cvt_pk_bf16_f32 v56, v56, v56
    v_cvt_pk_bf16_f32 v60, v60, v60
    v_and_b32 v32, 0xffff0000, v56
    v_and_b32 v33, 0xffff0000, v60
    v_mfma_f32_16x16x32_bf16 v[160:163], v[196:199], v[140:143], 0
    v_mfma_f32_16x16x32_bf16 v[176:179], v[204:207], v[140:143], 0
    v_mfma_f32_16x16x32_bf16 v[164:167], v[196:199], v[144:147], v[148:151]
    v_mfma_f32_16x16x32_bf16 v[180:183], v[204:207], v[144:147], v[148:151]
    v_max3_f32 v58, v96, v97, v98
    v_max3_f32 v62, v224, v225, v226
    v_max3_f32 v58, v58, v99, v100
    v_max3_f32 v62, v62, v227, v228
    v_max3_f32 v58, v58, v101, v102
    v_max3_f32 v62, v62, v229, v230
    v_max3_f32 v58, v58, v103, v104
    v_max3_f32 v62, v62, v231, v232
    v_max3_f32 v58, v58, v105, v106
    v_max3_f32 v62, v62, v233, v234
    v_max3_f32 v58, v58, v107, v108
    v_max3_f32 v62, v62, v235, v236
    v_max3_f32 v58, v58, v109, v110
    v_max3_f32 v62, v62, v237, v238
    v_max3_f32 v58, v58, v111, v112
    v_max3_f32 v62, v62, v239, v44
    v_max_f32 v58, v58, v113
    v_max_f32 v62, v62, v45
    v_mul_f32 v58, s69, v58
    v_mul_f32 v62, s69, v62
    v_pk_fma_f32 v[96:97], v[96:97], s[68:69], v[58:59] op_sel_hi:[1,0,0]
    v_pk_fma_f32 v[224:225], v[224:225], s[68:69], v[62:63] op_sel_hi:[1,0,0]
    v_pk_fma_f32 v[98:99], v[98:99], s[68:69], v[58:59] op_sel_hi:[1,0,0]
    v_pk_fma_f32 v[226:227], v[226:227], s[68:69], v[62:63] op_sel_hi:[1,0,0]
    v_pk_fma_f32 v[100:101], v[100:101], s[68:69], v[58:59] op_sel_hi:[1,0,0]
    v_pk_fma_f32 v[228:229], v[228:229], s[68:69], v[62:63] op_sel_hi:[1,0,0]
    v_pk_fma_f32 v[102:103], v[102:103], s[68:69], v[58:59] op_sel_hi:[1,0,0]
    v_pk_fma_f32 v[230:231], v[230:231], s[68:69], v[62:63] op_sel_hi:[1,0,0]
    v_pk_fma_f32 v[104:105], v[104:105], s[68:69], v[58:59] op_sel_hi:[1,0,0]
    v_pk_fma_f32 v[232:233], v[232:233], s[68:69], v[62:63] op_sel_hi:[1,0,0]
    v_pk_fma_f32 v[106:107], v[106:107], s[68:69], v[58:59] op_sel_hi:[1,0,0]
    v_pk_fma_f32 v[234:235], v[234:235], s[68:69], v[62:63] op_sel_hi:[1,0,0]
    v_pk_fma_f32 v[108:109], v[108:109], s[68:69], v[58:59] op_sel_hi:[1,0,0]
    v_pk_fma_f32 v[236:237], v[236:237], s[68:69], v[62:63] op_sel_hi:[1,0,0]
    v_pk_fma_f32 v[110:111], v[110:111], s[68:69], v[58:59] op_sel_hi:[1,0,0]
    v_pk_fma_f32 v[238:239], v[238:239], s[68:69], v[62:63] op_sel_hi:[1,0,0]
    v_pk_fma_f32 v[112:113], v[112:113], s[68:69], v[58:59] op_sel_hi:[1,0,0]
    v_pk_fma_f32 v[44:45], v[44:45], s[68:69], v[62:63] op_sel_hi:[1,0,0]
    v_exp_f32 v96, v96
    v_exp_f32 v224, v224
    v_exp_f32 v97, v97
    v_exp_f32 v225, v225
    v_exp_f32 v98, v98
    v_exp_f32 v226, v226
    v_exp_f32 v99, v99
    v_exp_f32 v227, v227
    v_exp_f32 v100, v100
    v_exp_f32 v228, v228
    v_exp_f32 v101, v101
    v_exp_f32 v229, v229
    v_exp_f32 v102, v102
    v_exp_f32 v230, v230
    v_exp_f32 v103, v103
    v_exp_f32 v231, v231
    v_exp_f32 v104, v104
    v_exp_f32 v232, v232
    v_exp_f32 v105, v105
    v_exp_f32 v233, v233
    v_exp_f32 v106, v106
    v_exp_f32 v234, v234
    v_exp_f32 v107, v107
    v_exp_f32 v235, v235
    v_exp_f32 v108, v108
    v_exp_f32 v236, v236
    v_exp_f32 v109, v109
    v_exp_f32 v237, v237
    v_exp_f32 v110, v110
    v_exp_f32 v238, v238
    v_exp_f32 v111, v111
    v_exp_f32 v239, v239
    v_exp_f32 v112, v112
    v_exp_f32 v44, v44
    v_exp_f32 v113, v113
    v_exp_f32 v45, v45
    v_pk_add_f32 v[56:57], v[96:97], v[98:99]
    v_pk_add_f32 v[60:61], v[224:225], v[226:227]
    v_pk_add_f32 v[56:57], v[56:57], v[100:101]
    v_pk_add_f32 v[60:61], v[60:61], v[228:229]
    v_pk_add_f32 v[56:57], v[56:57], v[102:103]
    v_pk_add_f32 v[60:61], v[60:61], v[230:231]
    v_pk_add_f32 v[56:57], v[56:57], v[104:105]
    v_pk_add_f32 v[60:61], v[60:61], v[232:233]
    v_pk_add_f32 v[56:57], v[56:57], v[106:107]
    v_pk_add_f32 v[60:61], v[60:61], v[234:235]
    v_pk_add_f32 v[56:57], v[56:57], v[108:109]
    v_pk_add_f32 v[60:61], v[60:61], v[236:237]
    v_pk_add_f32 v[56:57], v[56:57], v[110:111]
    v_pk_add_f32 v[60:61], v[60:61], v[238:239]
    v_pk_add_f32 v[56:57], v[56:57], v[112:113]
    v_pk_add_f32 v[60:61], v[60:61], v[44:45]
    v_add_f32 v56, v56, v57
    v_add_f32 v60, v60, v61
    v_rcp_f32 v56, v56
    v_rcp_f32 v60, v60
    s_nop 0
    s_nop 0
    v_pk_mul_f32 v[96:97], v[96:97], v[56:57] op_sel_hi:[1,0]
    v_pk_mul_f32 v[224:225], v[224:225], v[60:61] op_sel_hi:[1,0]
    v_pk_mul_f32 v[98:99], v[98:99], v[56:57] op_sel_hi:[1,0]
    v_pk_mul_f32 v[226:227], v[226:227], v[60:61] op_sel_hi:[1,0]
    v_pk_mul_f32 v[100:101], v[100:101], v[56:57] op_sel_hi:[1,0]
    v_pk_mul_f32 v[228:229], v[228:229], v[60:61] op_sel_hi:[1,0]
    v_pk_mul_f32 v[102:103], v[102:103], v[56:57] op_sel_hi:[1,0]
    v_pk_mul_f32 v[230:231], v[230:231], v[60:61] op_sel_hi:[1,0]
    v_pk_mul_f32 v[104:105], v[104:105], v[56:57] op_sel_hi:[1,0]
    v_pk_mul_f32 v[232:233], v[232:233], v[60:61] op_sel_hi:[1,0]
    v_pk_mul_f32 v[106:107], v[106:107], v[56:57] op_sel_hi:[1,0]
    v_pk_mul_f32 v[234:235], v[234:235], v[60:61] op_sel_hi:[1,0]
    v_pk_mul_f32 v[108:109], v[108:109], v[56:57] op_sel_hi:[1,0]
    v_pk_mul_f32 v[236:237], v[236:237], v[60:61] op_sel_hi:[1,0]
    v_pk_mul_f32 v[110:111], v[110:111], v[56:57] op_sel_hi:[1,0]
    v_pk_mul_f32 v[238:239], v[238:239], v[60:61] op_sel_hi:[1,0]
    v_pk_mul_f32 v[112:113], v[112:113], v[56:57] op_sel_hi:[1,0]
    v_pk_mul_f32 v[44:45], v[44:45], v[60:61] op_sel_hi:[1,0]
    v_cvt_pk_bf16_f32 v8, v96, v97
    v_cvt_pk_bf16_f32 v116, v224, v225
    v_cvt_pk_bf16_f32 v9, v98, v99
    v_cvt_pk_bf16_f32 v117, v226, v227
    v_cvt_pk_bf16_f32 v10, v100, v101
    v_cvt_pk_bf16_f32 v118, v228, v229
    v_cvt_pk_bf16_f32 v11, v102, v103
    v_cvt_pk_bf16_f32 v119, v230, v231
    v_cvt_pk_bf16_f32 v12, v104, v105
    v_cvt_pk_bf16_f32 v120, v232, v233
    v_cvt_pk_bf16_f32 v13, v106, v107
    v_cvt_pk_bf16_f32 v121, v234, v235
    v_cvt_pk_bf16_f32 v14, v108, v109
    v_cvt_pk_bf16_f32 v122, v236, v237
    v_cvt_pk_bf16_f32 v15, v110, v111
    v_cvt_pk_bf16_f32 v123, v238, v239
    v_cvt_pk_bf16_f32 v16, v112, v113
    v_cvt_pk_bf16_f32 v124, v44, v45
    buffer_store_dwordx4 v[8:11], v20, s[32:35], s66 offen offset:0
    s_add_u32 s24, s66, 4608
    buffer_store_dwordx4 v[12:15], v20, s[32:35], s66 offen offset:16
    buffer_store_dwordx4 v[116:119], v20, s[32:35], s24 offen offset:0
    buffer_store_dword v16, v21, s[32:35], s66 offen offset:64
    buffer_store_dwordx4 v[120:123], v20, s[32:35], s24 offen offset:16
    v_mfma_f32_16x16x32_bf16 v[96:99], v[8:11], v[136:139], 0
    buffer_store_dword v124, v21, s[32:35], s24 offen offset:64
    v_mfma_f32_16x16x32_bf16 v[100:103], v[12:15], v[136:139], 0
    v_mfma_f32_16x16x32_bf16 v[224:227], v[116:119], v[136:139], 0
    v_mfma_f32_16x16x32_bf16 v[104:107], v[16:19], v[136:139], 0
    v_mfma_f32_16x16x32_bf16 v[228:231], v[120:123], v[136:139], 0
    v_mfma_f32_16x16x32_bf16 v[232:235], v[124:127], v[136:139], 0
    v_cvt_pk_bf16_f32 v152, v160, v161
    v_cvt_pk_bf16_f32 v153, v162, v163
    v_cvt_pk_bf16_f32 v154, v176, v177
    v_cvt_pk_bf16_f32 v155, v178, v179
    v_cvt_pk_bf16_f32 v156, v164, v165
    v_cvt_pk_bf16_f32 v157, v166, v167
    v_cvt_pk_bf16_f32 v158, v180, v181
    v_cvt_pk_bf16_f32 v159, v182, v183
    v_cvt_pk_bf16_f32 v168, v96, v97
    v_cvt_pk_bf16_f32 v169, v98, v99
    v_cvt_pk_bf16_f32 v170, v224, v225
    v_cvt_pk_bf16_f32 v171, v226, v227
    v_cvt_pk_bf16_f32 v172, v100, v101
    v_cvt_pk_bf16_f32 v173, v102, v103
    v_cvt_pk_bf16_f32 v174, v228, v229
    v_cvt_pk_bf16_f32 v175, v230, v231
    v_cvt_pk_bf16_f32 v184, v104, v105
    v_cvt_pk_bf16_f32 v185, v106, v107
    v_cvt_pk_bf16_f32 v186, v232, v233
    v_cvt_pk_bf16_f32 v187, v234, v235
    v_mfma_f32_16x16x32_bf16 a[64:67], v[168:171], v[152:155], 0
    v_mfma_f32_16x16x32_bf16 a[68:71], v[168:171], v[156:159], 0
    v_mfma_f32_16x16x32_bf16 a[72:75], v[172:175], v[152:155], 0
    v_mfma_f32_16x16x32_bf16 a[76:79], v[172:175], v[156:159], 0
    v_mfma_f32_16x16x32_bf16 a[80:83], v[184:187], v[152:155], 0
    v_mfma_f32_16x16x32_bf16 a[84:87], v[184:187], v[156:159], 0
    s_cmp_lg_u32 s22, 0
    s_cbranch_scc1 f1_w0_6
    s_waitcnt vmcnt(15)
    v_readfirstlane_b32 s25, v22
    s_nop 0
    s_cmp_ge_u32 s25, 32
    s_cbranch_scc0 f1_pk
f1_pk_r:
f1_w0_6:
    s_barrier
    s_add_u32 m0, s30, 147456
    v_cvt_pk_bf16_f32 v192, v208, v209
    v_cvt_pk_bf16_f32 v200, v240, v241
    v_cvt_pk_bf16_f32 v193, v210, v211
    v_cvt_pk_bf16_f32 v201, v242, v243
    v_cvt_pk_bf16_f32 v194, v212, v213
    v_cvt_pk_bf16_f32 v202, v244, v245
    s_add_u32 s23, s30, 0
    v_cvt_pk_bf16_f32 v195, v214, v215
    v_cvt_pk_bf16_f32 v203, v246, v247
    v_cvt_pk_bf16_f32 v196, v216, v217
    v_cvt_pk_bf16_f32 v204, v248, v249
    v_cvt_pk_bf16_f32 v197, v218, v219
    v_cvt_pk_bf16_f32 v205, v250, v251
    v_cvt_pk_bf16_f32 v198, v220, v221
    buffer_load_dwordx4 v29, s[44:47], s23 offen offset:0 sc1 lds
    v_cvt_pk_bf16_f32 v206, v252, v253
    v_cvt_pk_bf16_f32 v199, v222, v223
    v_cvt_pk_bf16_f32 v207, v254, v255
    v_mfma_f32_16x16x32_bf16 v[96:99], v[64:67], v[192:195], 0
    v_mfma_f32_16x16x32_bf16 v[224:227], v[64:67], v[200:203], 0
    v_mfma_f32_16x16x32_bf16 v[96:99], v[68:71], v[196:199], v[96:99]
    v_mfma_f32_16x16x32_bf16 v[224:227], v[68:71], v[204:207], v[224:227]
    buffer_load_dwordx4 v29, s[44:47], s23 offen offset:1024 sc1 lds
    v_mfma_f32_16x16x32_bf16 v[100:103], v[72:75], v[192:195], 0
    v_mfma_f32_16x16x32_bf16 v[228:231], v[72:75], v[200:203], 0
    v_mfma_f32_16x16x32_bf16 v[100:103], v[76:79], v[196:199], v[100:103]
    v_mfma_f32_16x16x32_bf16 v[228:231], v[76:79], v[204:207], v[228:231]
    v_mfma_f32_16x16x32_bf16 v[104:107], v[80:83], v[192:195], 0
    v_mfma_f32_16x16x32_bf16 v[232:235], v[80:83], v[200:203], 0
    v_mfma_f32_16x16x32_bf16 v[104:107], v[84:87], v[196:199], v[104:107]
    buffer_load_dwordx4 v29, s[44:47], s23 offen offset:2048 sc1 lds
    v_mfma_f32_16x16x32_bf16 v[232:235], v[84:87], v[204:207], v[232:235]
    v_mfma_f32_16x16x32_bf16 v[108:111], v[88:91], v[192:195], 0
    v_mfma_f32_16x16x32_bf16 v[236:239], v[88:91], v[200:203], 0
    v_mfma_f32_16x16x32_bf16 v[108:111], v[92:95], v[196:199], v[108:111]
    v_mfma_f32_16x16x32_bf16 v[236:239], v[92:95], v[204:207], v[236:239]
    v_mfma_f32_16x16x32_bf16 v[112:115], v[128:131], v[192:195], 0
    buffer_load_dwordx4 v29, s[44:47], s23 offen offset:3072 sc1 lds
    v_mfma_f32_16x16x32_bf16 v[44:47], v[128:131], v[200:203], 0
    v_mfma_f32_16x16x32_bf16 v[112:115], v[132:135], v[196:199], v[112:115]
    v_mfma_f32_16x16x32_bf16 v[44:47], v[132:135], v[204:207], v[44:47]
    v_lshlrev_b32 v56, 16, v198
    v_lshlrev_b32 v60, 16, v206
    v_mul_f32 v56, s69, v56
    v_mul_f32 v60, s69, v60
    s_add_u32 m0, s30, 32768
    v_exp_f32 v56, v56
    v_exp_f32 v60, v60
    s_nop 0
    s_nop 0
    v_add_f32 v56, 1.0, v56
    v_add_f32 v60, 1.0, v60
    v_rcp_f32 v56, v56
    s_add_u32 s23, s30, 16384
    v_rcp_f32 v60, v60
    s_nop 0
    s_nop 0
    v_cvt_pk_bf16_f32 v56, v56, v56
    v_cvt_pk_bf16_f32 v60, v60, v60
    v_and_b32 v34, 0xffff0000, v56
    v_and_b32 v35, 0xffff0000, v60
    buffer_load_dwordx4 v29, s[44:47], s23 offen offset:0 sc1 lds
    v_mfma_f32_16x16x32_bf16 v[208:211], v[196:199], v[140:143], 0
    v_mfma_f32_16x16x32_bf16 v[240:243], v[204:207], v[140:143], 0
    v_mfma_f32_16x16x32_bf16 v[212:215], v[196:199], v[144:147], v[148:151]
    v_mfma_f32_16x16x32_bf16 v[244:247], v[204:207], v[144:147], v[148:151]
    v_max3_f32 v58, v96, v97, v98
    v_max3_f32 v62, v224, v225, v226
    buffer_load_dwordx4 v29, s[44:47], s23 offen offset:1024 sc1 lds
    v_max3_f32 v58, v58, v99, v100
    v_max3_f32 v62, v62, v227, v228
    v_max3_f32 v58, v58, v101, v102
    v_max3_f32 v62, v62, v229, v230
    v_max3_f32 v58, v58, v103, v104
    v_max3_f32 v62, v62, v231, v232
    v_max3_f32 v58, v58, v105, v106
    buffer_load_dwordx4 v29, s[44:47], s23 offen offset:2048 sc1 lds
    v_max3_f32 v62, v62, v233, v234
    v_max3_f32 v58, v58, v107, v108
    v_max3_f32 v62, v62, v235, v236
    v_max3_f32 v58, v58, v109, v110
    v_max3_f32 v62, v62, v237, v238
    v_max3_f32 v58, v58, v111, v112
    v_max3_f32 v62, v62, v239, v44
    buffer_load_dwordx4 v29, s[44:47], s23 offen offset:3072 sc1 lds
    v_max_f32 v58, v58, v113
    v_max_f32 v62, v62, v45
    v_mul_f32 v58, s69, v58
    v_mul_f32 v62, s69, v62
    v_pk_fma_f32 v[96:97], v[96:97], s[68:69], v[58:59] op_sel_hi:[1,0,0]
    v_pk_fma_f32 v[224:225], v[224:225], s[68:69], v[62:63] op_sel_hi:[1,0,0]
    v_pk_fma_f32 v[98:99], v[98:99], s[68:69], v[58:59] op_sel_hi:[1,0,0]
    s_add_u32 m0, s30, 49152
    v_pk_fma_f32 v[226:227], v[226:227], s[68:69], v[62:63] op_sel_hi:[1,0,0]
    v_pk_fma_f32 v[100:101], v[100:101], s[68:69], v[58:59] op_sel_hi:[1,0,0]
    v_pk_fma_f32 v[228:229], v[228:229], s[68:69], v[62:63] op_sel_hi:[1,0,0]
    v_pk_fma_f32 v[102:103], v[102:103], s[68:69], v[58:59] op_sel_hi:[1,0,0]
    v_pk_fma_f32 v[230:231], v[230:231], s[68:69], v[62:63] op_sel_hi:[1,0,0]
    v_pk_fma_f32 v[104:105], v[104:105], s[68:69], v[58:59] op_sel_hi:[1,0,0]
    s_add_u32 s23, s30, 32768
    v_pk_fma_f32 v[232:233], v[232:233], s[68:69], v[62:63] op_sel_hi:[1,0,0]
    v_pk_fma_f32 v[106:107], v[106:107], s[68:69], v[58:59] op_sel_hi:[1,0,0]
    v_pk_fma_f32 v[234:235], v[234:235], s[68:69], v[62:63] op_sel_hi:[1,0,0]
    v_pk_fma_f32 v[108:109], v[108:109], s[68:69], v[58:59] op_sel_hi:[1,0,0]
    v_pk_fma_f32 v[236:237], v[236:237], s[68:69], v[62:63] op_sel_hi:[1,0,0]
    v_pk_fma_f32 v[110:111], v[110:111], s[68:69], v[58:59] op_sel_hi:[1,0,0]
    v_pk_fma_f32 v[238:239], v[238:239], s[68:69], v[62:63] op_sel_hi:[1,0,0]
    buffer_load_dwordx4 v29, s[44:47], s23 offen offset:0 sc1 lds
    v_pk_fma_f32 v[112:113], v[112:113], s[68:69], v[58:59] op_sel_hi:[1,0,0]
    v_pk_fma_f32 v[44:45], v[44:45], s[68:69], v[62:63] op_sel_hi:[1,0,0]
    v_exp_f32 v96, v96
    v_exp_f32 v224, v224
    v_exp_f32 v97, v97
    v_exp_f32 v225, v225
    v_exp_f32 v98, v98
    buffer_load_dwordx4 v29, s[44:47], s23 offen offset:1024 sc1 lds
    v_exp_f32 v226, v226
    v_exp_f32 v99, v99
    v_exp_f32 v227, v227
    v_exp_f32 v100, v100
    v_exp_f32 v228, v228
    v_exp_f32 v101, v101
    v_exp_f32 v229, v229
    buffer_load_dwordx4 v29, s[44:47], s23 offen offset:2048 sc1 lds
    v_exp_f32 v102, v102
    v_exp_f32 v230, v230
    v_exp_f32 v103, v103
    v_exp_f32 v231, v231
    v_exp_f32 v104, v104
    v_exp_f32 v232, v232
    v_exp_f32 v105, v105
    buffer_load_dwordx4 v29, s[44:47], s23 offen offset:3072 sc1 lds
    v_exp_f32 v233, v233
    v_exp_f32 v106, v106
    v_exp_f32 v234, v234
    v_exp_f32 v107, v107
    v_exp_f32 v235, v235
    v_exp_f32 v108, v108
    s_add_u32 m0, s30, 65536
    v_exp_f32 v236, v236
    v_exp_f32 v109, v109
    v_exp_f32 v237, v237
    v_exp_f32 v110, v110
    v_exp_f32 v238, v238
    v_exp_f32 v111, v111
    v_exp_f32 v239, v239
    s_add_u32 s23, s30, 49152
    v_exp_f32 v112, v112
    v_exp_f32 v44, v44
    v_exp_f32 v113, v113
    v_exp_f32 v45, v45
    v_pk_add_f32 v[56:57], v[96:97], v[98:99]
    v_pk_add_f32 v[60:61], v[224:225], v[226:227]
    v_pk_add_f32 v[56:57], v[56:57], v[100:101]
    buffer_load_dwordx4 v29, s[44:47], s23 offen offset:0 sc1 lds
    v_pk_add_f32 v[60:61], v[60:61], v[228:229]
    v_pk_add_f32 v[56:57], v[56:57], v[102:103]
    v_pk_add_f32 v[60:61], v[60:61], v[230:231]
    v_pk_add_f32 v[56:57], v[56:57], v[104:105]
    v_pk_add_f32 v[60:61], v[60:61], v[232:233]
    v_pk_add_f32 v[56:57], v[56:57], v[106:107]
    v_pk_add_f32 v[60:61], v[60:61], v[234:235]
    buffer_load_dwordx4 v29, s[44:47], s23 offen offset:1024 sc1 lds
    v_pk_add_f32 v[56:57], v[56:57], v[108:109]
    v_pk_add_f32 v[60:61], v[60:61], v[236:237]
    v_pk_add_f32 v[56:57], v[56:57], v[110:111]
    v_pk_add_f32 v[60:61], v[60:61], v[238:239]
    v_pk_add_f32 v[56:57], v[56:57], v[112:113]
    v_pk_add_f32 v[60:61], v[60:61], v[44:45]
    buffer_load_dwordx4 v29, s[44:47], s23 offen offset:2048 sc1 lds
    v_add_f32 v56, v56, v57
    v_add_f32 v60, v60, v61
    v_rcp_f32 v56, v56
    v_rcp_f32 v60, v60
    s_nop 0
    s_nop 0
    v_pk_mul_f32 v[96:97], v[96:97], v[56:57] op_sel_hi:[1,0]
    buffer_load_dwordx4 v29, s[44:47], s23 offen offset:3072 sc1 lds
    v_pk_mul_f32 v[224:225], v[224:225], v[60:61] op_sel_hi:[1,0]
    v_pk_mul_f32 v[98:99], v[98:99], v[56:57] op_sel_hi:[1,0]
    v_pk_mul_f32 v[226:227], v[226:227], v[60:61] op_sel_hi:[1,0]
    v_pk_mul_f32 v[100:101], v[100:101], v[56:57] op_sel_hi:[1,0]
    v_pk_mul_f32 v[228:229], v[228:229], v[60:61] op_sel_hi:[1,0]
    v_pk_mul_f32 v[102:103], v[102:103], v[56:57] op_sel_hi:[1,0]
    v_pk_mul_f32 v[230:231], v[230:231], v[60:61] op_sel_hi:[1,0]
    s_add_u32 m0, s30, 81920
    v_pk_mul_f32 v[104:105], v[104:105], v[56:57] op_sel_hi:[1,0]
    v_pk_mul_f32 v[232:233], v[232:233], v[60:61] op_sel_hi:[1,0]
    v_pk_mul_f32 v[106:107], v[106:107], v[56:57] op_sel_hi:[1,0]
    v_pk_mul_f32 v[234:235], v[234:235], v[60:61] op_sel_hi:[1,0]
    v_pk_mul_f32 v[108:109], v[108:109], v[56:57] op_sel_hi:[1,0]
    v_pk_mul_f32 v[236:237], v[236:237], v[60:61] op_sel_hi:[1,0]
    v_pk_mul_f32 v[110:111], v[110:111], v[56:57] op_sel_hi:[1,0]
    s_add_u32 s23, s30, 65536
    v_pk_mul_f32 v[238:239], v[238:239], v[60:61] op_sel_hi:[1,0]
    v_pk_mul_f32 v[112:113], v[112:113], v[56:57] op_sel_hi:[1,0]
    v_pk_mul_f32 v[44:45], v[44:45], v[60:61] op_sel_hi:[1,0]
    v_cvt_pk_bf16_f32 v8, v96, v97
    v_cvt_pk_bf16_f32 v116, v224, v225
    v_cvt_pk_bf16_f32 v9, v98, v99
    buffer_load_dwordx4 v29, s[44:47], s23 offen offset:0 sc1 lds
    v_cvt_pk_bf16_f32 v117, v226, v227
    v_cvt_pk_bf16_f32 v10, v100, v101
    v_cvt_pk_bf16_f32 v118, v228, v229
    v_cvt_pk_bf16_f32 v11, v102, v103
    v_cvt_pk_bf16_f32 v119, v230, v231
    v_cvt_pk_bf16_f32 v12, v104, v105
    v_cvt_pk_bf16_f32 v120, v232, v233
    buffer_load_dwordx4 v29, s[44:47], s23 offen offset:1024 sc1 lds
    v_cvt_pk_bf16_f32 v13, v106, v107
    v_cvt_pk_bf16_f32 v121, v234, v235
    v_cvt_pk_bf16_f32 v14, v108, v109
    v_cvt_pk_bf16_f32 v122, v236, v237
    v_cvt_pk_bf16_f32 v15, v110, v111
    v_cvt_pk_bf16_f32 v123, v238, v239
    v_cvt_pk_bf16_f32 v16, v112, v113
    buffer_load_dwordx4 v29, s[44:47], s23 offen offset:2048 sc1 lds
    v_cvt_pk_bf16_f32 v124, v44, v45
    buffer_store_dwordx4 v[8:11], v20, s[32:35], s67 offen offset:0
    s_add_u32 s24, s67, 4608
    buffer_store_dwordx4 v[12:15], v20, s[32:35], s67 offen offset:16
    buffer_store_dwordx4 v[116:119], v20, s[32:35], s24 offen offset:0
    buffer_store_dword v16, v21, s[32:35], s67 offen offset:64
    buffer_store_dwordx4 v[120:123], v20, s[32:35], s24 offen offset:16
    buffer_load_dwordx4 v29, s[44:47], s23 offen offset:3072 sc1 lds
    v_mfma_f32_16x16x32_bf16 v[96:99], v[8:11], v[136:139], 0
    buffer_store_dword v124, v21, s[32:35], s24 offen offset:64
    v_mfma_f32_16x16x32_bf16 v[100:103], v[12:15], v[136:139], 0
    v_mfma_f32_16x16x32_bf16 v[224:227], v[116:119], v[136:139], 0
    v_mfma_f32_16x16x32_bf16 v[104:107], v[16:19], v[136:139], 0
    v_mfma_f32_16x16x32_bf16 v[228:231], v[120:123], v[136:139], 0
    v_mfma_f32_16x16x32_bf16 v[232:235], v[124:127], v[136:139], 0
    v_cvt_pk_bf16_f32 v152, v208, v209
    v_cvt_pk_bf16_f32 v153, v210, v211
    v_cvt_pk_bf16_f32 v154, v240, v241
    v_cvt_pk_bf16_f32 v155, v242, v243
    v_cvt_pk_bf16_f32 v156, v212, v213
    v_cvt_pk_bf16_f32 v157, v214, v215
    v_cvt_pk_bf16_f32 v158, v244, v245
    v_cvt_pk_bf16_f32 v159, v246, v247
    v_cvt_pk_bf16_f32 v216, v96, v97
    v_cvt_pk_bf16_f32 v217, v98, v99
    v_cvt_pk_bf16_f32 v218, v224, v225
    v_cvt_pk_bf16_f32 v219, v226, v227
    v_cvt_pk_bf16_f32 v220, v100, v101
    v_cvt_pk_bf16_f32 v221, v102, v103
    v_cvt_pk_bf16_f32 v222, v228, v229
    v_cvt_pk_bf16_f32 v223, v230, v231
    v_cvt_pk_bf16_f32 v248, v104, v105
    v_cvt_pk_bf16_f32 v249, v106, v107
    v_cvt_pk_bf16_f32 v250, v232, v233
    v_cvt_pk_bf16_f32 v251, v234, v235
    v_mfma_f32_16x16x32_bf16 a[64:67], v[216:219], v[152:155], a[64:67]
    v_mfma_f32_16x16x32_bf16 a[68:71], v[216:219], v[156:159], a[68:71]
    v_mfma_f32_16x16x32_bf16 a[72:75], v[220:223], v[152:155], a[72:75]
    v_mfma_f32_16x16x32_bf16 a[76:79], v[220:223], v[156:159], a[76:79]
    v_mfma_f32_16x16x32_bf16 a[80:83], v[248:251], v[152:155], a[80:83]
    v_mfma_f32_16x16x32_bf16 a[84:87], v[248:251], v[156:159], a[84:87]
    v_add_u32 v57, s74, v29
    s_nop 1
    ds_write_b128 v57, a[64:67] offset:0
    ds_write_b128 v57, a[68:71] offset:1024
    ds_write_b128 v57, a[72:75] offset:2048
    ds_write_b128 v57, a[76:79] offset:3072
    ds_write_b128 v57, a[80:83] offset:4096
    ds_write_b128 v57, a[84:87] offset:5120
    v_add_u32 v57, s10, v29
    s_lshl_b32 s70, s20, 3
    s_add_u32 s70, s70, s21
    s_mul_i32 s70, s70, 3040
    v_lshrrev_b32 v58, 1, v3
    v_and_b32 v59, 1, v3
    v_mov_b32 v63, 2147483392
    s_and_b32 s25, s22, 1
    s_lshl_b32 s25, s25, 4
    v_add_u32 v60, s25, v2
    v_mul_u32_u24 v61, 160, v60
    v_cmp_gt_u32 vcc, 19, v60
    s_lshr_b32 s26, s22, 1
    s_lshl_b32 s26, s26, 5
    v_cndmask_b32 v61, v63, v61, vcc
    v_lshlrev_b32 v62, 6, v58
    v_lshl_add_u32 v62, v59, 4, v62
    v_add3_u32 v62, v62, s26, v61
    v_lshlrev_b32 v56, 4, v58
    v_add3_u32 v56, v56, v61, 64
    v_add_u32 v56, 64, v56
    v_cmp_eq_u32 vcc, 0, v59
    s_cmp_lt_u32 s22, 2
    s_cselect_b32 s71, 0, 0x40000000
    v_cndmask_b32 v56, v63, v56, vcc
    s_add_u32 s71, s71, s70
    v_lshlrev_b32 v40, 2, v2
    v_add_u32 v40, 192, v40
    ds_bpermute_b32 v36, v40, v32
    ds_bpermute_b32 v37, v40, v33
    ds_bpermute_b32 v38, v40, v34
    ds_bpermute_b32 v39, v40, v35
    v_and_b32 v41, 1, v3
    v_cmp_eq_u32 vcc, 1, v41
    s_waitcnt lgkmcnt(0)
    s_nop 0
    v_cndmask_b32 v6, v36, v37, vcc
    v_cndmask_b32 v7, v38, v39, vcc
    v_mov_b32 v16, v36
    v_mov_b32 v17, v37
    v_mov_b32 v18, v38
    v_mov_b32 v19, v39
    v_mov_b32 v26, 0x3e0293ee
    v_mov_b32 v27, v26
    v_add_u32 v2, 131072, v29
    v_and_b32 v20, 31, v1
    v_lshrrev_b32 v21, 5, v1
    v_lshrrev_b32 v22, 4, v1
    v_lshlrev_b32 v22, 2, v22
    v_and_b32 v3, 15, v1
    v_sub_u32 v3, v3, v22
    s_lshl_b32 s23, s22, 4
    v_add_u32 v3, s23, v3
    v_mov_b32 v5, 0xff800000
    v_mov_b32 v13, 0
    v_mov_b32 v14, 0
    v_mov_b32 v15, 0
    v_mov_b32 v30, 0
    v_mov_b32 v208, 0x3f803f80
    v_mov_b32 v209, v208
    v_mov_b32 v210, v208
    v_mov_b32 v211, v208
    s_mov_b32 s74, 131072
    s_mov_b32 s82, 0
    s_waitcnt vmcnt(22)
    s_barrier
    ds_read_b128 v[64:67], v57 offset:0
    ds_read_b128 v[68:71], v57 offset:8192
    ds_read_b128 v[72:75], v57 offset:16384
    ds_read_b128 v[76:79], v57 offset:24576
    ds_read_b128 v[80:83], v57 offset:4096
    ds_read_b128 v[84:87], v57 offset:12288
    ds_read_b128 v[88:91], v57 offset:20480
    ds_read_b128 v[92:95], v57 offset:28672
    ds_read_b128 a[192:195], v2 offset:16384
    ds_read_b128 a[196:199], v2 offset:17408
    ds_read_b128 a[200:203], v2 offset:18432
    ds_read_b128 a[204:207], v2 offset:19456
    ds_read_b128 a[208:211], v2 offset:20480
    ds_read_b128 a[212:215], v2 offset:21504
    ds_read_b128 a[216:219], v2 offset:22528
    v_accvgpr_read_b32 v160, a112
    v_accvgpr_read_b32 v161, a113
    v_accvgpr_read_b32 v162, a114
    v_accvgpr_read_b32 v163, a115
    v_accvgpr_read_b32 v164, a120
    v_accvgpr_read_b32 v165, a121
    v_accvgpr_read_b32 v166, a122
    v_accvgpr_read_b32 v167, a123
    v_pk_mul_f32 v[160:161], v[160:161], v[26:27]
    v_pk_mul_f32 v[162:163], v[162:163], v[26:27]
    v_pk_mul_f32 v[164:165], v[164:165], v[26:27]
    v_pk_mul_f32 v[166:167], v[166:167], v[26:27]
    v_cvt_pk_bf16_f32 v96, v160, v161
    v_cvt_pk_bf16_f32 v97, v162, v163
    v_cvt_pk_bf16_f32 v98, v164, v165
    v_cvt_pk_bf16_f32 v99, v166, v167
    v_accvgpr_read_b32 v168, a128
    v_accvgpr_read_b32 v169, a129
    v_accvgpr_read_b32 v170, a130
    v_accvgpr_read_b32 v171, a131
    v_accvgpr_read_b32 v172, a136
    v_accvgpr_read_b32 v173, a137
    v_accvgpr_read_b32 v174, a138
    v_accvgpr_read_b32 v175, a139
    s_waitcnt lgkmcnt(11)
    v_pk_add_f32 v[64:65], v[64:65], v[68:69]
    v_pk_add_f32 v[72:73], v[72:73], v[76:77]
    v_pk_add_f32 v[66:67], v[66:67], v[70:71]
    v_pk_add_f32 v[74:75], v[74:75], v[78:79]
    v_pk_add_f32 v[64:65], v[64:65], v[72:73]
    v_pk_add_f32 v[66:67], v[66:67], v[74:75]
    buffer_store_dwordx4 v[64:67], v62, s[36:39], s70 offen
    s_waitcnt lgkmcnt(7)
    v_pk_add_f32 v[80:81], v[80:81], v[84:85]
    v_pk_add_f32 v[88:89], v[88:89], v[92:93]
    v_pk_add_f32 v[82:83], v[82:83], v[86:87]
    v_pk_add_f32 v[90:91], v[90:91], v[94:95]
    v_pk_add_f32 v[80:81], v[80:81], v[88:89]
    v_pk_add_f32 v[82:83], v[82:83], v[90:91]
    buffer_store_dwordx4 v[80:83], v56, s[36:39], s71 offen
    ds_read_b128 a[220:223], v2 offset:23552
    v_pk_mul_f32 v[168:169], v[168:169], v[26:27]
    v_pk_mul_f32 v[170:171], v[170:171], v[26:27]
    v_pk_mul_f32 v[172:173], v[172:173], v[26:27]
    v_pk_mul_f32 v[174:175], v[174:175], v[26:27]
    v_cvt_pk_bf16_f32 v100, v168, v169
    v_cvt_pk_bf16_f32 v101, v170, v171
    v_cvt_pk_bf16_f32 v102, v172, v173
    v_cvt_pk_bf16_f32 v103, v174, v175
    v_accvgpr_read_b32 v176, a144
    s_add_u32 m0, s30, 98304
    v_accvgpr_read_b32 v177, a145
    v_accvgpr_read_b32 v178, a146
    v_accvgpr_read_b32 v179, a147
    v_accvgpr_read_b32 v180, a152
    s_add_u32 s23, s30, 81920
    v_accvgpr_read_b32 v181, a153
    v_accvgpr_read_b32 v182, a154
    v_accvgpr_read_b32 v183, a155
    v_pk_mul_f32 v[176:177], v[176:177], v[26:27]
    v_pk_mul_f32 v[178:179], v[178:179], v[26:27]
    buffer_load_dwordx4 v29, s[44:47], s23 offen offset:0 sc1 lds
    v_pk_mul_f32 v[180:181], v[180:181], v[26:27]
    v_pk_mul_f32 v[182:183], v[182:183], v[26:27]
    v_cvt_pk_bf16_f32 v104, v176, v177
    v_cvt_pk_bf16_f32 v105, v178, v179
    v_cvt_pk_bf16_f32 v106, v180, v181
    buffer_load_dwordx4 v29, s[44:47], s23 offen offset:1024 sc1 lds
    v_cvt_pk_bf16_f32 v107, v182, v183
    v_accvgpr_read_b32 v184, a160
    v_accvgpr_read_b32 v185, a161
    v_accvgpr_read_b32 v186, a162
    v_accvgpr_read_b32 v187, a163
    buffer_load_dwordx4 v29, s[44:47], s23 offen offset:2048 sc1 lds
    v_accvgpr_read_b32 v188, a168
    v_accvgpr_read_b32 v189, a169
    v_accvgpr_read_b32 v190, a170
    v_accvgpr_read_b32 v191, a171
    v_pk_mul_f32 v[184:185], v[184:185], v[26:27]
    buffer_load_dwordx4 v29, s[44:47], s23 offen offset:3072 sc1 lds
    v_pk_mul_f32 v[186:187], v[186:187], v[26:27]
    v_pk_mul_f32 v[188:189], v[188:189], v[26:27]
    v_pk_mul_f32 v[190:191], v[190:191], v[26:27]
    v_cvt_pk_bf16_f32 v108, v184, v185
    v_cvt_pk_bf16_f32 v109, v186, v187
    s_add_u32 m0, s30, 114688
    v_cvt_pk_bf16_f32 v110, v188, v189
    v_cvt_pk_bf16_f32 v111, v190, v191
    v_accvgpr_read_b32 v160, a116
    v_accvgpr_read_b32 v161, a117
    v_accvgpr_read_b32 v162, a118
    s_add_u32 s23, s30, 98304
    v_accvgpr_read_b32 v163, a119
    v_accvgpr_read_b32 v164, a124
    v_accvgpr_read_b32 v165, a125
    v_accvgpr_read_b32 v166, a126
    v_accvgpr_read_b32 v167, a127
    buffer_load_dwordx4 v29, s[44:47], s23 offen offset:0 sc1 lds
    v_pk_mul_f32 v[160:161], v[160:161], v[26:27]
    v_pk_mul_f32 v[162:163], v[162:163], v[26:27]
    v_pk_mul_f32 v[164:165], v[164:165], v[26:27]
    v_pk_mul_f32 v[166:167], v[166:167], v[26:27]
    buffer_load_dwordx4 v29, s[44:47], s23 offen offset:1024 sc1 lds
    v_cvt_pk_bf16_f32 v112, v160, v161
    v_cvt_pk_bf16_f32 v113, v162, v163
    v_cvt_pk_bf16_f32 v114, v164, v165
    v_cvt_pk_bf16_f32 v115, v166, v167
    v_accvgpr_read_b32 v168, a132
    buffer_load_dwordx4 v29, s[44:47], s23 offen offset:2048 sc1 lds
    v_accvgpr_read_b32 v169, a133
    v_accvgpr_read_b32 v170, a134
    v_accvgpr_read_b32 v171, a135
    v_accvgpr_read_b32 v172, a140
    v_accvgpr_read_b32 v173, a141
    buffer_load_dwordx4 v29, s[44:47], s23 offen offset:3072 sc1 lds
    v_accvgpr_read_b32 v174, a142
    v_accvgpr_read_b32 v175, a143
    v_pk_mul_f32 v[168:169], v[168:169], v[26:27]
    v_pk_mul_f32 v[170:171], v[170:171], v[26:27]
    v_pk_mul_f32 v[172:173], v[172:173], v[26:27]
    s_add_u32 s40, s18, 71303168
    s_addc_u32 s41, s19, 0
    v_pk_mul_f32 v[174:175], v[174:175], v[26:27]
    v_cvt_pk_bf16_f32 v116, v168, v169
    v_cvt_pk_bf16_f32 v117, v170, v171
    v_cvt_pk_bf16_f32 v118, v172, v173
    v_cvt_pk_bf16_f32 v119, v174, v175
    s_mov_b32 s42, 5382144
    v_accvgpr_read_b32 v176, a148
    v_accvgpr_read_b32 v177, a149
    v_accvgpr_read_b32 v178, a150
    v_accvgpr_read_b32 v179, a151
    v_accvgpr_read_b32 v180, a156
    s_mov_b32 s43, 0x00020000
    v_accvgpr_read_b32 v181, a157
    v_accvgpr_read_b32 v182, a158
    v_accvgpr_read_b32 v183, a159
    v_pk_mul_f32 v[176:177], v[176:177], v[26:27]
    v_pk_mul_f32 v[178:179], v[178:179], v[26:27]
    v_pk_mul_f32 v[180:181], v[180:181], v[26:27]
    v_pk_mul_f32 v[182:183], v[182:183], v[26:27]
    v_cvt_pk_bf16_f32 v120, v176, v177
    v_cvt_pk_bf16_f32 v121, v178, v179
    v_cvt_pk_bf16_f32 v122, v180, v181
    s_add_u32 s7, s4, 0
    buffer_store_dwordx4 a[224:227], v29, s[40:43], s7 offen sc1
    v_cvt_pk_bf16_f32 v123, v182, v183
    v_accvgpr_read_b32 v184, a164
    v_accvgpr_read_b32 v185, a165
    v_accvgpr_read_b32 v186, a166
    v_accvgpr_read_b32 v187, a167
    s_add_u32 s7, s4, 4096
    buffer_store_dwordx4 a[228:231], v29, s[40:43], s7 offen sc1
    v_accvgpr_read_b32 v188, a172
    v_accvgpr_read_b32 v189, a173
    v_accvgpr_read_b32 v190, a174
    v_accvgpr_read_b32 v191, a175
    s_add_u32 s7, s4, 8192
    s_add_u32 s7, s7, s6
    buffer_store_dwordx4 a[232:235], v29, s[40:43], s7 offen sc1
    v_pk_mul_f32 v[184:185], v[184:185], v[26:27]
    v_pk_mul_f32 v[186:187], v[186:187], v[26:27]
    v_pk_mul_f32 v[188:189], v[188:189], v[26:27]
    v_pk_mul_f32 v[190:191], v[190:191], v[26:27]
    v_cvt_pk_bf16_f32 v124, v184, v185
    s_add_u32 s7, s4, 589824
    buffer_store_dwordx4 a[236:239], v29, s[40:43], s7 offen sc1
    v_cvt_pk_bf16_f32 v125, v186, v187
    v_cvt_pk_bf16_f32 v126, v188, v189
    v_cvt_pk_bf16_f32 v127, v190, v191
    v_accvgpr_write_b32 a128, v96
    v_accvgpr_write_b32 a129, v97
    s_add_u32 s7, s4, 593920
    buffer_store_dwordx4 a[240:243], v29, s[40:43], s7 offen sc1
    v_accvgpr_write_b32 a130, v98
    v_accvgpr_write_b32 a131, v99
    v_accvgpr_write_b32 a132, v100
    v_accvgpr_write_b32 a133, v101
    v_accvgpr_write_b32 a134, v102
    s_add_u32 s7, s4, 598016
    s_add_u32 s7, s7, s6
    buffer_store_dwordx4 a[244:247], v29, s[40:43], s7 offen sc1
    v_accvgpr_write_b32 a135, v103
    v_accvgpr_write_b32 a136, v104
    v_accvgpr_write_b32 a137, v105
    v_accvgpr_write_b32 a138, v106
    v_accvgpr_write_b32 a139, v107
    s_add_u32 s7, s4, 1179648
    s_cmp_gt_u32 s5, 17
    s_cselect_b32 s7, 0x40000000, s7
    buffer_store_dwordx4 a[248:251], v29, s[40:43], s7 offen sc1
    v_accvgpr_write_b32 a140, v108
    v_accvgpr_write_b32 a141, v109
    v_accvgpr_write_b32 a142, v110
    v_accvgpr_write_b32 a143, v111
    v_accvgpr_write_b32 a144, v112
    s_add_u32 s7, s4, 1183744
    s_cmp_gt_u32 s5, 17
    s_cselect_b32 s7, 0x40000000, s7
    buffer_store_dwordx4 a[252:255], v29, s[40:43], s7 offen sc1
    v_accvgpr_write_b32 a145, v113
    v_accvgpr_write_b32 a146, v114
    v_accvgpr_write_b32 a147, v115
    v_accvgpr_write_b32 a148, v116
    v_accvgpr_write_b32 a149, v117
    s_add_u32 s7, s4, 1187840
    s_add_u32 s7, s7, s6
    s_cmp_gt_u32 s5, 17
    s_cselect_b32 s7, 0x40000000, s7
    buffer_store_dwordx4 a[176:179], v29, s[40:43], s7 offen sc1
    v_accvgpr_write_b32 a150, v118
    v_accvgpr_write_b32 a151, v119
    v_accvgpr_write_b32 a152, v120
    v_accvgpr_write_b32 a153, v121
    v_accvgpr_write_b32 a154, v122
    ds_read_b128 a[224:227], v2 offset:24576
    ds_read_b128 a[228:231], v2 offset:25600
    ds_read_b128 a[232:235], v2 offset:26624
    ds_read_b128 a[236:239], v2 offset:27648
    ds_read_b128 a[240:243], v2 offset:28672
    ds_read_b128 a[244:247], v2 offset:29696
    ds_read_b128 a[248:251], v2 offset:30720
    ds_read_b128 a[252:255], v2 offset:31744
    v_accvgpr_write_b32 a155, v123
    v_accvgpr_write_b32 a156, v124
    v_accvgpr_write_b32 a157, v125
    v_accvgpr_write_b32 a158, v126
    v_accvgpr_write_b32 a159, v127
    s_waitcnt lgkmcnt(12)
    v_mfma_f32_16x16x32_bf16 v[32:35], a[192:195], a[128:131], 0
    v_accvgpr_read_b32 v160, a0
    v_accvgpr_read_b32 v161, a1
    v_accvgpr_read_b32 v162, a2
    v_mfma_f32_16x16x32_bf16 v[48:51], a[192:195], a[144:147], 0
    v_accvgpr_read_b32 v163, a3
    v_accvgpr_read_b32 v164, a8
    v_accvgpr_read_b32 v165, a9
    v_mfma_f32_16x16x32_bf16 v[32:35], a[196:199], a[132:135], v[32:35]
    v_accvgpr_read_b32 v166, a10
    v_accvgpr_read_b32 v167, a11
    v_mul_f32 v160, v160, v26
    v_mfma_f32_16x16x32_bf16 v[48:51], a[196:199], a[148:151], v[48:51]
    v_mul_f32 v161, v161, v26
    v_mul_f32 v162, v162, v26
    v_mul_f32 v163, v163, v26
    v_mfma_f32_16x16x32_bf16 v[32:35], a[200:203], a[136:139], v[32:35]
    v_mul_f32 v164, v164, v26
    v_mul_f32 v165, v165, v26
    v_mul_f32 v166, v166, v26
    v_mfma_f32_16x16x32_bf16 v[48:51], a[200:203], a[152:155], v[48:51]
    v_mul_f32 v167, v167, v26
    v_cvt_pk_bf16_f32 v128, v160, v161
    v_cvt_pk_bf16_f32 v129, v162, v163
    v_mfma_f32_16x16x32_bf16 v[32:35], a[204:207], a[140:143], v[32:35]
    v_cvt_pk_bf16_f32 v130, v164, v165
    v_cvt_pk_bf16_f32 v131, v166, v167
    v_accvgpr_write_b32 a160, v128
    v_accvgpr_write_b32 a161, v129
    v_mfma_f32_16x16x32_bf16 v[48:51], a[204:207], a[156:159], v[48:51]
    s_waitcnt lgkmcnt(8)
    v_accvgpr_write_b32 a162, v130
    v_accvgpr_write_b32 a163, v131
    v_mfma_f32_16x16x32_bf16 v[36:39], a[208:211], a[128:131], 0
    v_accvgpr_read_b32 v168, a16
    v_accvgpr_read_b32 v169, a17
    v_accvgpr_read_b32 v170, a18
    v_mfma_f32_16x16x32_bf16 v[52:55], a[208:211], a[144:147], 0
    v_accvgpr_read_b32 v171, a19
    v_accvgpr_read_b32 v172, a24
    v_accvgpr_read_b32 v173, a25
    v_mfma_f32_16x16x32_bf16 v[36:39], a[212:215], a[132:135], v[36:39]
    v_accvgpr_read_b32 v174, a26
    v_accvgpr_read_b32 v175, a27
    v_mul_f32 v168, v168, v26
    v_mfma_f32_16x16x32_bf16 v[52:55], a[212:215], a[148:151], v[52:55]
    v_mul_f32 v169, v169, v26
    v_mul_f32 v170, v170, v26
    v_mul_f32 v171, v171, v26
    v_mfma_f32_16x16x32_bf16 v[36:39], a[216:219], a[136:139], v[36:39]
    v_mul_f32 v172, v172, v26
    v_mul_f32 v173, v173, v26
    v_mul_f32 v174, v174, v26
    v_mfma_f32_16x16x32_bf16 v[52:55], a[216:219], a[152:155], v[52:55]
    v_mul_f32 v175, v175, v26
    v_cvt_pk_bf16_f32 v132, v168, v169
    v_cvt_pk_bf16_f32 v133, v170, v171
    v_mfma_f32_16x16x32_bf16 v[36:39], a[220:223], a[140:143], v[36:39]
    v_cvt_pk_bf16_f32 v134, v172, v173
    v_cvt_pk_bf16_f32 v135, v174, v175
    v_accvgpr_write_b32 a164, v132
    v_mfma_f32_16x16x32_bf16 v[52:55], a[220:223], a[156:159], v[52:55]
    s_waitcnt lgkmcnt(4)
    v_accvgpr_write_b32 a165, v133
    v_accvgpr_write_b32 a166, v134
    v_accvgpr_write_b32 a167, v135
    v_mfma_f32_16x16x32_bf16 v[40:43], a[224:227], a[128:131], 0
    v_accvgpr_read_b32 v176, a32
    v_accvgpr_read_b32 v177, a33
    v_accvgpr_read_b32 v178, a34
    v_mfma_f32_16x16x32_bf16 v[56:59], a[224:227], a[144:147], 0
    v_accvgpr_read_b32 v179, a35
    v_accvgpr_read_b32 v180, a40
    v_accvgpr_read_b32 v181, a41
    v_mfma_f32_16x16x32_bf16 v[40:43], a[228:231], a[132:135], v[40:43]
    v_accvgpr_read_b32 v182, a42
    v_accvgpr_read_b32 v183, a43
    v_mul_f32 v176, v176, v26
    v_mfma_f32_16x16x32_bf16 v[56:59], a[228:231], a[148:151], v[56:59]
    v_mul_f32 v177, v177, v26
    v_mul_f32 v178, v178, v26
    v_mul_f32 v179, v179, v26
    v_mfma_f32_16x16x32_bf16 v[40:43], a[232:235], a[136:139], v[40:43]
    v_mul_f32 v180, v180, v26
    v_mul_f32 v181, v181, v26
    v_mul_f32 v182, v182, v26
    v_mfma_f32_16x16x32_bf16 v[56:59], a[232:235], a[152:155], v[56:59]
    v_mul_f32 v183, v183, v26
    v_cvt_pk_bf16_f32 v136, v176, v177
    v_cvt_pk_bf16_f32 v137, v178, v179
    v_mfma_f32_16x16x32_bf16 v[40:43], a[236:239], a[140:143], v[40:43]
    v_cvt_pk_bf16_f32 v138, v180, v181
    v_cvt_pk_bf16_f32 v139, v182, v183
    v_accvgpr_write_b32 a168, v136
    v_mfma_f32_16x16x32_bf16 v[56:59], a[236:239], a[156:159], v[56:59]
    s_waitcnt lgkmcnt(0)
    v_accvgpr_write_b32 a169, v137
    v_accvgpr_write_b32 a170, v138
    v_mfma_f32_16x16x32_bf16 v[44:47], a[240:243], a[128:131], 0
    v_accvgpr_write_b32 a171, v139
    v_accvgpr_read_b32 v184, a48
    v_accvgpr_read_b32 v185, a49
    v_mfma_f32_16x16x32_bf16 v[60:63], a[240:243], a[144:147], 0
    v_accvgpr_read_b32 v186, a50
    v_accvgpr_read_b32 v187, a51
    v_accvgpr_read_b32 v188, a56
    v_accvgpr_read_b32 v189, a57
    v_mfma_f32_16x16x32_bf16 v[44:47], a[244:247], a[132:135], v[44:47]
    v_accvgpr_read_b32 v190, a58
    v_accvgpr_read_b32 v191, a59
    v_mul_f32 v184, v184, v26
    v_mfma_f32_16x16x32_bf16 v[60:63], a[244:247], a[148:151], v[60:63]
    v_mul_f32 v185, v185, v26
    v_mul_f32 v186, v186, v26
    v_mul_f32 v187, v187, v26
    v_mfma_f32_16x16x32_bf16 v[44:47], a[248:251], a[136:139], v[44:47]
    v_mul_f32 v188, v188, v26
    v_mul_f32 v189, v189, v26
    v_mul_f32 v190, v190, v26
    v_mfma_f32_16x16x32_bf16 v[60:63], a[248:251], a[152:155], v[60:63]
    v_mul_f32 v191, v191, v26
    v_cvt_pk_bf16_f32 v140, v184, v185
    v_cvt_pk_bf16_f32 v141, v186, v187
    v_mfma_f32_16x16x32_bf16 v[44:47], a[252:255], a[140:143], v[44:47]
    v_cvt_pk_bf16_f32 v142, v188, v189
    v_cvt_pk_bf16_f32 v143, v190, v191
    v_accvgpr_write_b32 a172, v140
    v_mfma_f32_16x16x32_bf16 v[60:63], a[252:255], a[156:159], v[60:63]
    v_accvgpr_write_b32 a173, v141
    v_accvgpr_write_b32 a174, v142
    v_accvgpr_write_b32 a175, v143
    v_accvgpr_read_b32 v160, a4
    v_accvgpr_read_b32 v161, a5
    v_accvgpr_read_b32 v162, a6
    v_accvgpr_read_b32 v163, a7
    v_accvgpr_read_b32 v164, a12
    v_accvgpr_read_b32 v165, a13
    v_accvgpr_read_b32 v166, a14
    v_accvgpr_read_b32 v167, a15
    v_pk_mul_f32 v[160:161], v[160:161], v[26:27]
    v_pk_mul_f32 v[162:163], v[162:163], v[26:27]
    v_pk_mul_f32 v[164:165], v[164:165], v[26:27]
    v_pk_mul_f32 v[166:167], v[166:167], v[26:27]
    v_cvt_pk_bf16_f32 v144, v160, v161
    v_cvt_pk_bf16_f32 v145, v162, v163
    v_cvt_pk_bf16_f32 v146, v164, v165
    v_cvt_pk_bf16_f32 v147, v166, v167
    v_accvgpr_write_b32 a176, v144
    v_accvgpr_write_b32 a177, v145
    v_accvgpr_write_b32 a178, v146
    v_accvgpr_write_b32 a179, v147
    v_accvgpr_read_b32 v168, a20
    v_accvgpr_read_b32 v169, a21
    v_accvgpr_read_b32 v170, a22
    v_accvgpr_read_b32 v171, a23
    v_accvgpr_read_b32 v172, a28
    v_accvgpr_read_b32 v173, a29
    v_accvgpr_read_b32 v174, a30
    v_accvgpr_read_b32 v175, a31
    v_pk_mul_f32 v[168:169], v[168:169], v[26:27]
    v_pk_mul_f32 v[170:171], v[170:171], v[26:27]
    v_pk_mul_f32 v[172:173], v[172:173], v[26:27]
    v_pk_mul_f32 v[174:175], v[174:175], v[26:27]
    v_cvt_pk_bf16_f32 v148, v168, v169
    v_cvt_pk_bf16_f32 v149, v170, v171
    v_cvt_pk_bf16_f32 v150, v172, v173
    v_cvt_pk_bf16_f32 v151, v174, v175
    v_accvgpr_write_b32 a180, v148
    v_accvgpr_write_b32 a181, v149
    v_accvgpr_write_b32 a182, v150
    v_accvgpr_write_b32 a183, v151
    v_accvgpr_read_b32 v176, a36
    v_accvgpr_read_b32 v177, a37
    v_accvgpr_read_b32 v178, a38
    v_accvgpr_read_b32 v179, a39
    v_accvgpr_read_b32 v180, a44
    v_accvgpr_read_b32 v181, a45
    v_accvgpr_read_b32 v182, a46
    v_accvgpr_read_b32 v183, a47
    v_pk_mul_f32 v[176:177], v[176:177], v[26:27]
    v_pk_mul_f32 v[178:179], v[178:179], v[26:27]
    v_pk_mul_f32 v[180:181], v[180:181], v[26:27]
    v_pk_mul_f32 v[182:183], v[182:183], v[26:27]
    v_cvt_pk_bf16_f32 v152, v176, v177
    v_cvt_pk_bf16_f32 v153, v178, v179
    v_cvt_pk_bf16_f32 v154, v180, v181
    v_cvt_pk_bf16_f32 v155, v182, v183
    v_accvgpr_write_b32 a184, v152
    v_accvgpr_write_b32 a185, v153
    v_accvgpr_write_b32 a186, v154
    v_accvgpr_write_b32 a187, v155
    v_accvgpr_read_b32 v184, a52
    v_accvgpr_read_b32 v185, a53
    v_accvgpr_read_b32 v186, a54
    v_accvgpr_read_b32 v187, a55
    v_accvgpr_read_b32 v188, a60
    v_accvgpr_read_b32 v189, a61
    v_accvgpr_read_b32 v190, a62
    v_accvgpr_read_b32 v191, a63
    v_pk_mul_f32 v[184:185], v[184:185], v[26:27]
    v_pk_mul_f32 v[186:187], v[186:187], v[26:27]
    v_pk_mul_f32 v[188:189], v[188:189], v[26:27]
    v_pk_mul_f32 v[190:191], v[190:191], v[26:27]
    v_cvt_pk_bf16_f32 v156, v184, v185
    v_cvt_pk_bf16_f32 v157, v186, v187
    v_cvt_pk_bf16_f32 v158, v188, v189
    v_cvt_pk_bf16_f32 v159, v190, v191
    v_accvgpr_write_b32 a188, v156
    v_accvgpr_write_b32 a189, v157
    v_accvgpr_write_b32 a190, v158
    v_accvgpr_write_b32 a191, v159
    s_cmp_eq_u32 s76, 1
    s_cbranch_scc1 f1_p_mask
f1_p_mask_r:
    v_mfma_f32_16x16x32_bf16 v[64:67], a[192:195], a[160:163], 0
    v_bfe_u32 v9, v1, 4, 1
    v_mul_u32_u24 v9, 598016, v9
    v_mfma_f32_16x16x32_bf16 v[80:83], a[192:195], a[176:179], 0
    v_and_b32 v22, 15, v1
    v_lshl_add_u32 v9, v22, 4, v9
    v_mfma_f32_16x16x32_bf16 v[64:67], a[196:199], a[164:167], v[64:67]
    v_lshl_add_u32 v8, v21, 8, v9
    v_mov_b32 v22, 2147483392
    v_mfma_f32_16x16x32_bf16 v[80:83], a[196:199], a[180:183], v[80:83]
    v_cmp_eq_u32 vcc, 0, v21
    s_nop 1
    v_cndmask_b32 v9, v22, v9, vcc
    v_and_b32 v10, 16, v20
    v_mfma_f32_16x16x32_bf16 v[64:67], a[200:203], a[168:171], v[64:67]
    v_mul_u32_u24 v10, 3, v10
    v_add_u32 v10, v10, v20
    v_mfma_f32_16x16x32_bf16 v[80:83], a[200:203], a[184:187], v[80:83]
    v_mul_u32_u24 v10, 72, v10
    v_lshl_add_u32 v11, v21, 2, v10
    v_mfma_f32_16x16x32_bf16 v[64:67], a[204:207], a[172:175], v[64:67]
    v_lshl_add_u32 v10, v21, 4, v10
    v_mov_b32 v12, 2147483392
    v_mfma_f32_16x16x32_bf16 v[80:83], a[204:207], a[188:191], v[80:83]
    v_cmp_gt_u32 vcc, 992, v29
    s_nop 1
    v_cndmask_b32 v12, v12, v29, vcc
    v_mfma_f32_16x16x32_bf16 v[68:71], a[208:211], a[160:163], 0
    v_max3_f32 v24, v32, v33, v34
    v_max3_f32 v24, v24, v35, v36
    v_max3_f32 v24, v24, v37, v38
    v_max3_f32 v24, v24, v39, v40
    v_max3_f32 v24, v24, v41, v42
    v_mfma_f32_16x16x32_bf16 v[84:87], a[208:211], a[176:179], 0
    v_max3_f32 v24, v24, v43, v44
    v_max3_f32 v24, v24, v45, v46
    v_max_f32 v24, v24, v47
    v_mov_b32 v25, v24
    s_nop 1
    v_mfma_f32_16x16x32_bf16 v[68:71], a[212:215], a[164:167], v[68:71]
    v_permlane32_swap_b32 v24, v25
    v_max_f32 v24, v24, v25
    v_mov_b32 v25, v24
    s_nop 1
    v_permlane16_swap_b32 v24, v25
    v_mfma_f32_16x16x32_bf16 v[84:87], a[212:215], a[180:183], v[84:87]
    v_max_f32 v24, v24, v25
    v_max3_f32 v26, v48, v49, v50
    v_max3_f32 v26, v26, v51, v52
    v_max3_f32 v26, v26, v53, v54
    v_max3_f32 v26, v26, v55, v56
    v_mfma_f32_16x16x32_bf16 v[68:71], a[216:219], a[168:171], v[68:71]
    v_max3_f32 v26, v26, v57, v58
    v_max3_f32 v26, v26, v59, v60
    v_max3_f32 v26, v26, v61, v62
    v_max_f32 v26, v26, v63
    v_mov_b32 v27, v26
    v_mfma_f32_16x16x32_bf16 v[84:87], a[216:219], a[184:187], v[84:87]
    s_nop 1
    v_permlane32_swap_b32 v26, v27
    v_max_f32 v26, v26, v27
    v_mov_b32 v27, v26
    s_nop 1
    v_mfma_f32_16x16x32_bf16 v[68:71], a[220:223], a[172:175], v[68:71]
    v_permlane16_swap_b32 v26, v27
    v_max_f32 v26, v26, v27
    v_sub_f32 v32, v32, v24
    v_sub_f32 v33, v33, v24
    v_sub_f32 v34, v34, v24
    v_mfma_f32_16x16x32_bf16 v[84:87], a[220:223], a[188:191], v[84:87]
    v_sub_f32 v35, v35, v24
    v_sub_f32 v36, v36, v24
    v_sub_f32 v37, v37, v24
    v_sub_f32 v38, v38, v24
    v_sub_f32 v39, v39, v24
    v_mfma_f32_16x16x32_bf16 v[72:75], a[224:227], a[160:163], 0
    v_sub_f32 v40, v40, v24
    v_sub_f32 v41, v41, v24
    v_sub_f32 v42, v42, v24
    v_sub_f32 v43, v43, v24
    v_sub_f32 v44, v44, v24
    v_mfma_f32_16x16x32_bf16 v[88:91], a[224:227], a[176:179], 0
    v_sub_f32 v45, v45, v24
    v_sub_f32 v46, v46, v24
    v_sub_f32 v47, v47, v24
    v_sub_f32 v224, 0, v24
    v_sub_f32 v225, 0, v24
    v_mfma_f32_16x16x32_bf16 v[72:75], a[228:231], a[164:167], v[72:75]
    v_sub_f32 v226, 0, v24
    v_sub_f32 v227, 0, v24
    v_sub_f32 v48, v48, v26
    v_sub_f32 v49, v49, v26
    v_sub_f32 v50, v50, v26
    v_mfma_f32_16x16x32_bf16 v[88:91], a[228:231], a[180:183], v[88:91]
    v_sub_f32 v51, v51, v26
    v_sub_f32 v52, v52, v26
    v_sub_f32 v53, v53, v26
    v_sub_f32 v54, v54, v26
    v_sub_f32 v55, v55, v26
    v_mfma_f32_16x16x32_bf16 v[72:75], a[232:235], a[168:171], v[72:75]
    v_sub_f32 v56, v56, v26
    v_sub_f32 v57, v57, v26
    v_sub_f32 v58, v58, v26
    v_sub_f32 v59, v59, v26
    v_sub_f32 v60, v60, v26
    v_mfma_f32_16x16x32_bf16 v[88:91], a[232:235], a[184:187], v[88:91]
    v_sub_f32 v61, v61, v26
    v_sub_f32 v62, v62, v26
    v_sub_f32 v63, v63, v26
    v_sub_f32 v228, 0, v26
    v_sub_f32 v229, 0, v26
    v_mfma_f32_16x16x32_bf16 v[72:75], a[236:239], a[172:175], v[72:75]
    v_sub_f32 v230, 0, v26
    v_sub_f32 v231, 0, v26
    v_exp_f32 v240, v32
    v_exp_f32 v241, v33
    v_mfma_f32_16x16x32_bf16 v[88:91], a[236:239], a[188:191], v[88:91]
    v_exp_f32 v242, v34
    v_exp_f32 v243, v35
    v_mfma_f32_16x16x32_bf16 v[76:79], a[240:243], a[160:163], 0
    v_exp_f32 v244, v36
    v_cvt_pk_bf16_f32 v160, v240, v241
    v_exp_f32 v245, v37
    v_mfma_f32_16x16x32_bf16 v[92:95], a[240:243], a[176:179], 0
    v_exp_f32 v246, v38
    v_cvt_pk_bf16_f32 v161, v242, v243
    v_exp_f32 v247, v39
    v_mfma_f32_16x16x32_bf16 v[76:79], a[244:247], a[164:167], v[76:79]
    v_exp_f32 v240, v48
    v_cvt_pk_bf16_f32 v162, v244, v245
    v_exp_f32 v241, v49
    v_mfma_f32_16x16x32_bf16 v[92:95], a[244:247], a[180:183], v[92:95]
    v_exp_f32 v242, v50
    v_cvt_pk_bf16_f32 v163, v246, v247
    v_exp_f32 v243, v51
    v_mfma_f32_16x16x32_bf16 v[76:79], a[248:251], a[168:171], v[76:79]
    v_exp_f32 v244, v52
    v_cvt_pk_bf16_f32 v164, v240, v241
    v_exp_f32 v245, v53
    v_mfma_f32_16x16x32_bf16 v[92:95], a[248:251], a[184:187], v[92:95]
    v_exp_f32 v246, v54
    v_cvt_pk_bf16_f32 v165, v242, v243
    v_exp_f32 v247, v55
    v_mfma_f32_16x16x32_bf16 v[76:79], a[252:255], a[172:175], v[76:79]
    v_mfma_f32_16x16x32_bf16 v[212:215], v[208:211], v[160:163], 0
    v_cvt_pk_bf16_f32 v166, v244, v245
    v_mfma_f32_16x16x32_bf16 v[92:95], a[252:255], a[188:191], v[92:95]
    v_cvt_pk_bf16_f32 v167, v246, v247
    s_nop 1
    v_mfma_f32_16x16x32_bf16 v[216:219], v[208:211], v[164:167], 0
    s_waitcnt vmcnt(17)
    s_barrier
    v_add_u32 v2, 32768, v29
    s_cmp_lg_u32 s22, 0
    s_cbranch_scc1 f1_sg1
    s_cmp_lg_u32 s14, 32
    s_cbranch_scc1 f1_sg1_wb
f1_sg1_wb_r:
    s_lshl_b32 s24, 16, s15
    s_mov_b64 exec, 1
    v_mov_b32 v24, s24
    buffer_atomic_add v24, off, s[56:59], s83 sc1
    s_mov_b64 exec, -1
f1_sg1:
    ds_read_b128 a[192:195], v2 offset:16384
    ds_read_b128 a[196:199], v2 offset:17408
    ds_read_b128 a[200:203], v2 offset:18432
    ds_read_b128 a[204:207], v2 offset:19456
    ds_read_b128 a[208:211], v2 offset:20480
    ds_read_b128 a[212:215], v2 offset:21504
    ds_read_b128 a[216:219], v2 offset:22528
    ds_read_b128 a[220:223], v2 offset:23552
    ds_read_b128 a[224:227], v2 offset:24576
    ds_read_b128 a[228:231], v2 offset:25600
    ds_read_b128 a[232:235], v2 offset:26624
    v_max3_f32 v24, v64, v65, v66
    v_max3_f32 v24, v24, v67, v68
    v_max3_f32 v24, v24, v69, v70
    v_max3_f32 v24, v24, v71, v72
    v_max3_f32 v24, v24, v73, v74
    v_max3_f32 v24, v24, v75, v76
    v_max3_f32 v24, v24, v77, v78
    v_max_f32 v24, v24, v79
    v_mov_b32 v25, v24
    s_nop 1
    v_permlane32_swap_b32 v24, v25
    v_max_f32 v24, v24, v25
    v_mov_b32 v25, v24
    s_nop 1
    v_permlane16_swap_b32 v24, v25
    v_max_f32 v24, v24, v25
    v_max3_f32 v26, v80, v81, v82
    v_max3_f32 v26, v26, v83, v84
    v_max3_f32 v26, v26, v85, v86
    v_max3_f32 v26, v26, v87, v88
    v_max3_f32 v26, v26, v89, v90
    v_max3_f32 v26, v26, v91, v92
    v_max3_f32 v26, v26, v93, v94
    v_max_f32 v26, v26, v95
    v_mov_b32 v27, v26
    s_nop 1
    v_permlane32_swap_b32 v26, v27
    v_max_f32 v26, v26, v27
    v_mov_b32 v27, v26
    s_nop 1
    v_permlane16_swap_b32 v26, v27
    v_max_f32 v26, v26, v27
    v_sub_f32 v64, v64, v24
    v_sub_f32 v65, v65, v24
    v_sub_f32 v66, v66, v24
    v_sub_f32 v67, v67, v24
    v_sub_f32 v68, v68, v24
    v_sub_f32 v69, v69, v24
    v_sub_f32 v70, v70, v24
    v_sub_f32 v71, v71, v24
    v_sub_f32 v72, v72, v24
    v_sub_f32 v73, v73, v24
    v_sub_f32 v74, v74, v24
    v_sub_f32 v75, v75, v24
    v_sub_f32 v76, v76, v24
    v_sub_f32 v77, v77, v24
    v_sub_f32 v78, v78, v24
    v_sub_f32 v79, v79, v24
    v_sub_f32 v232, 0, v24
    v_sub_f32 v233, 0, v24
    v_sub_f32 v234, 0, v24
    v_sub_f32 v235, 0, v24
    v_sub_f32 v80, v80, v26
    v_sub_f32 v81, v81, v26
    v_sub_f32 v82, v82, v26
    v_sub_f32 v83, v83, v26
    v_sub_f32 v84, v84, v26
    v_sub_f32 v85, v85, v26
    v_sub_f32 v86, v86, v26
    v_sub_f32 v87, v87, v26
    v_sub_f32 v88, v88, v26
    v_sub_f32 v89, v89, v26
    v_sub_f32 v90, v90, v26
    v_sub_f32 v91, v91, v26
    v_sub_f32 v92, v92, v26
    v_sub_f32 v93, v93, v26
    v_sub_f32 v94, v94, v26
    v_sub_f32 v95, v95, v26
    v_sub_f32 v236, 0, v26
    v_sub_f32 v237, 0, v26
    v_sub_f32 v238, 0, v26
    v_sub_f32 v239, 0, v26
    v_exp_f32 v240, v64
    v_exp_f32 v241, v65
    v_exp_f32 v242, v66
    v_exp_f32 v243, v67
    v_exp_f32 v244, v68
    v_cvt_pk_bf16_f32 v168, v240, v241
    v_exp_f32 v245, v69
    v_exp_f32 v246, v70
    v_cvt_pk_bf16_f32 v169, v242, v243
    v_exp_f32 v247, v71
    v_exp_f32 v240, v80
    v_cvt_pk_bf16_f32 v170, v244, v245
    v_exp_f32 v241, v81
    v_exp_f32 v242, v82
    v_cvt_pk_bf16_f32 v171, v246, v247
    v_exp_f32 v243, v83
    v_exp_f32 v244, v84
    v_cvt_pk_bf16_f32 v172, v240, v241
    v_exp_f32 v245, v85
    v_exp_f32 v246, v86
    v_cvt_pk_bf16_f32 v173, v242, v243
    v_exp_f32 v247, v87
    v_mfma_f32_16x16x32_bf16 v[248:251], v[208:211], v[168:171], 0
    v_cvt_pk_bf16_f32 v174, v244, v245
    v_cvt_pk_bf16_f32 v175, v246, v247
    s_nop 1
    v_mfma_f32_16x16x32_bf16 v[252:255], v[208:211], v[172:175], 0
    s_waitcnt lgkmcnt(7)
    v_mfma_f32_16x16x32_bf16 v[96:99], a[192:195], a[128:131], v[224:227]
    v_exp_f32 v240, v40
    v_mfma_f32_16x16x32_bf16 v[112:115], a[192:195], a[144:147], v[228:231]
    s_add_u32 m0, s30, 147456
    v_mfma_f32_16x16x32_bf16 v[128:131], a[192:195], a[160:163], v[232:235]
    v_exp_f32 v241, v41
    v_mfma_f32_16x16x32_bf16 v[144:147], a[192:195], a[176:179], v[236:239]
    ds_read_b128 a[236:239], v2 offset:27648
    v_exp_f32 v242, v42
    v_mfma_f32_16x16x32_bf16 v[96:99], a[196:199], a[132:135], v[96:99]
    v_exp_f32 v243, v43
    v_mfma_f32_16x16x32_bf16 v[112:115], a[196:199], a[148:151], v[112:115]
    s_add_u32 s23, s30, 131072
    v_mfma_f32_16x16x32_bf16 v[128:131], a[196:199], a[164:167], v[128:131]
    v_exp_f32 v244, v44
    v_mfma_f32_16x16x32_bf16 v[144:147], a[196:199], a[180:183], v[144:147]
    ds_read_b128 a[240:243], v2 offset:28672
    v_cvt_pk_bf16_f32 v192, v240, v241
    v_mfma_f32_16x16x32_bf16 v[96:99], a[200:203], a[136:139], v[96:99]
    buffer_load_dwordx4 v29, s[44:47], s23 offen offset:0 sc1 lds
    v_exp_f32 v245, v45
    v_mfma_f32_16x16x32_bf16 v[112:115], a[200:203], a[152:155], v[112:115]
    v_exp_f32 v246, v46
    v_mfma_f32_16x16x32_bf16 v[128:131], a[200:203], a[168:171], v[128:131]
    v_cvt_pk_bf16_f32 v193, v242, v243
    v_mfma_f32_16x16x32_bf16 v[144:147], a[200:203], a[184:187], v[144:147]
    ds_read_b128 a[244:247], v2 offset:29696
    v_exp_f32 v247, v47
    v_mfma_f32_16x16x32_bf16 v[96:99], a[204:207], a[140:143], v[96:99]
    buffer_load_dwordx4 v29, s[44:47], s23 offen offset:1024 sc1 lds
    v_mfma_f32_16x16x32_bf16 v[112:115], a[204:207], a[156:159], v[112:115]
    v_cvt_pk_bf16_f32 v194, v244, v245
    v_cvt_pk_bf16_f32 v195, v246, v247
    v_mfma_f32_16x16x32_bf16 v[128:131], a[204:207], a[172:175], v[128:131]
    v_exp_f32 v240, v56
    v_mfma_f32_16x16x32_bf16 v[144:147], a[204:207], a[188:191], v[144:147]
    ds_read_b128 a[248:251], v2 offset:30720
    buffer_load_dwordx4 v29, s[44:47], s23 offen offset:2048 sc1 lds
    v_mfma_f32_16x16x32_bf16 v[212:215], v[208:211], v[192:195], v[212:215]
    s_waitcnt lgkmcnt(7)
    v_exp_f32 v241, v57
    v_mfma_f32_16x16x32_bf16 v[100:103], a[208:211], a[128:131], v[224:227]
    v_exp_f32 v242, v58
    v_mfma_f32_16x16x32_bf16 v[116:119], a[208:211], a[144:147], v[228:231]
    v_exp_f32 v243, v59
    v_mfma_f32_16x16x32_bf16 v[132:135], a[208:211], a[160:163], v[232:235]
    buffer_load_dwordx4 v29, s[44:47], s23 offen offset:3072 sc1 lds
    v_mfma_f32_16x16x32_bf16 v[148:151], a[208:211], a[176:179], v[236:239]
    ds_read_b128 a[252:255], v2 offset:31744
    v_exp_f32 v244, v60
    v_mfma_f32_16x16x32_bf16 v[100:103], a[212:215], a[132:135], v[100:103]
    v_cvt_pk_bf16_f32 v196, v240, v241
    v_mfma_f32_16x16x32_bf16 v[116:119], a[212:215], a[148:151], v[116:119]
    v_exp_f32 v245, v61
    v_mfma_f32_16x16x32_bf16 v[132:135], a[212:215], a[164:167], v[132:135]
    s_add_u32 m0, s30, 16384
    v_exp_f32 v246, v62
    v_mfma_f32_16x16x32_bf16 v[148:151], a[212:215], a[180:183], v[148:151]
    ds_read_b128 a[192:195], v2 offset:0
    v_mfma_f32_16x16x32_bf16 v[100:103], a[216:219], a[136:139], v[100:103]
    v_cvt_pk_bf16_f32 v197, v242, v243
    v_exp_f32 v247, v63
    v_mfma_f32_16x16x32_bf16 v[116:119], a[216:219], a[152:155], v[116:119]
    s_add_u32 s23, s30, 163840
    v_mfma_f32_16x16x32_bf16 v[132:135], a[216:219], a[168:171], v[132:135]
    v_cvt_pk_bf16_f32 v198, v244, v245
    v_cvt_pk_bf16_f32 v199, v246, v247
    v_mfma_f32_16x16x32_bf16 v[148:151], a[216:219], a[184:187], v[148:151]
    ds_read_b128 a[196:199], v2 offset:2048
    v_exp_f32 v240, v72
    v_mfma_f32_16x16x32_bf16 v[100:103], a[220:223], a[140:143], v[100:103]
    v_exp_f32 v241, v73
    v_mfma_f32_16x16x32_bf16 v[216:219], v[208:211], v[196:199], v[216:219]
    buffer_load_dwordx4 v29, s[44:47], s23 offen offset:0 sc1 lds
    v_mfma_f32_16x16x32_bf16 v[116:119], a[220:223], a[156:159], v[116:119]
    v_exp_f32 v242, v74
    v_mfma_f32_16x16x32_bf16 v[132:135], a[220:223], a[172:175], v[132:135]
    v_exp_f32 v243, v75
    v_mfma_f32_16x16x32_bf16 v[148:151], a[220:223], a[188:191], v[148:151]
    ds_read_b128 a[200:203], v2 offset:4096
    s_waitcnt lgkmcnt(7)
    v_mfma_f32_16x16x32_bf16 v[104:107], a[224:227], a[128:131], v[224:227]
    buffer_load_dwordx4 v29, s[44:47], s23 offen offset:1024 sc1 lds
    v_exp_f32 v244, v76
    v_mfma_f32_16x16x32_bf16 v[120:123], a[224:227], a[144:147], v[228:231]
    v_cvt_pk_bf16_f32 v200, v240, v241
    v_mfma_f32_16x16x32_bf16 v[136:139], a[224:227], a[160:163], v[232:235]
    v_exp_f32 v245, v77
    v_mfma_f32_16x16x32_bf16 v[152:155], a[224:227], a[176:179], v[236:239]
    ds_read_b128 a[204:207], v2 offset:6144
    v_exp_f32 v246, v78
    v_mfma_f32_16x16x32_bf16 v[104:107], a[228:231], a[132:135], v[104:107]
    buffer_load_dwordx4 v29, s[44:47], s23 offen offset:2048 sc1 lds
    v_cvt_pk_bf16_f32 v201, v242, v243
    v_mfma_f32_16x16x32_bf16 v[120:123], a[228:231], a[148:151], v[120:123]
    v_exp_f32 v247, v79
    v_mfma_f32_16x16x32_bf16 v[136:139], a[228:231], a[164:167], v[136:139]
    v_cvt_pk_bf16_f32 v202, v244, v245
    v_mfma_f32_16x16x32_bf16 v[152:155], a[228:231], a[180:183], v[152:155]
    ds_read_b128 a[208:211], v2 offset:8192
    buffer_load_dwordx4 v29, s[44:47], s23 offen offset:3072 sc1 lds
    v_cvt_pk_bf16_f32 v203, v246, v247
    v_mfma_f32_16x16x32_bf16 v[104:107], a[232:235], a[136:139], v[104:107]
    v_exp_f32 v240, v88
    v_mfma_f32_16x16x32_bf16 v[120:123], a[232:235], a[152:155], v[120:123]
    v_exp_f32 v241, v89
    v_mfma_f32_16x16x32_bf16 v[248:251], v[208:211], v[200:203], v[248:251]
    v_mfma_f32_16x16x32_bf16 v[136:139], a[232:235], a[168:171], v[136:139]
    v_exp_f32 v242, v90
    v_mfma_f32_16x16x32_bf16 v[152:155], a[232:235], a[184:187], v[152:155]
    ds_read_b128 a[212:215], v2 offset:10240
    v_exp_f32 v243, v91
    v_mfma_f32_16x16x32_bf16 v[104:107], a[236:239], a[140:143], v[104:107]
    v_exp_f32 v244, v92
    v_mfma_f32_16x16x32_bf16 v[120:123], a[236:239], a[156:159], v[120:123]
    s_add_u32 m0, s74, s30
    s_nop 0
    buffer_load_dwordx4 v29, s[48:51], s75 offen offset:0 sc1 lds
    v_mfma_f32_16x16x32_bf16 v[136:139], a[236:239], a[172:175], v[136:139]
    v_cvt_pk_bf16_f32 v204, v240, v241
    v_mfma_f32_16x16x32_bf16 v[152:155], a[236:239], a[188:191], v[152:155]
    ds_read_b128 a[216:219], v2 offset:12288
    s_waitcnt lgkmcnt(7)
    v_mfma_f32_16x16x32_bf16 v[108:111], a[240:243], a[128:131], v[224:227]
    v_exp_f32 v245, v93
    v_mfma_f32_16x16x32_bf16 v[124:127], a[240:243], a[144:147], v[228:231]
    v_exp_f32 v246, v94
    v_mfma_f32_16x16x32_bf16 v[140:143], a[240:243], a[160:163], v[232:235]
    v_cvt_pk_bf16_f32 v205, v242, v243
    v_mfma_f32_16x16x32_bf16 v[156:159], a[240:243], a[176:179], v[236:239]
    ds_read_b128 a[220:223], v2 offset:14336
    v_exp_f32 v247, v95
    v_mfma_f32_16x16x32_bf16 v[108:111], a[244:247], a[132:135], v[108:111]
    v_cvt_pk_bf16_f32 v206, v244, v245
    v_mfma_f32_16x16x32_bf16 v[124:127], a[244:247], a[148:151], v[124:127]
    buffer_load_dwordx4 v29, s[48:51], s75 offen offset:1024 sc1 lds
    v_cvt_pk_bf16_f32 v207, v246, v247
    v_mfma_f32_16x16x32_bf16 v[140:143], a[244:247], a[164:167], v[140:143]
    v_mfma_f32_16x16x32_bf16 v[156:159], a[244:247], a[180:183], v[156:159]
    ds_read_b128 a[224:227], v2 offset:1024
    v_mfma_f32_16x16x32_bf16 v[252:255], v[208:211], v[204:207], v[252:255]
    buffer_load_dwordx4 v29, s[48:51], s75 offen offset:2048 sc1 lds
    v_mfma_f32_16x16x32_bf16 v[108:111], a[248:251], a[136:139], v[108:111]
    v_mfma_f32_16x16x32_bf16 v[124:127], a[248:251], a[152:155], v[124:127]
    v_mfma_f32_16x16x32_bf16 v[140:143], a[248:251], a[168:171], v[140:143]
    buffer_load_dwordx4 v29, s[48:51], s75 offen offset:3072 sc1 lds
    v_mfma_f32_16x16x32_bf16 v[156:159], a[248:251], a[184:187], v[156:159]
    ds_read_b128 a[228:231], v2 offset:3072
    v_max3_f32 v20, v212, v216, v248
    v_mfma_f32_16x16x32_bf16 v[108:111], a[252:255], a[140:143], v[108:111]
    v_max_f32 v20, v20, v252
    v_cmp_nge_f32 vcc, s77, v20
    v_mfma_f32_16x16x32_bf16 v[124:127], a[252:255], a[156:159], v[124:127]
    v_mfma_f32_16x16x32_bf16 v[140:143], a[252:255], a[172:175], v[140:143]
    v_mfma_f32_16x16x32_bf16 v[156:159], a[252:255], a[188:191], v[156:159]
    ds_read_b128 a[232:235], v2 offset:5120
    s_cbranch_vccnz f1_dd0_rare
f1_dd0_rare_r:
    s_cmp_eq_u32 s76, 1
    s_cbranch_scc1 f1_dd0_mask
f1_dd0_mask_r:
    s_waitcnt lgkmcnt(7)
    v_mfma_f32_16x16x32_bf16 a[0:3], a[192:195], v[160:163], 0
    v_add_f32 v13, v13, v212
    v_exp_f32 v240, v96
    v_mfma_f32_16x16x32_bf16 a[32:35], a[192:195], v[164:167], 0
    v_add_f32 v14, v14, v216
    v_mfma_f32_16x16x32_bf16 a[64:67], a[192:195], v[168:171], 0
    v_add_f32 v15, v15, v248
    v_exp_f32 v241, v97
    v_mfma_f32_16x16x32_bf16 a[96:99], a[192:195], v[172:175], 0
    ds_read_b128 a[236:239], v2 offset:7168
    v_add_f32 v30, v30, v252
    v_mfma_f32_16x16x32_bf16 a[4:7], a[196:199], v[160:163], 0
    v_exp_f32 v242, v98
    v_mfma_f32_16x16x32_bf16 a[36:39], a[196:199], v[164:167], 0
    v_mfma_f32_16x16x32_bf16 a[68:71], a[196:199], v[168:171], 0
    v_exp_f32 v243, v99
    v_mfma_f32_16x16x32_bf16 a[100:103], a[196:199], v[172:175], 0
    ds_read_b128 a[240:243], v2 offset:9216
    v_exp_f32 v244, v100
    v_mfma_f32_16x16x32_bf16 a[8:11], a[200:203], v[160:163], 0
    v_cvt_pk_bf16_f32 v176, v240, v241
    v_mfma_f32_16x16x32_bf16 a[40:43], a[200:203], v[164:167], 0
    v_exp_f32 v245, v101
    v_mfma_f32_16x16x32_bf16 a[72:75], a[200:203], v[168:171], 0
    v_exp_f32 v246, v102
    v_mfma_f32_16x16x32_bf16 a[104:107], a[200:203], v[172:175], 0
    ds_read_b128 a[244:247], v2 offset:11264
    v_mfma_f32_16x16x32_bf16 a[12:15], a[204:207], v[160:163], 0
    v_cvt_pk_bf16_f32 v177, v242, v243
    v_mfma_f32_16x16x32_bf16 a[44:47], a[204:207], v[164:167], 0
    v_exp_f32 v247, v103
    v_mfma_f32_16x16x32_bf16 a[76:79], a[204:207], v[168:171], 0
    v_cvt_pk_bf16_f32 v178, v244, v245
    v_cvt_pk_bf16_f32 v179, v246, v247
    v_mfma_f32_16x16x32_bf16 a[108:111], a[204:207], v[172:175], 0
    ds_read_b128 a[248:251], v2 offset:13312
    s_waitcnt lgkmcnt(7)
    s_mov_b32 s74, s73
    s_mov_b32 s73, s72
    v_mfma_f32_16x16x32_bf16 a[16:19], a[208:211], v[160:163], 0
    v_exp_f32 v240, v112
    v_mfma_f32_16x16x32_bf16 a[48:51], a[208:211], v[164:167], 0
    s_add_u32 s72, s72, 0x8000
    v_mfma_f32_16x16x32_bf16 v[212:215], v[208:211], v[176:179], 0
    v_exp_f32 v241, v113
    v_mfma_f32_16x16x32_bf16 a[80:83], a[208:211], v[168:171], 0
    s_cmp_eq_u32 s72, 0x28000
    s_cselect_b32 s72, 0, s72
    v_mfma_f32_16x16x32_bf16 a[112:115], a[208:211], v[172:175], 0
    ds_read_b128 a[252:255], v2 offset:15360
    s_waitcnt vmcnt(31)
    s_barrier
    v_add_u32 v2, s72, v29
    v_mfma_f32_16x16x32_bf16 a[20:23], a[212:215], v[160:163], 0
    v_exp_f32 v242, v114
    v_mfma_f32_16x16x32_bf16 a[52:55], a[212:215], v[164:167], 0
    v_exp_f32 v243, v115
    v_mfma_f32_16x16x32_bf16 a[84:87], a[212:215], v[168:171], 0
    v_exp_f32 v244, v116
    v_mfma_f32_16x16x32_bf16 a[116:119], a[212:215], v[172:175], 0
    ds_read_b128 a[192:195], v2 offset:16384
    s_add_u32 m0, s73, s28
    v_mfma_f32_16x16x32_bf16 a[24:27], a[216:219], v[160:163], 0
    v_cvt_pk_bf16_f32 v180, v240, v241
    v_mfma_f32_16x16x32_bf16 a[56:59], a[216:219], v[164:167], 0
    v_exp_f32 v245, v117
    v_mfma_f32_16x16x32_bf16 a[88:91], a[216:219], v[168:171], 0
    v_exp_f32 v246, v118
    v_mfma_f32_16x16x32_bf16 a[120:123], a[216:219], v[172:175], 0
    ds_read_b128 a[196:199], v2 offset:17408
    v_mfma_f32_16x16x32_bf16 a[28:31], a[220:223], v[160:163], 0
    v_cvt_pk_bf16_f32 v181, v242, v243
    v_mfma_f32_16x16x32_bf16 a[60:63], a[220:223], v[164:167], 0
    v_exp_f32 v247, v119
    v_mfma_f32_16x16x32_bf16 a[92:95], a[220:223], v[168:171], 0
    v_cvt_pk_bf16_f32 v182, v244, v245
    v_cvt_pk_bf16_f32 v183, v246, v247
    v_mfma_f32_16x16x32_bf16 a[124:127], a[220:223], v[172:175], 0
    ds_read_b128 a[200:203], v2 offset:18432
    s_waitcnt lgkmcnt(7)
    v_mfma_f32_16x16x32_bf16 a[0:3], a[224:227], v[192:195], a[0:3]
    s_add_u32 s75, s75, 0x8000
    v_mfma_f32_16x16x32_bf16 v[216:219], v[208:211], v[180:183], 0
    v_exp_f32 v240, v128
    v_mfma_f32_16x16x32_bf16 a[32:35], a[224:227], v[196:199], a[32:35]
    v_exp_f32 v241, v129
    v_mfma_f32_16x16x32_bf16 a[64:67], a[224:227], v[200:203], a[64:67]
    v_exp_f32 v242, v130
    v_mfma_f32_16x16x32_bf16 a[96:99], a[224:227], v[204:207], a[96:99]
    ds_read_b128 a[204:207], v2 offset:19456
    v_mfma_f32_16x16x32_bf16 a[4:7], a[228:231], v[192:195], a[4:7]
    v_exp_f32 v243, v131
    v_mfma_f32_16x16x32_bf16 a[36:39], a[228:231], v[196:199], a[36:39]
    v_exp_f32 v244, v132
    v_mfma_f32_16x16x32_bf16 a[68:71], a[228:231], v[200:203], a[68:71]
    buffer_load_dwordx4 v29, s[44:47], s75 offen offset:0 sc1 lds
    v_mfma_f32_16x16x32_bf16 a[100:103], a[228:231], v[204:207], a[100:103]
    ds_read_b128 a[208:211], v2 offset:20480
    v_cvt_pk_bf16_f32 v184, v240, v241
    v_mfma_f32_16x16x32_bf16 a[8:11], a[232:235], v[192:195], a[8:11]
    v_exp_f32 v245, v133
    v_mfma_f32_16x16x32_bf16 a[40:43], a[232:235], v[196:199], a[40:43]
    v_exp_f32 v246, v134
    v_mfma_f32_16x16x32_bf16 a[72:75], a[232:235], v[200:203], a[72:75]
    v_cvt_pk_bf16_f32 v185, v242, v243
    v_mfma_f32_16x16x32_bf16 a[104:107], a[232:235], v[204:207], a[104:107]
    ds_read_b128 a[212:215], v2 offset:21504
    v_mfma_f32_16x16x32_bf16 a[12:15], a[236:239], v[192:195], a[12:15]
    v_exp_f32 v247, v135
    v_mfma_f32_16x16x32_bf16 a[44:47], a[236:239], v[196:199], a[44:47]
    v_cvt_pk_bf16_f32 v186, v244, v245
    v_cvt_pk_bf16_f32 v187, v246, v247
    v_mfma_f32_16x16x32_bf16 a[76:79], a[236:239], v[200:203], a[76:79]
    buffer_load_dwordx4 v29, s[44:47], s75 offen offset:1024 sc1 lds
    v_mfma_f32_16x16x32_bf16 a[108:111], a[236:239], v[204:207], a[108:111]
    ds_read_b128 a[216:219], v2 offset:22528
    v_exp_f32 v240, v144
    v_mfma_f32_16x16x32_bf16 v[248:251], v[208:211], v[184:187], 0
    s_waitcnt lgkmcnt(7)
    v_mfma_f32_16x16x32_bf16 a[16:19], a[240:243], v[192:195], a[16:19]
    v_exp_f32 v241, v145
    v_mfma_f32_16x16x32_bf16 a[48:51], a[240:243], v[196:199], a[48:51]
    v_exp_f32 v242, v146
    v_mfma_f32_16x16x32_bf16 a[80:83], a[240:243], v[200:203], a[80:83]
    v_mfma_f32_16x16x32_bf16 a[112:115], a[240:243], v[204:207], a[112:115]
    ds_read_b128 a[220:223], v2 offset:23552
    v_exp_f32 v243, v147
    v_mfma_f32_16x16x32_bf16 a[20:23], a[244:247], v[192:195], a[20:23]
    v_exp_f32 v244, v148
    v_mfma_f32_16x16x32_bf16 a[52:55], a[244:247], v[196:199], a[52:55]
    buffer_load_dwordx4 v29, s[44:47], s75 offen offset:2048 sc1 lds
    v_mfma_f32_16x16x32_bf16 a[84:87], a[244:247], v[200:203], a[84:87]
    v_cvt_pk_bf16_f32 v188, v240, v241
    v_mfma_f32_16x16x32_bf16 a[116:119], a[244:247], v[204:207], a[116:119]
    ds_read_b128 a[224:227], v2 offset:24576
    v_exp_f32 v245, v149
    v_mfma_f32_16x16x32_bf16 a[24:27], a[248:251], v[192:195], a[24:27]
    v_mfma_f32_16x16x32_bf16 a[56:59], a[248:251], v[196:199], a[56:59]
    v_exp_f32 v246, v150
    v_mfma_f32_16x16x32_bf16 a[88:91], a[248:251], v[200:203], a[88:91]
    v_cvt_pk_bf16_f32 v189, v242, v243
    v_mfma_f32_16x16x32_bf16 a[120:123], a[248:251], v[204:207], a[120:123]
    ds_read_b128 a[228:231], v2 offset:25600
    v_exp_f32 v247, v151
    v_mfma_f32_16x16x32_bf16 a[28:31], a[252:255], v[192:195], a[28:31]
    v_cvt_pk_bf16_f32 v190, v244, v245
    v_mfma_f32_16x16x32_bf16 a[60:63], a[252:255], v[196:199], a[60:63]
    buffer_load_dwordx4 v29, s[44:47], s75 offen offset:3072 sc1 lds
    v_cvt_pk_bf16_f32 v191, v246, v247
    v_mfma_f32_16x16x32_bf16 a[92:95], a[252:255], v[200:203], a[92:95]
    v_mfma_f32_16x16x32_bf16 a[124:127], a[252:255], v[204:207], a[124:127]
    ds_read_b128 a[232:235], v2 offset:26624
    v_mfma_f32_16x16x32_bf16 v[252:255], v[208:211], v[188:191], 0
    s_branch f1_c1
f1_dual:
    s_waitcnt lgkmcnt(7)
    v_mfma_f32_16x16x32_bf16 v[96:99], a[192:195], a[128:131], v[224:227]
    v_exp_f32 v240, v40
    v_mfma_f32_16x16x32_bf16 v[112:115], a[192:195], a[144:147], v[228:231]
    v_exp_f32 v241, v41
    v_mfma_f32_16x16x32_bf16 v[128:131], a[192:195], a[160:163], v[232:235]
    v_exp_f32 v242, v42
    v_mfma_f32_16x16x32_bf16 v[144:147], a[192:195], a[176:179], v[236:239]
    ds_read_b128 a[236:239], v2 offset:27648
    v_mfma_f32_16x16x32_bf16 v[96:99], a[196:199], a[132:135], v[96:99]
    v_exp_f32 v243, v43
    v_mfma_f32_16x16x32_bf16 v[112:115], a[196:199], a[148:151], v[112:115]
    v_exp_f32 v244, v44
    v_mfma_f32_16x16x32_bf16 v[128:131], a[196:199], a[164:167], v[128:131]
    v_cvt_pk_bf16_f32 v192, v240, v241
    v_mfma_f32_16x16x32_bf16 v[144:147], a[196:199], a[180:183], v[144:147]
    ds_read_b128 a[240:243], v2 offset:28672
    v_mfma_f32_16x16x32_bf16 v[96:99], a[200:203], a[136:139], v[96:99]
    s_add_u32 m0, s74, s30
    s_nop 0
    buffer_load_dwordx4 v29, s[48:51], s75 offen offset:0 sc1 lds
    v_mfma_f32_16x16x32_bf16 v[112:115], a[200:203], a[152:155], v[112:115]
    v_exp_f32 v245, v45
    v_mfma_f32_16x16x32_bf16 v[128:131], a[200:203], a[168:171], v[128:131]
    v_exp_f32 v246, v46
    v_mfma_f32_16x16x32_bf16 v[144:147], a[200:203], a[184:187], v[144:147]
    ds_read_b128 a[244:247], v2 offset:29696
    v_cvt_pk_bf16_f32 v193, v242, v243
    v_mfma_f32_16x16x32_bf16 v[96:99], a[204:207], a[140:143], v[96:99]
    v_exp_f32 v247, v47
    v_mfma_f32_16x16x32_bf16 v[112:115], a[204:207], a[156:159], v[112:115]
    v_cvt_pk_bf16_f32 v194, v244, v245
    v_cvt_pk_bf16_f32 v195, v246, v247
    v_mfma_f32_16x16x32_bf16 v[128:131], a[204:207], a[172:175], v[128:131]
    v_exp_f32 v240, v56
    v_mfma_f32_16x16x32_bf16 v[144:147], a[204:207], a[188:191], v[144:147]
    ds_read_b128 a[248:251], v2 offset:30720
    v_mfma_f32_16x16x32_bf16 v[212:215], v[208:211], v[192:195], v[212:215]
    s_waitcnt lgkmcnt(7)
    v_exp_f32 v241, v57
    v_mfma_f32_16x16x32_bf16 v[100:103], a[208:211], a[128:131], v[224:227]
    v_exp_f32 v242, v58
    v_mfma_f32_16x16x32_bf16 v[116:119], a[208:211], a[144:147], v[228:231]
    v_exp_f32 v243, v59
    v_mfma_f32_16x16x32_bf16 v[132:135], a[208:211], a[160:163], v[232:235]
    buffer_load_dwordx4 v29, s[48:51], s75 offen offset:1024 sc1 lds
    v_mfma_f32_16x16x32_bf16 v[148:151], a[208:211], a[176:179], v[236:239]
    ds_read_b128 a[252:255], v2 offset:31744
    v_exp_f32 v244, v60
    v_mfma_f32_16x16x32_bf16 v[100:103], a[212:215], a[132:135], v[100:103]
    v_cvt_pk_bf16_f32 v196, v240, v241
    v_mfma_f32_16x16x32_bf16 v[116:119], a[212:215], a[148:151], v[116:119]
    v_exp_f32 v245, v61
    v_mfma_f32_16x16x32_bf16 v[132:135], a[212:215], a[164:167], v[132:135]
    v_exp_f32 v246, v62
    v_mfma_f32_16x16x32_bf16 v[148:151], a[212:215], a[180:183], v[148:151]
    ds_read_b128 a[192:195], v2 offset:0
    v_cvt_pk_bf16_f32 v197, v242, v243
    v_mfma_f32_16x16x32_bf16 v[100:103], a[216:219], a[136:139], v[100:103]
    buffer_load_dwordx4 v29, s[48:51], s75 offen offset:2048 sc1 lds
    v_mfma_f32_16x16x32_bf16 v[116:119], a[216:219], a[152:155], v[116:119]
    v_exp_f32 v247, v63
    v_mfma_f32_16x16x32_bf16 v[132:135], a[216:219], a[168:171], v[132:135]
    v_cvt_pk_bf16_f32 v198, v244, v245
    v_cvt_pk_bf16_f32 v199, v246, v247
    v_mfma_f32_16x16x32_bf16 v[148:151], a[216:219], a[184:187], v[148:151]
    ds_read_b128 a[196:199], v2 offset:2048
    v_exp_f32 v240, v72
    v_mfma_f32_16x16x32_bf16 v[100:103], a[220:223], a[140:143], v[100:103]
    v_mfma_f32_16x16x32_bf16 v[216:219], v[208:211], v[196:199], v[216:219]
    buffer_load_dwordx4 v29, s[48:51], s75 offen offset:3072 sc1 lds
    v_exp_f32 v241, v73
    v_mfma_f32_16x16x32_bf16 v[116:119], a[220:223], a[156:159], v[116:119]
    v_exp_f32 v242, v74
    v_mfma_f32_16x16x32_bf16 v[132:135], a[220:223], a[172:175], v[132:135]
    v_exp_f32 v243, v75
    v_mfma_f32_16x16x32_bf16 v[148:151], a[220:223], a[188:191], v[148:151]
    ds_read_b128 a[200:203], v2 offset:4096
    s_waitcnt lgkmcnt(7)
    v_mfma_f32_16x16x32_bf16 v[104:107], a[224:227], a[128:131], v[224:227]
    v_exp_f32 v244, v76
    v_mfma_f32_16x16x32_bf16 v[120:123], a[224:227], a[144:147], v[228:231]
    v_cvt_pk_bf16_f32 v200, v240, v241
    v_mfma_f32_16x16x32_bf16 v[136:139], a[224:227], a[160:163], v[232:235]
    v_exp_f32 v245, v77
    v_mfma_f32_16x16x32_bf16 v[152:155], a[224:227], a[176:179], v[236:239]
    ds_read_b128 a[204:207], v2 offset:6144
    v_mfma_f32_16x16x32_bf16 v[104:107], a[228:231], a[132:135], v[104:107]
    v_exp_f32 v246, v78
    v_cvt_pk_bf16_f32 v201, v242, v243
    v_mfma_f32_16x16x32_bf16 v[120:123], a[228:231], a[148:151], v[120:123]
    v_exp_f32 v247, v79
    v_mfma_f32_16x16x32_bf16 v[136:139], a[228:231], a[164:167], v[136:139]
    v_cvt_pk_bf16_f32 v202, v244, v245
    v_mfma_f32_16x16x32_bf16 v[152:155], a[228:231], a[180:183], v[152:155]
    ds_read_b128 a[208:211], v2 offset:8192
    v_cvt_pk_bf16_f32 v203, v246, v247
    v_mfma_f32_16x16x32_bf16 v[104:107], a[232:235], a[136:139], v[104:107]
    v_exp_f32 v240, v88
    v_mfma_f32_16x16x32_bf16 v[120:123], a[232:235], a[152:155], v[120:123]
    v_exp_f32 v241, v89
    v_mfma_f32_16x16x32_bf16 v[248:251], v[208:211], v[200:203], v[248:251]
    v_mfma_f32_16x16x32_bf16 v[136:139], a[232:235], a[168:171], v[136:139]
    v_exp_f32 v242, v90
    v_mfma_f32_16x16x32_bf16 v[152:155], a[232:235], a[184:187], v[152:155]
    ds_read_b128 a[212:215], v2 offset:10240
    v_mfma_f32_16x16x32_bf16 v[104:107], a[236:239], a[140:143], v[104:107]
    v_exp_f32 v243, v91
    v_mfma_f32_16x16x32_bf16 v[120:123], a[236:239], a[156:159], v[120:123]
    v_exp_f32 v244, v92
    v_mfma_f32_16x16x32_bf16 v[136:139], a[236:239], a[172:175], v[136:139]
    v_cvt_pk_bf16_f32 v204, v240, v241
    v_mfma_f32_16x16x32_bf16 v[152:155], a[236:239], a[188:191], v[152:155]
    ds_read_b128 a[216:219], v2 offset:12288
    s_waitcnt lgkmcnt(7)
    v_mfma_f32_16x16x32_bf16 v[108:111], a[240:243], a[128:131], v[224:227]
    v_exp_f32 v245, v93
    v_mfma_f32_16x16x32_bf16 v[124:127], a[240:243], a[144:147], v[228:231]
    v_exp_f32 v246, v94
    v_mfma_f32_16x16x32_bf16 v[140:143], a[240:243], a[160:163], v[232:235]
    v_cvt_pk_bf16_f32 v205, v242, v243
    v_mfma_f32_16x16x32_bf16 v[156:159], a[240:243], a[176:179], v[236:239]
    ds_read_b128 a[220:223], v2 offset:14336
    v_mfma_f32_16x16x32_bf16 v[108:111], a[244:247], a[132:135], v[108:111]
    v_exp_f32 v247, v95
    v_mfma_f32_16x16x32_bf16 v[124:127], a[244:247], a[148:151], v[124:127]
    v_cvt_pk_bf16_f32 v206, v244, v245
    v_cvt_pk_bf16_f32 v207, v246, v247
    v_mfma_f32_16x16x32_bf16 v[140:143], a[244:247], a[164:167], v[140:143]
    v_mfma_f32_16x16x32_bf16 v[156:159], a[244:247], a[180:183], v[156:159]
    ds_read_b128 a[224:227], v2 offset:1024
    v_mfma_f32_16x16x32_bf16 v[252:255], v[208:211], v[204:207], v[252:255]
    v_mfma_f32_16x16x32_bf16 v[108:111], a[248:251], a[136:139], v[108:111]
    v_mfma_f32_16x16x32_bf16 v[124:127], a[248:251], a[152:155], v[124:127]
    v_mfma_f32_16x16x32_bf16 v[140:143], a[248:251], a[168:171], v[140:143]
    v_mfma_f32_16x16x32_bf16 v[156:159], a[248:251], a[184:187], v[156:159]
    ds_read_b128 a[228:231], v2 offset:3072
    v_max3_f32 v20, v212, v216, v248
    v_mfma_f32_16x16x32_bf16 v[108:111], a[252:255], a[140:143], v[108:111]
    s_nop 0
    v_max_f32 v20, v20, v252
    v_cmp_nge_f32 vcc, s77, v20
    v_mfma_f32_16x16x32_bf16 v[124:127], a[252:255], a[156:159], v[124:127]
    v_mfma_f32_16x16x32_bf16 v[140:143], a[252:255], a[172:175], v[140:143]
    v_mfma_f32_16x16x32_bf16 v[156:159], a[252:255], a[188:191], v[156:159]
    ds_read_b128 a[232:235], v2 offset:5120
    s_cbranch_vccnz f1_dde_rare
f1_dde_rare_r:
    s_cmp_eq_u32 s76, 1
    s_cbranch_scc1 f1_dde_mask
f1_dde_mask_r:
    s_waitcnt lgkmcnt(7)
    v_mfma_f32_16x16x32_bf16 a[0:3], a[192:195], v[160:163], a[0:3]
    v_add_f32 v13, v13, v212
    v_exp_f32 v240, v96
    v_mfma_f32_16x16x32_bf16 a[32:35], a[192:195], v[164:167], a[32:35]
    v_add_f32 v14, v14, v216
    v_mfma_f32_16x16x32_bf16 a[64:67], a[192:195], v[168:171], a[64:67]
    v_add_f32 v15, v15, v248
    v_exp_f32 v241, v97
    v_mfma_f32_16x16x32_bf16 a[96:99], a[192:195], v[172:175], a[96:99]
    ds_read_b128 a[236:239], v2 offset:7168
    v_add_f32 v30, v30, v252
    v_mfma_f32_16x16x32_bf16 a[4:7], a[196:199], v[160:163], a[4:7]
    v_exp_f32 v242, v98
    v_mfma_f32_16x16x32_bf16 a[36:39], a[196:199], v[164:167], a[36:39]
    v_mfma_f32_16x16x32_bf16 a[68:71], a[196:199], v[168:171], a[68:71]
    v_exp_f32 v243, v99
    v_mfma_f32_16x16x32_bf16 a[100:103], a[196:199], v[172:175], a[100:103]
    ds_read_b128 a[240:243], v2 offset:9216
    v_exp_f32 v244, v100
    v_mfma_f32_16x16x32_bf16 a[8:11], a[200:203], v[160:163], a[8:11]
    v_cvt_pk_bf16_f32 v176, v240, v241
    v_mfma_f32_16x16x32_bf16 a[40:43], a[200:203], v[164:167], a[40:43]
    v_exp_f32 v245, v101
    v_mfma_f32_16x16x32_bf16 a[72:75], a[200:203], v[168:171], a[72:75]
    v_exp_f32 v246, v102
    v_mfma_f32_16x16x32_bf16 a[104:107], a[200:203], v[172:175], a[104:107]
    ds_read_b128 a[244:247], v2 offset:11264
    v_mfma_f32_16x16x32_bf16 a[12:15], a[204:207], v[160:163], a[12:15]
    v_cvt_pk_bf16_f32 v177, v242, v243
    v_mfma_f32_16x16x32_bf16 a[44:47], a[204:207], v[164:167], a[44:47]
    v_exp_f32 v247, v103
    v_mfma_f32_16x16x32_bf16 a[76:79], a[204:207], v[168:171], a[76:79]
    v_cvt_pk_bf16_f32 v178, v244, v245
    v_cvt_pk_bf16_f32 v179, v246, v247
    v_mfma_f32_16x16x32_bf16 a[108:111], a[204:207], v[172:175], a[108:111]
    ds_read_b128 a[248:251], v2 offset:13312
    s_waitcnt lgkmcnt(7)
    s_mov_b32 s74, s73
    s_mov_b32 s73, s72
    v_mfma_f32_16x16x32_bf16 a[16:19], a[208:211], v[160:163], a[16:19]
    v_exp_f32 v240, v112
    v_mfma_f32_16x16x32_bf16 a[48:51], a[208:211], v[164:167], a[48:51]
    s_add_u32 s72, s72, 0x8000
    v_mfma_f32_16x16x32_bf16 v[212:215], v[208:211], v[176:179], 0
    v_exp_f32 v241, v113
    v_mfma_f32_16x16x32_bf16 a[80:83], a[208:211], v[168:171], a[80:83]
    s_cmp_eq_u32 s72, 0x28000
    s_cselect_b32 s72, 0, s72
    v_mfma_f32_16x16x32_bf16 a[112:115], a[208:211], v[172:175], a[112:115]
    ds_read_b128 a[252:255], v2 offset:15360
    s_waitcnt vmcnt(16)
    s_barrier
    v_add_u32 v2, s72, v29
    v_mfma_f32_16x16x32_bf16 a[20:23], a[212:215], v[160:163], a[20:23]
    v_exp_f32 v242, v114
    v_mfma_f32_16x16x32_bf16 a[52:55], a[212:215], v[164:167], a[52:55]
    v_exp_f32 v243, v115
    v_mfma_f32_16x16x32_bf16 a[84:87], a[212:215], v[168:171], a[84:87]
    v_exp_f32 v244, v116
    v_mfma_f32_16x16x32_bf16 a[116:119], a[212:215], v[172:175], a[116:119]
    ds_read_b128 a[192:195], v2 offset:16384
    s_add_u32 m0, s73, s28
    v_mfma_f32_16x16x32_bf16 a[24:27], a[216:219], v[160:163], a[24:27]
    v_cvt_pk_bf16_f32 v180, v240, v241
    v_mfma_f32_16x16x32_bf16 a[56:59], a[216:219], v[164:167], a[56:59]
    v_exp_f32 v245, v117
    v_mfma_f32_16x16x32_bf16 a[88:91], a[216:219], v[168:171], a[88:91]
    v_exp_f32 v246, v118
    v_mfma_f32_16x16x32_bf16 a[120:123], a[216:219], v[172:175], a[120:123]
    ds_read_b128 a[196:199], v2 offset:17408
    v_mfma_f32_16x16x32_bf16 a[28:31], a[220:223], v[160:163], a[28:31]
    v_cvt_pk_bf16_f32 v181, v242, v243
    v_mfma_f32_16x16x32_bf16 a[60:63], a[220:223], v[164:167], a[60:63]
    v_exp_f32 v247, v119
    v_mfma_f32_16x16x32_bf16 a[92:95], a[220:223], v[168:171], a[92:95]
    v_cvt_pk_bf16_f32 v182, v244, v245
    v_cvt_pk_bf16_f32 v183, v246, v247
    v_mfma_f32_16x16x32_bf16 a[124:127], a[220:223], v[172:175], a[124:127]
    ds_read_b128 a[200:203], v2 offset:18432
    s_waitcnt lgkmcnt(7)
    v_mfma_f32_16x16x32_bf16 a[0:3], a[224:227], v[192:195], a[0:3]
    s_add_u32 s75, s75, 0x8000
    v_mfma_f32_16x16x32_bf16 v[216:219], v[208:211], v[180:183], 0
    v_exp_f32 v240, v128
    v_mfma_f32_16x16x32_bf16 a[32:35], a[224:227], v[196:199], a[32:35]
    v_exp_f32 v241, v129
    v_mfma_f32_16x16x32_bf16 a[64:67], a[224:227], v[200:203], a[64:67]
    v_exp_f32 v242, v130
    v_mfma_f32_16x16x32_bf16 a[96:99], a[224:227], v[204:207], a[96:99]
    ds_read_b128 a[204:207], v2 offset:19456
    v_mfma_f32_16x16x32_bf16 a[4:7], a[228:231], v[192:195], a[4:7]
    v_exp_f32 v243, v131
    v_mfma_f32_16x16x32_bf16 a[36:39], a[228:231], v[196:199], a[36:39]
    v_exp_f32 v244, v132
    v_mfma_f32_16x16x32_bf16 a[68:71], a[228:231], v[200:203], a[68:71]
    buffer_load_dwordx4 v29, s[44:47], s75 offen offset:0 sc1 lds
    v_mfma_f32_16x16x32_bf16 a[100:103], a[228:231], v[204:207], a[100:103]
    ds_read_b128 a[208:211], v2 offset:20480
    v_cvt_pk_bf16_f32 v184, v240, v241
    v_mfma_f32_16x16x32_bf16 a[8:11], a[232:235], v[192:195], a[8:11]
    v_exp_f32 v245, v133
    v_mfma_f32_16x16x32_bf16 a[40:43], a[232:235], v[196:199], a[40:43]
    v_exp_f32 v246, v134
    v_mfma_f32_16x16x32_bf16 a[72:75], a[232:235], v[200:203], a[72:75]
    v_cvt_pk_bf16_f32 v185, v242, v243
    v_mfma_f32_16x16x32_bf16 a[104:107], a[232:235], v[204:207], a[104:107]
    ds_read_b128 a[212:215], v2 offset:21504
    v_mfma_f32_16x16x32_bf16 a[12:15], a[236:239], v[192:195], a[12:15]
    v_exp_f32 v247, v135
    v_mfma_f32_16x16x32_bf16 a[44:47], a[236:239], v[196:199], a[44:47]
    v_cvt_pk_bf16_f32 v186, v244, v245
    v_cvt_pk_bf16_f32 v187, v246, v247
    v_mfma_f32_16x16x32_bf16 a[76:79], a[236:239], v[200:203], a[76:79]
    buffer_load_dwordx4 v29, s[44:47], s75 offen offset:1024 sc1 lds
    v_mfma_f32_16x16x32_bf16 a[108:111], a[236:239], v[204:207], a[108:111]
    ds_read_b128 a[216:219], v2 offset:22528
    v_exp_f32 v240, v144
    v_mfma_f32_16x16x32_bf16 v[248:251], v[208:211], v[184:187], 0
    s_waitcnt lgkmcnt(7)
    v_mfma_f32_16x16x32_bf16 a[16:19], a[240:243], v[192:195], a[16:19]
    v_exp_f32 v241, v145
    v_mfma_f32_16x16x32_bf16 a[48:51], a[240:243], v[196:199], a[48:51]
    v_exp_f32 v242, v146
    v_mfma_f32_16x16x32_bf16 a[80:83], a[240:243], v[200:203], a[80:83]
    v_mfma_f32_16x16x32_bf16 a[112:115], a[240:243], v[204:207], a[112:115]
    ds_read_b128 a[220:223], v2 offset:23552
    v_exp_f32 v243, v147
    v_mfma_f32_16x16x32_bf16 a[20:23], a[244:247], v[192:195], a[20:23]
    v_exp_f32 v244, v148
    v_mfma_f32_16x16x32_bf16 a[52:55], a[244:247], v[196:199], a[52:55]
    buffer_load_dwordx4 v29, s[44:47], s75 offen offset:2048 sc1 lds
    v_mfma_f32_16x16x32_bf16 a[84:87], a[244:247], v[200:203], a[84:87]
    v_cvt_pk_bf16_f32 v188, v240, v241
    v_mfma_f32_16x16x32_bf16 a[116:119], a[244:247], v[204:207], a[116:119]
    ds_read_b128 a[224:227], v2 offset:24576
    v_exp_f32 v245, v149
    v_mfma_f32_16x16x32_bf16 a[24:27], a[248:251], v[192:195], a[24:27]
    v_mfma_f32_16x16x32_bf16 a[56:59], a[248:251], v[196:199], a[56:59]
    v_exp_f32 v246, v150
    v_mfma_f32_16x16x32_bf16 a[88:91], a[248:251], v[200:203], a[88:91]
    v_cvt_pk_bf16_f32 v189, v242, v243
    v_mfma_f32_16x16x32_bf16 a[120:123], a[248:251], v[204:207], a[120:123]
    ds_read_b128 a[228:231], v2 offset:25600
    v_exp_f32 v247, v151
    v_mfma_f32_16x16x32_bf16 a[28:31], a[252:255], v[192:195], a[28:31]
    v_cvt_pk_bf16_f32 v190, v244, v245
    v_mfma_f32_16x16x32_bf16 a[60:63], a[252:255], v[196:199], a[60:63]
    buffer_load_dwordx4 v29, s[44:47], s75 offen offset:3072 sc1 lds
    v_cvt_pk_bf16_f32 v191, v246, v247
    v_mfma_f32_16x16x32_bf16 a[92:95], a[252:255], v[200:203], a[92:95]
    v_mfma_f32_16x16x32_bf16 a[124:127], a[252:255], v[204:207], a[124:127]
    ds_read_b128 a[232:235], v2 offset:26624
    v_mfma_f32_16x16x32_bf16 v[252:255], v[208:211], v[188:191], 0
    s_cmp_lg_u32 s82, 0
    s_cbranch_scc1 f1_sg2a_x
    s_mov_b32 s82, 1
    s_cmp_lg_u32 s22, 0
    s_cbranch_scc1 f1_sg2a
    s_mov_b64 exec, 1
    v_mov_b32 v27, 1
    s_movk_i32 s23, 224
    buffer_atomic_add v27, off, s[56:59], s23 sc1
    s_mov_b64 exec, -1
f1_sg2a:
f1_sg2a_x:
f1_c1:
    s_sub_u32 s76, s76, 1
    s_cmp_eq_u32 s76, 0
    s_cbranch_scc1 f1_trans
    s_waitcnt lgkmcnt(7)
    v_mfma_f32_16x16x32_bf16 v[32:35], a[192:195], a[128:131], v[224:227]
    v_exp_f32 v240, v104
    v_mfma_f32_16x16x32_bf16 v[48:51], a[192:195], a[144:147], v[228:231]
    v_exp_f32 v241, v105
    v_mfma_f32_16x16x32_bf16 v[64:67], a[192:195], a[160:163], v[232:235]
    v_exp_f32 v242, v106
    v_mfma_f32_16x16x32_bf16 v[80:83], a[192:195], a[176:179], v[236:239]
    ds_read_b128 a[236:239], v2 offset:27648
    v_mfma_f32_16x16x32_bf16 v[32:35], a[196:199], a[132:135], v[32:35]
    v_exp_f32 v243, v107
    v_mfma_f32_16x16x32_bf16 v[48:51], a[196:199], a[148:151], v[48:51]
    v_exp_f32 v244, v108
    v_mfma_f32_16x16x32_bf16 v[64:67], a[196:199], a[164:167], v[64:67]
    v_cvt_pk_bf16_f32 v192, v240, v241
    v_mfma_f32_16x16x32_bf16 v[80:83], a[196:199], a[180:183], v[80:83]
    ds_read_b128 a[240:243], v2 offset:28672
    v_mfma_f32_16x16x32_bf16 v[32:35], a[200:203], a[136:139], v[32:35]
    s_add_u32 m0, s74, s30
    s_nop 0
    buffer_load_dwordx4 v29, s[48:51], s75 offen offset:0 sc1 lds
    v_mfma_f32_16x16x32_bf16 v[48:51], a[200:203], a[152:155], v[48:51]
    v_exp_f32 v245, v109
    v_mfma_f32_16x16x32_bf16 v[64:67], a[200:203], a[168:171], v[64:67]
    v_exp_f32 v246, v110
    v_mfma_f32_16x16x32_bf16 v[80:83], a[200:203], a[184:187], v[80:83]
    ds_read_b128 a[244:247], v2 offset:29696
    v_cvt_pk_bf16_f32 v193, v242, v243
    v_mfma_f32_16x16x32_bf16 v[32:35], a[204:207], a[140:143], v[32:35]
    v_exp_f32 v247, v111
    v_mfma_f32_16x16x32_bf16 v[48:51], a[204:207], a[156:159], v[48:51]
    v_cvt_pk_bf16_f32 v194, v244, v245
    v_cvt_pk_bf16_f32 v195, v246, v247
    v_mfma_f32_16x16x32_bf16 v[64:67], a[204:207], a[172:175], v[64:67]
    v_exp_f32 v240, v120
    v_mfma_f32_16x16x32_bf16 v[80:83], a[204:207], a[188:191], v[80:83]
    ds_read_b128 a[248:251], v2 offset:30720
    v_mfma_f32_16x16x32_bf16 v[212:215], v[208:211], v[192:195], v[212:215]
    s_waitcnt lgkmcnt(7)
    v_exp_f32 v241, v121
    v_mfma_f32_16x16x32_bf16 v[36:39], a[208:211], a[128:131], v[224:227]
    v_exp_f32 v242, v122
    v_mfma_f32_16x16x32_bf16 v[52:55], a[208:211], a[144:147], v[228:231]
    v_exp_f32 v243, v123
    v_mfma_f32_16x16x32_bf16 v[68:71], a[208:211], a[160:163], v[232:235]
    buffer_load_dwordx4 v29, s[48:51], s75 offen offset:1024 sc1 lds
    v_mfma_f32_16x16x32_bf16 v[84:87], a[208:211], a[176:179], v[236:239]
    ds_read_b128 a[252:255], v2 offset:31744
    v_exp_f32 v244, v124
    v_mfma_f32_16x16x32_bf16 v[36:39], a[212:215], a[132:135], v[36:39]
    v_cvt_pk_bf16_f32 v196, v240, v241
    v_mfma_f32_16x16x32_bf16 v[52:55], a[212:215], a[148:151], v[52:55]
    v_exp_f32 v245, v125
    v_mfma_f32_16x16x32_bf16 v[68:71], a[212:215], a[164:167], v[68:71]
    v_exp_f32 v246, v126
    v_mfma_f32_16x16x32_bf16 v[84:87], a[212:215], a[180:183], v[84:87]
    ds_read_b128 a[192:195], v2 offset:0
    v_cvt_pk_bf16_f32 v197, v242, v243
    v_mfma_f32_16x16x32_bf16 v[36:39], a[216:219], a[136:139], v[36:39]
    buffer_load_dwordx4 v29, s[48:51], s75 offen offset:2048 sc1 lds
    v_mfma_f32_16x16x32_bf16 v[52:55], a[216:219], a[152:155], v[52:55]
    v_exp_f32 v247, v127
    v_mfma_f32_16x16x32_bf16 v[68:71], a[216:219], a[168:171], v[68:71]
    v_cvt_pk_bf16_f32 v198, v244, v245
    v_cvt_pk_bf16_f32 v199, v246, v247
    v_mfma_f32_16x16x32_bf16 v[84:87], a[216:219], a[184:187], v[84:87]
    ds_read_b128 a[196:199], v2 offset:2048
    v_exp_f32 v240, v136
    v_mfma_f32_16x16x32_bf16 v[36:39], a[220:223], a[140:143], v[36:39]
    v_mfma_f32_16x16x32_bf16 v[216:219], v[208:211], v[196:199], v[216:219]
    buffer_load_dwordx4 v29, s[48:51], s75 offen offset:3072 sc1 lds
    v_exp_f32 v241, v137
    v_mfma_f32_16x16x32_bf16 v[52:55], a[220:223], a[156:159], v[52:55]
    v_exp_f32 v242, v138
    v_mfma_f32_16x16x32_bf16 v[68:71], a[220:223], a[172:175], v[68:71]
    v_exp_f32 v243, v139
    v_mfma_f32_16x16x32_bf16 v[84:87], a[220:223], a[188:191], v[84:87]
    ds_read_b128 a[200:203], v2 offset:4096
    s_waitcnt lgkmcnt(7)
    v_mfma_f32_16x16x32_bf16 v[40:43], a[224:227], a[128:131], v[224:227]
    v_exp_f32 v244, v140
    v_mfma_f32_16x16x32_bf16 v[56:59], a[224:227], a[144:147], v[228:231]
    v_cvt_pk_bf16_f32 v200, v240, v241
    v_mfma_f32_16x16x32_bf16 v[72:75], a[224:227], a[160:163], v[232:235]
    v_exp_f32 v245, v141
    v_mfma_f32_16x16x32_bf16 v[88:91], a[224:227], a[176:179], v[236:239]
    ds_read_b128 a[204:207], v2 offset:6144
    v_mfma_f32_16x16x32_bf16 v[40:43], a[228:231], a[132:135], v[40:43]
    v_exp_f32 v246, v142
    v_cvt_pk_bf16_f32 v201, v242, v243
    v_mfma_f32_16x16x32_bf16 v[56:59], a[228:231], a[148:151], v[56:59]
    v_exp_f32 v247, v143
    v_mfma_f32_16x16x32_bf16 v[72:75], a[228:231], a[164:167], v[72:75]
    v_cvt_pk_bf16_f32 v202, v244, v245
    v_mfma_f32_16x16x32_bf16 v[88:91], a[228:231], a[180:183], v[88:91]
    ds_read_b128 a[208:211], v2 offset:8192
    v_cvt_pk_bf16_f32 v203, v246, v247
    v_mfma_f32_16x16x32_bf16 v[40:43], a[232:235], a[136:139], v[40:43]
    v_exp_f32 v240, v152
    v_mfma_f32_16x16x32_bf16 v[56:59], a[232:235], a[152:155], v[56:59]
    v_exp_f32 v241, v153
    v_mfma_f32_16x16x32_bf16 v[248:251], v[208:211], v[200:203], v[248:251]
    v_mfma_f32_16x16x32_bf16 v[72:75], a[232:235], a[168:171], v[72:75]
    v_exp_f32 v242, v154
    v_mfma_f32_16x16x32_bf16 v[88:91], a[232:235], a[184:187], v[88:91]
    ds_read_b128 a[212:215], v2 offset:10240
    v_mfma_f32_16x16x32_bf16 v[40:43], a[236:239], a[140:143], v[40:43]
    v_exp_f32 v243, v155
    v_mfma_f32_16x16x32_bf16 v[56:59], a[236:239], a[156:159], v[56:59]
    v_exp_f32 v244, v156
    v_mfma_f32_16x16x32_bf16 v[72:75], a[236:239], a[172:175], v[72:75]
    v_cvt_pk_bf16_f32 v204, v240, v241
    v_mfma_f32_16x16x32_bf16 v[88:91], a[236:239], a[188:191], v[88:91]
    ds_read_b128 a[216:219], v2 offset:12288
    s_waitcnt lgkmcnt(7)
    v_mfma_f32_16x16x32_bf16 v[44:47], a[240:243], a[128:131], v[224:227]
    v_exp_f32 v245, v157
    v_mfma_f32_16x16x32_bf16 v[60:63], a[240:243], a[144:147], v[228:231]
    v_exp_f32 v246, v158
    v_mfma_f32_16x16x32_bf16 v[76:79], a[240:243], a[160:163], v[232:235]
    v_cvt_pk_bf16_f32 v205, v242, v243
    v_mfma_f32_16x16x32_bf16 v[92:95], a[240:243], a[176:179], v[236:239]
    ds_read_b128 a[220:223], v2 offset:14336
    v_mfma_f32_16x16x32_bf16 v[44:47], a[244:247], a[132:135], v[44:47]
    v_exp_f32 v247, v159
    v_mfma_f32_16x16x32_bf16 v[60:63], a[244:247], a[148:151], v[60:63]
    v_cvt_pk_bf16_f32 v206, v244, v245
    v_cvt_pk_bf16_f32 v207, v246, v247
    v_mfma_f32_16x16x32_bf16 v[76:79], a[244:247], a[164:167], v[76:79]
    v_mfma_f32_16x16x32_bf16 v[92:95], a[244:247], a[180:183], v[92:95]
    ds_read_b128 a[224:227], v2 offset:1024
    v_mfma_f32_16x16x32_bf16 v[252:255], v[208:211], v[204:207], v[252:255]
    v_mfma_f32_16x16x32_bf16 v[44:47], a[248:251], a[136:139], v[44:47]
    v_mfma_f32_16x16x32_bf16 v[60:63], a[248:251], a[152:155], v[60:63]
    v_mfma_f32_16x16x32_bf16 v[76:79], a[248:251], a[168:171], v[76:79]
    v_mfma_f32_16x16x32_bf16 v[92:95], a[248:251], a[184:187], v[92:95]
    ds_read_b128 a[228:231], v2 offset:3072
    v_max3_f32 v20, v212, v216, v248
    v_mfma_f32_16x16x32_bf16 v[44:47], a[252:255], a[140:143], v[44:47]
    s_nop 0
    v_max_f32 v20, v20, v252
    v_cmp_nge_f32 vcc, s77, v20
    v_mfma_f32_16x16x32_bf16 v[60:63], a[252:255], a[156:159], v[60:63]
    v_mfma_f32_16x16x32_bf16 v[76:79], a[252:255], a[172:175], v[76:79]
    v_mfma_f32_16x16x32_bf16 v[92:95], a[252:255], a[188:191], v[92:95]
    ds_read_b128 a[232:235], v2 offset:5120
    s_cbranch_vccnz f1_ddo_rare
f1_ddo_rare_r:
    s_cmp_eq_u32 s76, 1
    s_cbranch_scc1 f1_ddo_mask
f1_ddo_mask_r:
    s_waitcnt lgkmcnt(7)
    v_mfma_f32_16x16x32_bf16 a[0:3], a[192:195], v[176:179], a[0:3]
    v_add_f32 v13, v13, v212
    v_exp_f32 v240, v32
    v_mfma_f32_16x16x32_bf16 a[32:35], a[192:195], v[180:183], a[32:35]
    v_add_f32 v14, v14, v216
    v_mfma_f32_16x16x32_bf16 a[64:67], a[192:195], v[184:187], a[64:67]
    v_add_f32 v15, v15, v248
    v_exp_f32 v241, v33
    v_mfma_f32_16x16x32_bf16 a[96:99], a[192:195], v[188:191], a[96:99]
    ds_read_b128 a[236:239], v2 offset:7168
    v_add_f32 v30, v30, v252
    v_mfma_f32_16x16x32_bf16 a[4:7], a[196:199], v[176:179], a[4:7]
    v_exp_f32 v242, v34
    v_mfma_f32_16x16x32_bf16 a[36:39], a[196:199], v[180:183], a[36:39]
    v_mfma_f32_16x16x32_bf16 a[68:71], a[196:199], v[184:187], a[68:71]
    v_exp_f32 v243, v35
    v_mfma_f32_16x16x32_bf16 a[100:103], a[196:199], v[188:191], a[100:103]
    ds_read_b128 a[240:243], v2 offset:9216
    v_exp_f32 v244, v36
    v_mfma_f32_16x16x32_bf16 a[8:11], a[200:203], v[176:179], a[8:11]
    v_cvt_pk_bf16_f32 v160, v240, v241
    v_mfma_f32_16x16x32_bf16 a[40:43], a[200:203], v[180:183], a[40:43]
    v_exp_f32 v245, v37
    v_mfma_f32_16x16x32_bf16 a[72:75], a[200:203], v[184:187], a[72:75]
    v_exp_f32 v246, v38
    v_mfma_f32_16x16x32_bf16 a[104:107], a[200:203], v[188:191], a[104:107]
    ds_read_b128 a[244:247], v2 offset:11264
    v_mfma_f32_16x16x32_bf16 a[12:15], a[204:207], v[176:179], a[12:15]
    v_cvt_pk_bf16_f32 v161, v242, v243
    v_mfma_f32_16x16x32_bf16 a[44:47], a[204:207], v[180:183], a[44:47]
    v_exp_f32 v247, v39
    v_mfma_f32_16x16x32_bf16 a[76:79], a[204:207], v[184:187], a[76:79]
    v_cvt_pk_bf16_f32 v162, v244, v245
    v_cvt_pk_bf16_f32 v163, v246, v247
    v_mfma_f32_16x16x32_bf16 a[108:111], a[204:207], v[188:191], a[108:111]
    ds_read_b128 a[248:251], v2 offset:13312
    s_waitcnt lgkmcnt(7)
    s_mov_b32 s74, s73
    s_mov_b32 s73, s72
    v_mfma_f32_16x16x32_bf16 a[16:19], a[208:211], v[176:179], a[16:19]
    v_exp_f32 v240, v48
    v_mfma_f32_16x16x32_bf16 a[48:51], a[208:211], v[180:183], a[48:51]
    s_add_u32 s72, s72, 0x8000
    v_mfma_f32_16x16x32_bf16 v[212:215], v[208:211], v[160:163], 0
    v_exp_f32 v241, v49
    v_mfma_f32_16x16x32_bf16 a[80:83], a[208:211], v[184:187], a[80:83]
    s_cmp_eq_u32 s72, 0x28000
    s_cselect_b32 s72, 0, s72
    v_mfma_f32_16x16x32_bf16 a[112:115], a[208:211], v[188:191], a[112:115]
    ds_read_b128 a[252:255], v2 offset:15360
    s_waitcnt vmcnt(29)
    s_cmp_eq_u32 s82, 0
    s_cbranch_scc1 f1_ddo_sw
    s_waitcnt vmcnt(16)
f1_ddo_sw:
    s_barrier
    v_add_u32 v2, s72, v29
    v_mfma_f32_16x16x32_bf16 a[20:23], a[212:215], v[176:179], a[20:23]
    v_exp_f32 v242, v50
    v_mfma_f32_16x16x32_bf16 a[52:55], a[212:215], v[180:183], a[52:55]
    v_exp_f32 v243, v51
    v_mfma_f32_16x16x32_bf16 a[84:87], a[212:215], v[184:187], a[84:87]
    v_exp_f32 v244, v52
    v_mfma_f32_16x16x32_bf16 a[116:119], a[212:215], v[188:191], a[116:119]
    ds_read_b128 a[192:195], v2 offset:16384
    s_add_u32 m0, s73, s28
    v_mfma_f32_16x16x32_bf16 a[24:27], a[216:219], v[176:179], a[24:27]
    v_cvt_pk_bf16_f32 v164, v240, v241
    v_mfma_f32_16x16x32_bf16 a[56:59], a[216:219], v[180:183], a[56:59]
    v_exp_f32 v245, v53
    v_mfma_f32_16x16x32_bf16 a[88:91], a[216:219], v[184:187], a[88:91]
    v_exp_f32 v246, v54
    v_mfma_f32_16x16x32_bf16 a[120:123], a[216:219], v[188:191], a[120:123]
    ds_read_b128 a[196:199], v2 offset:17408
    v_mfma_f32_16x16x32_bf16 a[28:31], a[220:223], v[176:179], a[28:31]
    v_cvt_pk_bf16_f32 v165, v242, v243
    v_mfma_f32_16x16x32_bf16 a[60:63], a[220:223], v[180:183], a[60:63]
    v_exp_f32 v247, v55
    v_mfma_f32_16x16x32_bf16 a[92:95], a[220:223], v[184:187], a[92:95]
    v_cvt_pk_bf16_f32 v166, v244, v245
    v_cvt_pk_bf16_f32 v167, v246, v247
    v_mfma_f32_16x16x32_bf16 a[124:127], a[220:223], v[188:191], a[124:127]
    ds_read_b128 a[200:203], v2 offset:18432
    s_waitcnt lgkmcnt(7)
    v_mfma_f32_16x16x32_bf16 a[0:3], a[224:227], v[192:195], a[0:3]
    s_add_u32 s75, s75, 0x8000
    v_mfma_f32_16x16x32_bf16 v[216:219], v[208:211], v[164:167], 0
    v_exp_f32 v240, v64
    v_mfma_f32_16x16x32_bf16 a[32:35], a[224:227], v[196:199], a[32:35]
    v_exp_f32 v241, v65
    v_mfma_f32_16x16x32_bf16 a[64:67], a[224:227], v[200:203], a[64:67]
    v_exp_f32 v242, v66
    v_mfma_f32_16x16x32_bf16 a[96:99], a[224:227], v[204:207], a[96:99]
    ds_read_b128 a[204:207], v2 offset:19456
    v_mfma_f32_16x16x32_bf16 a[4:7], a[228:231], v[192:195], a[4:7]
    v_exp_f32 v243, v67
    v_mfma_f32_16x16x32_bf16 a[36:39], a[228:231], v[196:199], a[36:39]
    v_exp_f32 v244, v68
    v_mfma_f32_16x16x32_bf16 a[68:71], a[228:231], v[200:203], a[68:71]
    buffer_load_dwordx4 v29, s[44:47], s75 offen offset:0 sc1 lds
    v_mfma_f32_16x16x32_bf16 a[100:103], a[228:231], v[204:207], a[100:103]
    ds_read_b128 a[208:211], v2 offset:20480
    v_cvt_pk_bf16_f32 v168, v240, v241
    v_mfma_f32_16x16x32_bf16 a[8:11], a[232:235], v[192:195], a[8:11]
    v_exp_f32 v245, v69
    v_mfma_f32_16x16x32_bf16 a[40:43], a[232:235], v[196:199], a[40:43]
    v_exp_f32 v246, v70
    v_mfma_f32_16x16x32_bf16 a[72:75], a[232:235], v[200:203], a[72:75]
    v_cvt_pk_bf16_f32 v169, v242, v243
    v_mfma_f32_16x16x32_bf16 a[104:107], a[232:235], v[204:207], a[104:107]
    ds_read_b128 a[212:215], v2 offset:21504
    v_mfma_f32_16x16x32_bf16 a[12:15], a[236:239], v[192:195], a[12:15]
    v_exp_f32 v247, v71
    v_mfma_f32_16x16x32_bf16 a[44:47], a[236:239], v[196:199], a[44:47]
    v_cvt_pk_bf16_f32 v170, v244, v245
    v_cvt_pk_bf16_f32 v171, v246, v247
    v_mfma_f32_16x16x32_bf16 a[76:79], a[236:239], v[200:203], a[76:79]
    buffer_load_dwordx4 v29, s[44:47], s75 offen offset:1024 sc1 lds
    v_mfma_f32_16x16x32_bf16 a[108:111], a[236:239], v[204:207], a[108:111]
    ds_read_b128 a[216:219], v2 offset:22528
    v_exp_f32 v240, v80
    v_mfma_f32_16x16x32_bf16 v[248:251], v[208:211], v[168:171], 0
    s_waitcnt lgkmcnt(7)
    v_mfma_f32_16x16x32_bf16 a[16:19], a[240:243], v[192:195], a[16:19]
    v_exp_f32 v241, v81
    v_mfma_f32_16x16x32_bf16 a[48:51], a[240:243], v[196:199], a[48:51]
    v_exp_f32 v242, v82
    v_mfma_f32_16x16x32_bf16 a[80:83], a[240:243], v[200:203], a[80:83]
    v_mfma_f32_16x16x32_bf16 a[112:115], a[240:243], v[204:207], a[112:115]
    ds_read_b128 a[220:223], v2 offset:23552
    v_exp_f32 v243, v83
    v_mfma_f32_16x16x32_bf16 a[20:23], a[244:247], v[192:195], a[20:23]
    v_exp_f32 v244, v84
    v_mfma_f32_16x16x32_bf16 a[52:55], a[244:247], v[196:199], a[52:55]
    buffer_load_dwordx4 v29, s[44:47], s75 offen offset:2048 sc1 lds
    v_mfma_f32_16x16x32_bf16 a[84:87], a[244:247], v[200:203], a[84:87]
    v_cvt_pk_bf16_f32 v172, v240, v241
    v_mfma_f32_16x16x32_bf16 a[116:119], a[244:247], v[204:207], a[116:119]
    ds_read_b128 a[224:227], v2 offset:24576
    v_exp_f32 v245, v85
    v_mfma_f32_16x16x32_bf16 a[24:27], a[248:251], v[192:195], a[24:27]
    v_mfma_f32_16x16x32_bf16 a[56:59], a[248:251], v[196:199], a[56:59]
    v_exp_f32 v246, v86
    v_mfma_f32_16x16x32_bf16 a[88:91], a[248:251], v[200:203], a[88:91]
    v_cvt_pk_bf16_f32 v173, v242, v243
    v_mfma_f32_16x16x32_bf16 a[120:123], a[248:251], v[204:207], a[120:123]
    ds_read_b128 a[228:231], v2 offset:25600
    v_exp_f32 v247, v87
    v_mfma_f32_16x16x32_bf16 a[28:31], a[252:255], v[192:195], a[28:31]
    v_cvt_pk_bf16_f32 v174, v244, v245
    v_mfma_f32_16x16x32_bf16 a[60:63], a[252:255], v[196:199], a[60:63]
    buffer_load_dwordx4 v29, s[44:47], s75 offen offset:3072 sc1 lds
    v_cvt_pk_bf16_f32 v175, v246, v247
    v_mfma_f32_16x16x32_bf16 a[92:95], a[252:255], v[200:203], a[92:95]
    v_mfma_f32_16x16x32_bf16 a[124:127], a[252:255], v[204:207], a[124:127]
    ds_read_b128 a[232:235], v2 offset:26624
    v_mfma_f32_16x16x32_bf16 v[252:255], v[208:211], v[172:175], 0
    s_branch f1_dual
f1_trans:
    s_lshl_b32 s76, s21, 1
    s_sub_u32 s76, 15, s76
    s_waitcnt lgkmcnt(7)
    v_mfma_f32_16x16x32_bf16 v[64:67], a[192:195], a[160:163], v[232:235]
    v_exp_f32 v240, v120
    v_exp_f32 v241, v121
    v_mfma_f32_16x16x32_bf16 v[80:83], a[192:195], a[176:179], v[236:239]
    ds_read_b128 a[236:239], v2 offset:27648
    v_exp_f32 v242, v122
    v_mfma_f32_16x16x32_bf16 v[64:67], a[196:199], a[164:167], v[64:67]
    v_exp_f32 v243, v123
    v_exp_f32 v244, v124
    v_mfma_f32_16x16x32_bf16 v[80:83], a[196:199], a[180:183], v[80:83]
    ds_read_b128 a[240:243], v2 offset:28672
    v_cvt_pk_bf16_f32 v196, v240, v241
    v_exp_f32 v245, v125
    v_mfma_f32_16x16x32_bf16 v[64:67], a[200:203], a[168:171], v[64:67]
    s_add_u32 m0, s74, s30
    s_nop 0
    buffer_load_dwordx4 v29, s[48:51], s75 offen offset:0 sc1 lds
    v_mfma_f32_16x16x32_bf16 v[80:83], a[200:203], a[184:187], v[80:83]
    ds_read_b128 a[244:247], v2 offset:29696
    v_exp_f32 v246, v126
    v_mfma_f32_16x16x32_bf16 v[64:67], a[204:207], a[172:175], v[64:67]
    v_cvt_pk_bf16_f32 v197, v242, v243
    v_exp_f32 v247, v127
    v_mfma_f32_16x16x32_bf16 v[80:83], a[204:207], a[188:191], v[80:83]
    ds_read_b128 a[248:251], v2 offset:30720
    s_waitcnt lgkmcnt(7)
    v_cvt_pk_bf16_f32 v198, v244, v245
    v_cvt_pk_bf16_f32 v199, v246, v247
    v_mfma_f32_16x16x32_bf16 v[68:71], a[208:211], a[160:163], v[232:235]
    v_exp_f32 v240, v136
    v_exp_f32 v241, v137
    v_mfma_f32_16x16x32_bf16 v[84:87], a[208:211], a[176:179], v[236:239]
    ds_read_b128 a[252:255], v2 offset:31744
    buffer_load_dwordx4 v29, s[48:51], s75 offen offset:1024 sc1 lds
    v_mfma_f32_16x16x32_bf16 v[216:219], v[208:211], v[196:199], v[216:219]
    v_exp_f32 v242, v138
    v_exp_f32 v243, v139
    v_mfma_f32_16x16x32_bf16 v[68:71], a[212:215], a[164:167], v[68:71]
    buffer_load_dwordx4 v29, s[48:51], s75 offen offset:2048 sc1 lds
    v_exp_f32 v244, v140
    v_mfma_f32_16x16x32_bf16 v[84:87], a[212:215], a[180:183], v[84:87]
    ds_read_b128 a[192:195], v2 offset:0
    v_cvt_pk_bf16_f32 v200, v240, v241
    v_exp_f32 v245, v141
    v_mfma_f32_16x16x32_bf16 v[68:71], a[216:219], a[168:171], v[68:71]
    v_exp_f32 v246, v142
    v_mfma_f32_16x16x32_bf16 v[84:87], a[216:219], a[184:187], v[84:87]
    ds_read_b128 a[196:199], v2 offset:2048
    buffer_load_dwordx4 v29, s[48:51], s75 offen offset:3072 sc1 lds
    v_cvt_pk_bf16_f32 v201, v242, v243
    v_mfma_f32_16x16x32_bf16 v[68:71], a[220:223], a[172:175], v[68:71]
    v_exp_f32 v247, v143
    v_cvt_pk_bf16_f32 v202, v244, v245
    v_cvt_pk_bf16_f32 v203, v246, v247
    v_mfma_f32_16x16x32_bf16 v[84:87], a[220:223], a[188:191], v[84:87]
    ds_read_b128 a[200:203], v2 offset:4096
    s_waitcnt lgkmcnt(7)
    v_exp_f32 v240, v152
    v_mfma_f32_16x16x32_bf16 v[72:75], a[224:227], a[160:163], v[232:235]
    v_exp_f32 v241, v153
    v_mfma_f32_16x16x32_bf16 v[248:251], v[208:211], v[200:203], v[248:251]
    v_exp_f32 v242, v154
    v_exp_f32 v243, v155
    v_mfma_f32_16x16x32_bf16 v[88:91], a[224:227], a[176:179], v[236:239]
    ds_read_b128 a[204:207], v2 offset:6144
    v_exp_f32 v244, v156
    v_mfma_f32_16x16x32_bf16 v[72:75], a[228:231], a[164:167], v[72:75]
    v_cvt_pk_bf16_f32 v204, v240, v241
    v_exp_f32 v245, v157
    v_mfma_f32_16x16x32_bf16 v[88:91], a[228:231], a[180:183], v[88:91]
    ds_read_b128 a[208:211], v2 offset:8192
    v_exp_f32 v246, v158
    v_mfma_f32_16x16x32_bf16 v[72:75], a[232:235], a[168:171], v[72:75]
    v_cvt_pk_bf16_f32 v205, v242, v243
    v_exp_f32 v247, v159
    v_mfma_f32_16x16x32_bf16 v[88:91], a[232:235], a[184:187], v[88:91]
    ds_read_b128 a[212:215], v2 offset:10240
    v_cvt_pk_bf16_f32 v206, v244, v245
    v_cvt_pk_bf16_f32 v207, v246, v247
    v_mfma_f32_16x16x32_bf16 v[72:75], a[236:239], a[172:175], v[72:75]
    v_mfma_f32_16x16x32_bf16 v[88:91], a[236:239], a[188:191], v[88:91]
    ds_read_b128 a[216:219], v2 offset:12288
    v_mfma_f32_16x16x32_bf16 v[252:255], v[208:211], v[204:207], v[252:255]
    s_waitcnt lgkmcnt(7)
    v_mfma_f32_16x16x32_bf16 v[76:79], a[240:243], a[160:163], v[232:235]
    v_mfma_f32_16x16x32_bf16 v[92:95], a[240:243], a[176:179], v[236:239]
    ds_read_b128 a[220:223], v2 offset:14336
    v_mfma_f32_16x16x32_bf16 v[76:79], a[244:247], a[164:167], v[76:79]
    v_mfma_f32_16x16x32_bf16 v[92:95], a[244:247], a[180:183], v[92:95]
    ds_read_b128 a[224:227], v2 offset:1024
    s_nop 0
    v_max3_f32 v20, v216, v248, v252
    v_mfma_f32_16x16x32_bf16 v[76:79], a[248:251], a[168:171], v[76:79]
    v_cmp_nge_f32 vcc, s77, v20
    v_mfma_f32_16x16x32_bf16 v[92:95], a[248:251], a[184:187], v[92:95]
    ds_read_b128 a[228:231], v2 offset:3072
    v_mfma_f32_16x16x32_bf16 v[76:79], a[252:255], a[172:175], v[76:79]
    v_mfma_f32_16x16x32_bf16 v[92:95], a[252:255], a[188:191], v[92:95]
    ds_read_b128 a[232:235], v2 offset:5120
    s_cbranch_vccnz f1_dso_rare
f1_dso_rare_r:
    s_cmp_eq_u32 s76, 1
    s_cbranch_scc1 f1_dso_mask
f1_dso_mask_r:
    s_waitcnt lgkmcnt(7)
    v_mfma_f32_16x16x32_bf16 a[32:35], a[192:195], v[180:183], a[32:35]
    v_add_f32 v14, v14, v216
    v_mfma_f32_16x16x32_bf16 a[64:67], a[192:195], v[184:187], a[64:67]
    v_add_f32 v15, v15, v248
    v_mfma_f32_16x16x32_bf16 a[96:99], a[192:195], v[188:191], a[96:99]
    ds_read_b128 a[236:239], v2 offset:7168
    v_mfma_f32_16x16x32_bf16 a[36:39], a[196:199], v[180:183], a[36:39]
    v_add_f32 v30, v30, v252
    v_mfma_f32_16x16x32_bf16 a[68:71], a[196:199], v[184:187], a[68:71]
    v_exp_f32 v240, v64
    v_mfma_f32_16x16x32_bf16 a[100:103], a[196:199], v[188:191], a[100:103]
    ds_read_b128 a[240:243], v2 offset:9216
    v_mfma_f32_16x16x32_bf16 a[40:43], a[200:203], v[180:183], a[40:43]
    v_exp_f32 v241, v65
    v_mfma_f32_16x16x32_bf16 a[72:75], a[200:203], v[184:187], a[72:75]
    v_exp_f32 v242, v66
    v_mfma_f32_16x16x32_bf16 a[104:107], a[200:203], v[188:191], a[104:107]
    ds_read_b128 a[244:247], v2 offset:11264
    v_mfma_f32_16x16x32_bf16 a[44:47], a[204:207], v[180:183], a[44:47]
    s_mov_b32 s74, s73
    s_mov_b32 s73, s72
    v_mfma_f32_16x16x32_bf16 a[76:79], a[204:207], v[184:187], a[76:79]
    v_exp_f32 v243, v67
    v_mfma_f32_16x16x32_bf16 a[108:111], a[204:207], v[188:191], a[108:111]
    ds_read_b128 a[248:251], v2 offset:13312
    s_waitcnt lgkmcnt(7)
    s_add_u32 s72, s72, 0x8000
    v_mfma_f32_16x16x32_bf16 a[48:51], a[208:211], v[180:183], a[48:51]
    v_exp_f32 v244, v68
    v_mfma_f32_16x16x32_bf16 a[80:83], a[208:211], v[184:187], a[80:83]
    s_cmp_eq_u32 s72, 0x28000
    s_cselect_b32 s72, 0, s72
    v_mfma_f32_16x16x32_bf16 a[112:115], a[208:211], v[188:191], a[112:115]
    ds_read_b128 a[252:255], v2 offset:15360
    s_waitcnt vmcnt(29)
    s_cmp_eq_u32 s82, 0
    s_cbranch_scc1 f1_dso_sw
    s_waitcnt vmcnt(16)
f1_dso_sw:
    s_barrier
    v_add_u32 v2, s72, v29
    v_mfma_f32_16x16x32_bf16 a[52:55], a[212:215], v[180:183], a[52:55]
    v_cvt_pk_bf16_f32 v168, v240, v241
    v_mfma_f32_16x16x32_bf16 a[84:87], a[212:215], v[184:187], a[84:87]
    v_exp_f32 v245, v69
    v_mfma_f32_16x16x32_bf16 a[116:119], a[212:215], v[188:191], a[116:119]
    ds_read_b128 a[192:195], v2 offset:16384
    s_add_u32 m0, s73, s28
    v_mfma_f32_16x16x32_bf16 a[56:59], a[216:219], v[180:183], a[56:59]
    v_exp_f32 v246, v70
    v_mfma_f32_16x16x32_bf16 a[88:91], a[216:219], v[184:187], a[88:91]
    v_cvt_pk_bf16_f32 v169, v242, v243
    v_mfma_f32_16x16x32_bf16 a[120:123], a[216:219], v[188:191], a[120:123]
    ds_read_b128 a[196:199], v2 offset:17408
    v_mfma_f32_16x16x32_bf16 a[60:63], a[220:223], v[180:183], a[60:63]
    v_exp_f32 v247, v71
    v_mfma_f32_16x16x32_bf16 a[92:95], a[220:223], v[184:187], a[92:95]
    v_cvt_pk_bf16_f32 v170, v244, v245
    v_cvt_pk_bf16_f32 v171, v246, v247
    v_mfma_f32_16x16x32_bf16 a[124:127], a[220:223], v[188:191], a[124:127]
    ds_read_b128 a[200:203], v2 offset:18432
    s_waitcnt lgkmcnt(7)
    v_mfma_f32_16x16x32_bf16 a[32:35], a[224:227], v[196:199], a[32:35]
    s_add_u32 s75, s75, 0x8000
    v_mfma_f32_16x16x32_bf16 v[248:251], v[208:211], v[168:171], 0
    v_exp_f32 v240, v80
    v_mfma_f32_16x16x32_bf16 a[64:67], a[224:227], v[200:203], a[64:67]
    v_mfma_f32_16x16x32_bf16 a[96:99], a[224:227], v[204:207], a[96:99]
    ds_read_b128 a[204:207], v2 offset:19456
    v_mfma_f32_16x16x32_bf16 a[36:39], a[228:231], v[196:199], a[36:39]
    v_exp_f32 v241, v81
    v_mfma_f32_16x16x32_bf16 a[68:71], a[228:231], v[200:203], a[68:71]
    buffer_load_dwordx4 v29, s[44:47], s75 offen offset:0 sc1 lds
    v_mfma_f32_16x16x32_bf16 a[100:103], a[228:231], v[204:207], a[100:103]
    ds_read_b128 a[208:211], v2 offset:20480
    v_mfma_f32_16x16x32_bf16 a[40:43], a[232:235], v[196:199], a[40:43]
    v_exp_f32 v242, v82
    v_mfma_f32_16x16x32_bf16 a[72:75], a[232:235], v[200:203], a[72:75]
    v_exp_f32 v243, v83
    v_mfma_f32_16x16x32_bf16 a[104:107], a[232:235], v[204:207], a[104:107]
    ds_read_b128 a[212:215], v2 offset:21504
    v_mfma_f32_16x16x32_bf16 a[44:47], a[236:239], v[196:199], a[44:47]
    v_exp_f32 v244, v84
    v_mfma_f32_16x16x32_bf16 a[76:79], a[236:239], v[200:203], a[76:79]
    buffer_load_dwordx4 v29, s[44:47], s75 offen offset:1024 sc1 lds
    v_cvt_pk_bf16_f32 v172, v240, v241
    v_mfma_f32_16x16x32_bf16 a[108:111], a[236:239], v[204:207], a[108:111]
    ds_read_b128 a[216:219], v2 offset:22528
    s_waitcnt lgkmcnt(7)
    v_mfma_f32_16x16x32_bf16 a[48:51], a[240:243], v[196:199], a[48:51]
    v_mfma_f32_16x16x32_bf16 a[80:83], a[240:243], v[200:203], a[80:83]
    v_exp_f32 v245, v85
    v_mfma_f32_16x16x32_bf16 a[112:115], a[240:243], v[204:207], a[112:115]
    ds_read_b128 a[220:223], v2 offset:23552
    v_mfma_f32_16x16x32_bf16 a[52:55], a[244:247], v[196:199], a[52:55]
    v_exp_f32 v246, v86
    v_mfma_f32_16x16x32_bf16 a[84:87], a[244:247], v[200:203], a[84:87]
    buffer_load_dwordx4 v29, s[44:47], s75 offen offset:2048 sc1 lds
    v_mfma_f32_16x16x32_bf16 a[116:119], a[244:247], v[204:207], a[116:119]
    ds_read_b128 a[224:227], v2 offset:24576
    v_cvt_pk_bf16_f32 v173, v242, v243
    v_mfma_f32_16x16x32_bf16 a[56:59], a[248:251], v[196:199], a[56:59]
    v_exp_f32 v247, v87
    v_mfma_f32_16x16x32_bf16 a[88:91], a[248:251], v[200:203], a[88:91]
    v_mfma_f32_16x16x32_bf16 a[120:123], a[248:251], v[204:207], a[120:123]
    ds_read_b128 a[228:231], v2 offset:25600
    v_cvt_pk_bf16_f32 v174, v244, v245
    v_mfma_f32_16x16x32_bf16 a[60:63], a[252:255], v[196:199], a[60:63]
    v_cvt_pk_bf16_f32 v175, v246, v247
    v_mfma_f32_16x16x32_bf16 a[92:95], a[252:255], v[200:203], a[92:95]
    buffer_load_dwordx4 v29, s[44:47], s75 offen offset:3072 sc1 lds
    v_mfma_f32_16x16x32_bf16 a[124:127], a[252:255], v[204:207], a[124:127]
    ds_read_b128 a[232:235], v2 offset:26624
    v_mfma_f32_16x16x32_bf16 v[252:255], v[208:211], v[172:175], 0
    s_cmp_lg_u32 s22, 0
    s_cbranch_scc1 f1_w0_9
    buffer_load_dword v28, off, s[56:59], s83 sc1
f1_w0_9:
    s_getpc_b64 s[60:61]
f1_pcr2:
    s_mov_b32 s62, f1_last-f1_pcr2
    s_mov_b32 s63, 0x00020000
    s_lshr_b32 s25, s2, 3
    s_lshl_b32 s25, s25, 2
    s_add_u32 s25, s25, s22
    s_lshl_b32 s25, s25, 10
    buffer_load_dwordx4 v[176:179], v29, s[60:63], s25 offen
    v_rcp_f32 v20, v13
    s_add_u32 s24, s78, 0
    v_mul_f32 v20, v20, v16
    v_accvgpr_read_b32 v32, a0
    v_accvgpr_read_b32 v33, a1
    v_accvgpr_read_b32 v34, a2
    v_accvgpr_read_b32 v35, a3
    v_accvgpr_read_b32 v36, a4
    v_accvgpr_read_b32 v37, a5
    v_accvgpr_read_b32 v38, a6
    v_accvgpr_read_b32 v39, a7
    v_pk_mul_f32 v[32:33], v[32:33], v[20:21] op_sel_hi:[1,0]
    v_pk_mul_f32 v[34:35], v[34:35], v[20:21] op_sel_hi:[1,0]
    v_pk_mul_f32 v[36:37], v[36:37], v[20:21] op_sel_hi:[1,0]
    v_pk_mul_f32 v[38:39], v[38:39], v[20:21] op_sel_hi:[1,0]
    v_cvt_pk_bf16_f32 v40, v32, v33
    v_cvt_pk_bf16_f32 v41, v34, v35
    v_cvt_pk_bf16_f32 v42, v36, v37
    v_cvt_pk_bf16_f32 v43, v38, v39
    buffer_store_dwordx4 v[40:43], v29, s[52:55], s24 offen offset:0 sc1
    v_accvgpr_read_b32 v48, a8
    v_accvgpr_read_b32 v49, a9
    v_accvgpr_read_b32 v50, a10
    v_accvgpr_read_b32 v51, a11
    v_accvgpr_read_b32 v52, a12
    v_accvgpr_read_b32 v53, a13
    v_accvgpr_read_b32 v54, a14
    v_accvgpr_read_b32 v55, a15
    v_pk_mul_f32 v[48:49], v[48:49], v[20:21] op_sel_hi:[1,0]
    v_pk_mul_f32 v[50:51], v[50:51], v[20:21] op_sel_hi:[1,0]
    v_pk_mul_f32 v[52:53], v[52:53], v[20:21] op_sel_hi:[1,0]
    v_pk_mul_f32 v[54:55], v[54:55], v[20:21] op_sel_hi:[1,0]
    v_cvt_pk_bf16_f32 v56, v48, v49
    v_cvt_pk_bf16_f32 v57, v50, v51
    v_cvt_pk_bf16_f32 v58, v52, v53
    v_cvt_pk_bf16_f32 v59, v54, v55
    buffer_store_dwordx4 v[56:59], v29, s[52:55], s24 offen offset:1024 sc1
    v_accvgpr_read_b32 v32, a16
    v_accvgpr_read_b32 v33, a17
    v_accvgpr_read_b32 v34, a18
    v_accvgpr_read_b32 v35, a19
    v_accvgpr_read_b32 v36, a20
    v_accvgpr_read_b32 v37, a21
    v_accvgpr_read_b32 v38, a22
    v_accvgpr_read_b32 v39, a23
    v_pk_mul_f32 v[32:33], v[32:33], v[20:21] op_sel_hi:[1,0]
    v_pk_mul_f32 v[34:35], v[34:35], v[20:21] op_sel_hi:[1,0]
    v_pk_mul_f32 v[36:37], v[36:37], v[20:21] op_sel_hi:[1,0]
    v_pk_mul_f32 v[38:39], v[38:39], v[20:21] op_sel_hi:[1,0]
    v_cvt_pk_bf16_f32 v40, v32, v33
    v_cvt_pk_bf16_f32 v41, v34, v35
    v_cvt_pk_bf16_f32 v42, v36, v37
    v_cvt_pk_bf16_f32 v43, v38, v39
    buffer_store_dwordx4 v[40:43], v29, s[52:55], s24 offen offset:2048 sc1
    v_accvgpr_read_b32 v48, a24
    v_accvgpr_read_b32 v49, a25
    v_accvgpr_read_b32 v50, a26
    v_accvgpr_read_b32 v51, a27
    v_accvgpr_read_b32 v52, a28
    v_accvgpr_read_b32 v53, a29
    v_accvgpr_read_b32 v54, a30
    v_accvgpr_read_b32 v55, a31
    v_pk_mul_f32 v[48:49], v[48:49], v[20:21] op_sel_hi:[1,0]
    v_pk_mul_f32 v[50:51], v[50:51], v[20:21] op_sel_hi:[1,0]
    v_pk_mul_f32 v[52:53], v[52:53], v[20:21] op_sel_hi:[1,0]
    v_pk_mul_f32 v[54:55], v[54:55], v[20:21] op_sel_hi:[1,0]
    v_cvt_pk_bf16_f32 v56, v48, v49
    v_cvt_pk_bf16_f32 v57, v50, v51
    v_cvt_pk_bf16_f32 v58, v52, v53
    v_cvt_pk_bf16_f32 v59, v54, v55
    buffer_store_dwordx4 v[56:59], v29, s[52:55], s24 offen offset:3072 sc1
    v_rcp_f32 v22, v14
    s_add_u32 s24, s78, 598016
    v_mul_f32 v22, v22, v17
    v_accvgpr_read_b32 v32, a32
    v_accvgpr_read_b32 v33, a33
    v_accvgpr_read_b32 v34, a34
    v_accvgpr_read_b32 v35, a35
    v_accvgpr_read_b32 v36, a36
    v_accvgpr_read_b32 v37, a37
    v_accvgpr_read_b32 v38, a38
    v_accvgpr_read_b32 v39, a39
    v_pk_mul_f32 v[32:33], v[32:33], v[22:23] op_sel_hi:[1,0]
    v_pk_mul_f32 v[34:35], v[34:35], v[22:23] op_sel_hi:[1,0]
    v_pk_mul_f32 v[36:37], v[36:37], v[22:23] op_sel_hi:[1,0]
    v_pk_mul_f32 v[38:39], v[38:39], v[22:23] op_sel_hi:[1,0]
    v_cvt_pk_bf16_f32 v40, v32, v33
    v_cvt_pk_bf16_f32 v41, v34, v35
    v_cvt_pk_bf16_f32 v42, v36, v37
    v_cvt_pk_bf16_f32 v43, v38, v39
    buffer_store_dwordx4 v[40:43], v29, s[52:55], s24 offen offset:0 sc1
    v_accvgpr_read_b32 v48, a40
    v_accvgpr_read_b32 v49, a41
    v_accvgpr_read_b32 v50, a42
    v_accvgpr_read_b32 v51, a43
    v_accvgpr_read_b32 v52, a44
    v_accvgpr_read_b32 v53, a45
    v_accvgpr_read_b32 v54, a46
    v_accvgpr_read_b32 v55, a47
    v_pk_mul_f32 v[48:49], v[48:49], v[22:23] op_sel_hi:[1,0]
    v_pk_mul_f32 v[50:51], v[50:51], v[22:23] op_sel_hi:[1,0]
    v_pk_mul_f32 v[52:53], v[52:53], v[22:23] op_sel_hi:[1,0]
    v_pk_mul_f32 v[54:55], v[54:55], v[22:23] op_sel_hi:[1,0]
    v_cvt_pk_bf16_f32 v56, v48, v49
    v_cvt_pk_bf16_f32 v57, v50, v51
    v_cvt_pk_bf16_f32 v58, v52, v53
    v_cvt_pk_bf16_f32 v59, v54, v55
    buffer_store_dwordx4 v[56:59], v29, s[52:55], s24 offen offset:1024 sc1
    v_accvgpr_read_b32 v32, a48
    v_accvgpr_read_b32 v33, a49
    v_accvgpr_read_b32 v34, a50
    v_accvgpr_read_b32 v35, a51
    v_accvgpr_read_b32 v36, a52
    v_accvgpr_read_b32 v37, a53
    v_accvgpr_read_b32 v38, a54
    v_accvgpr_read_b32 v39, a55
    v_pk_mul_f32 v[32:33], v[32:33], v[22:23] op_sel_hi:[1,0]
    v_pk_mul_f32 v[34:35], v[34:35], v[22:23] op_sel_hi:[1,0]
    v_pk_mul_f32 v[36:37], v[36:37], v[22:23] op_sel_hi:[1,0]
    v_pk_mul_f32 v[38:39], v[38:39], v[22:23] op_sel_hi:[1,0]
    v_cvt_pk_bf16_f32 v40, v32, v33
    v_cvt_pk_bf16_f32 v41, v34, v35
    v_cvt_pk_bf16_f32 v42, v36, v37
    v_cvt_pk_bf16_f32 v43, v38, v39
    buffer_store_dwordx4 v[40:43], v29, s[52:55], s24 offen offset:2048 sc1
    v_accvgpr_read_b32 v48, a56
    v_accvgpr_read_b32 v49, a57
    v_accvgpr_read_b32 v50, a58
    v_accvgpr_read_b32 v51, a59
    v_accvgpr_read_b32 v52, a60
    v_accvgpr_read_b32 v53, a61
    v_accvgpr_read_b32 v54, a62
    v_accvgpr_read_b32 v55, a63
    v_pk_mul_f32 v[48:49], v[48:49], v[22:23] op_sel_hi:[1,0]
    v_pk_mul_f32 v[50:51], v[50:51], v[22:23] op_sel_hi:[1,0]
    v_pk_mul_f32 v[52:53], v[52:53], v[22:23] op_sel_hi:[1,0]
    v_pk_mul_f32 v[54:55], v[54:55], v[22:23] op_sel_hi:[1,0]
    v_cvt_pk_bf16_f32 v56, v48, v49
    v_cvt_pk_bf16_f32 v57, v50, v51
    v_cvt_pk_bf16_f32 v58, v52, v53
    v_cvt_pk_bf16_f32 v59, v54, v55
    buffer_store_dwordx4 v[56:59], v29, s[52:55], s24 offen offset:3072 sc1
    s_waitcnt lgkmcnt(7)
    v_mfma_f32_16x16x32_bf16 v[128:131], a[192:195], a[160:163], v[232:235]
    v_exp_f32 v240, v72
    v_mfma_f32_16x16x32_bf16 v[144:147], a[192:195], a[176:179], v[236:239]
    ds_read_b128 a[236:239], v2 offset:27648
    v_exp_f32 v241, v73
    v_mfma_f32_16x16x32_bf16 v[128:131], a[196:199], a[164:167], v[128:131]
    v_exp_f32 v242, v74
    v_mfma_f32_16x16x32_bf16 v[144:147], a[196:199], a[180:183], v[144:147]
    ds_read_b128 a[240:243], v2 offset:28672
    v_exp_f32 v243, v75
    v_mfma_f32_16x16x32_bf16 v[128:131], a[200:203], a[168:171], v[128:131]
    s_add_u32 m0, s74, s30
    s_nop 0
    buffer_load_dwordx4 v29, s[48:51], s75 offen offset:0 sc1 lds
    v_mfma_f32_16x16x32_bf16 v[144:147], a[200:203], a[184:187], v[144:147]
    ds_read_b128 a[244:247], v2 offset:29696
    v_exp_f32 v244, v76
    v_cvt_pk_bf16_f32 v200, v240, v241
    v_mfma_f32_16x16x32_bf16 v[128:131], a[204:207], a[172:175], v[128:131]
    v_exp_f32 v245, v77
    v_mfma_f32_16x16x32_bf16 v[144:147], a[204:207], a[188:191], v[144:147]
    ds_read_b128 a[248:251], v2 offset:30720
    s_waitcnt lgkmcnt(7)
    v_exp_f32 v246, v78
    v_mfma_f32_16x16x32_bf16 v[132:135], a[208:211], a[160:163], v[232:235]
    v_cvt_pk_bf16_f32 v201, v242, v243
    v_mfma_f32_16x16x32_bf16 v[148:151], a[208:211], a[176:179], v[236:239]
    ds_read_b128 a[252:255], v2 offset:31744
    buffer_load_dwordx4 v29, s[48:51], s75 offen offset:1024 sc1 lds
    v_exp_f32 v247, v79
    v_mfma_f32_16x16x32_bf16 v[132:135], a[212:215], a[164:167], v[132:135]
    v_cvt_pk_bf16_f32 v202, v244, v245
    v_cvt_pk_bf16_f32 v203, v246, v247
    v_mfma_f32_16x16x32_bf16 v[148:151], a[212:215], a[180:183], v[148:151]
    ds_read_b128 a[192:195], v2 offset:0
    v_exp_f32 v240, v88
    v_mfma_f32_16x16x32_bf16 v[132:135], a[216:219], a[168:171], v[132:135]
    buffer_load_dwordx4 v29, s[48:51], s75 offen offset:2048 sc1 lds
    v_mfma_f32_16x16x32_bf16 v[248:251], v[208:211], v[200:203], v[248:251]
    v_exp_f32 v241, v89
    v_mfma_f32_16x16x32_bf16 v[148:151], a[216:219], a[184:187], v[148:151]
    ds_read_b128 a[196:199], v2 offset:2048
    buffer_load_dwordx4 v29, s[48:51], s75 offen offset:3072 sc1 lds
    v_mfma_f32_16x16x32_bf16 v[132:135], a[220:223], a[172:175], v[132:135]
    v_exp_f32 v242, v90
    v_mfma_f32_16x16x32_bf16 v[148:151], a[220:223], a[188:191], v[148:151]
    ds_read_b128 a[200:203], v2 offset:4096
    s_waitcnt lgkmcnt(7)
    v_mfma_f32_16x16x32_bf16 v[136:139], a[224:227], a[160:163], v[232:235]
    v_exp_f32 v243, v91
    v_mfma_f32_16x16x32_bf16 v[152:155], a[224:227], a[176:179], v[236:239]
    ds_read_b128 a[204:207], v2 offset:6144
    v_exp_f32 v244, v92
    v_mfma_f32_16x16x32_bf16 v[136:139], a[228:231], a[164:167], v[136:139]
    v_cvt_pk_bf16_f32 v204, v240, v241
    v_exp_f32 v245, v93
    v_mfma_f32_16x16x32_bf16 v[152:155], a[228:231], a[180:183], v[152:155]
    ds_read_b128 a[208:211], v2 offset:8192
    v_exp_f32 v246, v94
    v_mfma_f32_16x16x32_bf16 v[136:139], a[232:235], a[168:171], v[136:139]
    v_cvt_pk_bf16_f32 v205, v242, v243
    v_exp_f32 v247, v95
    v_mfma_f32_16x16x32_bf16 v[152:155], a[232:235], a[184:187], v[152:155]
    ds_read_b128 a[212:215], v2 offset:10240
    v_cvt_pk_bf16_f32 v206, v244, v245
    v_cvt_pk_bf16_f32 v207, v246, v247
    v_mfma_f32_16x16x32_bf16 v[136:139], a[236:239], a[172:175], v[136:139]
    v_mfma_f32_16x16x32_bf16 v[152:155], a[236:239], a[188:191], v[152:155]
    ds_read_b128 a[216:219], v2 offset:12288
    v_mfma_f32_16x16x32_bf16 v[252:255], v[208:211], v[204:207], v[252:255]
    s_waitcnt lgkmcnt(7)
    v_mfma_f32_16x16x32_bf16 v[140:143], a[240:243], a[160:163], v[232:235]
    v_mfma_f32_16x16x32_bf16 v[156:159], a[240:243], a[176:179], v[236:239]
    ds_read_b128 a[220:223], v2 offset:14336
    v_mfma_f32_16x16x32_bf16 v[140:143], a[244:247], a[164:167], v[140:143]
    v_mfma_f32_16x16x32_bf16 v[156:159], a[244:247], a[180:183], v[156:159]
    ds_read_b128 a[224:227], v2 offset:1024
    s_nop 0
    v_max_f32 v20, v248, v252
    v_mfma_f32_16x16x32_bf16 v[140:143], a[248:251], a[168:171], v[140:143]
    v_cmp_nge_f32 vcc, s77, v20
    v_mfma_f32_16x16x32_bf16 v[156:159], a[248:251], a[184:187], v[156:159]
    ds_read_b128 a[228:231], v2 offset:3072
    v_mfma_f32_16x16x32_bf16 v[140:143], a[252:255], a[172:175], v[140:143]
    v_mfma_f32_16x16x32_bf16 v[156:159], a[252:255], a[188:191], v[156:159]
    ds_read_b128 a[232:235], v2 offset:5120
    s_cbranch_vccnz f1_sse1_rare
f1_sse1_rare_r:
    s_cmp_eq_u32 s76, 1
    s_cbranch_scc1 f1_sse1_mask
f1_sse1_mask_r:
    s_waitcnt lgkmcnt(7)
    v_mfma_f32_16x16x32_bf16 a[64:67], a[192:195], v[168:171], a[64:67]
    v_add_f32 v15, v15, v248
    v_exp_f32 v240, v128
    v_mfma_f32_16x16x32_bf16 a[96:99], a[192:195], v[172:175], a[96:99]
    ds_read_b128 a[236:239], v2 offset:7168
    v_mfma_f32_16x16x32_bf16 a[68:71], a[196:199], v[168:171], a[68:71]
    v_add_f32 v30, v30, v252
    v_exp_f32 v241, v129
    v_mfma_f32_16x16x32_bf16 a[100:103], a[196:199], v[172:175], a[100:103]
    ds_read_b128 a[240:243], v2 offset:9216
    v_exp_f32 v242, v130
    v_mfma_f32_16x16x32_bf16 a[72:75], a[200:203], v[168:171], a[72:75]
    s_mov_b32 s74, s73
    s_mov_b32 s73, s72
    v_mfma_f32_16x16x32_bf16 a[104:107], a[200:203], v[172:175], a[104:107]
    ds_read_b128 a[244:247], v2 offset:11264
    v_exp_f32 v243, v131
    v_mfma_f32_16x16x32_bf16 a[76:79], a[204:207], v[168:171], a[76:79]
    s_add_u32 s72, s72, 0x8000
    v_exp_f32 v244, v132
    v_mfma_f32_16x16x32_bf16 a[108:111], a[204:207], v[172:175], a[108:111]
    ds_read_b128 a[248:251], v2 offset:13312
    s_waitcnt lgkmcnt(7)
    v_mfma_f32_16x16x32_bf16 a[80:83], a[208:211], v[168:171], a[80:83]
    s_cmp_eq_u32 s72, 0x28000
    s_cselect_b32 s72, 0, s72
    v_cvt_pk_bf16_f32 v184, v240, v241
    v_mfma_f32_16x16x32_bf16 a[112:115], a[208:211], v[172:175], a[112:115]
    ds_read_b128 a[252:255], v2 offset:15360
    s_waitcnt vmcnt(24)
    s_barrier
    v_add_u32 v2, s72, v29
    v_mfma_f32_16x16x32_bf16 a[84:87], a[212:215], v[168:171], a[84:87]
    v_exp_f32 v245, v133
    v_mfma_f32_16x16x32_bf16 a[116:119], a[212:215], v[172:175], a[116:119]
    ds_read_b128 a[192:195], v2 offset:16384
    s_add_u32 m0, s73, s28
    v_mfma_f32_16x16x32_bf16 a[88:91], a[216:219], v[168:171], a[88:91]
    v_exp_f32 v246, v134
    v_cvt_pk_bf16_f32 v185, v242, v243
    v_mfma_f32_16x16x32_bf16 a[120:123], a[216:219], v[172:175], a[120:123]
    ds_read_b128 a[196:199], v2 offset:17408
    v_exp_f32 v247, v135
    v_mfma_f32_16x16x32_bf16 a[92:95], a[220:223], v[168:171], a[92:95]
    v_cvt_pk_bf16_f32 v186, v244, v245
    v_cvt_pk_bf16_f32 v187, v246, v247
    v_mfma_f32_16x16x32_bf16 a[124:127], a[220:223], v[172:175], a[124:127]
    ds_read_b128 a[200:203], v2 offset:18432
    s_waitcnt lgkmcnt(7)
    v_mfma_f32_16x16x32_bf16 a[64:67], a[224:227], v[200:203], a[64:67]
    s_add_u32 s75, s75, 0x8000
    v_exp_f32 v240, v144
    v_mfma_f32_16x16x32_bf16 v[248:251], v[208:211], v[184:187], 0
    v_exp_f32 v241, v145
    v_mfma_f32_16x16x32_bf16 a[96:99], a[224:227], v[204:207], a[96:99]
    ds_read_b128 a[204:207], v2 offset:19456
    v_mfma_f32_16x16x32_bf16 a[68:71], a[228:231], v[200:203], a[68:71]
    buffer_load_dwordx4 v29, s[44:47], s75 offen offset:0 sc1 lds
    v_exp_f32 v242, v146
    v_mfma_f32_16x16x32_bf16 a[100:103], a[228:231], v[204:207], a[100:103]
    ds_read_b128 a[208:211], v2 offset:20480
    v_exp_f32 v243, v147
    v_mfma_f32_16x16x32_bf16 a[72:75], a[232:235], v[200:203], a[72:75]
    v_mfma_f32_16x16x32_bf16 a[104:107], a[232:235], v[204:207], a[104:107]
    ds_read_b128 a[212:215], v2 offset:21504
    v_exp_f32 v244, v148
    v_mfma_f32_16x16x32_bf16 a[76:79], a[236:239], v[200:203], a[76:79]
    buffer_load_dwordx4 v29, s[44:47], s75 offen offset:1024 sc1 lds
    v_cvt_pk_bf16_f32 v188, v240, v241
    v_mfma_f32_16x16x32_bf16 a[108:111], a[236:239], v[204:207], a[108:111]
    ds_read_b128 a[216:219], v2 offset:22528
    s_waitcnt lgkmcnt(7)
    v_mfma_f32_16x16x32_bf16 a[80:83], a[240:243], v[200:203], a[80:83]
    v_exp_f32 v245, v149
    v_mfma_f32_16x16x32_bf16 a[112:115], a[240:243], v[204:207], a[112:115]
    ds_read_b128 a[220:223], v2 offset:23552
    v_exp_f32 v246, v150
    v_mfma_f32_16x16x32_bf16 a[84:87], a[244:247], v[200:203], a[84:87]
    v_cvt_pk_bf16_f32 v189, v242, v243
    v_mfma_f32_16x16x32_bf16 a[116:119], a[244:247], v[204:207], a[116:119]
    ds_read_b128 a[224:227], v2 offset:24576
    buffer_load_dwordx4 v29, s[44:47], s75 offen offset:2048 sc1 lds
    v_mfma_f32_16x16x32_bf16 a[88:91], a[248:251], v[200:203], a[88:91]
    v_exp_f32 v247, v151
    v_cvt_pk_bf16_f32 v190, v244, v245
    v_mfma_f32_16x16x32_bf16 a[120:123], a[248:251], v[204:207], a[120:123]
    ds_read_b128 a[228:231], v2 offset:25600
    v_cvt_pk_bf16_f32 v191, v246, v247
    v_mfma_f32_16x16x32_bf16 a[92:95], a[252:255], v[200:203], a[92:95]
    v_mfma_f32_16x16x32_bf16 a[124:127], a[252:255], v[204:207], a[124:127]
    ds_read_b128 a[232:235], v2 offset:26624
    buffer_load_dwordx4 v29, s[44:47], s75 offen offset:3072 sc1 lds
    v_mfma_f32_16x16x32_bf16 v[252:255], v[208:211], v[188:191], 0
    s_cmp_lg_u32 s82, 0
    s_cbranch_scc1 f1_sg2b_x
    s_mov_b32 s82, 1
    s_cmp_lg_u32 s22, 0
    s_cbranch_scc1 f1_sg2b
    s_mov_b64 exec, 1
    v_mov_b32 v27, 1
    s_movk_i32 s23, 224
    buffer_atomic_add v27, off, s[56:59], s23 sc1
    s_mov_b64 exec, -1
f1_sg2b:
f1_sg2b_x:
    s_cmp_lg_u32 s22, 0
    s_cbranch_scc1 f1_w0_7
    s_waitcnt vmcnt(17)
    v_readfirstlane_b32 s25, v28
    s_nop 0
    s_lshr_b32 s25, s25, s15
    s_bfe_u32 s25, s25, 262148
    s_cmp_ge_u32 s25, 8
    s_cbranch_scc0 f1_pp
f1_pp_r:
f1_w0_7:
    s_sub_u32 s76, s76, 1
    s_cmp_eq_u32 s76, 0
    s_cbranch_scc0 f1_go1
    s_barrier
    s_lshl_b32 s25, s20, 3
    s_lshl_b32 s26, s22, 1
    s_add_u32 s25, s25, s26
    s_mul_i32 s25, s25, 3040
    s_add_u32 s26, s25, 3040
    buffer_load_dwordx4 v[96:99], v29, s[36:39], s25 offen offset:0 sc1
    buffer_load_dwordx4 v[100:103], v29, s[36:39], s25 offen offset:1024 sc1
    buffer_load_dwordx4 v[104:107], v12, s[36:39], s25 offen offset:2048 sc1
    buffer_load_dwordx4 v[108:111], v29, s[36:39], s26 offen offset:0 sc1
    buffer_load_dwordx4 v[112:115], v29, s[36:39], s26 offen offset:1024 sc1
    buffer_load_dwordx4 v[116:119], v12, s[36:39], s26 offen offset:2048 sc1
    buffer_load_dwordx4 v[224:227], v10, s[32:35], s66 offen
    buffer_load_dwordx4 v[228:231], v10, s[32:35], s66 offen offset:32
    buffer_load_dword v216, v11, s[32:35], s66 offen offset:64
    v_mov_b32 v217, 0
    v_mov_b32 v218, 0
    v_mov_b32 v219, 0
    buffer_load_dwordx4 v[220:223], v10, s[32:35], s67 offen
    buffer_load_dwordx4 v[120:123], v10, s[32:35], s67 offen offset:32
    buffer_load_dword v124, v11, s[32:35], s67 offen offset:64
    v_mov_b32 v125, 0
    v_mov_b32 v126, 0
    v_mov_b32 v127, 0
    s_branch f1_fin
f1_go1:
    s_waitcnt lgkmcnt(7)
    v_mfma_f32_16x16x32_bf16 v[64:67], a[192:195], a[160:163], v[232:235]
    v_exp_f32 v240, v136
    v_mfma_f32_16x16x32_bf16 v[80:83], a[192:195], a[176:179], v[236:239]
    ds_read_b128 a[236:239], v2 offset:27648
    v_exp_f32 v241, v137
    v_mfma_f32_16x16x32_bf16 v[64:67], a[196:199], a[164:167], v[64:67]
    v_exp_f32 v242, v138
    v_mfma_f32_16x16x32_bf16 v[80:83], a[196:199], a[180:183], v[80:83]
    ds_read_b128 a[240:243], v2 offset:28672
    v_exp_f32 v243, v139
    v_mfma_f32_16x16x32_bf16 v[64:67], a[200:203], a[168:171], v[64:67]
    s_add_u32 m0, s74, s30
    s_nop 0
    buffer_load_dwordx4 v29, s[48:51], s75 offen offset:0 sc1 lds
    v_mfma_f32_16x16x32_bf16 v[80:83], a[200:203], a[184:187], v[80:83]
    ds_read_b128 a[244:247], v2 offset:29696
    v_exp_f32 v244, v140
    v_cvt_pk_bf16_f32 v200, v240, v241
    v_mfma_f32_16x16x32_bf16 v[64:67], a[204:207], a[172:175], v[64:67]
    v_exp_f32 v245, v141
    v_mfma_f32_16x16x32_bf16 v[80:83], a[204:207], a[188:191], v[80:83]
    ds_read_b128 a[248:251], v2 offset:30720
    s_waitcnt lgkmcnt(7)
    v_exp_f32 v246, v142
    v_mfma_f32_16x16x32_bf16 v[68:71], a[208:211], a[160:163], v[232:235]
    v_cvt_pk_bf16_f32 v201, v242, v243
    v_mfma_f32_16x16x32_bf16 v[84:87], a[208:211], a[176:179], v[236:239]
    ds_read_b128 a[252:255], v2 offset:31744
    buffer_load_dwordx4 v29, s[48:51], s75 offen offset:1024 sc1 lds
    v_exp_f32 v247, v143
    v_mfma_f32_16x16x32_bf16 v[68:71], a[212:215], a[164:167], v[68:71]
    v_cvt_pk_bf16_f32 v202, v244, v245
    v_cvt_pk_bf16_f32 v203, v246, v247
    v_mfma_f32_16x16x32_bf16 v[84:87], a[212:215], a[180:183], v[84:87]
    ds_read_b128 a[192:195], v2 offset:0
    v_exp_f32 v240, v152
    v_mfma_f32_16x16x32_bf16 v[68:71], a[216:219], a[168:171], v[68:71]
    buffer_load_dwordx4 v29, s[48:51], s75 offen offset:2048 sc1 lds
    v_mfma_f32_16x16x32_bf16 v[248:251], v[208:211], v[200:203], v[248:251]
    v_exp_f32 v241, v153
    v_mfma_f32_16x16x32_bf16 v[84:87], a[216:219], a[184:187], v[84:87]
    ds_read_b128 a[196:199], v2 offset:2048
    buffer_load_dwordx4 v29, s[48:51], s75 offen offset:3072 sc1 lds
    v_mfma_f32_16x16x32_bf16 v[68:71], a[220:223], a[172:175], v[68:71]
    v_exp_f32 v242, v154
    v_mfma_f32_16x16x32_bf16 v[84:87], a[220:223], a[188:191], v[84:87]
    ds_read_b128 a[200:203], v2 offset:4096
    s_waitcnt lgkmcnt(7)
    v_mfma_f32_16x16x32_bf16 v[72:75], a[224:227], a[160:163], v[232:235]
    v_exp_f32 v243, v155
    v_mfma_f32_16x16x32_bf16 v[88:91], a[224:227], a[176:179], v[236:239]
    ds_read_b128 a[204:207], v2 offset:6144
    v_exp_f32 v244, v156
    v_mfma_f32_16x16x32_bf16 v[72:75], a[228:231], a[164:167], v[72:75]
    v_cvt_pk_bf16_f32 v204, v240, v241
    v_exp_f32 v245, v157
    v_mfma_f32_16x16x32_bf16 v[88:91], a[228:231], a[180:183], v[88:91]
    ds_read_b128 a[208:211], v2 offset:8192
    v_exp_f32 v246, v158
    v_mfma_f32_16x16x32_bf16 v[72:75], a[232:235], a[168:171], v[72:75]
    v_cvt_pk_bf16_f32 v205, v242, v243
    v_exp_f32 v247, v159
    v_mfma_f32_16x16x32_bf16 v[88:91], a[232:235], a[184:187], v[88:91]
    ds_read_b128 a[212:215], v2 offset:10240
    v_cvt_pk_bf16_f32 v206, v244, v245
    v_cvt_pk_bf16_f32 v207, v246, v247
    v_mfma_f32_16x16x32_bf16 v[72:75], a[236:239], a[172:175], v[72:75]
    v_mfma_f32_16x16x32_bf16 v[88:91], a[236:239], a[188:191], v[88:91]
    ds_read_b128 a[216:219], v2 offset:12288
    v_mfma_f32_16x16x32_bf16 v[252:255], v[208:211], v[204:207], v[252:255]
    s_waitcnt lgkmcnt(7)
    v_mfma_f32_16x16x32_bf16 v[76:79], a[240:243], a[160:163], v[232:235]
    v_mfma_f32_16x16x32_bf16 v[92:95], a[240:243], a[176:179], v[236:239]
    ds_read_b128 a[220:223], v2 offset:14336
    v_mfma_f32_16x16x32_bf16 v[76:79], a[244:247], a[164:167], v[76:79]
    v_mfma_f32_16x16x32_bf16 v[92:95], a[244:247], a[180:183], v[92:95]
    ds_read_b128 a[224:227], v2 offset:1024
    s_nop 0
    v_max_f32 v20, v248, v252
    v_mfma_f32_16x16x32_bf16 v[76:79], a[248:251], a[168:171], v[76:79]
    v_cmp_nge_f32 vcc, s77, v20
    v_mfma_f32_16x16x32_bf16 v[92:95], a[248:251], a[184:187], v[92:95]
    ds_read_b128 a[228:231], v2 offset:3072
    v_mfma_f32_16x16x32_bf16 v[76:79], a[252:255], a[172:175], v[76:79]
    v_mfma_f32_16x16x32_bf16 v[92:95], a[252:255], a[188:191], v[92:95]
    ds_read_b128 a[232:235], v2 offset:5120
    s_cbranch_vccnz f1_sso1_rare
f1_sso1_rare_r:
    s_waitcnt lgkmcnt(7)
    v_mfma_f32_16x16x32_bf16 a[64:67], a[192:195], v[184:187], a[64:67]
    v_add_f32 v15, v15, v248
    v_exp_f32 v240, v64
    v_mfma_f32_16x16x32_bf16 a[96:99], a[192:195], v[188:191], a[96:99]
    ds_read_b128 a[236:239], v2 offset:7168
    v_mfma_f32_16x16x32_bf16 a[68:71], a[196:199], v[184:187], a[68:71]
    v_add_f32 v30, v30, v252
    v_exp_f32 v241, v65
    v_mfma_f32_16x16x32_bf16 a[100:103], a[196:199], v[188:191], a[100:103]
    ds_read_b128 a[240:243], v2 offset:9216
    v_exp_f32 v242, v66
    v_mfma_f32_16x16x32_bf16 a[72:75], a[200:203], v[184:187], a[72:75]
    s_mov_b32 s74, s73
    s_mov_b32 s73, s72
    v_mfma_f32_16x16x32_bf16 a[104:107], a[200:203], v[188:191], a[104:107]
    ds_read_b128 a[244:247], v2 offset:11264
    v_exp_f32 v243, v67
    v_mfma_f32_16x16x32_bf16 a[76:79], a[204:207], v[184:187], a[76:79]
    s_add_u32 s72, s72, 0x8000
    v_exp_f32 v244, v68
    v_mfma_f32_16x16x32_bf16 a[108:111], a[204:207], v[188:191], a[108:111]
    ds_read_b128 a[248:251], v2 offset:13312
    s_waitcnt lgkmcnt(7)
    v_mfma_f32_16x16x32_bf16 a[80:83], a[208:211], v[184:187], a[80:83]
    s_cmp_eq_u32 s72, 0x28000
    s_cselect_b32 s72, 0, s72
    v_cvt_pk_bf16_f32 v168, v240, v241
    v_mfma_f32_16x16x32_bf16 a[112:115], a[208:211], v[188:191], a[112:115]
    ds_read_b128 a[252:255], v2 offset:15360
    s_waitcnt vmcnt(24)
    s_barrier
    v_add_u32 v2, s72, v29
    v_mfma_f32_16x16x32_bf16 a[84:87], a[212:215], v[184:187], a[84:87]
    v_exp_f32 v245, v69
    v_mfma_f32_16x16x32_bf16 a[116:119], a[212:215], v[188:191], a[116:119]
    ds_read_b128 a[192:195], v2 offset:16384
    s_add_u32 m0, s73, s28
    v_mfma_f32_16x16x32_bf16 a[88:91], a[216:219], v[184:187], a[88:91]
    v_exp_f32 v246, v70
    v_cvt_pk_bf16_f32 v169, v242, v243
    v_mfma_f32_16x16x32_bf16 a[120:123], a[216:219], v[188:191], a[120:123]
    ds_read_b128 a[196:199], v2 offset:17408
    v_exp_f32 v247, v71
    v_mfma_f32_16x16x32_bf16 a[92:95], a[220:223], v[184:187], a[92:95]
    v_cvt_pk_bf16_f32 v170, v244, v245
    v_cvt_pk_bf16_f32 v171, v246, v247
    v_mfma_f32_16x16x32_bf16 a[124:127], a[220:223], v[188:191], a[124:127]
    ds_read_b128 a[200:203], v2 offset:18432
    s_waitcnt lgkmcnt(7)
    v_mfma_f32_16x16x32_bf16 a[64:67], a[224:227], v[200:203], a[64:67]
    s_add_u32 s75, s75, 0x8000
    v_exp_f32 v240, v80
    v_mfma_f32_16x16x32_bf16 v[248:251], v[208:211], v[168:171], 0
    v_exp_f32 v241, v81
    v_mfma_f32_16x16x32_bf16 a[96:99], a[224:227], v[204:207], a[96:99]
    ds_read_b128 a[204:207], v2 offset:19456
    v_mfma_f32_16x16x32_bf16 a[68:71], a[228:231], v[200:203], a[68:71]
    buffer_load_dwordx4 v29, s[44:47], s75 offen offset:0 sc1 lds
    v_exp_f32 v242, v82
    v_mfma_f32_16x16x32_bf16 a[100:103], a[228:231], v[204:207], a[100:103]
    ds_read_b128 a[208:211], v2 offset:20480
    v_exp_f32 v243, v83
    v_mfma_f32_16x16x32_bf16 a[72:75], a[232:235], v[200:203], a[72:75]
    v_mfma_f32_16x16x32_bf16 a[104:107], a[232:235], v[204:207], a[104:107]
    ds_read_b128 a[212:215], v2 offset:21504
    v_exp_f32 v244, v84
    v_mfma_f32_16x16x32_bf16 a[76:79], a[236:239], v[200:203], a[76:79]
    buffer_load_dwordx4 v29, s[44:47], s75 offen offset:1024 sc1 lds
    v_cvt_pk_bf16_f32 v172, v240, v241
    v_mfma_f32_16x16x32_bf16 a[108:111], a[236:239], v[204:207], a[108:111]
    ds_read_b128 a[216:219], v2 offset:22528
    s_waitcnt lgkmcnt(7)
    v_mfma_f32_16x16x32_bf16 a[80:83], a[240:243], v[200:203], a[80:83]
    v_exp_f32 v245, v85
    v_mfma_f32_16x16x32_bf16 a[112:115], a[240:243], v[204:207], a[112:115]
    ds_read_b128 a[220:223], v2 offset:23552
    v_exp_f32 v246, v86
    v_mfma_f32_16x16x32_bf16 a[84:87], a[244:247], v[200:203], a[84:87]
    v_cvt_pk_bf16_f32 v173, v242, v243
    v_mfma_f32_16x16x32_bf16 a[116:119], a[244:247], v[204:207], a[116:119]
    ds_read_b128 a[224:227], v2 offset:24576
    buffer_load_dwordx4 v29, s[44:47], s75 offen offset:2048 sc1 lds
    v_mfma_f32_16x16x32_bf16 a[88:91], a[248:251], v[200:203], a[88:91]
    v_exp_f32 v247, v87
    v_cvt_pk_bf16_f32 v174, v244, v245
    v_mfma_f32_16x16x32_bf16 a[120:123], a[248:251], v[204:207], a[120:123]
    ds_read_b128 a[228:231], v2 offset:25600
    v_cvt_pk_bf16_f32 v175, v246, v247
    v_mfma_f32_16x16x32_bf16 a[92:95], a[252:255], v[200:203], a[92:95]
    v_mfma_f32_16x16x32_bf16 a[124:127], a[252:255], v[204:207], a[124:127]
    ds_read_b128 a[232:235], v2 offset:26624
    buffer_load_dwordx4 v29, s[44:47], s75 offen offset:3072 sc1 lds
    v_mfma_f32_16x16x32_bf16 v[252:255], v[208:211], v[172:175], 0
    s_lshl_b32 s25, s20, 3
    s_lshl_b32 s26, s22, 1
    s_add_u32 s25, s25, s26
    s_mul_i32 s25, s25, 3040
    s_add_u32 s26, s25, 3040
    buffer_load_dwordx4 v[96:99], v29, s[36:39], s25 offen offset:0 sc1
    buffer_load_dwordx4 v[100:103], v29, s[36:39], s25 offen offset:1024 sc1
    buffer_load_dwordx4 v[104:107], v12, s[36:39], s25 offen offset:2048 sc1
    buffer_load_dwordx4 v[108:111], v29, s[36:39], s26 offen offset:0 sc1
    buffer_load_dwordx4 v[112:115], v29, s[36:39], s26 offen offset:1024 sc1
    buffer_load_dwordx4 v[116:119], v12, s[36:39], s26 offen offset:2048 sc1
    buffer_load_dwordx4 v[224:227], v10, s[32:35], s66 offen
    buffer_load_dwordx4 v[228:231], v10, s[32:35], s66 offen offset:32
    buffer_load_dword v216, v11, s[32:35], s66 offen offset:64
    v_mov_b32 v217, 0
    v_mov_b32 v218, 0
    v_mov_b32 v219, 0
    buffer_load_dwordx4 v[220:223], v10, s[32:35], s67 offen
    buffer_load_dwordx4 v[120:123], v10, s[32:35], s67 offen offset:32
    buffer_load_dword v124, v11, s[32:35], s67 offen offset:64
    v_mov_b32 v125, 0
    v_mov_b32 v126, 0
    v_mov_b32 v127, 0
    s_sub_u32 s76, s76, 2
f1_single:
    s_waitcnt lgkmcnt(7)
    v_mfma_f32_16x16x32_bf16 v[128:131], a[192:195], a[160:163], v[232:235]
    v_exp_f32 v240, v72
    v_mfma_f32_16x16x32_bf16 v[144:147], a[192:195], a[176:179], v[236:239]
    ds_read_b128 a[236:239], v2 offset:27648
    v_exp_f32 v241, v73
    v_mfma_f32_16x16x32_bf16 v[128:131], a[196:199], a[164:167], v[128:131]
    v_exp_f32 v242, v74
    v_mfma_f32_16x16x32_bf16 v[144:147], a[196:199], a[180:183], v[144:147]
    ds_read_b128 a[240:243], v2 offset:28672
    v_exp_f32 v243, v75
    v_mfma_f32_16x16x32_bf16 v[128:131], a[200:203], a[168:171], v[128:131]
    s_add_u32 m0, s74, s30
    s_nop 0
    buffer_load_dwordx4 v29, s[48:51], s75 offen offset:0 sc1 lds
    v_mfma_f32_16x16x32_bf16 v[144:147], a[200:203], a[184:187], v[144:147]
    ds_read_b128 a[244:247], v2 offset:29696
    v_exp_f32 v244, v76
    v_cvt_pk_bf16_f32 v200, v240, v241
    v_mfma_f32_16x16x32_bf16 v[128:131], a[204:207], a[172:175], v[128:131]
    v_exp_f32 v245, v77
    v_mfma_f32_16x16x32_bf16 v[144:147], a[204:207], a[188:191], v[144:147]
    ds_read_b128 a[248:251], v2 offset:30720
    s_waitcnt lgkmcnt(7)
    v_exp_f32 v246, v78
    v_mfma_f32_16x16x32_bf16 v[132:135], a[208:211], a[160:163], v[232:235]
    v_cvt_pk_bf16_f32 v201, v242, v243
    v_mfma_f32_16x16x32_bf16 v[148:151], a[208:211], a[176:179], v[236:239]
    ds_read_b128 a[252:255], v2 offset:31744
    buffer_load_dwordx4 v29, s[48:51], s75 offen offset:1024 sc1 lds
    v_exp_f32 v247, v79
    v_mfma_f32_16x16x32_bf16 v[132:135], a[212:215], a[164:167], v[132:135]
    v_cvt_pk_bf16_f32 v202, v244, v245
    v_cvt_pk_bf16_f32 v203, v246, v247
    v_mfma_f32_16x16x32_bf16 v[148:151], a[212:215], a[180:183], v[148:151]
    ds_read_b128 a[192:195], v2 offset:0
    v_exp_f32 v240, v88
    v_mfma_f32_16x16x32_bf16 v[132:135], a[216:219], a[168:171], v[132:135]
    buffer_load_dwordx4 v29, s[48:51], s75 offen offset:2048 sc1 lds
    v_mfma_f32_16x16x32_bf16 v[248:251], v[208:211], v[200:203], v[248:251]
    v_exp_f32 v241, v89
    v_mfma_f32_16x16x32_bf16 v[148:151], a[216:219], a[184:187], v[148:151]
    ds_read_b128 a[196:199], v2 offset:2048
    buffer_load_dwordx4 v29, s[48:51], s75 offen offset:3072 sc1 lds
    v_mfma_f32_16x16x32_bf16 v[132:135], a[220:223], a[172:175], v[132:135]
    v_exp_f32 v242, v90
    v_mfma_f32_16x16x32_bf16 v[148:151], a[220:223], a[188:191], v[148:151]
    ds_read_b128 a[200:203], v2 offset:4096
    s_waitcnt lgkmcnt(7)
    v_mfma_f32_16x16x32_bf16 v[136:139], a[224:227], a[160:163], v[232:235]
    v_exp_f32 v243, v91
    v_mfma_f32_16x16x32_bf16 v[152:155], a[224:227], a[176:179], v[236:239]
    ds_read_b128 a[204:207], v2 offset:6144
    v_exp_f32 v244, v92
    v_mfma_f32_16x16x32_bf16 v[136:139], a[228:231], a[164:167], v[136:139]
    v_cvt_pk_bf16_f32 v204, v240, v241
    v_exp_f32 v245, v93
    v_mfma_f32_16x16x32_bf16 v[152:155], a[228:231], a[180:183], v[152:155]
    ds_read_b128 a[208:211], v2 offset:8192
    v_exp_f32 v246, v94
    v_mfma_f32_16x16x32_bf16 v[136:139], a[232:235], a[168:171], v[136:139]
    v_cvt_pk_bf16_f32 v205, v242, v243
    v_exp_f32 v247, v95
    v_mfma_f32_16x16x32_bf16 v[152:155], a[232:235], a[184:187], v[152:155]
    ds_read_b128 a[212:215], v2 offset:10240
    v_cvt_pk_bf16_f32 v206, v244, v245
    v_cvt_pk_bf16_f32 v207, v246, v247
    v_mfma_f32_16x16x32_bf16 v[136:139], a[236:239], a[172:175], v[136:139]
    v_mfma_f32_16x16x32_bf16 v[152:155], a[236:239], a[188:191], v[152:155]
    ds_read_b128 a[216:219], v2 offset:12288
    v_mfma_f32_16x16x32_bf16 v[252:255], v[208:211], v[204:207], v[252:255]
    s_waitcnt lgkmcnt(7)
    v_mfma_f32_16x16x32_bf16 v[140:143], a[240:243], a[160:163], v[232:235]
    v_mfma_f32_16x16x32_bf16 v[156:159], a[240:243], a[176:179], v[236:239]
    ds_read_b128 a[220:223], v2 offset:14336
    v_mfma_f32_16x16x32_bf16 v[140:143], a[244:247], a[164:167], v[140:143]
    v_mfma_f32_16x16x32_bf16 v[156:159], a[244:247], a[180:183], v[156:159]
    ds_read_b128 a[224:227], v2 offset:1024
    s_nop 0
    v_max_f32 v20, v248, v252
    v_mfma_f32_16x16x32_bf16 v[140:143], a[248:251], a[168:171], v[140:143]
    v_cmp_nge_f32 vcc, s77, v20
    v_mfma_f32_16x16x32_bf16 v[156:159], a[248:251], a[184:187], v[156:159]
    ds_read_b128 a[228:231], v2 offset:3072
    v_mfma_f32_16x16x32_bf16 v[140:143], a[252:255], a[172:175], v[140:143]
    v_mfma_f32_16x16x32_bf16 v[156:159], a[252:255], a[188:191], v[156:159]
    ds_read_b128 a[232:235], v2 offset:5120
    s_cbranch_vccnz f1_sse_rare
f1_sse_rare_r:
    s_waitcnt lgkmcnt(7)
    v_mfma_f32_16x16x32_bf16 a[64:67], a[192:195], v[168:171], a[64:67]
    v_add_f32 v15, v15, v248
    v_exp_f32 v240, v128
    v_mfma_f32_16x16x32_bf16 a[96:99], a[192:195], v[172:175], a[96:99]
    ds_read_b128 a[236:239], v2 offset:7168
    v_mfma_f32_16x16x32_bf16 a[68:71], a[196:199], v[168:171], a[68:71]
    v_add_f32 v30, v30, v252
    v_exp_f32 v241, v129
    v_mfma_f32_16x16x32_bf16 a[100:103], a[196:199], v[172:175], a[100:103]
    ds_read_b128 a[240:243], v2 offset:9216
    v_exp_f32 v242, v130
    v_mfma_f32_16x16x32_bf16 a[72:75], a[200:203], v[168:171], a[72:75]
    s_mov_b32 s74, s73
    s_mov_b32 s73, s72
    v_mfma_f32_16x16x32_bf16 a[104:107], a[200:203], v[172:175], a[104:107]
    ds_read_b128 a[244:247], v2 offset:11264
    v_exp_f32 v243, v131
    v_mfma_f32_16x16x32_bf16 a[76:79], a[204:207], v[168:171], a[76:79]
    s_add_u32 s72, s72, 0x8000
    v_exp_f32 v244, v132
    v_mfma_f32_16x16x32_bf16 a[108:111], a[204:207], v[172:175], a[108:111]
    ds_read_b128 a[248:251], v2 offset:13312
    s_waitcnt lgkmcnt(7)
    v_mfma_f32_16x16x32_bf16 a[80:83], a[208:211], v[168:171], a[80:83]
    s_cmp_eq_u32 s72, 0x28000
    s_cselect_b32 s72, 0, s72
    v_cvt_pk_bf16_f32 v184, v240, v241
    v_mfma_f32_16x16x32_bf16 a[112:115], a[208:211], v[172:175], a[112:115]
    ds_read_b128 a[252:255], v2 offset:15360
    s_waitcnt vmcnt(16)
    s_barrier
    v_add_u32 v2, s72, v29
    v_mfma_f32_16x16x32_bf16 a[84:87], a[212:215], v[168:171], a[84:87]
    v_exp_f32 v245, v133
    v_mfma_f32_16x16x32_bf16 a[116:119], a[212:215], v[172:175], a[116:119]
    ds_read_b128 a[192:195], v2 offset:16384
    s_add_u32 m0, s73, s28
    v_mfma_f32_16x16x32_bf16 a[88:91], a[216:219], v[168:171], a[88:91]
    v_exp_f32 v246, v134
    v_cvt_pk_bf16_f32 v185, v242, v243
    v_mfma_f32_16x16x32_bf16 a[120:123], a[216:219], v[172:175], a[120:123]
    ds_read_b128 a[196:199], v2 offset:17408
    v_exp_f32 v247, v135
    v_mfma_f32_16x16x32_bf16 a[92:95], a[220:223], v[168:171], a[92:95]
    v_cvt_pk_bf16_f32 v186, v244, v245
    v_cvt_pk_bf16_f32 v187, v246, v247
    v_mfma_f32_16x16x32_bf16 a[124:127], a[220:223], v[172:175], a[124:127]
    ds_read_b128 a[200:203], v2 offset:18432
    s_waitcnt lgkmcnt(7)
    v_mfma_f32_16x16x32_bf16 a[64:67], a[224:227], v[200:203], a[64:67]
    s_add_u32 s75, s75, 0x8000
    v_exp_f32 v240, v144
    v_mfma_f32_16x16x32_bf16 v[248:251], v[208:211], v[184:187], 0
    v_exp_f32 v241, v145
    v_mfma_f32_16x16x32_bf16 a[96:99], a[224:227], v[204:207], a[96:99]
    ds_read_b128 a[204:207], v2 offset:19456
    v_mfma_f32_16x16x32_bf16 a[68:71], a[228:231], v[200:203], a[68:71]
    buffer_load_dwordx4 v29, s[44:47], s75 offen offset:0 sc1 lds
    v_exp_f32 v242, v146
    v_mfma_f32_16x16x32_bf16 a[100:103], a[228:231], v[204:207], a[100:103]
    ds_read_b128 a[208:211], v2 offset:20480
    v_exp_f32 v243, v147
    v_mfma_f32_16x16x32_bf16 a[72:75], a[232:235], v[200:203], a[72:75]
    v_mfma_f32_16x16x32_bf16 a[104:107], a[232:235], v[204:207], a[104:107]
    ds_read_b128 a[212:215], v2 offset:21504
    v_exp_f32 v244, v148
    v_mfma_f32_16x16x32_bf16 a[76:79], a[236:239], v[200:203], a[76:79]
    buffer_load_dwordx4 v29, s[44:47], s75 offen offset:1024 sc1 lds
    v_cvt_pk_bf16_f32 v188, v240, v241
    v_mfma_f32_16x16x32_bf16 a[108:111], a[236:239], v[204:207], a[108:111]
    ds_read_b128 a[216:219], v2 offset:22528
    s_waitcnt lgkmcnt(7)
    v_mfma_f32_16x16x32_bf16 a[80:83], a[240:243], v[200:203], a[80:83]
    v_exp_f32 v245, v149
    v_mfma_f32_16x16x32_bf16 a[112:115], a[240:243], v[204:207], a[112:115]
    ds_read_b128 a[220:223], v2 offset:23552
    v_exp_f32 v246, v150
    v_mfma_f32_16x16x32_bf16 a[84:87], a[244:247], v[200:203], a[84:87]
    v_cvt_pk_bf16_f32 v189, v242, v243
    v_mfma_f32_16x16x32_bf16 a[116:119], a[244:247], v[204:207], a[116:119]
    ds_read_b128 a[224:227], v2 offset:24576
    buffer_load_dwordx4 v29, s[44:47], s75 offen offset:2048 sc1 lds
    v_mfma_f32_16x16x32_bf16 a[88:91], a[248:251], v[200:203], a[88:91]
    v_exp_f32 v247, v151
    v_cvt_pk_bf16_f32 v190, v244, v245
    v_mfma_f32_16x16x32_bf16 a[120:123], a[248:251], v[204:207], a[120:123]
    ds_read_b128 a[228:231], v2 offset:25600
    v_cvt_pk_bf16_f32 v191, v246, v247
    v_mfma_f32_16x16x32_bf16 a[92:95], a[252:255], v[200:203], a[92:95]
    v_mfma_f32_16x16x32_bf16 a[124:127], a[252:255], v[204:207], a[124:127]
    ds_read_b128 a[232:235], v2 offset:26624
    buffer_load_dwordx4 v29, s[44:47], s75 offen offset:3072 sc1 lds
    v_mfma_f32_16x16x32_bf16 v[252:255], v[208:211], v[188:191], 0
    s_sub_u32 s76, s76, 1
    s_cbranch_scc1 f1_lastp
    s_waitcnt lgkmcnt(7)
    v_mfma_f32_16x16x32_bf16 v[64:67], a[192:195], a[160:163], v[232:235]
    v_exp_f32 v240, v136
    v_mfma_f32_16x16x32_bf16 v[80:83], a[192:195], a[176:179], v[236:239]
    ds_read_b128 a[236:239], v2 offset:27648
    v_exp_f32 v241, v137
    v_mfma_f32_16x16x32_bf16 v[64:67], a[196:199], a[164:167], v[64:67]
    v_exp_f32 v242, v138
    v_mfma_f32_16x16x32_bf16 v[80:83], a[196:199], a[180:183], v[80:83]
    ds_read_b128 a[240:243], v2 offset:28672
    v_exp_f32 v243, v139
    v_mfma_f32_16x16x32_bf16 v[64:67], a[200:203], a[168:171], v[64:67]
    s_add_u32 m0, s74, s30
    s_nop 0
    buffer_load_dwordx4 v29, s[48:51], s75 offen offset:0 sc1 lds
    v_mfma_f32_16x16x32_bf16 v[80:83], a[200:203], a[184:187], v[80:83]
    ds_read_b128 a[244:247], v2 offset:29696
    v_exp_f32 v244, v140
    v_cvt_pk_bf16_f32 v200, v240, v241
    v_mfma_f32_16x16x32_bf16 v[64:67], a[204:207], a[172:175], v[64:67]
    v_exp_f32 v245, v141
    v_mfma_f32_16x16x32_bf16 v[80:83], a[204:207], a[188:191], v[80:83]
    ds_read_b128 a[248:251], v2 offset:30720
    s_waitcnt lgkmcnt(7)
    v_exp_f32 v246, v142
    v_mfma_f32_16x16x32_bf16 v[68:71], a[208:211], a[160:163], v[232:235]
    v_cvt_pk_bf16_f32 v201, v242, v243
    v_mfma_f32_16x16x32_bf16 v[84:87], a[208:211], a[176:179], v[236:239]
    ds_read_b128 a[252:255], v2 offset:31744
    buffer_load_dwordx4 v29, s[48:51], s75 offen offset:1024 sc1 lds
    v_exp_f32 v247, v143
    v_mfma_f32_16x16x32_bf16 v[68:71], a[212:215], a[164:167], v[68:71]
    v_cvt_pk_bf16_f32 v202, v244, v245
    v_cvt_pk_bf16_f32 v203, v246, v247
    v_mfma_f32_16x16x32_bf16 v[84:87], a[212:215], a[180:183], v[84:87]
    ds_read_b128 a[192:195], v2 offset:0
    v_exp_f32 v240, v152
    v_mfma_f32_16x16x32_bf16 v[68:71], a[216:219], a[168:171], v[68:71]
    buffer_load_dwordx4 v29, s[48:51], s75 offen offset:2048 sc1 lds
    v_mfma_f32_16x16x32_bf16 v[248:251], v[208:211], v[200:203], v[248:251]
    v_exp_f32 v241, v153
    v_mfma_f32_16x16x32_bf16 v[84:87], a[216:219], a[184:187], v[84:87]
    ds_read_b128 a[196:199], v2 offset:2048
    buffer_load_dwordx4 v29, s[48:51], s75 offen offset:3072 sc1 lds
    v_mfma_f32_16x16x32_bf16 v[68:71], a[220:223], a[172:175], v[68:71]
    v_exp_f32 v242, v154
    v_mfma_f32_16x16x32_bf16 v[84:87], a[220:223], a[188:191], v[84:87]
    ds_read_b128 a[200:203], v2 offset:4096
    s_waitcnt lgkmcnt(7)
    v_mfma_f32_16x16x32_bf16 v[72:75], a[224:227], a[160:163], v[232:235]
    v_exp_f32 v243, v155
    v_mfma_f32_16x16x32_bf16 v[88:91], a[224:227], a[176:179], v[236:239]
    ds_read_b128 a[204:207], v2 offset:6144
    v_exp_f32 v244, v156
    v_mfma_f32_16x16x32_bf16 v[72:75], a[228:231], a[164:167], v[72:75]
    v_cvt_pk_bf16_f32 v204, v240, v241
    v_exp_f32 v245, v157
    v_mfma_f32_16x16x32_bf16 v[88:91], a[228:231], a[180:183], v[88:91]
    ds_read_b128 a[208:211], v2 offset:8192
    v_exp_f32 v246, v158
    v_mfma_f32_16x16x32_bf16 v[72:75], a[232:235], a[168:171], v[72:75]
    v_cvt_pk_bf16_f32 v205, v242, v243
    v_exp_f32 v247, v159
    v_mfma_f32_16x16x32_bf16 v[88:91], a[232:235], a[184:187], v[88:91]
    ds_read_b128 a[212:215], v2 offset:10240
    v_cvt_pk_bf16_f32 v206, v244, v245
    v_cvt_pk_bf16_f32 v207, v246, v247
    v_mfma_f32_16x16x32_bf16 v[72:75], a[236:239], a[172:175], v[72:75]
    v_mfma_f32_16x16x32_bf16 v[88:91], a[236:239], a[188:191], v[88:91]
    ds_read_b128 a[216:219], v2 offset:12288
    v_mfma_f32_16x16x32_bf16 v[252:255], v[208:211], v[204:207], v[252:255]
    s_waitcnt lgkmcnt(7)
    v_mfma_f32_16x16x32_bf16 v[76:79], a[240:243], a[160:163], v[232:235]
    v_mfma_f32_16x16x32_bf16 v[92:95], a[240:243], a[176:179], v[236:239]
    ds_read_b128 a[220:223], v2 offset:14336
    v_mfma_f32_16x16x32_bf16 v[76:79], a[244:247], a[164:167], v[76:79]
    v_mfma_f32_16x16x32_bf16 v[92:95], a[244:247], a[180:183], v[92:95]
    ds_read_b128 a[224:227], v2 offset:1024
    s_nop 0
    v_max_f32 v20, v248, v252
    v_mfma_f32_16x16x32_bf16 v[76:79], a[248:251], a[168:171], v[76:79]
    v_cmp_nge_f32 vcc, s77, v20
    v_mfma_f32_16x16x32_bf16 v[92:95], a[248:251], a[184:187], v[92:95]
    ds_read_b128 a[228:231], v2 offset:3072
    v_mfma_f32_16x16x32_bf16 v[76:79], a[252:255], a[172:175], v[76:79]
    v_mfma_f32_16x16x32_bf16 v[92:95], a[252:255], a[188:191], v[92:95]
    ds_read_b128 a[232:235], v2 offset:5120
    s_cbranch_vccnz f1_sso_rare
f1_sso_rare_r:
    s_waitcnt lgkmcnt(7)
    v_mfma_f32_16x16x32_bf16 a[64:67], a[192:195], v[184:187], a[64:67]
    v_add_f32 v15, v15, v248
    v_exp_f32 v240, v64
    v_mfma_f32_16x16x32_bf16 a[96:99], a[192:195], v[188:191], a[96:99]
    ds_read_b128 a[236:239], v2 offset:7168
    v_mfma_f32_16x16x32_bf16 a[68:71], a[196:199], v[184:187], a[68:71]
    v_add_f32 v30, v30, v252
    v_exp_f32 v241, v65
    v_mfma_f32_16x16x32_bf16 a[100:103], a[196:199], v[188:191], a[100:103]
    ds_read_b128 a[240:243], v2 offset:9216
    v_exp_f32 v242, v66
    v_mfma_f32_16x16x32_bf16 a[72:75], a[200:203], v[184:187], a[72:75]
    s_mov_b32 s74, s73
    s_mov_b32 s73, s72
    v_mfma_f32_16x16x32_bf16 a[104:107], a[200:203], v[188:191], a[104:107]
    ds_read_b128 a[244:247], v2 offset:11264
    v_exp_f32 v243, v67
    v_mfma_f32_16x16x32_bf16 a[76:79], a[204:207], v[184:187], a[76:79]
    s_add_u32 s72, s72, 0x8000
    v_exp_f32 v244, v68
    v_mfma_f32_16x16x32_bf16 a[108:111], a[204:207], v[188:191], a[108:111]
    ds_read_b128 a[248:251], v2 offset:13312
    s_waitcnt lgkmcnt(7)
    v_mfma_f32_16x16x32_bf16 a[80:83], a[208:211], v[184:187], a[80:83]
    s_cmp_eq_u32 s72, 0x28000
    s_cselect_b32 s72, 0, s72
    v_cvt_pk_bf16_f32 v168, v240, v241
    v_mfma_f32_16x16x32_bf16 a[112:115], a[208:211], v[188:191], a[112:115]
    ds_read_b128 a[252:255], v2 offset:15360
    s_waitcnt vmcnt(16)
    s_barrier
    v_add_u32 v2, s72, v29
    v_mfma_f32_16x16x32_bf16 a[84:87], a[212:215], v[184:187], a[84:87]
    v_exp_f32 v245, v69
    v_mfma_f32_16x16x32_bf16 a[116:119], a[212:215], v[188:191], a[116:119]
    ds_read_b128 a[192:195], v2 offset:16384
    s_add_u32 m0, s73, s28
    v_mfma_f32_16x16x32_bf16 a[88:91], a[216:219], v[184:187], a[88:91]
    v_exp_f32 v246, v70
    v_cvt_pk_bf16_f32 v169, v242, v243
    v_mfma_f32_16x16x32_bf16 a[120:123], a[216:219], v[188:191], a[120:123]
    ds_read_b128 a[196:199], v2 offset:17408
    v_exp_f32 v247, v71
    v_mfma_f32_16x16x32_bf16 a[92:95], a[220:223], v[184:187], a[92:95]
    v_cvt_pk_bf16_f32 v170, v244, v245
    v_cvt_pk_bf16_f32 v171, v246, v247
    v_mfma_f32_16x16x32_bf16 a[124:127], a[220:223], v[188:191], a[124:127]
    ds_read_b128 a[200:203], v2 offset:18432
    s_waitcnt lgkmcnt(7)
    v_mfma_f32_16x16x32_bf16 a[64:67], a[224:227], v[200:203], a[64:67]
    s_add_u32 s75, s75, 0x8000
    v_exp_f32 v240, v80
    v_mfma_f32_16x16x32_bf16 v[248:251], v[208:211], v[168:171], 0
    v_exp_f32 v241, v81
    v_mfma_f32_16x16x32_bf16 a[96:99], a[224:227], v[204:207], a[96:99]
    ds_read_b128 a[204:207], v2 offset:19456
    v_mfma_f32_16x16x32_bf16 a[68:71], a[228:231], v[200:203], a[68:71]
    buffer_load_dwordx4 v29, s[44:47], s75 offen offset:0 sc1 lds
    v_exp_f32 v242, v82
    v_mfma_f32_16x16x32_bf16 a[100:103], a[228:231], v[204:207], a[100:103]
    ds_read_b128 a[208:211], v2 offset:20480
    v_exp_f32 v243, v83
    v_mfma_f32_16x16x32_bf16 a[72:75], a[232:235], v[200:203], a[72:75]
    v_mfma_f32_16x16x32_bf16 a[104:107], a[232:235], v[204:207], a[104:107]
    ds_read_b128 a[212:215], v2 offset:21504
    v_exp_f32 v244, v84
    v_mfma_f32_16x16x32_bf16 a[76:79], a[236:239], v[200:203], a[76:79]
    buffer_load_dwordx4 v29, s[44:47], s75 offen offset:1024 sc1 lds
    v_cvt_pk_bf16_f32 v172, v240, v241
    v_mfma_f32_16x16x32_bf16 a[108:111], a[236:239], v[204:207], a[108:111]
    ds_read_b128 a[216:219], v2 offset:22528
    s_waitcnt lgkmcnt(7)
    v_mfma_f32_16x16x32_bf16 a[80:83], a[240:243], v[200:203], a[80:83]
    v_exp_f32 v245, v85
    v_mfma_f32_16x16x32_bf16 a[112:115], a[240:243], v[204:207], a[112:115]
    ds_read_b128 a[220:223], v2 offset:23552
    v_exp_f32 v246, v86
    v_mfma_f32_16x16x32_bf16 a[84:87], a[244:247], v[200:203], a[84:87]
    v_cvt_pk_bf16_f32 v173, v242, v243
    v_mfma_f32_16x16x32_bf16 a[116:119], a[244:247], v[204:207], a[116:119]
    ds_read_b128 a[224:227], v2 offset:24576
    buffer_load_dwordx4 v29, s[44:47], s75 offen offset:2048 sc1 lds
    v_mfma_f32_16x16x32_bf16 a[88:91], a[248:251], v[200:203], a[88:91]
    v_exp_f32 v247, v87
    v_cvt_pk_bf16_f32 v174, v244, v245
    v_mfma_f32_16x16x32_bf16 a[120:123], a[248:251], v[204:207], a[120:123]
    ds_read_b128 a[228:231], v2 offset:25600
    v_cvt_pk_bf16_f32 v175, v246, v247
    v_mfma_f32_16x16x32_bf16 a[92:95], a[252:255], v[200:203], a[92:95]
    v_mfma_f32_16x16x32_bf16 a[124:127], a[252:255], v[204:207], a[124:127]
    ds_read_b128 a[232:235], v2 offset:26624
    buffer_load_dwordx4 v29, s[44:47], s75 offen offset:3072 sc1 lds
    v_mfma_f32_16x16x32_bf16 v[252:255], v[208:211], v[172:175], 0
    s_branch f1_single
f1_lastp:
    s_waitcnt lgkmcnt(7)
    v_mfma_f32_16x16x32_bf16 v[64:67], a[192:195], a[160:163], v[232:235]
    v_exp_f32 v240, v136
    v_mfma_f32_16x16x32_bf16 v[80:83], a[192:195], a[176:179], v[236:239]
    ds_read_b128 a[236:239], v2 offset:27648
    v_exp_f32 v241, v137
    v_mfma_f32_16x16x32_bf16 v[64:67], a[196:199], a[164:167], v[64:67]
    v_exp_f32 v242, v138
    v_mfma_f32_16x16x32_bf16 v[80:83], a[196:199], a[180:183], v[80:83]
    ds_read_b128 a[240:243], v2 offset:28672
    v_exp_f32 v243, v139
    v_mfma_f32_16x16x32_bf16 v[64:67], a[200:203], a[168:171], v[64:67]
    s_add_u32 m0, s74, s30
    s_nop 0
    buffer_load_dwordx4 v29, s[48:51], s75 offen offset:0 sc1 lds
    v_mfma_f32_16x16x32_bf16 v[80:83], a[200:203], a[184:187], v[80:83]
    ds_read_b128 a[244:247], v2 offset:29696
    v_exp_f32 v244, v140
    v_cvt_pk_bf16_f32 v200, v240, v241
    v_mfma_f32_16x16x32_bf16 v[64:67], a[204:207], a[172:175], v[64:67]
    v_exp_f32 v245, v141
    v_mfma_f32_16x16x32_bf16 v[80:83], a[204:207], a[188:191], v[80:83]
    ds_read_b128 a[248:251], v2 offset:30720
    s_waitcnt lgkmcnt(7)
    v_exp_f32 v246, v142
    v_mfma_f32_16x16x32_bf16 v[68:71], a[208:211], a[160:163], v[232:235]
    v_cvt_pk_bf16_f32 v201, v242, v243
    v_mfma_f32_16x16x32_bf16 v[84:87], a[208:211], a[176:179], v[236:239]
    ds_read_b128 a[252:255], v2 offset:31744
    buffer_load_dwordx4 v29, s[48:51], s75 offen offset:1024 sc1 lds
    v_exp_f32 v247, v143
    v_mfma_f32_16x16x32_bf16 v[68:71], a[212:215], a[164:167], v[68:71]
    v_cvt_pk_bf16_f32 v202, v244, v245
    v_cvt_pk_bf16_f32 v203, v246, v247
    v_mfma_f32_16x16x32_bf16 v[84:87], a[212:215], a[180:183], v[84:87]
    ds_read_b128 a[192:195], v2 offset:0
    v_exp_f32 v240, v152
    v_mfma_f32_16x16x32_bf16 v[68:71], a[216:219], a[168:171], v[68:71]
    buffer_load_dwordx4 v29, s[48:51], s75 offen offset:2048 sc1 lds
    v_mfma_f32_16x16x32_bf16 v[248:251], v[208:211], v[200:203], v[248:251]
    v_exp_f32 v241, v153
    v_mfma_f32_16x16x32_bf16 v[84:87], a[216:219], a[184:187], v[84:87]
    ds_read_b128 a[196:199], v2 offset:2048
    buffer_load_dwordx4 v29, s[48:51], s75 offen offset:3072 sc1 lds
    v_mfma_f32_16x16x32_bf16 v[68:71], a[220:223], a[172:175], v[68:71]
    v_exp_f32 v242, v154
    v_mfma_f32_16x16x32_bf16 v[84:87], a[220:223], a[188:191], v[84:87]
    ds_read_b128 a[200:203], v2 offset:4096
    s_waitcnt lgkmcnt(7)
    v_mfma_f32_16x16x32_bf16 v[72:75], a[224:227], a[160:163], v[232:235]
    v_exp_f32 v243, v155
    v_mfma_f32_16x16x32_bf16 v[88:91], a[224:227], a[176:179], v[236:239]
    ds_read_b128 a[204:207], v2 offset:6144
    v_exp_f32 v244, v156
    v_mfma_f32_16x16x32_bf16 v[72:75], a[228:231], a[164:167], v[72:75]
    v_cvt_pk_bf16_f32 v204, v240, v241
    v_exp_f32 v245, v157
    v_mfma_f32_16x16x32_bf16 v[88:91], a[228:231], a[180:183], v[88:91]
    ds_read_b128 a[208:211], v2 offset:8192
    v_exp_f32 v246, v158
    v_mfma_f32_16x16x32_bf16 v[72:75], a[232:235], a[168:171], v[72:75]
    v_cvt_pk_bf16_f32 v205, v242, v243
    v_exp_f32 v247, v159
    v_mfma_f32_16x16x32_bf16 v[88:91], a[232:235], a[184:187], v[88:91]
    ds_read_b128 a[212:215], v2 offset:10240
    v_cvt_pk_bf16_f32 v206, v244, v245
    v_cvt_pk_bf16_f32 v207, v246, v247
    v_mfma_f32_16x16x32_bf16 v[72:75], a[236:239], a[172:175], v[72:75]
    v_mfma_f32_16x16x32_bf16 v[88:91], a[236:239], a[188:191], v[88:91]
    ds_read_b128 a[216:219], v2 offset:12288
    v_mfma_f32_16x16x32_bf16 v[252:255], v[208:211], v[204:207], v[252:255]
    s_waitcnt lgkmcnt(7)
    v_mfma_f32_16x16x32_bf16 v[76:79], a[240:243], a[160:163], v[232:235]
    v_mfma_f32_16x16x32_bf16 v[92:95], a[240:243], a[176:179], v[236:239]
    ds_read_b128 a[220:223], v2 offset:14336
    v_mfma_f32_16x16x32_bf16 v[76:79], a[244:247], a[164:167], v[76:79]
    v_mfma_f32_16x16x32_bf16 v[92:95], a[244:247], a[180:183], v[92:95]
    ds_read_b128 a[224:227], v2 offset:1024
    s_nop 0
    v_max_f32 v20, v248, v252
    v_mfma_f32_16x16x32_bf16 v[76:79], a[248:251], a[168:171], v[76:79]
    v_cmp_nge_f32 vcc, s77, v20
    v_mfma_f32_16x16x32_bf16 v[92:95], a[248:251], a[184:187], v[92:95]
    ds_read_b128 a[228:231], v2 offset:3072
    v_mfma_f32_16x16x32_bf16 v[76:79], a[252:255], a[172:175], v[76:79]
    v_mfma_f32_16x16x32_bf16 v[92:95], a[252:255], a[188:191], v[92:95]
    ds_read_b128 a[232:235], v2 offset:5120
    s_cbranch_vccnz f1_ssol_rare
f1_ssol_rare_r:
    s_branch f1_ssol_mask
f1_ssol_mask_r:
    s_waitcnt lgkmcnt(7)
    v_mfma_f32_16x16x32_bf16 a[64:67], a[192:195], v[184:187], a[64:67]
    v_add_f32 v15, v15, v248
    v_exp_f32 v240, v64
    v_mfma_f32_16x16x32_bf16 a[96:99], a[192:195], v[188:191], a[96:99]
    ds_read_b128 a[236:239], v2 offset:7168
    v_mfma_f32_16x16x32_bf16 a[68:71], a[196:199], v[184:187], a[68:71]
    v_add_f32 v30, v30, v252
    v_exp_f32 v241, v65
    v_mfma_f32_16x16x32_bf16 a[100:103], a[196:199], v[188:191], a[100:103]
    ds_read_b128 a[240:243], v2 offset:9216
    v_exp_f32 v242, v66
    v_mfma_f32_16x16x32_bf16 a[72:75], a[200:203], v[184:187], a[72:75]
    s_mov_b32 s74, s73
    s_mov_b32 s73, s72
    v_mfma_f32_16x16x32_bf16 a[104:107], a[200:203], v[188:191], a[104:107]
    ds_read_b128 a[244:247], v2 offset:11264
    v_exp_f32 v243, v67
    v_mfma_f32_16x16x32_bf16 a[76:79], a[204:207], v[184:187], a[76:79]
    s_add_u32 s72, s72, 0x8000
    v_exp_f32 v244, v68
    v_mfma_f32_16x16x32_bf16 a[108:111], a[204:207], v[188:191], a[108:111]
    ds_read_b128 a[248:251], v2 offset:13312
    s_waitcnt lgkmcnt(7)
    v_mfma_f32_16x16x32_bf16 a[80:83], a[208:211], v[184:187], a[80:83]
    s_cmp_eq_u32 s72, 0x28000
    s_cselect_b32 s72, 0, s72
    v_cvt_pk_bf16_f32 v168, v240, v241
    v_mfma_f32_16x16x32_bf16 a[112:115], a[208:211], v[188:191], a[112:115]
    ds_read_b128 a[252:255], v2 offset:15360
    s_waitcnt vmcnt(16)
    s_barrier
    v_add_u32 v2, s72, v29
    v_mfma_f32_16x16x32_bf16 a[84:87], a[212:215], v[184:187], a[84:87]
    v_exp_f32 v245, v69
    v_mfma_f32_16x16x32_bf16 a[116:119], a[212:215], v[188:191], a[116:119]
    ds_read_b128 a[192:195], v2 offset:16384
    s_add_u32 m0, s73, s28
    v_mfma_f32_16x16x32_bf16 a[88:91], a[216:219], v[184:187], a[88:91]
    v_exp_f32 v246, v70
    v_cvt_pk_bf16_f32 v169, v242, v243
    v_mfma_f32_16x16x32_bf16 a[120:123], a[216:219], v[188:191], a[120:123]
    ds_read_b128 a[196:199], v2 offset:17408
    v_exp_f32 v247, v71
    v_mfma_f32_16x16x32_bf16 a[92:95], a[220:223], v[184:187], a[92:95]
    v_cvt_pk_bf16_f32 v170, v244, v245
    v_cvt_pk_bf16_f32 v171, v246, v247
    v_mfma_f32_16x16x32_bf16 a[124:127], a[220:223], v[188:191], a[124:127]
    ds_read_b128 a[200:203], v2 offset:18432
    s_waitcnt lgkmcnt(7)
    v_mfma_f32_16x16x32_bf16 a[64:67], a[224:227], v[200:203], a[64:67]
    s_add_u32 s75, s75, 0x8000
    v_exp_f32 v240, v80
    v_mfma_f32_16x16x32_bf16 v[248:251], v[208:211], v[168:171], 0
    v_exp_f32 v241, v81
    v_mfma_f32_16x16x32_bf16 a[96:99], a[224:227], v[204:207], a[96:99]
    ds_read_b128 a[204:207], v2 offset:19456
    v_mfma_f32_16x16x32_bf16 a[68:71], a[228:231], v[200:203], a[68:71]
    buffer_load_dwordx4 v29, s[44:47], s75 offen offset:0 sc1 lds
    v_exp_f32 v242, v82
    v_mfma_f32_16x16x32_bf16 a[100:103], a[228:231], v[204:207], a[100:103]
    ds_read_b128 a[208:211], v2 offset:20480
    v_exp_f32 v243, v83
    v_mfma_f32_16x16x32_bf16 a[72:75], a[232:235], v[200:203], a[72:75]
    v_mfma_f32_16x16x32_bf16 a[104:107], a[232:235], v[204:207], a[104:107]
    ds_read_b128 a[212:215], v2 offset:21504
    v_exp_f32 v244, v84
    v_mfma_f32_16x16x32_bf16 a[76:79], a[236:239], v[200:203], a[76:79]
    buffer_load_dwordx4 v29, s[44:47], s75 offen offset:1024 sc1 lds
    v_cvt_pk_bf16_f32 v172, v240, v241
    v_mfma_f32_16x16x32_bf16 a[108:111], a[236:239], v[204:207], a[108:111]
    ds_read_b128 a[216:219], v2 offset:22528
    s_waitcnt lgkmcnt(7)
    v_mfma_f32_16x16x32_bf16 a[80:83], a[240:243], v[200:203], a[80:83]
    v_exp_f32 v245, v85
    v_mfma_f32_16x16x32_bf16 a[112:115], a[240:243], v[204:207], a[112:115]
    ds_read_b128 a[220:223], v2 offset:23552
    v_exp_f32 v246, v86
    v_mfma_f32_16x16x32_bf16 a[84:87], a[244:247], v[200:203], a[84:87]
    v_cvt_pk_bf16_f32 v173, v242, v243
    v_mfma_f32_16x16x32_bf16 a[116:119], a[244:247], v[204:207], a[116:119]
    ds_read_b128 a[224:227], v2 offset:24576
    buffer_load_dwordx4 v29, s[44:47], s75 offen offset:2048 sc1 lds
    v_mfma_f32_16x16x32_bf16 a[88:91], a[248:251], v[200:203], a[88:91]
    v_exp_f32 v247, v87
    v_cvt_pk_bf16_f32 v174, v244, v245
    v_mfma_f32_16x16x32_bf16 a[120:123], a[248:251], v[204:207], a[120:123]
    ds_read_b128 a[228:231], v2 offset:25600
    v_cvt_pk_bf16_f32 v175, v246, v247
    v_mfma_f32_16x16x32_bf16 a[92:95], a[252:255], v[200:203], a[92:95]
    v_mfma_f32_16x16x32_bf16 a[124:127], a[252:255], v[204:207], a[124:127]
    ds_read_b128 a[232:235], v2 offset:26624
    buffer_load_dwordx4 v29, s[44:47], s75 offen offset:3072 sc1 lds
    v_mfma_f32_16x16x32_bf16 v[252:255], v[208:211], v[172:175], 0
    s_waitcnt lgkmcnt(7)
    v_mfma_f32_16x16x32_bf16 v[144:147], a[192:195], a[176:179], v[236:239]
    ds_read_b128 a[236:239], v2 offset:27648
    v_exp_f32 v240, v72
    v_exp_f32 v241, v73
    v_exp_f32 v242, v74
    v_mfma_f32_16x16x32_bf16 v[144:147], a[196:199], a[180:183], v[144:147]
    ds_read_b128 a[240:243], v2 offset:28672
    v_exp_f32 v243, v75
    v_exp_f32 v244, v76
    v_cvt_pk_bf16_f32 v200, v240, v241
    v_exp_f32 v245, v77
    v_mfma_f32_16x16x32_bf16 v[144:147], a[200:203], a[184:187], v[144:147]
    ds_read_b128 a[244:247], v2 offset:29696
    v_exp_f32 v246, v78
    v_cvt_pk_bf16_f32 v201, v242, v243
    v_exp_f32 v247, v79
    v_cvt_pk_bf16_f32 v202, v244, v245
    v_cvt_pk_bf16_f32 v203, v246, v247
    v_mfma_f32_16x16x32_bf16 v[144:147], a[204:207], a[188:191], v[144:147]
    ds_read_b128 a[248:251], v2 offset:30720
    s_waitcnt lgkmcnt(7)
    v_exp_f32 v240, v88
    v_exp_f32 v241, v89
    v_exp_f32 v242, v90
    v_mfma_f32_16x16x32_bf16 v[148:151], a[208:211], a[176:179], v[236:239]
    ds_read_b128 a[252:255], v2 offset:31744
    v_exp_f32 v243, v91
    v_exp_f32 v244, v92
    v_cvt_pk_bf16_f32 v204, v240, v241
    v_mfma_f32_16x16x32_bf16 v[248:251], v[208:211], v[200:203], v[248:251]
    s_add_u32 m0, s74, s30
    s_nop 0
    buffer_load_dwordx4 v29, s[48:51], s75 offen offset:0 sc1 lds
    v_exp_f32 v245, v93
    v_exp_f32 v246, v94
    v_mfma_f32_16x16x32_bf16 v[148:151], a[212:215], a[180:183], v[148:151]
    ds_read_b128 a[192:195], v2 offset:0
    buffer_load_dwordx4 v29, s[48:51], s75 offen offset:1024 sc1 lds
    v_cvt_pk_bf16_f32 v205, v242, v243
    v_exp_f32 v247, v95
    v_cvt_pk_bf16_f32 v206, v244, v245
    v_cvt_pk_bf16_f32 v207, v246, v247
    v_mfma_f32_16x16x32_bf16 v[148:151], a[216:219], a[184:187], v[148:151]
    ds_read_b128 a[196:199], v2 offset:2048
    buffer_load_dwordx4 v29, s[48:51], s75 offen offset:2048 sc1 lds
    v_mfma_f32_16x16x32_bf16 v[148:151], a[220:223], a[188:191], v[148:151]
    ds_read_b128 a[200:203], v2 offset:4096
    buffer_load_dwordx4 v29, s[48:51], s75 offen offset:3072 sc1 lds
    v_mfma_f32_16x16x32_bf16 v[252:255], v[208:211], v[204:207], v[252:255]
    s_waitcnt lgkmcnt(7)
    v_mfma_f32_16x16x32_bf16 v[152:155], a[224:227], a[176:179], v[236:239]
    ds_read_b128 a[204:207], v2 offset:6144
    v_mfma_f32_16x16x32_bf16 v[152:155], a[228:231], a[180:183], v[152:155]
    ds_read_b128 a[208:211], v2 offset:8192
    v_mfma_f32_16x16x32_bf16 v[152:155], a[232:235], a[184:187], v[152:155]
    ds_read_b128 a[212:215], v2 offset:10240
    v_mfma_f32_16x16x32_bf16 v[152:155], a[236:239], a[188:191], v[152:155]
    ds_read_b128 a[216:219], v2 offset:12288
    s_waitcnt lgkmcnt(7)
    v_max_f32 v20, v248, v252
    v_mfma_f32_16x16x32_bf16 v[156:159], a[240:243], a[176:179], v[236:239]
    ds_read_b128 a[220:223], v2 offset:14336
    v_cmp_nge_f32 vcc, s77, v20
    v_mfma_f32_16x16x32_bf16 v[156:159], a[244:247], a[180:183], v[156:159]
    ds_read_b128 a[224:227], v2 offset:1024
    v_mfma_f32_16x16x32_bf16 v[156:159], a[248:251], a[184:187], v[156:159]
    ds_read_b128 a[228:231], v2 offset:3072
    v_mfma_f32_16x16x32_bf16 v[156:159], a[252:255], a[188:191], v[156:159]
    ds_read_b128 a[232:235], v2 offset:5120
    s_cbranch_vccnz f1_ssel_rare
f1_ssel_rare_r:
    s_branch f1_ssel_mask
f1_ssel_mask_r:
    s_waitcnt lgkmcnt(7)
    v_mfma_f32_16x16x32_bf16 a[64:67], a[192:195], v[168:171], a[64:67]
    v_add_f32 v15, v15, v248
    v_mfma_f32_16x16x32_bf16 a[96:99], a[192:195], v[172:175], a[96:99]
    ds_read_b128 a[236:239], v2 offset:7168
    v_exp_f32 v240, v144
    v_mfma_f32_16x16x32_bf16 a[68:71], a[196:199], v[168:171], a[68:71]
    v_add_f32 v30, v30, v252
    v_mfma_f32_16x16x32_bf16 a[100:103], a[196:199], v[172:175], a[100:103]
    ds_read_b128 a[240:243], v2 offset:9216
    v_mfma_f32_16x16x32_bf16 a[72:75], a[200:203], v[168:171], a[72:75]
    s_mov_b32 s74, s73
    s_mov_b32 s73, s72
    v_mfma_f32_16x16x32_bf16 a[104:107], a[200:203], v[172:175], a[104:107]
    ds_read_b128 a[244:247], v2 offset:11264
    v_exp_f32 v241, v145
    v_mfma_f32_16x16x32_bf16 a[76:79], a[204:207], v[168:171], a[76:79]
    s_add_u32 s72, s72, 0x8000
    v_mfma_f32_16x16x32_bf16 a[108:111], a[204:207], v[172:175], a[108:111]
    ds_read_b128 a[248:251], v2 offset:13312
    s_waitcnt lgkmcnt(7)
    v_mfma_f32_16x16x32_bf16 a[80:83], a[208:211], v[168:171], a[80:83]
    s_cmp_eq_u32 s72, 0x28000
    s_cselect_b32 s72, 0, s72
    v_mfma_f32_16x16x32_bf16 a[112:115], a[208:211], v[172:175], a[112:115]
    ds_read_b128 a[252:255], v2 offset:15360
    s_waitcnt vmcnt(16)
    s_barrier
    v_add_u32 v2, s72, v29
    v_mfma_f32_16x16x32_bf16 a[84:87], a[212:215], v[168:171], a[84:87]
    v_exp_f32 v242, v146
    v_mfma_f32_16x16x32_bf16 a[116:119], a[212:215], v[172:175], a[116:119]
    ds_read_b128 a[192:195], v2 offset:16384
    s_add_u32 m0, s73, s28
    v_mfma_f32_16x16x32_bf16 a[88:91], a[216:219], v[168:171], a[88:91]
    v_exp_f32 v243, v147
    v_mfma_f32_16x16x32_bf16 a[120:123], a[216:219], v[172:175], a[120:123]
    ds_read_b128 a[196:199], v2 offset:17408
    v_mfma_f32_16x16x32_bf16 a[92:95], a[220:223], v[168:171], a[92:95]
    v_exp_f32 v244, v148
    v_mfma_f32_16x16x32_bf16 a[124:127], a[220:223], v[172:175], a[124:127]
    ds_read_b128 a[200:203], v2 offset:18432
    s_waitcnt lgkmcnt(7)
    v_mfma_f32_16x16x32_bf16 a[64:67], a[224:227], v[200:203], a[64:67]
    s_add_u32 s75, s75, 0x8000
    v_mfma_f32_16x16x32_bf16 a[96:99], a[224:227], v[204:207], a[96:99]
    ds_read_b128 a[204:207], v2 offset:19456
    v_cvt_pk_bf16_f32 v188, v240, v241
    v_mfma_f32_16x16x32_bf16 a[68:71], a[228:231], v[200:203], a[68:71]
    v_exp_f32 v245, v149
    v_mfma_f32_16x16x32_bf16 a[100:103], a[228:231], v[204:207], a[100:103]
    ds_read_b128 a[208:211], v2 offset:20480
    buffer_load_dwordx4 v29, s[44:47], s75 offen offset:0 sc1 lds
    v_mfma_f32_16x16x32_bf16 a[72:75], a[232:235], v[200:203], a[72:75]
    v_mfma_f32_16x16x32_bf16 a[104:107], a[232:235], v[204:207], a[104:107]
    ds_read_b128 a[212:215], v2 offset:21504
    v_exp_f32 v246, v150
    v_mfma_f32_16x16x32_bf16 a[76:79], a[236:239], v[200:203], a[76:79]
    v_mfma_f32_16x16x32_bf16 a[108:111], a[236:239], v[204:207], a[108:111]
    ds_read_b128 a[216:219], v2 offset:22528
    s_waitcnt lgkmcnt(7)
    v_cvt_pk_bf16_f32 v189, v242, v243
    v_mfma_f32_16x16x32_bf16 a[80:83], a[240:243], v[200:203], a[80:83]
    buffer_load_dwordx4 v29, s[44:47], s75 offen offset:1024 sc1 lds
    v_mfma_f32_16x16x32_bf16 a[112:115], a[240:243], v[204:207], a[112:115]
    ds_read_b128 a[220:223], v2 offset:23552
    v_mfma_f32_16x16x32_bf16 a[84:87], a[244:247], v[200:203], a[84:87]
    v_exp_f32 v247, v151
    v_mfma_f32_16x16x32_bf16 a[116:119], a[244:247], v[204:207], a[116:119]
    ds_read_b128 a[224:227], v2 offset:24576
    buffer_load_dwordx4 v29, s[44:47], s75 offen offset:2048 sc1 lds
    v_mfma_f32_16x16x32_bf16 a[88:91], a[248:251], v[200:203], a[88:91]
    v_cvt_pk_bf16_f32 v190, v244, v245
    v_mfma_f32_16x16x32_bf16 a[120:123], a[248:251], v[204:207], a[120:123]
    ds_read_b128 a[228:231], v2 offset:25600
    v_cvt_pk_bf16_f32 v191, v246, v247
    v_mfma_f32_16x16x32_bf16 a[92:95], a[252:255], v[200:203], a[92:95]
    v_mfma_f32_16x16x32_bf16 a[124:127], a[252:255], v[204:207], a[124:127]
    ds_read_b128 a[232:235], v2 offset:26624
    buffer_load_dwordx4 v29, s[44:47], s75 offen offset:3072 sc1 lds
    v_mfma_f32_16x16x32_bf16 v[252:255], v[208:211], v[188:191], 0
f1_fin:
    s_cmp_lg_u32 s22, 0
    s_cbranch_scc1 f1_w0_10
    s_movk_i32 s23, 224
    buffer_load_dword v28, off, s[56:59], s23 sc1
f1_w0_10:
    s_getpc_b64 s[60:61]
f1_pcr3:
    s_mov_b32 s62, f1_last-f1_pcr3
    s_mov_b32 s63, 0x00020000
    s_lshr_b32 s25, s2, 3
    s_lshl_b32 s25, s25, 2
    s_add_u32 s25, s25, s22
    s_lshl_b32 s25, s25, 10
    buffer_load_dwordx4 v[176:179], v29, s[60:63], s25 offen
    ds_read_b128 a[192:195], v2 offset:0
    ds_read_b128 a[196:199], v2 offset:2048
    ds_read_b128 a[200:203], v2 offset:4096
    ds_read_b128 a[204:207], v2 offset:6144
    ds_read_b128 a[208:211], v2 offset:8192
    ds_read_b128 a[212:215], v2 offset:10240
    ds_read_b128 a[216:219], v2 offset:12288
    ds_read_b128 a[220:223], v2 offset:14336
    ds_read_b128 a[224:227], v2 offset:1024
    ds_read_b128 a[228:231], v2 offset:3072
    ds_read_b128 a[232:235], v2 offset:5120
    v_exp_f32 v240, v152
    v_exp_f32 v241, v153
    v_exp_f32 v242, v154
    v_exp_f32 v243, v155
    v_exp_f32 v244, v156
    v_cvt_pk_bf16_f32 v204, v240, v241
    v_exp_f32 v245, v157
    v_exp_f32 v246, v158
    v_cvt_pk_bf16_f32 v205, v242, v243
    v_exp_f32 v247, v159
    v_cvt_pk_bf16_f32 v206, v244, v245
    v_cvt_pk_bf16_f32 v207, v246, v247
    s_nop 1
    v_mfma_f32_16x16x32_bf16 v[252:255], v[208:211], v[204:207], v[252:255]
    s_nop 7
    v_max_f32 v20, v252, v252
    v_cmp_nge_f32 vcc, s77, v20
    s_cbranch_vccnz f1_seo_rare
f1_seo_rare_r:
    s_waitcnt lgkmcnt(7)
    v_mfma_f32_16x16x32_bf16 a[96:99], a[192:195], v[188:191], a[96:99]
    ds_read_b128 a[236:239], v2 offset:7168
    v_mfma_f32_16x16x32_bf16 a[100:103], a[196:199], v[188:191], a[100:103]
    ds_read_b128 a[240:243], v2 offset:9216
    v_add_f32 v30, v30, v252
    v_mfma_f32_16x16x32_bf16 a[104:107], a[200:203], v[188:191], a[104:107]
    ds_read_b128 a[244:247], v2 offset:11264
    v_mfma_f32_16x16x32_bf16 a[108:111], a[204:207], v[188:191], a[108:111]
    ds_read_b128 a[248:251], v2 offset:13312
    s_waitcnt lgkmcnt(7)
    v_mfma_f32_16x16x32_bf16 a[112:115], a[208:211], v[188:191], a[112:115]
    ds_read_b128 a[252:255], v2 offset:15360
    v_mfma_f32_16x16x32_bf16 a[116:119], a[212:215], v[188:191], a[116:119]
    v_mfma_f32_16x16x32_bf16 a[120:123], a[216:219], v[188:191], a[120:123]
    v_mfma_f32_16x16x32_bf16 a[124:127], a[220:223], v[188:191], a[124:127]
    s_waitcnt lgkmcnt(4)
    v_mfma_f32_16x16x32_bf16 a[96:99], a[224:227], v[204:207], a[96:99]
    v_mfma_f32_16x16x32_bf16 a[100:103], a[228:231], v[204:207], a[100:103]
    v_mfma_f32_16x16x32_bf16 a[104:107], a[232:235], v[204:207], a[104:107]
    v_mfma_f32_16x16x32_bf16 a[108:111], a[236:239], v[204:207], a[108:111]
    s_waitcnt lgkmcnt(0)
    v_mfma_f32_16x16x32_bf16 a[112:115], a[240:243], v[204:207], a[112:115]
    v_mfma_f32_16x16x32_bf16 a[116:119], a[244:247], v[204:207], a[116:119]
    v_mfma_f32_16x16x32_bf16 a[120:123], a[248:251], v[204:207], a[120:123]
    v_mfma_f32_16x16x32_bf16 a[124:127], a[252:255], v[204:207], a[124:127]
    s_waitcnt vmcnt(0)
    v_rcp_f32 v20, v15
    s_add_u32 s24, s79, 0
    v_mul_f32 v20, v20, v18
    v_accvgpr_read_b32 v32, a64
    v_accvgpr_read_b32 v33, a65
    v_accvgpr_read_b32 v34, a66
    v_accvgpr_read_b32 v35, a67
    v_accvgpr_read_b32 v36, a68
    s_load_dwordx2 s[72:73], s[0:1], 88
    v_accvgpr_read_b32 v37, a69
    v_accvgpr_read_b32 v38, a70
    v_accvgpr_read_b32 v39, a71
    s_bfe_u32 s66, s2, 0x20001
    v_pk_mul_f32 v[32:33], v[32:33], v[20:21] op_sel_hi:[1,0]
    v_pk_mul_f32 v[34:35], v[34:35], v[20:21] op_sel_hi:[1,0]
    v_pk_mul_f32 v[36:37], v[36:37], v[20:21] op_sel_hi:[1,0]
    s_and_b32 s67, s2, 1
    v_pk_mul_f32 v[38:39], v[38:39], v[20:21] op_sel_hi:[1,0]
    v_cvt_pk_bf16_f32 v40, v32, v33
    v_cvt_pk_bf16_f32 v41, v34, v35
    s_mul_i32 s67, s67, 60
    v_cvt_pk_bf16_f32 v42, v36, v37
    v_cvt_pk_bf16_f32 v43, v38, v39
    buffer_store_dwordx4 v[40:43], v29, s[52:55], s24 offen offset:0 sc1
    s_lshr_b32 s23, s2, 3
    v_accvgpr_read_b32 v48, a72
    v_accvgpr_read_b32 v49, a73
    v_accvgpr_read_b32 v50, a74
    s_xor_b32 s67, s67, s23
    v_accvgpr_read_b32 v51, a75
    v_accvgpr_read_b32 v52, a76
    v_accvgpr_read_b32 v53, a77
    v_accvgpr_read_b32 v54, a78
    s_lshr_b32 s27, s67, 2
    v_accvgpr_read_b32 v55, a79
    v_pk_mul_f32 v[48:49], v[48:49], v[20:21] op_sel_hi:[1,0]
    v_pk_mul_f32 v[50:51], v[50:51], v[20:21] op_sel_hi:[1,0]
    s_and_b32 s31, s67, 3
    v_pk_mul_f32 v[52:53], v[52:53], v[20:21] op_sel_hi:[1,0]
    v_pk_mul_f32 v[54:55], v[54:55], v[20:21] op_sel_hi:[1,0]
    v_cvt_pk_bf16_f32 v56, v48, v49
    s_lshl_b32 s64, s27, 3
    v_cvt_pk_bf16_f32 v57, v50, v51
    v_cvt_pk_bf16_f32 v58, v52, v53
    v_cvt_pk_bf16_f32 v59, v54, v55
    s_lshl_b32 s23, s22, 1
    buffer_store_dwordx4 v[56:59], v29, s[52:55], s24 offen offset:1024 sc1
    v_accvgpr_read_b32 v32, a80
    v_accvgpr_read_b32 v33, a81
    s_add_u32 s64, s64, s23
    v_accvgpr_read_b32 v34, a82
    v_accvgpr_read_b32 v35, a83
    v_accvgpr_read_b32 v36, a84
    v_accvgpr_read_b32 v37, a85
    s_mul_i32 s64, s64, 149504
    v_accvgpr_read_b32 v38, a86
    v_accvgpr_read_b32 v39, a87
    v_pk_mul_f32 v[32:33], v[32:33], v[20:21] op_sel_hi:[1,0]
    s_lshl_b32 s23, s66, 15
    v_pk_mul_f32 v[34:35], v[34:35], v[20:21] op_sel_hi:[1,0]
    v_pk_mul_f32 v[36:37], v[36:37], v[20:21] op_sel_hi:[1,0]
    v_pk_mul_f32 v[38:39], v[38:39], v[20:21] op_sel_hi:[1,0]
    s_add_u32 s64, s64, s23
    v_cvt_pk_bf16_f32 v40, v32, v33
    v_cvt_pk_bf16_f32 v41, v34, v35
    v_cvt_pk_bf16_f32 v42, v36, v37
    s_add_u32 s65, s64, 149504
    v_cvt_pk_bf16_f32 v43, v38, v39
    buffer_store_dwordx4 v[40:43], v29, s[52:55], s24 offen offset:2048 sc1
    v_accvgpr_read_b32 v48, a88
    s_mul_i32 s70, s31, 1345536
    v_accvgpr_read_b32 v49, a89
    v_accvgpr_read_b32 v50, a90
    v_accvgpr_read_b32 v51, a91
    v_accvgpr_read_b32 v52, a92
    s_mul_i32 s69, s22, 9216
    v_accvgpr_read_b32 v53, a93
    v_accvgpr_read_b32 v54, a94
    v_accvgpr_read_b32 v55, a95
    s_add_u32 s70, s70, s69
    v_pk_mul_f32 v[48:49], v[48:49], v[20:21] op_sel_hi:[1,0]
    v_pk_mul_f32 v[50:51], v[50:51], v[20:21] op_sel_hi:[1,0]
    v_pk_mul_f32 v[52:53], v[52:53], v[20:21] op_sel_hi:[1,0]
    s_mul_i32 s23, s66, 294912
    v_pk_mul_f32 v[54:55], v[54:55], v[20:21] op_sel_hi:[1,0]
    v_cvt_pk_bf16_f32 v56, v48, v49
    v_cvt_pk_bf16_f32 v57, v50, v51
    s_add_u32 s68, s70, s23
    v_cvt_pk_bf16_f32 v58, v52, v53
    v_cvt_pk_bf16_f32 v59, v54, v55
    buffer_store_dwordx4 v[56:59], v29, s[52:55], s24 offen offset:3072 sc1
    s_lshl_b32 s76, s22, 10
    v_rcp_f32 v22, v30
    s_add_u32 s24, s79, 598016
    v_mul_f32 v22, v22, v19
    v_accvgpr_read_b32 v32, a96
    s_sub_u32 s76, s76, s69
    v_accvgpr_read_b32 v33, a97
    v_accvgpr_read_b32 v34, a98
    v_accvgpr_read_b32 v35, a99
    s_add_u32 s76, s76, s70
    v_accvgpr_read_b32 v36, a100
    v_accvgpr_read_b32 v37, a101
    v_accvgpr_read_b32 v38, a102
    s_lshr_b32 s23, s66, 1
    v_accvgpr_read_b32 v39, a103
    v_pk_mul_f32 v[32:33], v[32:33], v[22:23] op_sel_hi:[1,0]
    v_pk_mul_f32 v[34:35], v[34:35], v[22:23] op_sel_hi:[1,0]
    s_add_u32 s23, s23, 144
    v_pk_mul_f32 v[36:37], v[36:37], v[22:23] op_sel_hi:[1,0]
    v_pk_mul_f32 v[38:39], v[38:39], v[22:23] op_sel_hi:[1,0]
    v_cvt_pk_bf16_f32 v40, v32, v33
    s_mul_i32 s23, s23, 9216
    v_cvt_pk_bf16_f32 v41, v34, v35
    v_cvt_pk_bf16_f32 v42, v36, v37
    v_cvt_pk_bf16_f32 v43, v38, v39
    s_add_u32 s76, s76, s23
    buffer_store_dwordx4 v[40:43], v29, s[52:55], s24 offen offset:0 sc1
    v_accvgpr_read_b32 v48, a104
    v_accvgpr_read_b32 v49, a105
    v_accvgpr_read_b32 v50, a106
    s_mul_i32 s23, s66, 36864
    v_accvgpr_read_b32 v51, a107
    v_accvgpr_read_b32 v52, a108
    v_accvgpr_read_b32 v53, a109
    s_add_u32 s70, s70, s23
    v_accvgpr_read_b32 v54, a110
    v_accvgpr_read_b32 v55, a111
    v_pk_mul_f32 v[48:49], v[48:49], v[22:23] op_sel_hi:[1,0]
    s_add_u32 s70, s70, 1179648
    v_pk_mul_f32 v[50:51], v[50:51], v[22:23] op_sel_hi:[1,0]
    v_pk_mul_f32 v[52:53], v[52:53], v[22:23] op_sel_hi:[1,0]
    v_pk_mul_f32 v[54:55], v[54:55], v[22:23] op_sel_hi:[1,0]
    s_bitcmp1_b32 s66, 0
    s_cselect_b32 s76, s76, 0x40000000
    v_cvt_pk_bf16_f32 v56, v48, v49
    v_cvt_pk_bf16_f32 v57, v50, v51
    v_cvt_pk_bf16_f32 v58, v52, v53
    s_and_b32 s83, s2, 1
    v_cvt_pk_bf16_f32 v59, v54, v55
    buffer_store_dwordx4 v[56:59], v29, s[52:55], s24 offen offset:1024 sc1
    v_accvgpr_read_b32 v32, a112
    v_accvgpr_read_b32 v33, a113
    s_sub_u32 s75, 15, s27
    v_accvgpr_read_b32 v34, a114
    v_accvgpr_read_b32 v35, a115
    v_accvgpr_read_b32 v36, a116
    s_min_u32 s74, s27, s75
    v_accvgpr_read_b32 v37, a117
    v_accvgpr_read_b32 v38, a118
    v_accvgpr_read_b32 v39, a119
    s_lshl_b32 s74, s74, 12
    v_pk_mul_f32 v[32:33], v[32:33], v[22:23] op_sel_hi:[1,0]
    v_pk_mul_f32 v[34:35], v[34:35], v[22:23] op_sel_hi:[1,0]
    v_pk_mul_f32 v[36:37], v[36:37], v[22:23] op_sel_hi:[1,0]
    s_add_u32 s60, s18, 66125824
    s_addc_u32 s61, s19, 0
    v_pk_mul_f32 v[38:39], v[38:39], v[22:23] op_sel_hi:[1,0]
    v_cvt_pk_bf16_f32 v40, v32, v33
    v_cvt_pk_bf16_f32 v41, v34, v35
    s_mov_b32 s62, 163840
    v_cvt_pk_bf16_f32 v42, v36, v37
    v_cvt_pk_bf16_f32 v43, v38, v39
    buffer_store_dwordx4 v[40:43], v29, s[52:55], s24 offen offset:2048 sc1
    v_accvgpr_read_b32 v48, a120
    s_mov_b32 s63, 0x00020000
    v_accvgpr_read_b32 v49, a121
    v_accvgpr_read_b32 v50, a122
    v_accvgpr_read_b32 v51, a123
    s_add_u32 s32, s18, 71303168
    s_addc_u32 s33, s19, 0
    v_accvgpr_read_b32 v52, a124
    v_accvgpr_read_b32 v53, a125
    v_accvgpr_read_b32 v54, a126
    s_mov_b32 s34, 5382144
    v_accvgpr_read_b32 v55, a127
    v_pk_mul_f32 v[48:49], v[48:49], v[22:23] op_sel_hi:[1,0]
    v_pk_mul_f32 v[50:51], v[50:51], v[22:23] op_sel_hi:[1,0]
    s_mov_b32 s35, 0x00020000
    v_pk_mul_f32 v[52:53], v[52:53], v[22:23] op_sel_hi:[1,0]
    v_pk_mul_f32 v[54:55], v[54:55], v[22:23] op_sel_hi:[1,0]
    v_cvt_pk_bf16_f32 v56, v48, v49
    s_cmp_lg_u32 s22, 0
    s_cbranch_scc1 f1_w0_8
    s_movk_i32 s75, 224
    v_readfirstlane_b32 s25, v28
    s_nop 0
    s_cmp_ge_u32 s25, 256
    s_cbranch_scc0 f1_pw
f1_pw_r:
f1_w0_8:
    v_cvt_pk_bf16_f32 v57, v50, v51
    v_cvt_pk_bf16_f32 v58, v52, v53
    v_cvt_pk_bf16_f32 v59, v54, v55
    buffer_store_dwordx4 v[56:59], v29, s[52:55], s24 offen offset:3072 sc1
    s_mul_i32 s23, s22, 3072
    s_add_u32 s23, s23, 147456
    v_add_u32 v22, s23, v29
    v_and_b32 v20, 31, v1
    v_lshrrev_b32 v21, 5, v1
    v_cmp_eq_u32 vcc, 22, v20
    v_mov_b32 v23, 18
    s_nop 0
    v_cndmask_b32 v23, v20, v23, vcc
    v_cmp_gt_u32 s[40:41], 19, v23
    v_min_u32 v23, 18, v23
    v_mul_u32_u24 v23, 160, v23
    v_add_u32 v23, 147456, v23
    v_lshl_add_u32 v24, v21, 4, v23
    v_lshl_add_u32 v23, v21, 5, v23
    s_mov_b32 s82, 0x358637bd
    v_add_f32 v96, v96, v108
    v_add_f32 v97, v97, v109
    v_add_f32 v98, v98, v110
    v_add_f32 v99, v99, v111
    v_add_f32 v100, v100, v112
    v_add_f32 v101, v101, v113
    v_add_f32 v102, v102, v114
    v_add_f32 v103, v103, v115
    v_add_f32 v104, v104, v116
    v_add_f32 v105, v105, v117
    v_add_f32 v106, v106, v118
    v_add_f32 v107, v107, v119
    s_barrier
    ds_write_b128 v22, v[96:99] offset:0
    ds_write_b128 v22, v[100:103] offset:1024
    ds_write_b128 v22, v[104:107] offset:2048
    s_mul_i32 s71, s83, 147456
    s_add_u32 s71, s71, 0
    s_add_u32 s71, s71, s68
    s_add_u32 m0, s69, 0
    s_nop 0
    buffer_load_dwordx4 v29, s[32:35], s71 offen offset:0 sc1 lds
    buffer_load_dwordx4 v29, s[32:35], s71 offen offset:1024 sc1 lds
    buffer_load_dwordx4 v29, s[32:35], s71 offen offset:2048 sc1 lds
    buffer_load_dwordx4 v29, s[32:35], s71 offen offset:3072 sc1 lds
    s_add_u32 m0, s69, 4096
    s_add_u32 s71, s71, 4096
    buffer_load_dwordx4 v29, s[32:35], s71 offen offset:0 sc1 lds
    buffer_load_dwordx4 v29, s[32:35], s71 offen offset:1024 sc1 lds
    buffer_load_dwordx4 v29, s[32:35], s71 offen offset:2048 sc1 lds
    buffer_load_dwordx4 v29, s[32:35], s71 offen offset:3072 sc1 lds
    s_add_u32 m0, s69, 8192
    s_add_u32 s71, s71, 4096
    buffer_load_dwordx4 v29, s[32:35], s71 offen offset:0 sc1 lds
    s_waitcnt vmcnt(9) lgkmcnt(0)
    s_barrier
    s_cmp_lg_u32 s22, 0
    s_cbranch_scc1 f1_sg31
    s_mov_b64 exec, 1
    v_mov_b32 v19, 1
    s_lshl_b32 s23, s21, 5
    s_add_u32 s23, s23, s20
    s_lshl_b32 s23, s23, 7
    buffer_store_dword v19, off, s[60:63], s23 sc1
    s_mov_b64 exec, -1
f1_sg31:
    s_mul_i32 s71, s83, 147456
    s_add_u32 s71, s71, 36864
    s_add_u32 s71, s71, s68
    s_add_u32 m0, s69, 36864
    s_nop 0
    buffer_load_dwordx4 v29, s[32:35], s71 offen offset:0 sc1 lds
    buffer_load_dwordx4 v29, s[32:35], s71 offen offset:1024 sc1 lds
    buffer_load_dwordx4 v29, s[32:35], s71 offen offset:2048 sc1 lds
    buffer_load_dwordx4 v29, s[32:35], s71 offen offset:3072 sc1 lds
    s_add_u32 m0, s69, 40960
    s_add_u32 s71, s71, 4096
    buffer_load_dwordx4 v29, s[32:35], s71 offen offset:0 sc1 lds
    buffer_load_dwordx4 v29, s[32:35], s71 offen offset:1024 sc1 lds
    buffer_load_dwordx4 v29, s[32:35], s71 offen offset:2048 sc1 lds
    buffer_load_dwordx4 v29, s[32:35], s71 offen offset:3072 sc1 lds
    s_add_u32 m0, s69, 45056
    s_add_u32 s71, s71, 4096
    buffer_load_dwordx4 v29, s[32:35], s71 offen offset:0 sc1 lds
    s_mul_i32 s71, s83, 147456
    s_add_u32 s71, s71, 73728
    s_add_u32 s71, s71, s68
    s_add_u32 m0, s69, 73728
    s_nop 0
    buffer_load_dwordx4 v29, s[32:35], s71 offen offset:0 sc1 lds
    buffer_load_dwordx4 v29, s[32:35], s71 offen offset:1024 sc1 lds
    buffer_load_dwordx4 v29, s[32:35], s71 offen offset:2048 sc1 lds
    buffer_load_dwordx4 v29, s[32:35], s71 offen offset:3072 sc1 lds
    s_add_u32 m0, s69, 77824
    s_add_u32 s71, s71, 4096
    buffer_load_dwordx4 v29, s[32:35], s71 offen offset:0 sc1 lds
    buffer_load_dwordx4 v29, s[32:35], s71 offen offset:1024 sc1 lds
    buffer_load_dwordx4 v29, s[32:35], s71 offen offset:2048 sc1 lds
    buffer_load_dwordx4 v29, s[32:35], s71 offen offset:3072 sc1 lds
    s_add_u32 m0, s69, 81920
    s_add_u32 s71, s71, 4096
    buffer_load_dwordx4 v29, s[32:35], s71 offen offset:0 sc1 lds
    s_mul_i32 s71, s83, 147456
    s_add_u32 s71, s71, 110592
    s_add_u32 s71, s71, s68
    s_add_u32 m0, s69, 110592
    s_nop 0
    buffer_load_dwordx4 v29, s[32:35], s71 offen offset:0 sc1 lds
    buffer_load_dwordx4 v29, s[32:35], s71 offen offset:1024 sc1 lds
    buffer_load_dwordx4 v29, s[32:35], s71 offen offset:2048 sc1 lds
    buffer_load_dwordx4 v29, s[32:35], s71 offen offset:3072 sc1 lds
    s_add_u32 m0, s69, 114688
    s_add_u32 s71, s71, 4096
    buffer_load_dwordx4 v29, s[32:35], s71 offen offset:0 sc1 lds
    buffer_load_dwordx4 v29, s[32:35], s71 offen offset:1024 sc1 lds
    buffer_load_dwordx4 v29, s[32:35], s71 offen offset:2048 sc1 lds
    buffer_load_dwordx4 v29, s[32:35], s71 offen offset:3072 sc1 lds
    s_add_u32 m0, s69, 118784
    s_add_u32 s71, s71, 4096
    buffer_load_dwordx4 v29, s[32:35], s71 offen offset:0 sc1 lds
    v_lshrrev_b32 v16, 2, v1
    v_mul_u32_u24 v16, 288, v16
    v_and_b32 v17, 3, v1
    v_lshl_add_u32 v10, v17, 3, v16
    v_add_u32 v11, 36864, v10
    v_add_u32 v12, 73728, v10
    v_add_u32 v13, 110592, v10
    s_and_b32 s23, s66, 1
    s_lshl_b32 s23, s23, 3
    s_add_u32 s24, s23, 7
    v_and_b32 v15, s24, v1
    s_lshl_b32 s24, s66, 3
    s_sub_u32 s24, s24, s23
    v_add_u32 v15, s24, v15
    v_lshlrev_b32 v15, 7, v15
    s_and_b32 s24, s2, 7
    s_lshl_b32 s24, s24, 2
    v_and_b32 v14, 3, v1
    v_add_u32 v14, s24, v14
    v_lshlrev_b32 v14, 7, v14
    s_add_u32 s44, s18, 83886080
    s_addc_u32 s45, s19, 0
    s_mov_b32 s46, 18874368
    s_mov_b32 s47, 0x00020000
    s_mov_b32 s26, 0x10000
f1_pc:
    buffer_load_dword v28, v14, s[60:63], s74 offen sc1
    s_waitcnt vmcnt(0)
    v_cmp_lt_u32 vcc, 0, v28
    s_nop 0
    s_cmp_eq_u64 vcc, -1
    s_cbranch_scc1 f1_pc_r
    s_sub_u32 s26, s26, 1
    s_cmp_lg_u32 s26, 0
    s_cbranch_scc1 f1_pc
f1_pc_r:
    s_lshl_b32 s24, s83, 14
    s_add_u32 s64, s64, s24
    s_add_u32 s65, s65, s24
    buffer_load_dwordx4 a[0:3], v29, s[52:55], s64 offen offset:0 sc1
    buffer_load_dwordx4 a[4:7], v29, s[52:55], s65 offen offset:0 sc1
    buffer_load_dwordx4 a[8:11], v29, s[52:55], s64 offen offset:1024 sc1
    buffer_load_dwordx4 a[12:15], v29, s[52:55], s65 offen offset:1024 sc1
    buffer_load_dwordx4 a[16:19], v29, s[52:55], s64 offen offset:2048 sc1
    buffer_load_dwordx4 a[20:23], v29, s[52:55], s65 offen offset:2048 sc1
    buffer_load_dwordx4 a[24:27], v29, s[52:55], s64 offen offset:3072 sc1
    buffer_load_dwordx4 a[28:31], v29, s[52:55], s65 offen offset:3072 sc1
    buffer_load_dword v28, v15, s[60:63], s74 offen sc1
    s_waitcnt lgkmcnt(0)
    s_barrier
    ds_read_b64_tr_b16 a[128:129], v10 offset:0
    ds_read_b64_tr_b16 a[130:131], v10 offset:4608
    ds_read_b64_tr_b16 a[132:133], v10 offset:32
    ds_read_b64_tr_b16 a[134:135], v10 offset:4640
    ds_read_b64_tr_b16 a[136:137], v10 offset:64
    ds_read_b64_tr_b16 a[138:139], v10 offset:4672
    ds_read_b64_tr_b16 a[140:141], v10 offset:96
    ds_read_b64_tr_b16 a[142:143], v10 offset:4704
    ds_read_b64_tr_b16 a[144:145], v10 offset:128
    ds_read_b64_tr_b16 a[146:147], v10 offset:4736
    ds_read_b64_tr_b16 a[148:149], v10 offset:160
    ds_read_b64_tr_b16 a[150:151], v10 offset:4768
    ds_read_b64_tr_b16 a[152:153], v10 offset:192
    ds_read_b64_tr_b16 a[154:155], v10 offset:4800
    ds_read_b64_tr_b16 a[156:157], v10 offset:224
    ds_read_b64_tr_b16 a[158:159], v10 offset:4832
    ds_read_b64_tr_b16 a[160:161], v10 offset:256
    ds_read_b64_tr_b16 a[162:163], v10 offset:4864
    s_mov_b32 s36, s72
    s_mov_b32 s37, s73
    s_mov_b32 s38, 2359296
    s_mov_b32 s39, 0x00020000
    s_waitcnt vmcnt(1) lgkmcnt(12)
    v_mfma_f32_16x16x32_bf16 v[32:35], a[128:131], a[0:3], 0
    ds_read_b64_tr_b16 a[164:165], v10 offset:9216
    s_add_u32 s64, s64, 4096
    ds_read_b128 v[128:131], v23 offset:0
    v_mfma_f32_16x16x32_bf16 v[100:103], a[128:131], a[4:7], 0
    ds_read_b64_tr_b16 a[166:167], v10 offset:13824
    s_add_u32 s65, s65, 4096
    ds_read_b128 v[132:135], v23 offset:16
    v_mfma_f32_16x16x32_bf16 v[36:39], a[132:135], a[0:3], 0
    ds_read_b64_tr_b16 a[168:169], v10 offset:9248
    buffer_load_dwordx4 a[32:35], v29, s[52:55], s64 offen offset:0 sc1
    ds_read_b128 v[136:139], v23 offset:64
    v_mfma_f32_16x16x32_bf16 v[104:107], a[132:135], a[4:7], 0
    ds_read_b64_tr_b16 a[170:171], v10 offset:13856
    ds_read_b64_tr_b16 a[172:173], v10 offset:9280
    ds_read_b128 v[140:143], v23 offset:80
    v_mfma_f32_16x16x32_bf16 v[40:43], a[136:139], a[0:3], 0
    ds_read_b64_tr_b16 a[174:175], v10 offset:13888
    buffer_load_dwordx4 a[36:39], v29, s[52:55], s65 offen offset:0 sc1
    ds_read_b64 v[144:145], v24 offset:128
    v_mfma_f32_16x16x32_bf16 v[108:111], a[136:139], a[4:7], 0
    s_waitcnt lgkmcnt(15)
    buffer_load_dwordx4 a[40:43], v29, s[52:55], s64 offen offset:1024 sc1
    ds_read_b128 v[148:151], v23 offset:3072
    v_mfma_f32_16x16x32_bf16 v[44:47], a[140:143], a[0:3], 0
    ds_read_b64_tr_b16 a[176:177], v10 offset:9312
    buffer_load_dwordx4 a[44:47], v29, s[52:55], s65 offen offset:1024 sc1
    ds_read_b128 v[152:155], v23 offset:3088
    v_mfma_f32_16x16x32_bf16 v[112:115], a[140:143], a[4:7], 0
    ds_read_b64_tr_b16 a[178:179], v10 offset:13920
    buffer_load_dwordx4 a[48:51], v29, s[52:55], s64 offen offset:2048 sc1
    ds_read_b128 v[156:159], v23 offset:3136
    v_mfma_f32_16x16x32_bf16 v[48:51], a[144:147], a[0:3], 0
    ds_read_b64_tr_b16 a[180:181], v10 offset:9344
    ds_read_b64_tr_b16 a[182:183], v10 offset:13952
    ds_read_b128 v[160:163], v23 offset:3152
    v_mfma_f32_16x16x32_bf16 v[116:119], a[144:147], a[4:7], 0
    ds_read_b64_tr_b16 a[184:185], v10 offset:9376
    buffer_load_dwordx4 a[52:55], v29, s[52:55], s65 offen offset:2048 sc1
    ds_read_b64 v[164:165], v24 offset:3200
    v_mfma_f32_16x16x32_bf16 v[52:55], a[148:151], a[0:3], 0
    ds_read_b64_tr_b16 a[186:187], v10 offset:13984
    ds_read_b128 v[168:171], v23 offset:6144
    ds_read_b128 v[172:175], v23 offset:6160
    v_mfma_f32_16x16x32_bf16 v[200:203], a[148:151], a[4:7], 0
    s_waitcnt lgkmcnt(15)
    buffer_load_dwordx4 a[56:59], v29, s[52:55], s64 offen offset:3072 sc1
    ds_read_b128 v[176:179], v23 offset:6208
    v_mfma_f32_16x16x32_bf16 v[56:59], a[152:155], a[0:3], 0
    ds_read_b64_tr_b16 a[188:189], v10 offset:9408
    ds_read_b64_tr_b16 a[190:191], v10 offset:14016
    ds_read_b128 v[180:183], v23 offset:6224
    v_mfma_f32_16x16x32_bf16 v[204:207], a[152:155], a[4:7], 0
    ds_read_b64_tr_b16 a[192:193], v10 offset:9440
    buffer_load_dwordx4 a[60:63], v29, s[52:55], s65 offen offset:3072 sc1
    ds_read_b64 v[184:185], v24 offset:6272
    v_mfma_f32_16x16x32_bf16 v[60:63], a[156:159], a[0:3], 0
    ds_read_b64_tr_b16 a[194:195], v10 offset:14048
    s_add_u32 s64, s64, 4096
    ds_read_b128 v[232:235], v23 offset:9216
    v_mfma_f32_16x16x32_bf16 v[208:211], a[156:159], a[4:7], 0
    ds_read_b64_tr_b16 a[196:197], v10 offset:9472
    s_add_u32 s65, s65, 4096
    ds_read_b128 v[236:239], v23 offset:9232
    v_mfma_f32_16x16x32_bf16 v[96:99], a[160:163], a[0:3], 0
    ds_read_b64_tr_b16 a[198:199], v10 offset:14080
    buffer_load_dwordx4 a[64:67], v29, s[52:55], s64 offen offset:0 sc1
    ds_read_b128 v[240:243], v23 offset:9280
    v_mfma_f32_16x16x32_bf16 v[212:215], a[160:163], a[4:7], 0
    buffer_load_dwordx4 a[68:71], v29, s[52:55], s65 offen offset:0 sc1
    buffer_load_dwordx4 a[72:75], v29, s[52:55], s64 offen offset:1024 sc1
    ds_read_b128 v[244:247], v23 offset:9296
    s_waitcnt lgkmcnt(15)
    v_mfma_f32_16x16x32_bf16 v[32:35], a[164:167], a[8:11], v[32:35]
    ds_read_b64_tr_b16 a[128:129], v10 offset:18432
    buffer_load_dwordx4 a[76:79], v29, s[52:55], s65 offen offset:1024 sc1
    ds_read_b64 v[248:249], v24 offset:9344
    v_mfma_f32_16x16x32_bf16 v[100:103], a[164:167], a[12:15], v[100:103]
    ds_read_b64_tr_b16 a[130:131], v10 offset:23040
    buffer_load_dwordx4 a[80:83], v29, s[52:55], s64 offen offset:2048 sc1
    s_waitcnt lgkmcnt(15)
    v_mfma_f32_16x16x32_bf16 v[36:39], a[168:171], a[8:11], v[36:39]
    ds_read_b64_tr_b16 a[132:133], v10 offset:18464
    buffer_load_dwordx4 a[84:87], v29, s[52:55], s65 offen offset:2048 sc1
    v_add_f32 v128, v128, v148
    v_mfma_f32_16x16x32_bf16 v[104:107], a[168:171], a[12:15], v[104:107]
    ds_read_b64_tr_b16 a[134:135], v10 offset:23072
    ds_read_b64_tr_b16 a[136:137], v10 offset:18496
    v_add_f32 v129, v129, v149
    v_mfma_f32_16x16x32_bf16 v[40:43], a[172:175], a[8:11], v[40:43]
    ds_read_b64_tr_b16 a[138:139], v10 offset:23104
    buffer_load_dwordx4 a[88:91], v29, s[52:55], s64 offen offset:3072 sc1
    v_add_f32 v130, v130, v150
    v_mfma_f32_16x16x32_bf16 v[108:111], a[172:175], a[12:15], v[108:111]
    s_waitcnt lgkmcnt(15)
    buffer_load_dwordx4 a[92:95], v29, s[52:55], s65 offen offset:3072 sc1
    v_add_f32 v131, v131, v151
    v_mfma_f32_16x16x32_bf16 v[44:47], a[176:179], a[8:11], v[44:47]
    ds_read_b64_tr_b16 a[140:141], v10 offset:18528
    s_add_u32 s64, s64, 4096
    v_add_f32 v132, v132, v152
    v_add_f32 v133, v133, v153
    v_mfma_f32_16x16x32_bf16 v[112:115], a[176:179], a[12:15], v[112:115]
    ds_read_b64_tr_b16 a[142:143], v10 offset:23136
    s_add_u32 s65, s65, 4096
    v_add_f32 v134, v134, v154
    v_mfma_f32_16x16x32_bf16 v[48:51], a[180:183], a[8:11], v[48:51]
    ds_read_b64_tr_b16 a[144:145], v10 offset:18560
    ds_read_b64_tr_b16 a[146:147], v10 offset:23168
    v_add_f32 v135, v135, v155
    v_mfma_f32_16x16x32_bf16 v[116:119], a[180:183], a[12:15], v[116:119]
    ds_read_b64_tr_b16 a[148:149], v10 offset:18592
    buffer_load_dwordx4 a[96:99], v29, s[52:55], s64 offen offset:0 sc1
    v_add_f32 v136, v136, v156
    v_mfma_f32_16x16x32_bf16 v[52:55], a[184:187], a[8:11], v[52:55]
    ds_read_b64_tr_b16 a[150:151], v10 offset:23200
    v_add_f32 v137, v137, v157
    v_mfma_f32_16x16x32_bf16 v[200:203], a[184:187], a[12:15], v[200:203]
    s_waitcnt lgkmcnt(15)
    buffer_load_dwordx4 a[100:103], v29, s[52:55], s65 offen offset:0 sc1
    v_add_f32 v138, v138, v158
    v_add_f32 v139, v139, v159
    v_mfma_f32_16x16x32_bf16 v[56:59], a[188:191], a[8:11], v[56:59]
    ds_read_b64_tr_b16 a[152:153], v10 offset:18624
    ds_read_b64_tr_b16 a[154:155], v10 offset:23232
    v_add_f32 v140, v140, v160
    v_mfma_f32_16x16x32_bf16 v[204:207], a[188:191], a[12:15], v[204:207]
    ds_read_b64_tr_b16 a[156:157], v10 offset:18656
    buffer_load_dwordx4 a[104:107], v29, s[52:55], s64 offen offset:1024 sc1
    v_add_f32 v141, v141, v161
    v_mfma_f32_16x16x32_bf16 v[60:63], a[192:195], a[8:11], v[60:63]
    ds_read_b64_tr_b16 a[158:159], v10 offset:23264
    buffer_load_dwordx4 a[108:111], v29, s[52:55], s65 offen offset:1024 sc1
    v_add_f32 v142, v142, v162
    v_mfma_f32_16x16x32_bf16 v[208:211], a[192:195], a[12:15], v[208:211]
    ds_read_b64_tr_b16 a[160:161], v10 offset:18688
    buffer_load_dwordx4 a[112:115], v29, s[52:55], s64 offen offset:2048 sc1
    v_add_f32 v143, v143, v163
    v_mfma_f32_16x16x32_bf16 v[96:99], a[196:199], a[8:11], v[96:99]
    ds_read_b64_tr_b16 a[162:163], v10 offset:23296
    buffer_load_dwordx4 a[116:119], v29, s[52:55], s65 offen offset:2048 sc1
    v_add_f32 v144, v144, v164
    v_mfma_f32_16x16x32_bf16 v[212:215], a[196:199], a[12:15], v[212:215]
    buffer_load_dwordx4 a[120:123], v29, s[52:55], s64 offen offset:3072 sc1
    buffer_load_dwordx4 a[124:127], v29, s[52:55], s65 offen offset:3072 sc1
    v_add_f32 v145, v145, v165
    s_waitcnt lgkmcnt(12)
    v_mfma_f32_16x16x32_bf16 v[32:35], a[128:131], a[16:19], v[32:35]
    ds_read_b64_tr_b16 a[164:165], v10 offset:27648
    ds_read_b64_tr_b16 a[166:167], v10 offset:32256
    v_mfma_f32_16x16x32_bf16 v[100:103], a[128:131], a[20:23], v[100:103]
    ds_read_b64_tr_b16 a[168:169], v10 offset:27680
    v_add_f32 v168, v168, v232
    v_mfma_f32_16x16x32_bf16 v[36:39], a[132:135], a[16:19], v[36:39]
    ds_read_b64_tr_b16 a[170:171], v10 offset:32288
    ds_read_b64_tr_b16 a[172:173], v10 offset:27712
    v_mfma_f32_16x16x32_bf16 v[104:107], a[132:135], a[20:23], v[104:107]
    ds_read_b64_tr_b16 a[174:175], v10 offset:32320
    ds_read_b64_tr_b16 a[176:177], v10 offset:27744
    v_add_f32 v169, v169, v233
    v_mfma_f32_16x16x32_bf16 v[40:43], a[136:139], a[16:19], v[40:43]
    ds_read_b64_tr_b16 a[178:179], v10 offset:32352
    v_add_f32 v170, v170, v234
    v_mfma_f32_16x16x32_bf16 v[108:111], a[136:139], a[20:23], v[108:111]
    s_waitcnt lgkmcnt(14)
    ds_read_b64_tr_b16 a[180:181], v10 offset:27776
    v_mfma_f32_16x16x32_bf16 v[44:47], a[140:143], a[16:19], v[44:47]
    ds_read_b64_tr_b16 a[182:183], v10 offset:32384
    ds_read_b64_tr_b16 a[184:185], v10 offset:27808
    v_add_f32 v171, v171, v235
    v_mfma_f32_16x16x32_bf16 v[112:115], a[140:143], a[20:23], v[112:115]
    ds_read_b64_tr_b16 a[186:187], v10 offset:32416
    v_add_f32 v172, v172, v236
    v_mfma_f32_16x16x32_bf16 v[48:51], a[144:147], a[16:19], v[48:51]
    ds_read_b64_tr_b16 a[188:189], v10 offset:27840
    ds_read_b64_tr_b16 a[190:191], v10 offset:32448
    v_add_f32 v173, v173, v237
    v_mfma_f32_16x16x32_bf16 v[116:119], a[144:147], a[20:23], v[116:119]
    ds_read_b64_tr_b16 a[192:193], v10 offset:27872
    ds_read_b64_tr_b16 a[194:195], v10 offset:32480
    v_mfma_f32_16x16x32_bf16 v[52:55], a[148:151], a[16:19], v[52:55]
    ds_read_b64_tr_b16 a[196:197], v10 offset:27904
    v_add_f32 v174, v174, v238
    v_mfma_f32_16x16x32_bf16 v[200:203], a[148:151], a[20:23], v[200:203]
    s_waitcnt lgkmcnt(15)
    ds_read_b64_tr_b16 a[198:199], v10 offset:32512
    v_add_f32 v175, v175, v239
    v_mfma_f32_16x16x32_bf16 v[56:59], a[152:155], a[16:19], v[56:59]
    v_add_f32 v176, v176, v240
    v_add_f32 v177, v177, v241
    v_mfma_f32_16x16x32_bf16 v[204:207], a[152:155], a[20:23], v[204:207]
    v_add_f32 v178, v178, v242
    v_mfma_f32_16x16x32_bf16 v[60:63], a[156:159], a[16:19], v[60:63]
    v_add_f32 v179, v179, v243
    v_add_f32 v180, v180, v244
    v_mfma_f32_16x16x32_bf16 v[208:211], a[156:159], a[20:23], v[208:211]
    v_add_f32 v181, v181, v245
    v_add_f32 v182, v182, v246
    v_mfma_f32_16x16x32_bf16 v[96:99], a[160:163], a[16:19], v[96:99]
    v_add_f32 v183, v183, v247
    v_mfma_f32_16x16x32_bf16 v[212:215], a[160:163], a[20:23], v[212:215]
    v_add_f32 v184, v184, v248
    v_add_f32 v185, v185, v249
    s_waitcnt lgkmcnt(0)
    v_mfma_f32_16x16x32_bf16 v[32:35], a[164:167], a[24:27], v[32:35]
    s_barrier
    v_add_f32 v128, v128, v168
    v_add_f32 v129, v129, v169
    v_mfma_f32_16x16x32_bf16 v[100:103], a[164:167], a[28:31], v[100:103]
    ds_read_b64_tr_b16 a[128:129], v11 offset:0
    s_mul_i32 s71, s83, -147456
    v_mfma_f32_16x16x32_bf16 v[36:39], a[168:171], a[24:27], v[36:39]
    ds_read_b64_tr_b16 a[130:131], v11 offset:4608
    v_add_f32 v130, v130, v170
    v_add_f32 v131, v131, v171
    v_mfma_f32_16x16x32_bf16 v[104:107], a[168:171], a[28:31], v[104:107]
    ds_read_b64_tr_b16 a[132:133], v11 offset:32
    s_add_u32 s71, s71, 147456
    v_add_f32 v132, v132, v172
    v_mfma_f32_16x16x32_bf16 v[40:43], a[172:175], a[24:27], v[40:43]
    ds_read_b64_tr_b16 a[134:135], v11 offset:4640
    ds_read_b64_tr_b16 a[136:137], v11 offset:64
    v_mfma_f32_16x16x32_bf16 v[108:111], a[172:175], a[28:31], v[108:111]
    ds_read_b64_tr_b16 a[138:139], v11 offset:4672
    v_add_f32 v133, v133, v173
    v_add_f32 v134, v134, v174
    v_mfma_f32_16x16x32_bf16 v[44:47], a[176:179], a[24:27], v[44:47]
    ds_read_b64_tr_b16 a[140:141], v11 offset:96
    s_add_u32 s71, s71, s68
    v_add_f32 v135, v135, v175
    v_mfma_f32_16x16x32_bf16 v[112:115], a[176:179], a[28:31], v[112:115]
    ds_read_b64_tr_b16 a[142:143], v11 offset:4704
    v_add_f32 v136, v136, v176
    v_mfma_f32_16x16x32_bf16 v[48:51], a[180:183], a[24:27], v[48:51]
    ds_read_b64_tr_b16 a[144:145], v11 offset:128
    s_add_u32 m0, s69, 0
    v_add_f32 v137, v137, v177
    v_mfma_f32_16x16x32_bf16 v[116:119], a[180:183], a[28:31], v[116:119]
    ds_read_b64_tr_b16 a[146:147], v11 offset:4736
    s_nop 0
    v_add_f32 v138, v138, v178
    v_mfma_f32_16x16x32_bf16 v[52:55], a[184:187], a[24:27], v[52:55]
    ds_read_b64_tr_b16 a[148:149], v11 offset:160
    v_add_f32 v139, v139, v179
    v_mfma_f32_16x16x32_bf16 v[200:203], a[184:187], a[28:31], v[200:203]
    ds_read_b64_tr_b16 a[150:151], v11 offset:4768
    buffer_load_dwordx4 v29, s[32:35], s71 offen offset:0 sc1 lds
    v_add_f32 v140, v140, v180
    v_mfma_f32_16x16x32_bf16 v[56:59], a[188:191], a[24:27], v[56:59]
    ds_read_b64_tr_b16 a[152:153], v11 offset:192
    ds_read_b64_tr_b16 a[154:155], v11 offset:4800
    v_add_f32 v141, v141, v181
    v_mfma_f32_16x16x32_bf16 v[204:207], a[188:191], a[28:31], v[204:207]
    ds_read_b64_tr_b16 a[156:157], v11 offset:224
    v_add_f32 v142, v142, v182
    v_mfma_f32_16x16x32_bf16 v[60:63], a[192:195], a[24:27], v[60:63]
    ds_read_b64_tr_b16 a[158:159], v11 offset:4832
    buffer_load_dwordx4 v29, s[32:35], s71 offen offset:1024 sc1 lds
    v_add_f32 v143, v143, v183
    v_mfma_f32_16x16x32_bf16 v[208:211], a[192:195], a[28:31], v[208:211]
    ds_read_b64_tr_b16 a[160:161], v11 offset:256
    v_add_f32 v144, v144, v184
    v_add_f32 v145, v145, v185
    v_mfma_f32_16x16x32_bf16 v[96:99], a[196:199], a[24:27], v[96:99]
    ds_read_b64_tr_b16 a[162:163], v11 offset:4864
    buffer_load_dwordx4 v29, s[32:35], s71 offen offset:2048 sc1 lds
    v_mfma_f32_16x16x32_bf16 v[212:215], a[196:199], a[28:31], v[212:215]
    buffer_load_dwordx4 v29, s[32:35], s71 offen offset:3072 sc1 lds
    v_cvt_pk_bf16_f32 v188, v128, v129
    v_cvt_pk_bf16_f32 v189, v130, v131
    s_waitcnt vmcnt(20) lgkmcnt(12)
    v_mfma_f32_16x16x32_bf16 v[32:35], a[128:131], a[32:35], v[32:35]
    ds_read_b64_tr_b16 a[164:165], v11 offset:9216
    s_add_u32 m0, s69, 4096
    v_cvt_pk_bf16_f32 v190, v132, v133
    v_mfma_f32_16x16x32_bf16 v[100:103], a[128:131], a[36:39], v[100:103]
    ds_read_b64_tr_b16 a[166:167], v11 offset:13824
    v_cvt_pk_bf16_f32 v191, v134, v135
    v_cvt_pk_bf16_f32 v192, v136, v137
    v_mfma_f32_16x16x32_bf16 v[36:39], a[132:135], a[32:35], v[36:39]
    ds_read_b64_tr_b16 a[168:169], v11 offset:9248
    s_add_u32 s71, s71, 4096
    v_mfma_f32_16x16x32_bf16 v[104:107], a[132:135], a[36:39], v[104:107]
    ds_read_b64_tr_b16 a[170:171], v11 offset:13856
    ds_read_b64_tr_b16 a[172:173], v11 offset:9280
    v_cvt_pk_bf16_f32 v193, v138, v139
    v_mfma_f32_16x16x32_bf16 v[40:43], a[136:139], a[32:35], v[40:43]
    ds_read_b64_tr_b16 a[174:175], v11 offset:13888
    v_cvt_pk_bf16_f32 v194, v140, v141
    v_cvt_pk_bf16_f32 v195, v142, v143
    v_mfma_f32_16x16x32_bf16 v[108:111], a[136:139], a[36:39], v[108:111]
    s_waitcnt lgkmcnt(12)
    buffer_load_dwordx4 v29, s[32:35], s71 offen offset:0 sc1 lds
    v_cvt_pk_bf16_f32 v196, v144, v145
    v_mfma_f32_16x16x32_bf16 v[44:47], a[140:143], a[32:35], v[44:47]
    ds_read_b64_tr_b16 a[176:177], v11 offset:9312
    v_cndmask_b32 v188, 0, v188, s[40:41]
    v_mfma_f32_16x16x32_bf16 v[112:115], a[140:143], a[36:39], v[112:115]
    ds_read_b64_tr_b16 a[178:179], v11 offset:13920
    buffer_load_dwordx4 v29, s[32:35], s71 offen offset:1024 sc1 lds
    v_cndmask_b32 v189, 0, v189, s[40:41]
    v_mfma_f32_16x16x32_bf16 v[48:51], a[144:147], a[32:35], v[48:51]
    ds_read_b64_tr_b16 a[180:181], v11 offset:9344
    ds_read_b64_tr_b16 a[182:183], v11 offset:13952
    v_cndmask_b32 v190, 0, v190, s[40:41]
    v_mfma_f32_16x16x32_bf16 v[116:119], a[144:147], a[36:39], v[116:119]
    ds_read_b64_tr_b16 a[184:185], v11 offset:9376
    buffer_load_dwordx4 v29, s[32:35], s71 offen offset:2048 sc1 lds
    v_cndmask_b32 v191, 0, v191, s[40:41]
    v_mfma_f32_16x16x32_bf16 v[52:55], a[148:151], a[32:35], v[52:55]
    ds_read_b64_tr_b16 a[186:187], v11 offset:13984
    v_cndmask_b32 v192, 0, v192, s[40:41]
    v_cndmask_b32 v193, 0, v193, s[40:41]
    v_mfma_f32_16x16x32_bf16 v[200:203], a[148:151], a[36:39], v[200:203]
    s_waitcnt lgkmcnt(12)
    buffer_load_dwordx4 v29, s[32:35], s71 offen offset:3072 sc1 lds
    v_mfma_f32_16x16x32_bf16 v[56:59], a[152:155], a[32:35], v[56:59]
    ds_read_b64_tr_b16 a[188:189], v11 offset:9408
    ds_read_b64_tr_b16 a[190:191], v11 offset:14016
    v_cndmask_b32 v194, 0, v194, s[40:41]
    v_mfma_f32_16x16x32_bf16 v[204:207], a[152:155], a[36:39], v[204:207]
    ds_read_b64_tr_b16 a[192:193], v11 offset:9440
    v_cndmask_b32 v195, 0, v195, s[40:41]
    v_cndmask_b32 v196, 0, v196, s[40:41]
    v_mfma_f32_16x16x32_bf16 v[60:63], a[156:159], a[32:35], v[60:63]
    ds_read_b64_tr_b16 a[194:195], v11 offset:14048
    s_add_u32 m0, s69, 8192
    v_mov_b32 v197, 0
    v_mfma_f32_16x16x32_bf16 v[208:211], a[156:159], a[36:39], v[208:211]
    ds_read_b64_tr_b16 a[196:197], v11 offset:9472
    v_mov_b32 v198, 0
    v_mfma_f32_16x16x32_bf16 v[96:99], a[160:163], a[32:35], v[96:99]
    ds_read_b64_tr_b16 a[198:199], v11 offset:14080
    s_add_u32 s71, s71, 4096
    v_mov_b32 v199, 0
    v_mfma_f32_16x16x32_bf16 v[212:215], a[160:163], a[36:39], v[212:215]
    buffer_load_dwordx4 v29, s[32:35], s71 offen offset:0 sc1 lds
    v_mfma_f32_32x32x16_bf16 v[64:79], v[188:191], v[224:227], 0
    s_waitcnt lgkmcnt(12)
    v_mfma_f32_16x16x32_bf16 v[32:35], a[164:167], a[40:43], v[32:35]
    ds_read_b64_tr_b16 a[128:129], v11 offset:18432
    v_mfma_f32_32x32x16_bf16 v[80:95], v[188:191], v[220:223], 0
    v_mfma_f32_16x16x32_bf16 v[100:103], a[164:167], a[44:47], v[100:103]
    ds_read_b64_tr_b16 a[130:131], v11 offset:23040
    v_mfma_f32_32x32x16_bf16 v[64:79], v[192:195], v[228:231], v[64:79]
    v_mfma_f32_16x16x32_bf16 v[36:39], a[168:171], a[40:43], v[36:39]
    ds_read_b64_tr_b16 a[132:133], v11 offset:18464
    v_cmp_lt_u32 vcc, 0, v28
    s_nop 0
    s_cmp_eq_u64 vcc, -1
    s_cbranch_scc0 f1_pd_e
f1_pd_r:
    v_mfma_f32_16x16x32_bf16 v[104:107], a[168:171], a[44:47], v[104:107]
    ds_read_b64_tr_b16 a[134:135], v11 offset:23072
    ds_read_b64_tr_b16 a[136:137], v11 offset:18496
    v_mfma_f32_32x32x16_bf16 v[80:95], v[192:195], v[120:123], v[80:95]
    v_mfma_f32_16x16x32_bf16 v[40:43], a[172:175], a[40:43], v[40:43]
    ds_read_b64_tr_b16 a[138:139], v11 offset:23104
    v_mfma_f32_32x32x16_bf16 v[64:79], v[196:199], v[216:219], v[64:79]
    v_mfma_f32_16x16x32_bf16 v[108:111], a[172:175], a[44:47], v[108:111]
    s_waitcnt lgkmcnt(12)
    v_mfma_f32_32x32x16_bf16 v[80:95], v[196:199], v[124:127], v[80:95]
    v_mfma_f32_16x16x32_bf16 v[44:47], a[176:179], a[40:43], v[44:47]
    ds_read_b64_tr_b16 a[140:141], v11 offset:18528
    s_lshl_b32 s24, s83, 15
    s_sub_u32 s24, 4096, s24
    s_add_u32 s64, s64, s24
    s_add_u32 s65, s65, s24
    v_mfma_f32_16x16x32_bf16 v[112:115], a[176:179], a[44:47], v[112:115]
    ds_read_b64_tr_b16 a[142:143], v11 offset:23136
    v_sub_f32 v25, 1.0, v6
    v_mfma_f32_16x16x32_bf16 v[48:51], a[180:183], a[40:43], v[48:51]
    ds_read_b64_tr_b16 a[144:145], v11 offset:18560
    ds_read_b64_tr_b16 a[146:147], v11 offset:23168
    s_nop 0
    v_cvt_pk_bf16_f32 v25, v25, v25
    v_mfma_f32_16x16x32_bf16 v[116:119], a[180:183], a[44:47], v[116:119]
    ds_read_b64_tr_b16 a[148:149], v11 offset:18592
    buffer_load_dwordx4 a[0:3], v29, s[52:55], s64 offen offset:0 sc1
    v_and_b32 v25, 0xffff0000, v25
    v_mfma_f32_16x16x32_bf16 v[52:55], a[184:187], a[40:43], v[52:55]
    ds_read_b64_tr_b16 a[150:151], v11 offset:23200
    buffer_load_dwordx4 a[4:7], v29, s[52:55], s65 offen offset:0 sc1
    v_sub_f32 v26, 1.0, v7
    v_mfma_f32_16x16x32_bf16 v[200:203], a[184:187], a[44:47], v[200:203]
    s_waitcnt lgkmcnt(12)
    buffer_load_dwordx4 a[8:11], v29, s[52:55], s64 offen offset:1024 sc1
    s_nop 0
    v_mfma_f32_16x16x32_bf16 v[56:59], a[188:191], a[40:43], v[56:59]
    ds_read_b64_tr_b16 a[152:153], v11 offset:18624
    ds_read_b64_tr_b16 a[154:155], v11 offset:23232
    v_cvt_pk_bf16_f32 v26, v26, v26
    v_and_b32 v26, 0xffff0000, v26
    v_mfma_f32_16x16x32_bf16 v[204:207], a[188:191], a[44:47], v[204:207]
    ds_read_b64_tr_b16 a[156:157], v11 offset:18656
    buffer_load_dwordx4 a[12:15], v29, s[52:55], s65 offen offset:1024 sc1
    v_add_f32 v20, s82, v74
    v_mfma_f32_16x16x32_bf16 v[60:63], a[192:195], a[40:43], v[60:63]
    ds_read_b64_tr_b16 a[158:159], v11 offset:23264
    buffer_load_dwordx4 a[16:19], v29, s[52:55], s64 offen offset:2048 sc1
    v_rcp_f32 v20, v20
    v_mfma_f32_16x16x32_bf16 v[208:211], a[192:195], a[44:47], v[208:211]
    ds_read_b64_tr_b16 a[160:161], v11 offset:18688
    buffer_load_dwordx4 a[20:23], v29, s[52:55], s65 offen offset:2048 sc1
    s_nop 0
    v_mfma_f32_16x16x32_bf16 v[96:99], a[196:199], a[40:43], v[96:99]
    ds_read_b64_tr_b16 a[162:163], v11 offset:23296
    buffer_load_dwordx4 a[24:27], v29, s[52:55], s64 offen offset:3072 sc1
    v_mul_f32 v20, v20, v25
    v_mfma_f32_16x16x32_bf16 v[212:215], a[196:199], a[44:47], v[212:215]
    buffer_load_dwordx4 a[28:31], v29, s[52:55], s65 offen offset:3072 sc1
    v_mul_f32 v64, v64, v20
    v_mul_f32 v65, v65, v20
    s_waitcnt lgkmcnt(12)
    v_mfma_f32_16x16x32_bf16 v[32:35], a[128:131], a[48:51], v[32:35]
    ds_read_b64_tr_b16 a[164:165], v11 offset:27648
    ds_read_b64_tr_b16 a[166:167], v11 offset:32256
    v_mul_f32 v66, v66, v20
    v_mfma_f32_16x16x32_bf16 v[100:103], a[128:131], a[52:55], v[100:103]
    ds_read_b64_tr_b16 a[168:169], v11 offset:27680
    v_mul_f32 v67, v67, v20
    v_mfma_f32_16x16x32_bf16 v[36:39], a[132:135], a[48:51], v[36:39]
    ds_read_b64_tr_b16 a[170:171], v11 offset:32288
    ds_read_b64_tr_b16 a[172:173], v11 offset:27712
    v_mfma_f32_16x16x32_bf16 v[104:107], a[132:135], a[52:55], v[104:107]
    ds_read_b64_tr_b16 a[174:175], v11 offset:32320
    ds_read_b64_tr_b16 a[176:177], v11 offset:27744
    v_mul_f32 v68, v68, v20
    v_mfma_f32_16x16x32_bf16 v[40:43], a[136:139], a[48:51], v[40:43]
    ds_read_b64_tr_b16 a[178:179], v11 offset:32352
    v_mul_f32 v69, v69, v20
    v_mfma_f32_16x16x32_bf16 v[108:111], a[136:139], a[52:55], v[108:111]
    s_waitcnt lgkmcnt(14)
    ds_read_b64_tr_b16 a[180:181], v11 offset:27776
    v_mul_f32 v70, v70, v20
    v_mfma_f32_16x16x32_bf16 v[44:47], a[140:143], a[48:51], v[44:47]
    ds_read_b64_tr_b16 a[182:183], v11 offset:32384
    ds_read_b64_tr_b16 a[184:185], v11 offset:27808
    v_mul_f32 v71, v71, v20
    v_mfma_f32_16x16x32_bf16 v[112:115], a[140:143], a[52:55], v[112:115]
    ds_read_b64_tr_b16 a[186:187], v11 offset:32416
    v_mul_f32 v72, v72, v20
    v_mfma_f32_16x16x32_bf16 v[48:51], a[144:147], a[48:51], v[48:51]
    ds_read_b64_tr_b16 a[188:189], v11 offset:27840
    ds_read_b64_tr_b16 a[190:191], v11 offset:32448
    v_mfma_f32_16x16x32_bf16 v[116:119], a[144:147], a[52:55], v[116:119]
    ds_read_b64_tr_b16 a[192:193], v11 offset:27872
    ds_read_b64_tr_b16 a[194:195], v11 offset:32480
    v_mul_f32 v73, v73, v20
    v_mfma_f32_16x16x32_bf16 v[52:55], a[148:151], a[48:51], v[52:55]
    ds_read_b64_tr_b16 a[196:197], v11 offset:27904
    v_cvt_pk_bf16_f32 v64, v64, v65
    v_mfma_f32_16x16x32_bf16 v[200:203], a[148:151], a[52:55], v[200:203]
    s_waitcnt lgkmcnt(15)
    ds_read_b64_tr_b16 a[198:199], v11 offset:32512
    v_cvt_pk_bf16_f32 v65, v66, v67
    v_mfma_f32_16x16x32_bf16 v[56:59], a[152:155], a[48:51], v[56:59]
    v_cvt_pk_bf16_f32 v66, v68, v69
    v_cvt_pk_bf16_f32 v67, v70, v71
    v_mfma_f32_16x16x32_bf16 v[204:207], a[152:155], a[52:55], v[204:207]
    v_cvt_pk_bf16_f32 v68, v72, v73
    s_add_u32 s25, s78, s80
    v_mfma_f32_16x16x32_bf16 v[60:63], a[156:159], a[48:51], v[60:63]
    buffer_store_dwordx4 v[64:67], v8, s[52:55], s25 offen sc1
    v_mfma_f32_16x16x32_bf16 v[208:211], a[156:159], a[52:55], v[208:211]
    s_add_u32 s25, s78, s81
    buffer_store_dword v68, v9, s[52:55], s25 offen sc1
    v_mfma_f32_16x16x32_bf16 v[96:99], a[160:163], a[48:51], v[96:99]
    v_add_f32 v20, s82, v90
    v_rcp_f32 v20, v20
    v_mfma_f32_16x16x32_bf16 v[212:215], a[160:163], a[52:55], v[212:215]
    s_nop 0
    s_waitcnt lgkmcnt(0)
    v_mfma_f32_16x16x32_bf16 v[32:35], a[164:167], a[56:59], v[32:35]
    s_barrier
    v_mul_f32 v20, v20, v26
    v_mul_f32 v80, v80, v20
    v_mfma_f32_16x16x32_bf16 v[100:103], a[164:167], a[60:63], v[100:103]
    ds_read_b64_tr_b16 a[128:129], v12 offset:0
    s_mul_i32 s71, s83, -147456
    v_mfma_f32_16x16x32_bf16 v[36:39], a[168:171], a[56:59], v[36:39]
    ds_read_b64_tr_b16 a[130:131], v12 offset:4608
    v_mul_f32 v81, v81, v20
    v_mul_f32 v82, v82, v20
    v_mfma_f32_16x16x32_bf16 v[104:107], a[168:171], a[60:63], v[104:107]
    ds_read_b64_tr_b16 a[132:133], v12 offset:32
    s_add_u32 s71, s71, 184320
    v_mul_f32 v83, v83, v20
    v_mfma_f32_16x16x32_bf16 v[40:43], a[172:175], a[56:59], v[40:43]
    ds_read_b64_tr_b16 a[134:135], v12 offset:4640
    ds_read_b64_tr_b16 a[136:137], v12 offset:64
    v_mfma_f32_16x16x32_bf16 v[108:111], a[172:175], a[60:63], v[108:111]
    ds_read_b64_tr_b16 a[138:139], v12 offset:4672
    v_mul_f32 v84, v84, v20
    v_mul_f32 v85, v85, v20
    v_mfma_f32_16x16x32_bf16 v[44:47], a[176:179], a[56:59], v[44:47]
    ds_read_b64_tr_b16 a[140:141], v12 offset:96
    s_add_u32 s71, s71, s68
    v_mul_f32 v86, v86, v20
    v_mfma_f32_16x16x32_bf16 v[112:115], a[176:179], a[60:63], v[112:115]
    ds_read_b64_tr_b16 a[142:143], v12 offset:4704
    v_mul_f32 v87, v87, v20
    v_mfma_f32_16x16x32_bf16 v[48:51], a[180:183], a[56:59], v[48:51]
    ds_read_b64_tr_b16 a[144:145], v12 offset:128
    s_add_u32 m0, s69, 36864
    v_mul_f32 v88, v88, v20
    v_mfma_f32_16x16x32_bf16 v[116:119], a[180:183], a[60:63], v[116:119]
    ds_read_b64_tr_b16 a[146:147], v12 offset:4736
    s_nop 0
    v_mul_f32 v89, v89, v20
    v_mfma_f32_16x16x32_bf16 v[52:55], a[184:187], a[56:59], v[52:55]
    ds_read_b64_tr_b16 a[148:149], v12 offset:160
    v_cvt_pk_bf16_f32 v80, v80, v81
    v_mfma_f32_16x16x32_bf16 v[200:203], a[184:187], a[60:63], v[200:203]
    ds_read_b64_tr_b16 a[150:151], v12 offset:4768
    buffer_load_dwordx4 v29, s[32:35], s71 offen offset:0 sc1 lds
    v_cvt_pk_bf16_f32 v81, v82, v83
    v_mfma_f32_16x16x32_bf16 v[56:59], a[188:191], a[56:59], v[56:59]
    ds_read_b64_tr_b16 a[152:153], v12 offset:192
    ds_read_b64_tr_b16 a[154:155], v12 offset:4800
    v_cvt_pk_bf16_f32 v82, v84, v85
    v_mfma_f32_16x16x32_bf16 v[204:207], a[188:191], a[60:63], v[204:207]
    ds_read_b64_tr_b16 a[156:157], v12 offset:224
    v_cvt_pk_bf16_f32 v83, v86, v87
    v_mfma_f32_16x16x32_bf16 v[60:63], a[192:195], a[56:59], v[60:63]
    ds_read_b64_tr_b16 a[158:159], v12 offset:4832
    buffer_load_dwordx4 v29, s[32:35], s71 offen offset:1024 sc1 lds
    v_cvt_pk_bf16_f32 v84, v88, v89
    v_mfma_f32_16x16x32_bf16 v[208:211], a[192:195], a[60:63], v[208:211]
    ds_read_b64_tr_b16 a[160:161], v12 offset:256
    s_add_u32 s25, s79, s80
    buffer_store_dwordx4 v[80:83], v8, s[52:55], s25 offen sc1
    v_mfma_f32_16x16x32_bf16 v[96:99], a[196:199], a[56:59], v[96:99]
    ds_read_b64_tr_b16 a[162:163], v12 offset:4864
    buffer_load_dwordx4 v29, s[32:35], s71 offen offset:2048 sc1 lds
    v_mfma_f32_16x16x32_bf16 v[212:215], a[196:199], a[60:63], v[212:215]
    buffer_load_dwordx4 v29, s[32:35], s71 offen offset:3072 sc1 lds
    s_add_u32 s25, s79, s81
    buffer_store_dword v84, v9, s[52:55], s25 offen sc1
    s_waitcnt vmcnt(33) lgkmcnt(12)
    v_mfma_f32_16x16x32_bf16 v[32:35], a[128:131], a[64:67], v[32:35]
    ds_read_b64_tr_b16 a[164:165], v12 offset:9216
    s_add_u32 m0, s69, 40960
    v_mfma_f32_16x16x32_bf16 v[100:103], a[128:131], a[68:71], v[100:103]
    ds_read_b64_tr_b16 a[166:167], v12 offset:13824
    v_mfma_f32_16x16x32_bf16 v[36:39], a[132:135], a[64:67], v[36:39]
    ds_read_b64_tr_b16 a[168:169], v12 offset:9248
    s_add_u32 s71, s71, 4096
    v_mfma_f32_16x16x32_bf16 v[104:107], a[132:135], a[68:71], v[104:107]
    ds_read_b64_tr_b16 a[170:171], v12 offset:13856
    ds_read_b64_tr_b16 a[172:173], v12 offset:9280
    v_mfma_f32_16x16x32_bf16 v[40:43], a[136:139], a[64:67], v[40:43]
    ds_read_b64_tr_b16 a[174:175], v12 offset:13888
    v_mfma_f32_16x16x32_bf16 v[108:111], a[136:139], a[68:71], v[108:111]
    s_waitcnt lgkmcnt(12)
    buffer_load_dwordx4 v29, s[32:35], s71 offen offset:0 sc1 lds
    v_mfma_f32_16x16x32_bf16 v[44:47], a[140:143], a[64:67], v[44:47]
    ds_read_b64_tr_b16 a[176:177], v12 offset:9312
    v_mfma_f32_16x16x32_bf16 v[112:115], a[140:143], a[68:71], v[112:115]
    ds_read_b64_tr_b16 a[178:179], v12 offset:13920
    buffer_load_dwordx4 v29, s[32:35], s71 offen offset:1024 sc1 lds
    v_mfma_f32_16x16x32_bf16 v[48:51], a[144:147], a[64:67], v[48:51]
    ds_read_b64_tr_b16 a[180:181], v12 offset:9344
    ds_read_b64_tr_b16 a[182:183], v12 offset:13952
    v_mfma_f32_16x16x32_bf16 v[116:119], a[144:147], a[68:71], v[116:119]
    ds_read_b64_tr_b16 a[184:185], v12 offset:9376
    buffer_load_dwordx4 v29, s[32:35], s71 offen offset:2048 sc1 lds
    v_mfma_f32_16x16x32_bf16 v[52:55], a[148:151], a[64:67], v[52:55]
    ds_read_b64_tr_b16 a[186:187], v12 offset:13984
    v_mfma_f32_16x16x32_bf16 v[200:203], a[148:151], a[68:71], v[200:203]
    s_waitcnt lgkmcnt(12)
    buffer_load_dwordx4 v29, s[32:35], s71 offen offset:3072 sc1 lds
    v_mfma_f32_16x16x32_bf16 v[56:59], a[152:155], a[64:67], v[56:59]
    ds_read_b64_tr_b16 a[188:189], v12 offset:9408
    ds_read_b64_tr_b16 a[190:191], v12 offset:14016
    v_mfma_f32_16x16x32_bf16 v[204:207], a[152:155], a[68:71], v[204:207]
    ds_read_b64_tr_b16 a[192:193], v12 offset:9440
    v_mfma_f32_16x16x32_bf16 v[60:63], a[156:159], a[64:67], v[60:63]
    ds_read_b64_tr_b16 a[194:195], v12 offset:14048
    s_add_u32 m0, s69, 45056
    v_mfma_f32_16x16x32_bf16 v[208:211], a[156:159], a[68:71], v[208:211]
    ds_read_b64_tr_b16 a[196:197], v12 offset:9472
    v_mfma_f32_16x16x32_bf16 v[96:99], a[160:163], a[64:67], v[96:99]
    ds_read_b64_tr_b16 a[198:199], v12 offset:14080
    s_add_u32 s71, s71, 4096
    v_mfma_f32_16x16x32_bf16 v[212:215], a[160:163], a[68:71], v[212:215]
    buffer_load_dwordx4 v29, s[32:35], s71 offen offset:0 sc1 lds
    s_waitcnt lgkmcnt(12)
    v_mfma_f32_16x16x32_bf16 v[32:35], a[164:167], a[72:75], v[32:35]
    ds_read_b64_tr_b16 a[128:129], v12 offset:18432
    s_add_u32 s64, s64, 4096
    v_mfma_f32_16x16x32_bf16 v[100:103], a[164:167], a[76:79], v[100:103]
    ds_read_b64_tr_b16 a[130:131], v12 offset:23040
    v_mfma_f32_16x16x32_bf16 v[36:39], a[168:171], a[72:75], v[36:39]
    ds_read_b64_tr_b16 a[132:133], v12 offset:18464
    s_add_u32 s65, s65, 4096
    v_mfma_f32_16x16x32_bf16 v[104:107], a[168:171], a[76:79], v[104:107]
    ds_read_b64_tr_b16 a[134:135], v12 offset:23072
    ds_read_b64_tr_b16 a[136:137], v12 offset:18496
    v_mfma_f32_16x16x32_bf16 v[40:43], a[172:175], a[72:75], v[40:43]
    ds_read_b64_tr_b16 a[138:139], v12 offset:23104
    buffer_load_dwordx4 a[32:35], v29, s[52:55], s64 offen offset:0 sc1
    v_mfma_f32_16x16x32_bf16 v[108:111], a[172:175], a[76:79], v[108:111]
    s_waitcnt lgkmcnt(12)
    v_mfma_f32_16x16x32_bf16 v[44:47], a[176:179], a[72:75], v[44:47]
    ds_read_b64_tr_b16 a[140:141], v12 offset:18528
    buffer_load_dwordx4 a[36:39], v29, s[52:55], s65 offen offset:0 sc1
    v_mfma_f32_16x16x32_bf16 v[112:115], a[176:179], a[76:79], v[112:115]
    ds_read_b64_tr_b16 a[142:143], v12 offset:23136
    v_mfma_f32_16x16x32_bf16 v[48:51], a[180:183], a[72:75], v[48:51]
    ds_read_b64_tr_b16 a[144:145], v12 offset:18560
    ds_read_b64_tr_b16 a[146:147], v12 offset:23168
    v_mfma_f32_16x16x32_bf16 v[116:119], a[180:183], a[76:79], v[116:119]
    ds_read_b64_tr_b16 a[148:149], v12 offset:18592
    buffer_load_dwordx4 a[40:43], v29, s[52:55], s64 offen offset:1024 sc1
    v_mfma_f32_16x16x32_bf16 v[52:55], a[184:187], a[72:75], v[52:55]
    ds_read_b64_tr_b16 a[150:151], v12 offset:23200
    buffer_load_dwordx4 a[44:47], v29, s[52:55], s65 offen offset:1024 sc1
    v_mfma_f32_16x16x32_bf16 v[200:203], a[184:187], a[76:79], v[200:203]
    s_waitcnt lgkmcnt(12)
    v_mfma_f32_16x16x32_bf16 v[56:59], a[188:191], a[72:75], v[56:59]
    ds_read_b64_tr_b16 a[152:153], v12 offset:18624
    ds_read_b64_tr_b16 a[154:155], v12 offset:23232
    v_mfma_f32_16x16x32_bf16 v[204:207], a[188:191], a[76:79], v[204:207]
    ds_read_b64_tr_b16 a[156:157], v12 offset:18656
    buffer_load_dwordx4 a[48:51], v29, s[52:55], s64 offen offset:2048 sc1
    v_mfma_f32_16x16x32_bf16 v[60:63], a[192:195], a[72:75], v[60:63]
    ds_read_b64_tr_b16 a[158:159], v12 offset:23264
    buffer_load_dwordx4 a[52:55], v29, s[52:55], s65 offen offset:2048 sc1
    v_mfma_f32_16x16x32_bf16 v[208:211], a[192:195], a[76:79], v[208:211]
    ds_read_b64_tr_b16 a[160:161], v12 offset:18688
    v_mfma_f32_16x16x32_bf16 v[96:99], a[196:199], a[72:75], v[96:99]
    ds_read_b64_tr_b16 a[162:163], v12 offset:23296
    buffer_load_dwordx4 a[56:59], v29, s[52:55], s64 offen offset:3072 sc1
    v_mfma_f32_16x16x32_bf16 v[212:215], a[196:199], a[76:79], v[212:215]
    buffer_load_dwordx4 a[60:63], v29, s[52:55], s65 offen offset:3072 sc1
    s_waitcnt lgkmcnt(12)
    v_mfma_f32_16x16x32_bf16 v[32:35], a[128:131], a[80:83], v[32:35]
    ds_read_b64_tr_b16 a[164:165], v12 offset:27648
    ds_read_b64_tr_b16 a[166:167], v12 offset:32256
    v_mfma_f32_16x16x32_bf16 v[100:103], a[128:131], a[84:87], v[100:103]
    ds_read_b64_tr_b16 a[168:169], v12 offset:27680
    v_mfma_f32_16x16x32_bf16 v[36:39], a[132:135], a[80:83], v[36:39]
    ds_read_b64_tr_b16 a[170:171], v12 offset:32288
    ds_read_b64_tr_b16 a[172:173], v12 offset:27712
    v_mfma_f32_16x16x32_bf16 v[104:107], a[132:135], a[84:87], v[104:107]
    ds_read_b64_tr_b16 a[174:175], v12 offset:32320
    ds_read_b64_tr_b16 a[176:177], v12 offset:27744
    v_mfma_f32_16x16x32_bf16 v[40:43], a[136:139], a[80:83], v[40:43]
    ds_read_b64_tr_b16 a[178:179], v12 offset:32352
    v_mfma_f32_16x16x32_bf16 v[108:111], a[136:139], a[84:87], v[108:111]
    s_waitcnt lgkmcnt(14)
    ds_read_b64_tr_b16 a[180:181], v12 offset:27776
    v_mfma_f32_16x16x32_bf16 v[44:47], a[140:143], a[80:83], v[44:47]
    ds_read_b64_tr_b16 a[182:183], v12 offset:32384
    ds_read_b64_tr_b16 a[184:185], v12 offset:27808
    v_mfma_f32_16x16x32_bf16 v[112:115], a[140:143], a[84:87], v[112:115]
    ds_read_b64_tr_b16 a[186:187], v12 offset:32416
    v_mfma_f32_16x16x32_bf16 v[48:51], a[144:147], a[80:83], v[48:51]
    ds_read_b64_tr_b16 a[188:189], v12 offset:27840
    ds_read_b64_tr_b16 a[190:191], v12 offset:32448
    v_mfma_f32_16x16x32_bf16 v[116:119], a[144:147], a[84:87], v[116:119]
    ds_read_b64_tr_b16 a[192:193], v12 offset:27872
    ds_read_b64_tr_b16 a[194:195], v12 offset:32480
    v_mfma_f32_16x16x32_bf16 v[52:55], a[148:151], a[80:83], v[52:55]
    ds_read_b64_tr_b16 a[196:197], v12 offset:27904
    v_mfma_f32_16x16x32_bf16 v[200:203], a[148:151], a[84:87], v[200:203]
    s_waitcnt lgkmcnt(15)
    ds_read_b64_tr_b16 a[198:199], v12 offset:32512
    v_mfma_f32_16x16x32_bf16 v[56:59], a[152:155], a[80:83], v[56:59]
    v_mfma_f32_16x16x32_bf16 v[204:207], a[152:155], a[84:87], v[204:207]
    v_mfma_f32_16x16x32_bf16 v[60:63], a[156:159], a[80:83], v[60:63]
    v_mfma_f32_16x16x32_bf16 v[208:211], a[156:159], a[84:87], v[208:211]
    v_mfma_f32_16x16x32_bf16 v[96:99], a[160:163], a[80:83], v[96:99]
    v_mfma_f32_16x16x32_bf16 v[212:215], a[160:163], a[84:87], v[212:215]
    s_waitcnt vmcnt(13) lgkmcnt(0)
    v_mfma_f32_16x16x32_bf16 v[32:35], a[164:167], a[88:91], v[32:35]
    s_barrier
    v_mfma_f32_16x16x32_bf16 v[100:103], a[164:167], a[92:95], v[100:103]
    ds_read_b64_tr_b16 a[128:129], v13 offset:0
    s_mul_i32 s71, s83, -147456
    v_mfma_f32_16x16x32_bf16 v[36:39], a[168:171], a[88:91], v[36:39]
    ds_read_b64_tr_b16 a[130:131], v13 offset:4608
    v_mfma_f32_16x16x32_bf16 v[104:107], a[168:171], a[92:95], v[104:107]
    ds_read_b64_tr_b16 a[132:133], v13 offset:32
    s_add_u32 s71, s71, 221184
    v_mfma_f32_16x16x32_bf16 v[40:43], a[172:175], a[88:91], v[40:43]
    ds_read_b64_tr_b16 a[134:135], v13 offset:4640
    ds_read_b64_tr_b16 a[136:137], v13 offset:64
    v_mfma_f32_16x16x32_bf16 v[108:111], a[172:175], a[92:95], v[108:111]
    ds_read_b64_tr_b16 a[138:139], v13 offset:4672
    v_mfma_f32_16x16x32_bf16 v[44:47], a[176:179], a[88:91], v[44:47]
    ds_read_b64_tr_b16 a[140:141], v13 offset:96
    s_add_u32 s71, s71, s68
    v_mfma_f32_16x16x32_bf16 v[112:115], a[176:179], a[92:95], v[112:115]
    ds_read_b64_tr_b16 a[142:143], v13 offset:4704
    v_mfma_f32_16x16x32_bf16 v[48:51], a[180:183], a[88:91], v[48:51]
    ds_read_b64_tr_b16 a[144:145], v13 offset:128
    s_add_u32 m0, s69, 73728
    v_mfma_f32_16x16x32_bf16 v[116:119], a[180:183], a[92:95], v[116:119]
    ds_read_b64_tr_b16 a[146:147], v13 offset:4736
    s_nop 0
    v_mfma_f32_16x16x32_bf16 v[52:55], a[184:187], a[88:91], v[52:55]
    ds_read_b64_tr_b16 a[148:149], v13 offset:160
    v_mfma_f32_16x16x32_bf16 v[200:203], a[184:187], a[92:95], v[200:203]
    ds_read_b64_tr_b16 a[150:151], v13 offset:4768
    buffer_load_dwordx4 v29, s[32:35], s71 offen offset:0 sc1 lds
    v_mfma_f32_16x16x32_bf16 v[56:59], a[188:191], a[88:91], v[56:59]
    ds_read_b64_tr_b16 a[152:153], v13 offset:192
    ds_read_b64_tr_b16 a[154:155], v13 offset:4800
    v_mfma_f32_16x16x32_bf16 v[204:207], a[188:191], a[92:95], v[204:207]
    ds_read_b64_tr_b16 a[156:157], v13 offset:224
    v_mfma_f32_16x16x32_bf16 v[60:63], a[192:195], a[88:91], v[60:63]
    ds_read_b64_tr_b16 a[158:159], v13 offset:4832
    buffer_load_dwordx4 v29, s[32:35], s71 offen offset:1024 sc1 lds
    v_mfma_f32_16x16x32_bf16 v[208:211], a[192:195], a[92:95], v[208:211]
    ds_read_b64_tr_b16 a[160:161], v13 offset:256
    v_mfma_f32_16x16x32_bf16 v[96:99], a[196:199], a[88:91], v[96:99]
    ds_read_b64_tr_b16 a[162:163], v13 offset:4864
    buffer_load_dwordx4 v29, s[32:35], s71 offen offset:2048 sc1 lds
    v_mfma_f32_16x16x32_bf16 v[212:215], a[196:199], a[92:95], v[212:215]
    buffer_load_dwordx4 v29, s[32:35], s71 offen offset:3072 sc1 lds
    s_waitcnt lgkmcnt(12)
    v_mfma_f32_16x16x32_bf16 v[32:35], a[128:131], a[96:99], v[32:35]
    ds_read_b64_tr_b16 a[164:165], v13 offset:9216
    s_add_u32 m0, s69, 77824
    v_mfma_f32_16x16x32_bf16 v[100:103], a[128:131], a[100:103], v[100:103]
    ds_read_b64_tr_b16 a[166:167], v13 offset:13824
    v_mfma_f32_16x16x32_bf16 v[36:39], a[132:135], a[96:99], v[36:39]
    ds_read_b64_tr_b16 a[168:169], v13 offset:9248
    s_add_u32 s71, s71, 4096
    v_mfma_f32_16x16x32_bf16 v[104:107], a[132:135], a[100:103], v[104:107]
    ds_read_b64_tr_b16 a[170:171], v13 offset:13856
    ds_read_b64_tr_b16 a[172:173], v13 offset:9280
    v_mfma_f32_16x16x32_bf16 v[40:43], a[136:139], a[96:99], v[40:43]
    ds_read_b64_tr_b16 a[174:175], v13 offset:13888
    v_mfma_f32_16x16x32_bf16 v[108:111], a[136:139], a[100:103], v[108:111]
    s_waitcnt lgkmcnt(12)
    buffer_load_dwordx4 v29, s[32:35], s71 offen offset:0 sc1 lds
    v_mfma_f32_16x16x32_bf16 v[44:47], a[140:143], a[96:99], v[44:47]
    ds_read_b64_tr_b16 a[176:177], v13 offset:9312
    v_mfma_f32_16x16x32_bf16 v[112:115], a[140:143], a[100:103], v[112:115]
    ds_read_b64_tr_b16 a[178:179], v13 offset:13920
    buffer_load_dwordx4 v29, s[32:35], s71 offen offset:1024 sc1 lds
    v_mfma_f32_16x16x32_bf16 v[48:51], a[144:147], a[96:99], v[48:51]
    ds_read_b64_tr_b16 a[180:181], v13 offset:9344
    ds_read_b64_tr_b16 a[182:183], v13 offset:13952
    v_mfma_f32_16x16x32_bf16 v[116:119], a[144:147], a[100:103], v[116:119]
    ds_read_b64_tr_b16 a[184:185], v13 offset:9376
    buffer_load_dwordx4 v29, s[32:35], s71 offen offset:2048 sc1 lds
    v_mfma_f32_16x16x32_bf16 v[52:55], a[148:151], a[96:99], v[52:55]
    ds_read_b64_tr_b16 a[186:187], v13 offset:13984
    s_cmp_lg_u32 s22, 0
    s_cbranch_scc1 f1_sg33
    s_mov_b64 exec, 1
    v_mov_b32 v19, 3
    s_lshl_b32 s23, s21, 5
    s_add_u32 s23, s23, s20
    s_lshl_b32 s23, s23, 7
    buffer_store_dword v19, off, s[60:63], s23 sc1
    s_mov_b64 exec, -1
f1_sg33:
    v_mfma_f32_16x16x32_bf16 v[200:203], a[148:151], a[100:103], v[200:203]
    s_waitcnt lgkmcnt(12)
    buffer_load_dwordx4 v29, s[32:35], s71 offen offset:3072 sc1 lds
    v_mfma_f32_16x16x32_bf16 v[56:59], a[152:155], a[96:99], v[56:59]
    ds_read_b64_tr_b16 a[188:189], v13 offset:9408
    ds_read_b64_tr_b16 a[190:191], v13 offset:14016
    v_mfma_f32_16x16x32_bf16 v[204:207], a[152:155], a[100:103], v[204:207]
    ds_read_b64_tr_b16 a[192:193], v13 offset:9440
    v_mfma_f32_16x16x32_bf16 v[60:63], a[156:159], a[96:99], v[60:63]
    ds_read_b64_tr_b16 a[194:195], v13 offset:14048
    s_add_u32 m0, s69, 81920
    v_mfma_f32_16x16x32_bf16 v[208:211], a[156:159], a[100:103], v[208:211]
    ds_read_b64_tr_b16 a[196:197], v13 offset:9472
    v_mfma_f32_16x16x32_bf16 v[96:99], a[160:163], a[96:99], v[96:99]
    ds_read_b64_tr_b16 a[198:199], v13 offset:14080
    s_add_u32 s71, s71, 4096
    v_mfma_f32_16x16x32_bf16 v[212:215], a[160:163], a[100:103], v[212:215]
    buffer_load_dwordx4 v29, s[32:35], s71 offen offset:0 sc1 lds
    s_waitcnt lgkmcnt(12)
    v_mfma_f32_16x16x32_bf16 v[32:35], a[164:167], a[104:107], v[32:35]
    ds_read_b64_tr_b16 a[128:129], v13 offset:18432
    s_add_u32 s64, s64, 4096
    v_mfma_f32_16x16x32_bf16 v[100:103], a[164:167], a[108:111], v[100:103]
    ds_read_b64_tr_b16 a[130:131], v13 offset:23040
    v_mfma_f32_16x16x32_bf16 v[36:39], a[168:171], a[104:107], v[36:39]
    ds_read_b64_tr_b16 a[132:133], v13 offset:18464
    s_add_u32 s65, s65, 4096
    v_mfma_f32_16x16x32_bf16 v[104:107], a[168:171], a[108:111], v[104:107]
    ds_read_b64_tr_b16 a[134:135], v13 offset:23072
    ds_read_b64_tr_b16 a[136:137], v13 offset:18496
    v_mfma_f32_16x16x32_bf16 v[40:43], a[172:175], a[104:107], v[40:43]
    ds_read_b64_tr_b16 a[138:139], v13 offset:23104
    buffer_load_dwordx4 a[64:67], v29, s[52:55], s64 offen offset:0 sc1
    v_mfma_f32_16x16x32_bf16 v[108:111], a[172:175], a[108:111], v[108:111]
    s_waitcnt lgkmcnt(12)
    v_mfma_f32_16x16x32_bf16 v[44:47], a[176:179], a[104:107], v[44:47]
    ds_read_b64_tr_b16 a[140:141], v13 offset:18528
    buffer_load_dwordx4 a[68:71], v29, s[52:55], s65 offen offset:0 sc1
    v_mfma_f32_16x16x32_bf16 v[112:115], a[176:179], a[108:111], v[112:115]
    ds_read_b64_tr_b16 a[142:143], v13 offset:23136
    v_mfma_f32_16x16x32_bf16 v[48:51], a[180:183], a[104:107], v[48:51]
    ds_read_b64_tr_b16 a[144:145], v13 offset:18560
    ds_read_b64_tr_b16 a[146:147], v13 offset:23168
    v_mfma_f32_16x16x32_bf16 v[116:119], a[180:183], a[108:111], v[116:119]
    ds_read_b64_tr_b16 a[148:149], v13 offset:18592
    buffer_load_dwordx4 a[72:75], v29, s[52:55], s64 offen offset:1024 sc1
    v_mfma_f32_16x16x32_bf16 v[52:55], a[184:187], a[104:107], v[52:55]
    ds_read_b64_tr_b16 a[150:151], v13 offset:23200
    buffer_load_dwordx4 a[76:79], v29, s[52:55], s65 offen offset:1024 sc1
    v_mfma_f32_16x16x32_bf16 v[200:203], a[184:187], a[108:111], v[200:203]
    s_waitcnt lgkmcnt(12)
    v_mfma_f32_16x16x32_bf16 v[56:59], a[188:191], a[104:107], v[56:59]
    ds_read_b64_tr_b16 a[152:153], v13 offset:18624
    ds_read_b64_tr_b16 a[154:155], v13 offset:23232
    v_mfma_f32_16x16x32_bf16 v[204:207], a[188:191], a[108:111], v[204:207]
    ds_read_b64_tr_b16 a[156:157], v13 offset:18656
    buffer_load_dwordx4 a[80:83], v29, s[52:55], s64 offen offset:2048 sc1
    v_mfma_f32_16x16x32_bf16 v[60:63], a[192:195], a[104:107], v[60:63]
    ds_read_b64_tr_b16 a[158:159], v13 offset:23264
    buffer_load_dwordx4 a[84:87], v29, s[52:55], s65 offen offset:2048 sc1
    v_mfma_f32_16x16x32_bf16 v[208:211], a[192:195], a[108:111], v[208:211]
    ds_read_b64_tr_b16 a[160:161], v13 offset:18688
    v_mfma_f32_16x16x32_bf16 v[96:99], a[196:199], a[104:107], v[96:99]
    ds_read_b64_tr_b16 a[162:163], v13 offset:23296
    buffer_load_dwordx4 a[88:91], v29, s[52:55], s64 offen offset:3072 sc1
    v_mfma_f32_16x16x32_bf16 v[212:215], a[196:199], a[108:111], v[212:215]
    buffer_load_dwordx4 a[92:95], v29, s[52:55], s65 offen offset:3072 sc1
    s_waitcnt lgkmcnt(12)
    v_mfma_f32_16x16x32_bf16 v[32:35], a[128:131], a[112:115], v[32:35]
    ds_read_b64_tr_b16 a[164:165], v13 offset:27648
    ds_read_b64_tr_b16 a[166:167], v13 offset:32256
    v_mfma_f32_16x16x32_bf16 v[100:103], a[128:131], a[116:119], v[100:103]
    ds_read_b64_tr_b16 a[168:169], v13 offset:27680
    v_mfma_f32_16x16x32_bf16 v[36:39], a[132:135], a[112:115], v[36:39]
    ds_read_b64_tr_b16 a[170:171], v13 offset:32288
    ds_read_b64_tr_b16 a[172:173], v13 offset:27712
    v_mfma_f32_16x16x32_bf16 v[104:107], a[132:135], a[116:119], v[104:107]
    ds_read_b64_tr_b16 a[174:175], v13 offset:32320
    ds_read_b64_tr_b16 a[176:177], v13 offset:27744
    v_mfma_f32_16x16x32_bf16 v[40:43], a[136:139], a[112:115], v[40:43]
    ds_read_b64_tr_b16 a[178:179], v13 offset:32352
    v_mfma_f32_16x16x32_bf16 v[108:111], a[136:139], a[116:119], v[108:111]
    s_waitcnt lgkmcnt(14)
    ds_read_b64_tr_b16 a[180:181], v13 offset:27776
    v_mfma_f32_16x16x32_bf16 v[44:47], a[140:143], a[112:115], v[44:47]
    ds_read_b64_tr_b16 a[182:183], v13 offset:32384
    ds_read_b64_tr_b16 a[184:185], v13 offset:27808
    v_mfma_f32_16x16x32_bf16 v[112:115], a[140:143], a[116:119], v[112:115]
    ds_read_b64_tr_b16 a[186:187], v13 offset:32416
    v_mfma_f32_16x16x32_bf16 v[48:51], a[144:147], a[112:115], v[48:51]
    ds_read_b64_tr_b16 a[188:189], v13 offset:27840
    ds_read_b64_tr_b16 a[190:191], v13 offset:32448
    v_mfma_f32_16x16x32_bf16 v[116:119], a[144:147], a[116:119], v[116:119]
    ds_read_b64_tr_b16 a[192:193], v13 offset:27872
    ds_read_b64_tr_b16 a[194:195], v13 offset:32480
    v_mfma_f32_16x16x32_bf16 v[52:55], a[148:151], a[112:115], v[52:55]
    ds_read_b64_tr_b16 a[196:197], v13 offset:27904
    v_mfma_f32_16x16x32_bf16 v[200:203], a[148:151], a[116:119], v[200:203]
    s_waitcnt lgkmcnt(15)
    ds_read_b64_tr_b16 a[198:199], v13 offset:32512
    v_mfma_f32_16x16x32_bf16 v[56:59], a[152:155], a[112:115], v[56:59]
    v_mfma_f32_16x16x32_bf16 v[204:207], a[152:155], a[116:119], v[204:207]
    v_mfma_f32_16x16x32_bf16 v[60:63], a[156:159], a[112:115], v[60:63]
    v_mfma_f32_16x16x32_bf16 v[208:211], a[156:159], a[116:119], v[208:211]
    v_mfma_f32_16x16x32_bf16 v[96:99], a[160:163], a[112:115], v[96:99]
    v_mfma_f32_16x16x32_bf16 v[212:215], a[160:163], a[116:119], v[212:215]
    s_waitcnt lgkmcnt(0)
    v_mfma_f32_16x16x32_bf16 v[32:35], a[164:167], a[120:123], v[32:35]
    s_barrier
    v_mfma_f32_16x16x32_bf16 v[100:103], a[164:167], a[124:127], v[100:103]
    ds_read_b64_tr_b16 a[128:129], v10 offset:0
    s_mul_i32 s71, s83, -147456
    v_mfma_f32_16x16x32_bf16 v[36:39], a[168:171], a[120:123], v[36:39]
    ds_read_b64_tr_b16 a[130:131], v10 offset:4608
    v_mfma_f32_16x16x32_bf16 v[104:107], a[168:171], a[124:127], v[104:107]
    ds_read_b64_tr_b16 a[132:133], v10 offset:32
    s_add_u32 s71, s71, 258048
    v_mfma_f32_16x16x32_bf16 v[40:43], a[172:175], a[120:123], v[40:43]
    ds_read_b64_tr_b16 a[134:135], v10 offset:4640
    ds_read_b64_tr_b16 a[136:137], v10 offset:64
    v_mfma_f32_16x16x32_bf16 v[108:111], a[172:175], a[124:127], v[108:111]
    ds_read_b64_tr_b16 a[138:139], v10 offset:4672
    v_mfma_f32_16x16x32_bf16 v[44:47], a[176:179], a[120:123], v[44:47]
    ds_read_b64_tr_b16 a[140:141], v10 offset:96
    s_add_u32 s71, s71, s68
    v_mfma_f32_16x16x32_bf16 v[112:115], a[176:179], a[124:127], v[112:115]
    ds_read_b64_tr_b16 a[142:143], v10 offset:4704
    v_mfma_f32_16x16x32_bf16 v[48:51], a[180:183], a[120:123], v[48:51]
    ds_read_b64_tr_b16 a[144:145], v10 offset:128
    s_add_u32 m0, s69, 110592
    v_mfma_f32_16x16x32_bf16 v[116:119], a[180:183], a[124:127], v[116:119]
    ds_read_b64_tr_b16 a[146:147], v10 offset:4736
    s_nop 0
    v_mfma_f32_16x16x32_bf16 v[52:55], a[184:187], a[120:123], v[52:55]
    ds_read_b64_tr_b16 a[148:149], v10 offset:160
    v_mfma_f32_16x16x32_bf16 v[200:203], a[184:187], a[124:127], v[200:203]
    ds_read_b64_tr_b16 a[150:151], v10 offset:4768
    buffer_load_dwordx4 v29, s[32:35], s71 offen offset:0 sc1 lds
    v_mfma_f32_16x16x32_bf16 v[56:59], a[188:191], a[120:123], v[56:59]
    ds_read_b64_tr_b16 a[152:153], v10 offset:192
    ds_read_b64_tr_b16 a[154:155], v10 offset:4800
    v_mfma_f32_16x16x32_bf16 v[204:207], a[188:191], a[124:127], v[204:207]
    ds_read_b64_tr_b16 a[156:157], v10 offset:224
    v_mfma_f32_16x16x32_bf16 v[60:63], a[192:195], a[120:123], v[60:63]
    ds_read_b64_tr_b16 a[158:159], v10 offset:4832
    buffer_load_dwordx4 v29, s[32:35], s71 offen offset:1024 sc1 lds
    v_mfma_f32_16x16x32_bf16 v[208:211], a[192:195], a[124:127], v[208:211]
    ds_read_b64_tr_b16 a[160:161], v10 offset:256
    v_mfma_f32_16x16x32_bf16 v[96:99], a[196:199], a[120:123], v[96:99]
    ds_read_b64_tr_b16 a[162:163], v10 offset:4864
    buffer_load_dwordx4 v29, s[32:35], s71 offen offset:2048 sc1 lds
    v_mfma_f32_16x16x32_bf16 v[212:215], a[196:199], a[124:127], v[212:215]
    buffer_load_dwordx4 v29, s[32:35], s71 offen offset:3072 sc1 lds
    s_waitcnt lgkmcnt(12)
    v_mfma_f32_16x16x32_bf16 v[32:35], a[128:131], a[0:3], v[32:35]
    ds_read_b64_tr_b16 a[164:165], v10 offset:9216
    s_add_u32 m0, s69, 114688
    v_mfma_f32_16x16x32_bf16 v[100:103], a[128:131], a[4:7], v[100:103]
    ds_read_b64_tr_b16 a[166:167], v10 offset:13824
    v_mfma_f32_16x16x32_bf16 v[36:39], a[132:135], a[0:3], v[36:39]
    ds_read_b64_tr_b16 a[168:169], v10 offset:9248
    s_add_u32 s71, s71, 4096
    v_mfma_f32_16x16x32_bf16 v[104:107], a[132:135], a[4:7], v[104:107]
    ds_read_b64_tr_b16 a[170:171], v10 offset:13856
    ds_read_b64_tr_b16 a[172:173], v10 offset:9280
    v_mfma_f32_16x16x32_bf16 v[40:43], a[136:139], a[0:3], v[40:43]
    ds_read_b64_tr_b16 a[174:175], v10 offset:13888
    v_mfma_f32_16x16x32_bf16 v[108:111], a[136:139], a[4:7], v[108:111]
    s_waitcnt lgkmcnt(12)
    buffer_load_dwordx4 v29, s[32:35], s71 offen offset:0 sc1 lds
    v_mfma_f32_16x16x32_bf16 v[44:47], a[140:143], a[0:3], v[44:47]
    ds_read_b64_tr_b16 a[176:177], v10 offset:9312
    v_mfma_f32_16x16x32_bf16 v[112:115], a[140:143], a[4:7], v[112:115]
    ds_read_b64_tr_b16 a[178:179], v10 offset:13920
    buffer_load_dwordx4 v29, s[32:35], s71 offen offset:1024 sc1 lds
    v_mfma_f32_16x16x32_bf16 v[48:51], a[144:147], a[0:3], v[48:51]
    ds_read_b64_tr_b16 a[180:181], v10 offset:9344
    ds_read_b64_tr_b16 a[182:183], v10 offset:13952
    v_mfma_f32_16x16x32_bf16 v[116:119], a[144:147], a[4:7], v[116:119]
    ds_read_b64_tr_b16 a[184:185], v10 offset:9376
    buffer_load_dwordx4 v29, s[32:35], s71 offen offset:2048 sc1 lds
    v_mfma_f32_16x16x32_bf16 v[52:55], a[148:151], a[0:3], v[52:55]
    ds_read_b64_tr_b16 a[186:187], v10 offset:13984
    v_mfma_f32_16x16x32_bf16 v[200:203], a[148:151], a[4:7], v[200:203]
    s_waitcnt lgkmcnt(12)
    buffer_load_dwordx4 v29, s[32:35], s71 offen offset:3072 sc1 lds
    v_mfma_f32_16x16x32_bf16 v[56:59], a[152:155], a[0:3], v[56:59]
    ds_read_b64_tr_b16 a[188:189], v10 offset:9408
    ds_read_b64_tr_b16 a[190:191], v10 offset:14016
    v_mfma_f32_16x16x32_bf16 v[204:207], a[152:155], a[4:7], v[204:207]
    ds_read_b64_tr_b16 a[192:193], v10 offset:9440
    v_mfma_f32_16x16x32_bf16 v[60:63], a[156:159], a[0:3], v[60:63]
    ds_read_b64_tr_b16 a[194:195], v10 offset:14048
    s_add_u32 m0, s69, 118784
    v_mfma_f32_16x16x32_bf16 v[208:211], a[156:159], a[4:7], v[208:211]
    ds_read_b64_tr_b16 a[196:197], v10 offset:9472
    v_mfma_f32_16x16x32_bf16 v[96:99], a[160:163], a[0:3], v[96:99]
    ds_read_b64_tr_b16 a[198:199], v10 offset:14080
    s_add_u32 s71, s71, 4096
    v_mfma_f32_16x16x32_bf16 v[212:215], a[160:163], a[4:7], v[212:215]
    buffer_load_dwordx4 v29, s[32:35], s71 offen offset:0 sc1 lds
    s_waitcnt lgkmcnt(12)
    v_mfma_f32_16x16x32_bf16 v[32:35], a[164:167], a[8:11], v[32:35]
    ds_read_b64_tr_b16 a[128:129], v10 offset:18432
    s_add_u32 s64, s64, 4096
    v_mfma_f32_16x16x32_bf16 v[100:103], a[164:167], a[12:15], v[100:103]
    ds_read_b64_tr_b16 a[130:131], v10 offset:23040
    v_mfma_f32_16x16x32_bf16 v[36:39], a[168:171], a[8:11], v[36:39]
    ds_read_b64_tr_b16 a[132:133], v10 offset:18464
    s_add_u32 s65, s65, 4096
    v_mfma_f32_16x16x32_bf16 v[104:107], a[168:171], a[12:15], v[104:107]
    ds_read_b64_tr_b16 a[134:135], v10 offset:23072
    ds_read_b64_tr_b16 a[136:137], v10 offset:18496
    v_mfma_f32_16x16x32_bf16 v[40:43], a[172:175], a[8:11], v[40:43]
    ds_read_b64_tr_b16 a[138:139], v10 offset:23104
    buffer_load_dwordx4 a[96:99], v29, s[52:55], s64 offen offset:0 sc1
    v_mfma_f32_16x16x32_bf16 v[108:111], a[172:175], a[12:15], v[108:111]
    s_waitcnt lgkmcnt(12)
    v_mfma_f32_16x16x32_bf16 v[44:47], a[176:179], a[8:11], v[44:47]
    ds_read_b64_tr_b16 a[140:141], v10 offset:18528
    buffer_load_dwordx4 a[100:103], v29, s[52:55], s65 offen offset:0 sc1
    v_mfma_f32_16x16x32_bf16 v[112:115], a[176:179], a[12:15], v[112:115]
    ds_read_b64_tr_b16 a[142:143], v10 offset:23136
    v_mfma_f32_16x16x32_bf16 v[48:51], a[180:183], a[8:11], v[48:51]
    ds_read_b64_tr_b16 a[144:145], v10 offset:18560
    ds_read_b64_tr_b16 a[146:147], v10 offset:23168
    v_mfma_f32_16x16x32_bf16 v[116:119], a[180:183], a[12:15], v[116:119]
    ds_read_b64_tr_b16 a[148:149], v10 offset:18592
    buffer_load_dwordx4 a[104:107], v29, s[52:55], s64 offen offset:1024 sc1
    v_mfma_f32_16x16x32_bf16 v[52:55], a[184:187], a[8:11], v[52:55]
    ds_read_b64_tr_b16 a[150:151], v10 offset:23200
    buffer_load_dwordx4 a[108:111], v29, s[52:55], s65 offen offset:1024 sc1
    v_mfma_f32_16x16x32_bf16 v[200:203], a[184:187], a[12:15], v[200:203]
    s_waitcnt lgkmcnt(12)
    v_mfma_f32_16x16x32_bf16 v[56:59], a[188:191], a[8:11], v[56:59]
    ds_read_b64_tr_b16 a[152:153], v10 offset:18624
    ds_read_b64_tr_b16 a[154:155], v10 offset:23232
    v_mfma_f32_16x16x32_bf16 v[204:207], a[188:191], a[12:15], v[204:207]
    ds_read_b64_tr_b16 a[156:157], v10 offset:18656
    buffer_load_dwordx4 a[112:115], v29, s[52:55], s64 offen offset:2048 sc1
    v_mfma_f32_16x16x32_bf16 v[60:63], a[192:195], a[8:11], v[60:63]
    ds_read_b64_tr_b16 a[158:159], v10 offset:23264
    buffer_load_dwordx4 a[116:119], v29, s[52:55], s65 offen offset:2048 sc1
    v_mfma_f32_16x16x32_bf16 v[208:211], a[192:195], a[12:15], v[208:211]
    ds_read_b64_tr_b16 a[160:161], v10 offset:18688
    v_mfma_f32_16x16x32_bf16 v[96:99], a[196:199], a[8:11], v[96:99]
    ds_read_b64_tr_b16 a[162:163], v10 offset:23296
    buffer_load_dwordx4 a[120:123], v29, s[52:55], s64 offen offset:3072 sc1
    v_mfma_f32_16x16x32_bf16 v[212:215], a[196:199], a[12:15], v[212:215]
    buffer_load_dwordx4 a[124:127], v29, s[52:55], s65 offen offset:3072 sc1
    s_waitcnt lgkmcnt(12)
    v_mfma_f32_16x16x32_bf16 v[32:35], a[128:131], a[16:19], v[32:35]
    ds_read_b64_tr_b16 a[164:165], v10 offset:27648
    ds_read_b64_tr_b16 a[166:167], v10 offset:32256
    v_mfma_f32_16x16x32_bf16 v[100:103], a[128:131], a[20:23], v[100:103]
    ds_read_b64_tr_b16 a[168:169], v10 offset:27680
    v_mfma_f32_16x16x32_bf16 v[36:39], a[132:135], a[16:19], v[36:39]
    ds_read_b64_tr_b16 a[170:171], v10 offset:32288
    ds_read_b64_tr_b16 a[172:173], v10 offset:27712
    v_mfma_f32_16x16x32_bf16 v[104:107], a[132:135], a[20:23], v[104:107]
    ds_read_b64_tr_b16 a[174:175], v10 offset:32320
    ds_read_b64_tr_b16 a[176:177], v10 offset:27744
    v_mfma_f32_16x16x32_bf16 v[40:43], a[136:139], a[16:19], v[40:43]
    ds_read_b64_tr_b16 a[178:179], v10 offset:32352
    v_mfma_f32_16x16x32_bf16 v[108:111], a[136:139], a[20:23], v[108:111]
    s_waitcnt lgkmcnt(14)
    ds_read_b64_tr_b16 a[180:181], v10 offset:27776
    v_mfma_f32_16x16x32_bf16 v[44:47], a[140:143], a[16:19], v[44:47]
    ds_read_b64_tr_b16 a[182:183], v10 offset:32384
    ds_read_b64_tr_b16 a[184:185], v10 offset:27808
    v_mfma_f32_16x16x32_bf16 v[112:115], a[140:143], a[20:23], v[112:115]
    ds_read_b64_tr_b16 a[186:187], v10 offset:32416
    v_mfma_f32_16x16x32_bf16 v[48:51], a[144:147], a[16:19], v[48:51]
    ds_read_b64_tr_b16 a[188:189], v10 offset:27840
    ds_read_b64_tr_b16 a[190:191], v10 offset:32448
    v_mfma_f32_16x16x32_bf16 v[116:119], a[144:147], a[20:23], v[116:119]
    ds_read_b64_tr_b16 a[192:193], v10 offset:27872
    ds_read_b64_tr_b16 a[194:195], v10 offset:32480
    v_mfma_f32_16x16x32_bf16 v[52:55], a[148:151], a[16:19], v[52:55]
    ds_read_b64_tr_b16 a[196:197], v10 offset:27904
    v_mfma_f32_16x16x32_bf16 v[200:203], a[148:151], a[20:23], v[200:203]
    s_waitcnt lgkmcnt(15)
    ds_read_b64_tr_b16 a[198:199], v10 offset:32512
    v_mfma_f32_16x16x32_bf16 v[56:59], a[152:155], a[16:19], v[56:59]
    v_mfma_f32_16x16x32_bf16 v[204:207], a[152:155], a[20:23], v[204:207]
    v_mfma_f32_16x16x32_bf16 v[60:63], a[156:159], a[16:19], v[60:63]
    v_mfma_f32_16x16x32_bf16 v[208:211], a[156:159], a[20:23], v[208:211]
    v_mfma_f32_16x16x32_bf16 v[96:99], a[160:163], a[16:19], v[96:99]
    v_mfma_f32_16x16x32_bf16 v[212:215], a[160:163], a[20:23], v[212:215]
    s_waitcnt vmcnt(42) lgkmcnt(0)
    v_mfma_f32_16x16x32_bf16 v[32:35], a[164:167], a[24:27], v[32:35]
    s_barrier
    v_mfma_f32_16x16x32_bf16 v[100:103], a[164:167], a[28:31], v[100:103]
    ds_read_b64_tr_b16 a[128:129], v11 offset:0
    s_mov_b32 s71, s70
    v_mfma_f32_16x16x32_bf16 v[36:39], a[168:171], a[24:27], v[36:39]
    ds_read_b64_tr_b16 a[130:131], v11 offset:4608
    v_mfma_f32_16x16x32_bf16 v[104:107], a[168:171], a[28:31], v[104:107]
    ds_read_b64_tr_b16 a[132:133], v11 offset:32
    s_add_u32 m0, s69, 0
    v_mfma_f32_16x16x32_bf16 v[40:43], a[172:175], a[24:27], v[40:43]
    ds_read_b64_tr_b16 a[134:135], v11 offset:4640
    ds_read_b64_tr_b16 a[136:137], v11 offset:64
    v_mfma_f32_16x16x32_bf16 v[108:111], a[172:175], a[28:31], v[108:111]
    ds_read_b64_tr_b16 a[138:139], v11 offset:4672
    v_mfma_f32_16x16x32_bf16 v[44:47], a[176:179], a[24:27], v[44:47]
    ds_read_b64_tr_b16 a[140:141], v11 offset:96
    s_nop 0
    v_mfma_f32_16x16x32_bf16 v[112:115], a[176:179], a[28:31], v[112:115]
    ds_read_b64_tr_b16 a[142:143], v11 offset:4704
    v_mfma_f32_16x16x32_bf16 v[48:51], a[180:183], a[24:27], v[48:51]
    ds_read_b64_tr_b16 a[144:145], v11 offset:128
    buffer_load_dwordx4 v29, s[32:35], s71 offen offset:0 sc1 lds
    v_mfma_f32_16x16x32_bf16 v[116:119], a[180:183], a[28:31], v[116:119]
    ds_read_b64_tr_b16 a[146:147], v11 offset:4736
    v_mfma_f32_16x16x32_bf16 v[52:55], a[184:187], a[24:27], v[52:55]
    ds_read_b64_tr_b16 a[148:149], v11 offset:160
    buffer_load_dwordx4 v29, s[32:35], s71 offen offset:1024 sc1 lds
    v_mfma_f32_16x16x32_bf16 v[200:203], a[184:187], a[28:31], v[200:203]
    ds_read_b64_tr_b16 a[150:151], v11 offset:4768
    v_mfma_f32_16x16x32_bf16 v[56:59], a[188:191], a[24:27], v[56:59]
    ds_read_b64_tr_b16 a[152:153], v11 offset:192
    ds_read_b64_tr_b16 a[154:155], v11 offset:4800
    v_mfma_f32_16x16x32_bf16 v[204:207], a[188:191], a[28:31], v[204:207]
    ds_read_b64_tr_b16 a[156:157], v11 offset:224
    buffer_load_dwordx4 v29, s[32:35], s71 offen offset:2048 sc1 lds
    v_mfma_f32_16x16x32_bf16 v[60:63], a[192:195], a[24:27], v[60:63]
    ds_read_b64_tr_b16 a[158:159], v11 offset:4832
    buffer_load_dword v28, v15, s[60:63], s74 offen sc1
    v_mfma_f32_16x16x32_bf16 v[208:211], a[192:195], a[28:31], v[208:211]
    ds_read_b64_tr_b16 a[160:161], v11 offset:256
    buffer_load_dwordx4 v29, s[32:35], s71 offen offset:3072 sc1 lds
    v_mfma_f32_16x16x32_bf16 v[96:99], a[196:199], a[24:27], v[96:99]
    ds_read_b64_tr_b16 a[162:163], v11 offset:4864
    v_mfma_f32_16x16x32_bf16 v[212:215], a[196:199], a[28:31], v[212:215]
    s_add_u32 m0, s69, 4096
    s_waitcnt vmcnt(39) lgkmcnt(12)
    v_mfma_f32_16x16x32_bf16 v[32:35], a[128:131], a[32:35], v[32:35]
    ds_read_b64_tr_b16 a[164:165], v11 offset:9216
    s_add_u32 s71, s71, 4096
    v_mfma_f32_16x16x32_bf16 v[100:103], a[128:131], a[36:39], v[100:103]
    ds_read_b64_tr_b16 a[166:167], v11 offset:13824
    v_mfma_f32_16x16x32_bf16 v[36:39], a[132:135], a[32:35], v[36:39]
    ds_read_b64_tr_b16 a[168:169], v11 offset:9248
    buffer_load_dwordx4 v29, s[32:35], s71 offen offset:0 sc1 lds
    v_mfma_f32_16x16x32_bf16 v[104:107], a[132:135], a[36:39], v[104:107]
    ds_read_b64_tr_b16 a[170:171], v11 offset:13856
    ds_read_b64_tr_b16 a[172:173], v11 offset:9280
    v_mfma_f32_16x16x32_bf16 v[40:43], a[136:139], a[32:35], v[40:43]
    ds_read_b64_tr_b16 a[174:175], v11 offset:13888
    v_mfma_f32_16x16x32_bf16 v[108:111], a[136:139], a[36:39], v[108:111]
    s_waitcnt lgkmcnt(12)
    buffer_load_dwordx4 v29, s[32:35], s71 offen offset:1024 sc1 lds
    v_mfma_f32_16x16x32_bf16 v[44:47], a[140:143], a[32:35], v[44:47]
    ds_read_b64_tr_b16 a[176:177], v11 offset:9312
    v_mfma_f32_16x16x32_bf16 v[112:115], a[140:143], a[36:39], v[112:115]
    ds_read_b64_tr_b16 a[178:179], v11 offset:13920
    buffer_load_dwordx4 v29, s[32:35], s71 offen offset:2048 sc1 lds
    v_mfma_f32_16x16x32_bf16 v[48:51], a[144:147], a[32:35], v[48:51]
    ds_read_b64_tr_b16 a[180:181], v11 offset:9344
    ds_read_b64_tr_b16 a[182:183], v11 offset:13952
    v_mfma_f32_16x16x32_bf16 v[116:119], a[144:147], a[36:39], v[116:119]
    ds_read_b64_tr_b16 a[184:185], v11 offset:9376
    v_mfma_f32_16x16x32_bf16 v[52:55], a[148:151], a[32:35], v[52:55]
    ds_read_b64_tr_b16 a[186:187], v11 offset:13984
    buffer_load_dwordx4 v29, s[32:35], s71 offen offset:3072 sc1 lds
    v_mfma_f32_16x16x32_bf16 v[200:203], a[148:151], a[36:39], v[200:203]
    s_waitcnt lgkmcnt(12)
    v_mfma_f32_16x16x32_bf16 v[56:59], a[152:155], a[32:35], v[56:59]
    ds_read_b64_tr_b16 a[188:189], v11 offset:9408
    ds_read_b64_tr_b16 a[190:191], v11 offset:14016
    v_mfma_f32_16x16x32_bf16 v[204:207], a[152:155], a[36:39], v[204:207]
    ds_read_b64_tr_b16 a[192:193], v11 offset:9440
    s_add_u32 m0, s69, 8192
    v_mfma_f32_16x16x32_bf16 v[60:63], a[156:159], a[32:35], v[60:63]
    ds_read_b64_tr_b16 a[194:195], v11 offset:14048
    v_mfma_f32_16x16x32_bf16 v[208:211], a[156:159], a[36:39], v[208:211]
    ds_read_b64_tr_b16 a[196:197], v11 offset:9472
    s_add_u32 s71, s71, 4096
    v_mfma_f32_16x16x32_bf16 v[96:99], a[160:163], a[32:35], v[96:99]
    ds_read_b64_tr_b16 a[198:199], v11 offset:14080
    v_mfma_f32_16x16x32_bf16 v[212:215], a[160:163], a[36:39], v[212:215]
    buffer_load_dwordx4 v29, s[32:35], s71 offen offset:0 sc1 lds
    s_waitcnt lgkmcnt(12)
    v_mfma_f32_16x16x32_bf16 v[32:35], a[164:167], a[40:43], v[32:35]
    ds_read_b64_tr_b16 a[128:129], v11 offset:18432
    v_mfma_f32_16x16x32_bf16 v[100:103], a[164:167], a[44:47], v[100:103]
    ds_read_b64_tr_b16 a[130:131], v11 offset:23040
    s_waitcnt vmcnt(6)
    v_cmp_lt_u32 vcc, 1, v28
    s_nop 0
    s_cmp_eq_u64 vcc, -1
    s_cbranch_scc0 f1_pe_e
f1_pe_r:
    v_mfma_f32_16x16x32_bf16 v[36:39], a[168:171], a[40:43], v[36:39]
    ds_read_b64_tr_b16 a[132:133], v11 offset:18464
    v_mfma_f32_16x16x32_bf16 v[104:107], a[168:171], a[44:47], v[104:107]
    ds_read_b64_tr_b16 a[134:135], v11 offset:23072
    ds_read_b64_tr_b16 a[136:137], v11 offset:18496
    v_mfma_f32_16x16x32_bf16 v[40:43], a[172:175], a[40:43], v[40:43]
    ds_read_b64_tr_b16 a[138:139], v11 offset:23104
    v_mfma_f32_16x16x32_bf16 v[108:111], a[172:175], a[44:47], v[108:111]
    s_waitcnt lgkmcnt(12)
    v_mfma_f32_16x16x32_bf16 v[44:47], a[176:179], a[40:43], v[44:47]
    ds_read_b64_tr_b16 a[140:141], v11 offset:18528
    v_mfma_f32_16x16x32_bf16 v[112:115], a[176:179], a[44:47], v[112:115]
    ds_read_b64_tr_b16 a[142:143], v11 offset:23136
    s_mul_i32 s24, s66, 28672
    s_sub_u32 s24, 102400, s24
    s_lshl_b32 s77, s83, 14
    s_add_u32 s24, s24, s77
    s_add_u32 s64, s64, s24
    s_add_u32 s65, s65, s24
    v_mfma_f32_16x16x32_bf16 v[48:51], a[180:183], a[40:43], v[48:51]
    ds_read_b64_tr_b16 a[144:145], v11 offset:18560
    ds_read_b64_tr_b16 a[146:147], v11 offset:23168
    v_mfma_f32_16x16x32_bf16 v[116:119], a[180:183], a[44:47], v[116:119]
    ds_read_b64_tr_b16 a[148:149], v11 offset:18592
    v_mfma_f32_16x16x32_bf16 v[52:55], a[184:187], a[40:43], v[52:55]
    ds_read_b64_tr_b16 a[150:151], v11 offset:23200
    buffer_load_dwordx4 a[0:3], v29, s[52:55], s64 offen offset:0 sc1
    v_mfma_f32_16x16x32_bf16 v[200:203], a[184:187], a[44:47], v[200:203]
    s_waitcnt lgkmcnt(12)
    buffer_load_dwordx4 a[4:7], v29, s[52:55], s65 offen offset:0 sc1
    v_mfma_f32_16x16x32_bf16 v[56:59], a[188:191], a[40:43], v[56:59]
    ds_read_b64_tr_b16 a[152:153], v11 offset:18624
    ds_read_b64_tr_b16 a[154:155], v11 offset:23232
    buffer_load_dwordx4 a[8:11], v29, s[52:55], s64 offen offset:1024 sc1
    v_mfma_f32_16x16x32_bf16 v[204:207], a[188:191], a[44:47], v[204:207]
    ds_read_b64_tr_b16 a[156:157], v11 offset:18656
    buffer_load_dwordx4 a[12:15], v29, s[52:55], s65 offen offset:1024 sc1
    v_mfma_f32_16x16x32_bf16 v[60:63], a[192:195], a[40:43], v[60:63]
    ds_read_b64_tr_b16 a[158:159], v11 offset:23264
    buffer_load_dwordx4 a[16:19], v29, s[52:55], s64 offen offset:2048 sc1
    v_mfma_f32_16x16x32_bf16 v[208:211], a[192:195], a[44:47], v[208:211]
    ds_read_b64_tr_b16 a[160:161], v11 offset:18688
    buffer_load_dwordx4 a[20:23], v29, s[52:55], s65 offen offset:2048 sc1
    v_mfma_f32_16x16x32_bf16 v[96:99], a[196:199], a[40:43], v[96:99]
    ds_read_b64_tr_b16 a[162:163], v11 offset:23296
    buffer_load_dwordx4 a[24:27], v29, s[52:55], s64 offen offset:3072 sc1
    v_mfma_f32_16x16x32_bf16 v[212:215], a[196:199], a[44:47], v[212:215]
    buffer_load_dwordx4 a[28:31], v29, s[52:55], s65 offen offset:3072 sc1
    s_waitcnt lgkmcnt(12)
    v_mfma_f32_16x16x32_bf16 v[32:35], a[128:131], a[48:51], v[32:35]
    ds_read_b64_tr_b16 a[164:165], v11 offset:27648
    ds_read_b64_tr_b16 a[166:167], v11 offset:32256
    v_mfma_f32_16x16x32_bf16 v[100:103], a[128:131], a[52:55], v[100:103]
    ds_read_b64_tr_b16 a[168:169], v11 offset:27680
    v_mfma_f32_16x16x32_bf16 v[36:39], a[132:135], a[48:51], v[36:39]
    ds_read_b64_tr_b16 a[170:171], v11 offset:32288
    ds_read_b64_tr_b16 a[172:173], v11 offset:27712
    v_mfma_f32_16x16x32_bf16 v[104:107], a[132:135], a[52:55], v[104:107]
    ds_read_b64_tr_b16 a[174:175], v11 offset:32320
    ds_read_b64_tr_b16 a[176:177], v11 offset:27744
    v_mfma_f32_16x16x32_bf16 v[40:43], a[136:139], a[48:51], v[40:43]
    ds_read_b64_tr_b16 a[178:179], v11 offset:32352
    v_mfma_f32_16x16x32_bf16 v[108:111], a[136:139], a[52:55], v[108:111]
    s_waitcnt lgkmcnt(14)
    ds_read_b64_tr_b16 a[180:181], v11 offset:27776
    v_mfma_f32_16x16x32_bf16 v[44:47], a[140:143], a[48:51], v[44:47]
    ds_read_b64_tr_b16 a[182:183], v11 offset:32384
    ds_read_b64_tr_b16 a[184:185], v11 offset:27808
    v_mfma_f32_16x16x32_bf16 v[112:115], a[140:143], a[52:55], v[112:115]
    ds_read_b64_tr_b16 a[186:187], v11 offset:32416
    v_mfma_f32_16x16x32_bf16 v[48:51], a[144:147], a[48:51], v[48:51]
    ds_read_b64_tr_b16 a[188:189], v11 offset:27840
    ds_read_b64_tr_b16 a[190:191], v11 offset:32448
    v_mfma_f32_16x16x32_bf16 v[116:119], a[144:147], a[52:55], v[116:119]
    ds_read_b64_tr_b16 a[192:193], v11 offset:27872
    ds_read_b64_tr_b16 a[194:195], v11 offset:32480
    v_mfma_f32_16x16x32_bf16 v[52:55], a[148:151], a[48:51], v[52:55]
    ds_read_b64_tr_b16 a[196:197], v11 offset:27904
    v_mfma_f32_16x16x32_bf16 v[200:203], a[148:151], a[52:55], v[200:203]
    s_waitcnt lgkmcnt(15)
    ds_read_b64_tr_b16 a[198:199], v11 offset:32512
    v_mfma_f32_16x16x32_bf16 v[56:59], a[152:155], a[48:51], v[56:59]
    v_mfma_f32_16x16x32_bf16 v[204:207], a[152:155], a[52:55], v[204:207]
    v_mfma_f32_16x16x32_bf16 v[60:63], a[156:159], a[48:51], v[60:63]
    v_mfma_f32_16x16x32_bf16 v[208:211], a[156:159], a[52:55], v[208:211]
    v_mfma_f32_16x16x32_bf16 v[96:99], a[160:163], a[48:51], v[96:99]
    v_mfma_f32_16x16x32_bf16 v[212:215], a[160:163], a[52:55], v[212:215]
    s_waitcnt lgkmcnt(0)
    v_mfma_f32_16x16x32_bf16 v[32:35], a[164:167], a[56:59], v[32:35]
    s_barrier
    v_mfma_f32_16x16x32_bf16 v[100:103], a[164:167], a[60:63], v[100:103]
    ds_read_b64_tr_b16 a[128:129], v12 offset:0
    v_mfma_f32_16x16x32_bf16 v[36:39], a[168:171], a[56:59], v[36:39]
    ds_read_b64_tr_b16 a[130:131], v12 offset:4608
    s_lshr_b32 s77, s30, 2
    v_mfma_f32_16x16x32_bf16 v[104:107], a[168:171], a[60:63], v[104:107]
    ds_read_b64_tr_b16 a[132:133], v12 offset:32
    v_mfma_f32_16x16x32_bf16 v[40:43], a[172:175], a[56:59], v[40:43]
    ds_read_b64_tr_b16 a[134:135], v12 offset:4640
    ds_read_b64_tr_b16 a[136:137], v12 offset:64
    v_mfma_f32_16x16x32_bf16 v[108:111], a[172:175], a[60:63], v[108:111]
    ds_read_b64_tr_b16 a[138:139], v12 offset:4672
    v_mfma_f32_16x16x32_bf16 v[44:47], a[176:179], a[56:59], v[44:47]
    ds_read_b64_tr_b16 a[140:141], v12 offset:96
    v_mfma_f32_16x16x32_bf16 v[112:115], a[176:179], a[60:63], v[112:115]
    ds_read_b64_tr_b16 a[142:143], v12 offset:4704
    s_add_u32 m0, s77, 36864
    v_mfma_f32_16x16x32_bf16 v[48:51], a[180:183], a[56:59], v[48:51]
    ds_read_b64_tr_b16 a[144:145], v12 offset:128
    v_mfma_f32_16x16x32_bf16 v[116:119], a[180:183], a[60:63], v[116:119]
    ds_read_b64_tr_b16 a[146:147], v12 offset:4736
    v_mfma_f32_16x16x32_bf16 v[52:55], a[184:187], a[56:59], v[52:55]
    ds_read_b64_tr_b16 a[148:149], v12 offset:160
    v_mfma_f32_16x16x32_bf16 v[200:203], a[184:187], a[60:63], v[200:203]
    ds_read_b64_tr_b16 a[150:151], v12 offset:4768
    s_add_u32 s71, s76, 0
    v_mfma_f32_16x16x32_bf16 v[56:59], a[188:191], a[56:59], v[56:59]
    ds_read_b64_tr_b16 a[152:153], v12 offset:192
    ds_read_b64_tr_b16 a[154:155], v12 offset:4800
    v_mfma_f32_16x16x32_bf16 v[204:207], a[188:191], a[60:63], v[204:207]
    ds_read_b64_tr_b16 a[156:157], v12 offset:224
    v_mfma_f32_16x16x32_bf16 v[60:63], a[192:195], a[56:59], v[60:63]
    ds_read_b64_tr_b16 a[158:159], v12 offset:4832
    v_mfma_f32_16x16x32_bf16 v[208:211], a[192:195], a[60:63], v[208:211]
    ds_read_b64_tr_b16 a[160:161], v12 offset:256
    v_mfma_f32_16x16x32_bf16 v[96:99], a[196:199], a[56:59], v[96:99]
    ds_read_b64_tr_b16 a[162:163], v12 offset:4864
    buffer_load_dwordx4 v29, s[32:35], s71 offen offset:0 sc1 lds
    v_mfma_f32_16x16x32_bf16 v[212:215], a[196:199], a[60:63], v[212:215]
    s_waitcnt lgkmcnt(12)
    v_mfma_f32_16x16x32_bf16 v[32:35], a[128:131], a[64:67], v[32:35]
    ds_read_b64_tr_b16 a[164:165], v12 offset:9216
    s_add_u32 m0, s77, 40960
    v_mfma_f32_16x16x32_bf16 v[100:103], a[128:131], a[68:71], v[100:103]
    ds_read_b64_tr_b16 a[166:167], v12 offset:13824
    v_mfma_f32_16x16x32_bf16 v[36:39], a[132:135], a[64:67], v[36:39]
    ds_read_b64_tr_b16 a[168:169], v12 offset:9248
    s_add_u32 s71, s76, 4096
    v_mfma_f32_16x16x32_bf16 v[104:107], a[132:135], a[68:71], v[104:107]
    ds_read_b64_tr_b16 a[170:171], v12 offset:13856
    ds_read_b64_tr_b16 a[172:173], v12 offset:9280
    v_mfma_f32_16x16x32_bf16 v[40:43], a[136:139], a[64:67], v[40:43]
    ds_read_b64_tr_b16 a[174:175], v12 offset:13888
    v_mfma_f32_16x16x32_bf16 v[108:111], a[136:139], a[68:71], v[108:111]
    s_waitcnt lgkmcnt(12)
    buffer_load_dwordx4 v29, s[32:35], s71 offen offset:0 sc1 lds
    v_mfma_f32_16x16x32_bf16 v[44:47], a[140:143], a[64:67], v[44:47]
    ds_read_b64_tr_b16 a[176:177], v12 offset:9312
    v_mfma_f32_16x16x32_bf16 v[112:115], a[140:143], a[68:71], v[112:115]
    ds_read_b64_tr_b16 a[178:179], v12 offset:13920
    v_mfma_f32_16x16x32_bf16 v[48:51], a[144:147], a[64:67], v[48:51]
    ds_read_b64_tr_b16 a[180:181], v12 offset:9344
    ds_read_b64_tr_b16 a[182:183], v12 offset:13952
    v_mfma_f32_16x16x32_bf16 v[116:119], a[144:147], a[68:71], v[116:119]
    ds_read_b64_tr_b16 a[184:185], v12 offset:9376
    v_mfma_f32_16x16x32_bf16 v[52:55], a[148:151], a[64:67], v[52:55]
    ds_read_b64_tr_b16 a[186:187], v12 offset:13984
    v_mfma_f32_16x16x32_bf16 v[200:203], a[148:151], a[68:71], v[200:203]
    s_waitcnt lgkmcnt(12)
    v_mfma_f32_16x16x32_bf16 v[56:59], a[152:155], a[64:67], v[56:59]
    ds_read_b64_tr_b16 a[188:189], v12 offset:9408
    ds_read_b64_tr_b16 a[190:191], v12 offset:14016
    v_mfma_f32_16x16x32_bf16 v[204:207], a[152:155], a[68:71], v[204:207]
    ds_read_b64_tr_b16 a[192:193], v12 offset:9440
    v_mfma_f32_16x16x32_bf16 v[60:63], a[156:159], a[64:67], v[60:63]
    ds_read_b64_tr_b16 a[194:195], v12 offset:14048
    v_mfma_f32_16x16x32_bf16 v[208:211], a[156:159], a[68:71], v[208:211]
    ds_read_b64_tr_b16 a[196:197], v12 offset:9472
    v_mfma_f32_16x16x32_bf16 v[96:99], a[160:163], a[64:67], v[96:99]
    ds_read_b64_tr_b16 a[198:199], v12 offset:14080
    v_mfma_f32_16x16x32_bf16 v[212:215], a[160:163], a[68:71], v[212:215]
    s_cmp_lg_u32 s22, 0
    s_cbranch_scc1 f1_w9
    s_mov_b32 m0, 45056
    s_add_u32 s71, s76, 8192
    buffer_load_dwordx4 v29, s[32:35], s71 offen offset:0 sc1 lds
f1_w9:
    s_waitcnt lgkmcnt(12)
    v_mfma_f32_16x16x32_bf16 v[32:35], a[164:167], a[72:75], v[32:35]
    ds_read_b64_tr_b16 a[128:129], v12 offset:18432
    v_mfma_f32_16x16x32_bf16 v[100:103], a[164:167], a[76:79], v[100:103]
    ds_read_b64_tr_b16 a[130:131], v12 offset:23040
    v_mfma_f32_16x16x32_bf16 v[36:39], a[168:171], a[72:75], v[36:39]
    ds_read_b64_tr_b16 a[132:133], v12 offset:18464
    v_mfma_f32_16x16x32_bf16 v[104:107], a[168:171], a[76:79], v[104:107]
    ds_read_b64_tr_b16 a[134:135], v12 offset:23072
    ds_read_b64_tr_b16 a[136:137], v12 offset:18496
    v_mfma_f32_16x16x32_bf16 v[40:43], a[172:175], a[72:75], v[40:43]
    ds_read_b64_tr_b16 a[138:139], v12 offset:23104
    v_mfma_f32_16x16x32_bf16 v[108:111], a[172:175], a[76:79], v[108:111]
    s_waitcnt lgkmcnt(12)
    v_mfma_f32_16x16x32_bf16 v[44:47], a[176:179], a[72:75], v[44:47]
    ds_read_b64_tr_b16 a[140:141], v12 offset:18528
    v_mfma_f32_16x16x32_bf16 v[112:115], a[176:179], a[76:79], v[112:115]
    ds_read_b64_tr_b16 a[142:143], v12 offset:23136
    s_lshr_b32 s24, s66, 1
    s_mul_i32 s24, s24, 7168
    s_sub_u32 s24, 12288, s24
    s_bitcmp1_b32 s66, 0
    s_cselect_b32 s24, s24, 0x40000000
    s_add_u32 s64, s64, s24
    s_add_u32 s65, s65, s24
    v_mfma_f32_16x16x32_bf16 v[48:51], a[180:183], a[72:75], v[48:51]
    ds_read_b64_tr_b16 a[144:145], v12 offset:18560
    ds_read_b64_tr_b16 a[146:147], v12 offset:23168
    v_mfma_f32_16x16x32_bf16 v[116:119], a[180:183], a[76:79], v[116:119]
    ds_read_b64_tr_b16 a[148:149], v12 offset:18592
    v_mfma_f32_16x16x32_bf16 v[52:55], a[184:187], a[72:75], v[52:55]
    ds_read_b64_tr_b16 a[150:151], v12 offset:23200
    v_mfma_f32_16x16x32_bf16 v[200:203], a[184:187], a[76:79], v[200:203]
    s_waitcnt lgkmcnt(12)
    v_mfma_f32_16x16x32_bf16 v[56:59], a[188:191], a[72:75], v[56:59]
    ds_read_b64_tr_b16 a[152:153], v12 offset:18624
    ds_read_b64_tr_b16 a[154:155], v12 offset:23232
    v_mfma_f32_16x16x32_bf16 v[204:207], a[188:191], a[76:79], v[204:207]
    ds_read_b64_tr_b16 a[156:157], v12 offset:18656
    v_mfma_f32_16x16x32_bf16 v[60:63], a[192:195], a[72:75], v[60:63]
    ds_read_b64_tr_b16 a[158:159], v12 offset:23264
    v_mfma_f32_16x16x32_bf16 v[208:211], a[192:195], a[76:79], v[208:211]
    ds_read_b64_tr_b16 a[160:161], v12 offset:18688
    buffer_load_dwordx4 a[32:35], v29, s[52:55], s64 offen offset:0 sc1
    v_mfma_f32_16x16x32_bf16 v[96:99], a[196:199], a[72:75], v[96:99]
    ds_read_b64_tr_b16 a[162:163], v12 offset:23296
    v_mfma_f32_16x16x32_bf16 v[212:215], a[196:199], a[76:79], v[212:215]
    buffer_load_dwordx4 a[36:39], v29, s[52:55], s65 offen offset:0 sc1
    s_waitcnt lgkmcnt(12)
    v_mfma_f32_16x16x32_bf16 v[32:35], a[128:131], a[80:83], v[32:35]
    ds_read_b64_tr_b16 a[164:165], v12 offset:27648
    ds_read_b64_tr_b16 a[166:167], v12 offset:32256
    v_mfma_f32_16x16x32_bf16 v[100:103], a[128:131], a[84:87], v[100:103]
    ds_read_b64_tr_b16 a[168:169], v12 offset:27680
    v_mfma_f32_16x16x32_bf16 v[36:39], a[132:135], a[80:83], v[36:39]
    ds_read_b64_tr_b16 a[170:171], v12 offset:32288
    ds_read_b64_tr_b16 a[172:173], v12 offset:27712
    v_mfma_f32_16x16x32_bf16 v[104:107], a[132:135], a[84:87], v[104:107]
    ds_read_b64_tr_b16 a[174:175], v12 offset:32320
    ds_read_b64_tr_b16 a[176:177], v12 offset:27744
    v_mfma_f32_16x16x32_bf16 v[40:43], a[136:139], a[80:83], v[40:43]
    ds_read_b64_tr_b16 a[178:179], v12 offset:32352
    v_mfma_f32_16x16x32_bf16 v[108:111], a[136:139], a[84:87], v[108:111]
    s_waitcnt lgkmcnt(14)
    ds_read_b64_tr_b16 a[180:181], v12 offset:27776
    v_mfma_f32_16x16x32_bf16 v[44:47], a[140:143], a[80:83], v[44:47]
    ds_read_b64_tr_b16 a[182:183], v12 offset:32384
    ds_read_b64_tr_b16 a[184:185], v12 offset:27808
    v_mfma_f32_16x16x32_bf16 v[112:115], a[140:143], a[84:87], v[112:115]
    ds_read_b64_tr_b16 a[186:187], v12 offset:32416
    v_mfma_f32_16x16x32_bf16 v[48:51], a[144:147], a[80:83], v[48:51]
    ds_read_b64_tr_b16 a[188:189], v12 offset:27840
    ds_read_b64_tr_b16 a[190:191], v12 offset:32448
    v_mfma_f32_16x16x32_bf16 v[116:119], a[144:147], a[84:87], v[116:119]
    ds_read_b64_tr_b16 a[192:193], v12 offset:27872
    ds_read_b64_tr_b16 a[194:195], v12 offset:32480
    v_mfma_f32_16x16x32_bf16 v[52:55], a[148:151], a[80:83], v[52:55]
    ds_read_b64_tr_b16 a[196:197], v12 offset:27904
    v_mfma_f32_16x16x32_bf16 v[200:203], a[148:151], a[84:87], v[200:203]
    s_waitcnt lgkmcnt(15)
    ds_read_b64_tr_b16 a[198:199], v12 offset:32512
    v_mfma_f32_16x16x32_bf16 v[56:59], a[152:155], a[80:83], v[56:59]
    v_mfma_f32_16x16x32_bf16 v[204:207], a[152:155], a[84:87], v[204:207]
    v_mfma_f32_16x16x32_bf16 v[60:63], a[156:159], a[80:83], v[60:63]
    v_mfma_f32_16x16x32_bf16 v[208:211], a[156:159], a[84:87], v[208:211]
    v_mfma_f32_16x16x32_bf16 v[96:99], a[160:163], a[80:83], v[96:99]
    v_mfma_f32_16x16x32_bf16 v[212:215], a[160:163], a[84:87], v[212:215]
    s_waitcnt lgkmcnt(0)
    v_mfma_f32_16x16x32_bf16 v[32:35], a[164:167], a[88:91], v[32:35]
    s_barrier
    v_mfma_f32_16x16x32_bf16 v[100:103], a[164:167], a[92:95], v[100:103]
    ds_read_b64_tr_b16 a[128:129], v13 offset:0
    v_mfma_f32_16x16x32_bf16 v[36:39], a[168:171], a[88:91], v[36:39]
    ds_read_b64_tr_b16 a[130:131], v13 offset:4608
    v_mfma_f32_16x16x32_bf16 v[104:107], a[168:171], a[92:95], v[104:107]
    ds_read_b64_tr_b16 a[132:133], v13 offset:32
    v_mfma_f32_16x16x32_bf16 v[40:43], a[172:175], a[88:91], v[40:43]
    ds_read_b64_tr_b16 a[134:135], v13 offset:4640
    ds_read_b64_tr_b16 a[136:137], v13 offset:64
    v_mfma_f32_16x16x32_bf16 v[108:111], a[172:175], a[92:95], v[108:111]
    ds_read_b64_tr_b16 a[138:139], v13 offset:4672
    v_mfma_f32_16x16x32_bf16 v[44:47], a[176:179], a[88:91], v[44:47]
    ds_read_b64_tr_b16 a[140:141], v13 offset:96
    v_mfma_f32_16x16x32_bf16 v[112:115], a[176:179], a[92:95], v[112:115]
    ds_read_b64_tr_b16 a[142:143], v13 offset:4704
    v_mfma_f32_16x16x32_bf16 v[48:51], a[180:183], a[88:91], v[48:51]
    ds_read_b64_tr_b16 a[144:145], v13 offset:128
    v_mfma_f32_16x16x32_bf16 v[116:119], a[180:183], a[92:95], v[116:119]
    ds_read_b64_tr_b16 a[146:147], v13 offset:4736
    v_mfma_f32_16x16x32_bf16 v[52:55], a[184:187], a[88:91], v[52:55]
    ds_read_b64_tr_b16 a[148:149], v13 offset:160
    v_mfma_f32_16x16x32_bf16 v[200:203], a[184:187], a[92:95], v[200:203]
    ds_read_b64_tr_b16 a[150:151], v13 offset:4768
    v_mfma_f32_16x16x32_bf16 v[56:59], a[188:191], a[88:91], v[56:59]
    ds_read_b64_tr_b16 a[152:153], v13 offset:192
    ds_read_b64_tr_b16 a[154:155], v13 offset:4800
    v_mfma_f32_16x16x32_bf16 v[204:207], a[188:191], a[92:95], v[204:207]
    ds_read_b64_tr_b16 a[156:157], v13 offset:224
    v_mfma_f32_16x16x32_bf16 v[60:63], a[192:195], a[88:91], v[60:63]
    ds_read_b64_tr_b16 a[158:159], v13 offset:4832
    v_mfma_f32_16x16x32_bf16 v[208:211], a[192:195], a[92:95], v[208:211]
    ds_read_b64_tr_b16 a[160:161], v13 offset:256
    v_mfma_f32_16x16x32_bf16 v[96:99], a[196:199], a[88:91], v[96:99]
    ds_read_b64_tr_b16 a[162:163], v13 offset:4864
    v_mfma_f32_16x16x32_bf16 v[212:215], a[196:199], a[92:95], v[212:215]
    s_waitcnt lgkmcnt(12)
    v_mfma_f32_16x16x32_bf16 v[32:35], a[128:131], a[96:99], v[32:35]
    ds_read_b64_tr_b16 a[164:165], v13 offset:9216
    v_mfma_f32_16x16x32_bf16 v[100:103], a[128:131], a[100:103], v[100:103]
    ds_read_b64_tr_b16 a[166:167], v13 offset:13824
    v_mfma_f32_16x16x32_bf16 v[36:39], a[132:135], a[96:99], v[36:39]
    ds_read_b64_tr_b16 a[168:169], v13 offset:9248
    v_mfma_f32_16x16x32_bf16 v[104:107], a[132:135], a[100:103], v[104:107]
    ds_read_b64_tr_b16 a[170:171], v13 offset:13856
    ds_read_b64_tr_b16 a[172:173], v13 offset:9280
    v_mfma_f32_16x16x32_bf16 v[40:43], a[136:139], a[96:99], v[40:43]
    ds_read_b64_tr_b16 a[174:175], v13 offset:13888
    v_mfma_f32_16x16x32_bf16 v[108:111], a[136:139], a[100:103], v[108:111]
    s_waitcnt lgkmcnt(12)
    v_mfma_f32_16x16x32_bf16 v[44:47], a[140:143], a[96:99], v[44:47]
    ds_read_b64_tr_b16 a[176:177], v13 offset:9312
    v_mfma_f32_16x16x32_bf16 v[112:115], a[140:143], a[100:103], v[112:115]
    ds_read_b64_tr_b16 a[178:179], v13 offset:13920
    v_mfma_f32_16x16x32_bf16 v[48:51], a[144:147], a[96:99], v[48:51]
    ds_read_b64_tr_b16 a[180:181], v13 offset:9344
    ds_read_b64_tr_b16 a[182:183], v13 offset:13952
    v_mfma_f32_16x16x32_bf16 v[116:119], a[144:147], a[100:103], v[116:119]
    ds_read_b64_tr_b16 a[184:185], v13 offset:9376
    v_mfma_f32_16x16x32_bf16 v[52:55], a[148:151], a[96:99], v[52:55]
    ds_read_b64_tr_b16 a[186:187], v13 offset:13984
    v_mfma_f32_16x16x32_bf16 v[200:203], a[148:151], a[100:103], v[200:203]
    s_waitcnt lgkmcnt(12)
    v_mfma_f32_16x16x32_bf16 v[56:59], a[152:155], a[96:99], v[56:59]
    ds_read_b64_tr_b16 a[188:189], v13 offset:9408
    ds_read_b64_tr_b16 a[190:191], v13 offset:14016
    v_mfma_f32_16x16x32_bf16 v[204:207], a[152:155], a[100:103], v[204:207]
    ds_read_b64_tr_b16 a[192:193], v13 offset:9440
    v_mfma_f32_16x16x32_bf16 v[60:63], a[156:159], a[96:99], v[60:63]
    ds_read_b64_tr_b16 a[194:195], v13 offset:14048
    v_mfma_f32_16x16x32_bf16 v[208:211], a[156:159], a[100:103], v[208:211]
    ds_read_b64_tr_b16 a[196:197], v13 offset:9472
    v_mfma_f32_16x16x32_bf16 v[96:99], a[160:163], a[96:99], v[96:99]
    ds_read_b64_tr_b16 a[198:199], v13 offset:14080
    v_mfma_f32_16x16x32_bf16 v[212:215], a[160:163], a[100:103], v[212:215]
    s_waitcnt lgkmcnt(12)
    v_mfma_f32_16x16x32_bf16 v[32:35], a[164:167], a[104:107], v[32:35]
    ds_read_b64_tr_b16 a[128:129], v13 offset:18432
    v_mfma_f32_16x16x32_bf16 v[100:103], a[164:167], a[108:111], v[100:103]
    ds_read_b64_tr_b16 a[130:131], v13 offset:23040
    v_mfma_f32_16x16x32_bf16 v[36:39], a[168:171], a[104:107], v[36:39]
    ds_read_b64_tr_b16 a[132:133], v13 offset:18464
    v_mfma_f32_16x16x32_bf16 v[104:107], a[168:171], a[108:111], v[104:107]
    ds_read_b64_tr_b16 a[134:135], v13 offset:23072
    ds_read_b64_tr_b16 a[136:137], v13 offset:18496
    v_mfma_f32_16x16x32_bf16 v[40:43], a[172:175], a[104:107], v[40:43]
    ds_read_b64_tr_b16 a[138:139], v13 offset:23104
    v_mfma_f32_16x16x32_bf16 v[108:111], a[172:175], a[108:111], v[108:111]
    s_waitcnt lgkmcnt(12)
    v_mfma_f32_16x16x32_bf16 v[44:47], a[176:179], a[104:107], v[44:47]
    ds_read_b64_tr_b16 a[140:141], v13 offset:18528
    v_mfma_f32_16x16x32_bf16 v[112:115], a[176:179], a[108:111], v[112:115]
    ds_read_b64_tr_b16 a[142:143], v13 offset:23136
    v_mfma_f32_16x16x32_bf16 v[48:51], a[180:183], a[104:107], v[48:51]
    ds_read_b64_tr_b16 a[144:145], v13 offset:18560
    ds_read_b64_tr_b16 a[146:147], v13 offset:23168
    v_mfma_f32_16x16x32_bf16 v[116:119], a[180:183], a[108:111], v[116:119]
    ds_read_b64_tr_b16 a[148:149], v13 offset:18592
    v_mfma_f32_16x16x32_bf16 v[52:55], a[184:187], a[104:107], v[52:55]
    ds_read_b64_tr_b16 a[150:151], v13 offset:23200
    v_mfma_f32_16x16x32_bf16 v[200:203], a[184:187], a[108:111], v[200:203]
    s_waitcnt lgkmcnt(12)
    v_mfma_f32_16x16x32_bf16 v[56:59], a[188:191], a[104:107], v[56:59]
    ds_read_b64_tr_b16 a[152:153], v13 offset:18624
    ds_read_b64_tr_b16 a[154:155], v13 offset:23232
    v_mfma_f32_16x16x32_bf16 v[204:207], a[188:191], a[108:111], v[204:207]
    ds_read_b64_tr_b16 a[156:157], v13 offset:18656
    v_mfma_f32_16x16x32_bf16 v[60:63], a[192:195], a[104:107], v[60:63]
    ds_read_b64_tr_b16 a[158:159], v13 offset:23264
    v_mfma_f32_16x16x32_bf16 v[208:211], a[192:195], a[108:111], v[208:211]
    ds_read_b64_tr_b16 a[160:161], v13 offset:18688
    v_mfma_f32_16x16x32_bf16 v[96:99], a[196:199], a[104:107], v[96:99]
    ds_read_b64_tr_b16 a[162:163], v13 offset:23296
    v_mfma_f32_16x16x32_bf16 v[212:215], a[196:199], a[108:111], v[212:215]
    s_waitcnt lgkmcnt(12)
    v_mfma_f32_16x16x32_bf16 v[32:35], a[128:131], a[112:115], v[32:35]
    ds_read_b64_tr_b16 a[164:165], v13 offset:27648
    ds_read_b64_tr_b16 a[166:167], v13 offset:32256
    v_mfma_f32_16x16x32_bf16 v[100:103], a[128:131], a[116:119], v[100:103]
    ds_read_b64_tr_b16 a[168:169], v13 offset:27680
    v_mfma_f32_16x16x32_bf16 v[36:39], a[132:135], a[112:115], v[36:39]
    ds_read_b64_tr_b16 a[170:171], v13 offset:32288
    ds_read_b64_tr_b16 a[172:173], v13 offset:27712
    v_mfma_f32_16x16x32_bf16 v[104:107], a[132:135], a[116:119], v[104:107]
    ds_read_b64_tr_b16 a[174:175], v13 offset:32320
    ds_read_b64_tr_b16 a[176:177], v13 offset:27744
    v_mfma_f32_16x16x32_bf16 v[40:43], a[136:139], a[112:115], v[40:43]
    ds_read_b64_tr_b16 a[178:179], v13 offset:32352
    v_mfma_f32_16x16x32_bf16 v[108:111], a[136:139], a[116:119], v[108:111]
    s_waitcnt lgkmcnt(14)
    ds_read_b64_tr_b16 a[180:181], v13 offset:27776
    v_mfma_f32_16x16x32_bf16 v[44:47], a[140:143], a[112:115], v[44:47]
    ds_read_b64_tr_b16 a[182:183], v13 offset:32384
    ds_read_b64_tr_b16 a[184:185], v13 offset:27808
    v_mfma_f32_16x16x32_bf16 v[112:115], a[140:143], a[116:119], v[112:115]
    ds_read_b64_tr_b16 a[186:187], v13 offset:32416
    v_mfma_f32_16x16x32_bf16 v[48:51], a[144:147], a[112:115], v[48:51]
    ds_read_b64_tr_b16 a[188:189], v13 offset:27840
    ds_read_b64_tr_b16 a[190:191], v13 offset:32448
    v_mfma_f32_16x16x32_bf16 v[116:119], a[144:147], a[116:119], v[116:119]
    ds_read_b64_tr_b16 a[192:193], v13 offset:27872
    ds_read_b64_tr_b16 a[194:195], v13 offset:32480
    v_mfma_f32_16x16x32_bf16 v[52:55], a[148:151], a[112:115], v[52:55]
    ds_read_b64_tr_b16 a[196:197], v13 offset:27904
    v_mfma_f32_16x16x32_bf16 v[200:203], a[148:151], a[116:119], v[200:203]
    s_waitcnt lgkmcnt(15)
    ds_read_b64_tr_b16 a[198:199], v13 offset:32512
    v_mfma_f32_16x16x32_bf16 v[56:59], a[152:155], a[112:115], v[56:59]
    v_mfma_f32_16x16x32_bf16 v[204:207], a[152:155], a[116:119], v[204:207]
    v_mfma_f32_16x16x32_bf16 v[60:63], a[156:159], a[112:115], v[60:63]
    v_mfma_f32_16x16x32_bf16 v[208:211], a[156:159], a[116:119], v[208:211]
    v_mfma_f32_16x16x32_bf16 v[96:99], a[160:163], a[112:115], v[96:99]
    v_mfma_f32_16x16x32_bf16 v[212:215], a[160:163], a[116:119], v[212:215]
    s_waitcnt vmcnt(12) lgkmcnt(0)
    v_mfma_f32_16x16x32_bf16 v[32:35], a[164:167], a[120:123], v[32:35]
    s_barrier
    v_mfma_f32_16x16x32_bf16 v[100:103], a[164:167], a[124:127], v[100:103]
    ds_read_b64_tr_b16 a[128:129], v10 offset:0
    v_mfma_f32_16x16x32_bf16 v[36:39], a[168:171], a[120:123], v[36:39]
    ds_read_b64_tr_b16 a[130:131], v10 offset:4608
    v_mfma_f32_16x16x32_bf16 v[104:107], a[168:171], a[124:127], v[104:107]
    ds_read_b64_tr_b16 a[132:133], v10 offset:32
    v_mfma_f32_16x16x32_bf16 v[40:43], a[172:175], a[120:123], v[40:43]
    ds_read_b64_tr_b16 a[134:135], v10 offset:4640
    ds_read_b64_tr_b16 a[136:137], v10 offset:64
    v_mfma_f32_16x16x32_bf16 v[108:111], a[172:175], a[124:127], v[108:111]
    ds_read_b64_tr_b16 a[138:139], v10 offset:4672
    v_mfma_f32_16x16x32_bf16 v[44:47], a[176:179], a[120:123], v[44:47]
    ds_read_b64_tr_b16 a[140:141], v10 offset:96
    v_mfma_f32_16x16x32_bf16 v[112:115], a[176:179], a[124:127], v[112:115]
    ds_read_b64_tr_b16 a[142:143], v10 offset:4704
    v_mfma_f32_16x16x32_bf16 v[48:51], a[180:183], a[120:123], v[48:51]
    ds_read_b64_tr_b16 a[144:145], v10 offset:128
    v_mfma_f32_16x16x32_bf16 v[116:119], a[180:183], a[124:127], v[116:119]
    ds_read_b64_tr_b16 a[146:147], v10 offset:4736
    v_mfma_f32_16x16x32_bf16 v[52:55], a[184:187], a[120:123], v[52:55]
    ds_read_b64_tr_b16 a[148:149], v10 offset:160
    v_mfma_f32_16x16x32_bf16 v[200:203], a[184:187], a[124:127], v[200:203]
    ds_read_b64_tr_b16 a[150:151], v10 offset:4768
    v_mfma_f32_16x16x32_bf16 v[56:59], a[188:191], a[120:123], v[56:59]
    ds_read_b64_tr_b16 a[152:153], v10 offset:192
    ds_read_b64_tr_b16 a[154:155], v10 offset:4800
    v_mfma_f32_16x16x32_bf16 v[204:207], a[188:191], a[124:127], v[204:207]
    ds_read_b64_tr_b16 a[156:157], v10 offset:224
    v_mfma_f32_16x16x32_bf16 v[60:63], a[192:195], a[120:123], v[60:63]
    ds_read_b64_tr_b16 a[158:159], v10 offset:4832
    v_mfma_f32_16x16x32_bf16 v[208:211], a[192:195], a[124:127], v[208:211]
    ds_read_b64_tr_b16 a[160:161], v10 offset:256
    v_mfma_f32_16x16x32_bf16 v[96:99], a[196:199], a[120:123], v[96:99]
    ds_read_b64_tr_b16 a[162:163], v10 offset:4864
    v_mfma_f32_16x16x32_bf16 v[212:215], a[196:199], a[124:127], v[212:215]
    s_waitcnt vmcnt(4) lgkmcnt(12)
    v_mfma_f32_16x16x32_bf16 v[32:35], a[128:131], a[0:3], v[32:35]
    ds_read_b64_tr_b16 a[164:165], v10 offset:9216
    v_mfma_f32_16x16x32_bf16 v[100:103], a[128:131], a[4:7], v[100:103]
    ds_read_b64_tr_b16 a[166:167], v10 offset:13824
    v_mfma_f32_16x16x32_bf16 v[36:39], a[132:135], a[0:3], v[36:39]
    ds_read_b64_tr_b16 a[168:169], v10 offset:9248
    v_mfma_f32_16x16x32_bf16 v[104:107], a[132:135], a[4:7], v[104:107]
    ds_read_b64_tr_b16 a[170:171], v10 offset:13856
    ds_read_b64_tr_b16 a[172:173], v10 offset:9280
    v_mfma_f32_16x16x32_bf16 v[40:43], a[136:139], a[0:3], v[40:43]
    ds_read_b64_tr_b16 a[174:175], v10 offset:13888
    v_mfma_f32_16x16x32_bf16 v[108:111], a[136:139], a[4:7], v[108:111]
    s_waitcnt lgkmcnt(12)
    v_mfma_f32_16x16x32_bf16 v[44:47], a[140:143], a[0:3], v[44:47]
    ds_read_b64_tr_b16 a[176:177], v10 offset:9312
    v_mfma_f32_16x16x32_bf16 v[112:115], a[140:143], a[4:7], v[112:115]
    ds_read_b64_tr_b16 a[178:179], v10 offset:13920
    v_mfma_f32_16x16x32_bf16 v[48:51], a[144:147], a[0:3], v[48:51]
    ds_read_b64_tr_b16 a[180:181], v10 offset:9344
    ds_read_b64_tr_b16 a[182:183], v10 offset:13952
    v_mfma_f32_16x16x32_bf16 v[116:119], a[144:147], a[4:7], v[116:119]
    ds_read_b64_tr_b16 a[184:185], v10 offset:9376
    v_mfma_f32_16x16x32_bf16 v[52:55], a[148:151], a[0:3], v[52:55]
    ds_read_b64_tr_b16 a[186:187], v10 offset:13984
    v_mfma_f32_16x16x32_bf16 v[200:203], a[148:151], a[4:7], v[200:203]
    s_waitcnt lgkmcnt(12)
    v_mfma_f32_16x16x32_bf16 v[56:59], a[152:155], a[0:3], v[56:59]
    ds_read_b64_tr_b16 a[188:189], v10 offset:9408
    ds_read_b64_tr_b16 a[190:191], v10 offset:14016
    v_mfma_f32_16x16x32_bf16 v[204:207], a[152:155], a[4:7], v[204:207]
    ds_read_b64_tr_b16 a[192:193], v10 offset:9440
    v_mfma_f32_16x16x32_bf16 v[60:63], a[156:159], a[0:3], v[60:63]
    ds_read_b64_tr_b16 a[194:195], v10 offset:14048
    v_mfma_f32_16x16x32_bf16 v[208:211], a[156:159], a[4:7], v[208:211]
    ds_read_b64_tr_b16 a[196:197], v10 offset:9472
    v_mfma_f32_16x16x32_bf16 v[96:99], a[160:163], a[0:3], v[96:99]
    ds_read_b64_tr_b16 a[198:199], v10 offset:14080
    v_mfma_f32_16x16x32_bf16 v[212:215], a[160:163], a[4:7], v[212:215]
    s_waitcnt lgkmcnt(12)
    v_mfma_f32_16x16x32_bf16 v[32:35], a[164:167], a[8:11], v[32:35]
    ds_read_b64_tr_b16 a[128:129], v10 offset:18432
    v_mfma_f32_16x16x32_bf16 v[100:103], a[164:167], a[12:15], v[100:103]
    ds_read_b64_tr_b16 a[130:131], v10 offset:23040
    v_mfma_f32_16x16x32_bf16 v[36:39], a[168:171], a[8:11], v[36:39]
    ds_read_b64_tr_b16 a[132:133], v10 offset:18464
    v_mfma_f32_16x16x32_bf16 v[104:107], a[168:171], a[12:15], v[104:107]
    ds_read_b64_tr_b16 a[134:135], v10 offset:23072
    ds_read_b64_tr_b16 a[136:137], v10 offset:18496
    v_mfma_f32_16x16x32_bf16 v[40:43], a[172:175], a[8:11], v[40:43]
    ds_read_b64_tr_b16 a[138:139], v10 offset:23104
    v_mfma_f32_16x16x32_bf16 v[108:111], a[172:175], a[12:15], v[108:111]
    s_waitcnt lgkmcnt(12)
    v_mfma_f32_16x16x32_bf16 v[44:47], a[176:179], a[8:11], v[44:47]
    ds_read_b64_tr_b16 a[140:141], v10 offset:18528
    v_mfma_f32_16x16x32_bf16 v[112:115], a[176:179], a[12:15], v[112:115]
    ds_read_b64_tr_b16 a[142:143], v10 offset:23136
    v_mfma_f32_16x16x32_bf16 v[48:51], a[180:183], a[8:11], v[48:51]
    ds_read_b64_tr_b16 a[144:145], v10 offset:18560
    ds_read_b64_tr_b16 a[146:147], v10 offset:23168
    v_mfma_f32_16x16x32_bf16 v[116:119], a[180:183], a[12:15], v[116:119]
    ds_read_b64_tr_b16 a[148:149], v10 offset:18592
    v_mfma_f32_16x16x32_bf16 v[52:55], a[184:187], a[8:11], v[52:55]
    ds_read_b64_tr_b16 a[150:151], v10 offset:23200
    v_mfma_f32_16x16x32_bf16 v[200:203], a[184:187], a[12:15], v[200:203]
    s_waitcnt lgkmcnt(12)
    v_mfma_f32_16x16x32_bf16 v[56:59], a[188:191], a[8:11], v[56:59]
    ds_read_b64_tr_b16 a[152:153], v10 offset:18624
    ds_read_b64_tr_b16 a[154:155], v10 offset:23232
    v_mfma_f32_16x16x32_bf16 v[204:207], a[188:191], a[12:15], v[204:207]
    ds_read_b64_tr_b16 a[156:157], v10 offset:18656
    v_mfma_f32_16x16x32_bf16 v[60:63], a[192:195], a[8:11], v[60:63]
    ds_read_b64_tr_b16 a[158:159], v10 offset:23264
    v_mfma_f32_16x16x32_bf16 v[208:211], a[192:195], a[12:15], v[208:211]
    ds_read_b64_tr_b16 a[160:161], v10 offset:18688
    v_mfma_f32_16x16x32_bf16 v[96:99], a[196:199], a[8:11], v[96:99]
    ds_read_b64_tr_b16 a[162:163], v10 offset:23296
    v_mfma_f32_16x16x32_bf16 v[212:215], a[196:199], a[12:15], v[212:215]
    s_waitcnt lgkmcnt(12)
    v_mfma_f32_16x16x32_bf16 v[32:35], a[128:131], a[16:19], v[32:35]
    ds_read_b64_tr_b16 a[164:165], v10 offset:27648
    ds_read_b64_tr_b16 a[166:167], v10 offset:32256
    v_mfma_f32_16x16x32_bf16 v[100:103], a[128:131], a[20:23], v[100:103]
    ds_read_b64_tr_b16 a[168:169], v10 offset:27680
    v_mfma_f32_16x16x32_bf16 v[36:39], a[132:135], a[16:19], v[36:39]
    ds_read_b64_tr_b16 a[170:171], v10 offset:32288
    ds_read_b64_tr_b16 a[172:173], v10 offset:27712
    v_mfma_f32_16x16x32_bf16 v[104:107], a[132:135], a[20:23], v[104:107]
    ds_read_b64_tr_b16 a[174:175], v10 offset:32320
    ds_read_b64_tr_b16 a[176:177], v10 offset:27744
    v_mfma_f32_16x16x32_bf16 v[40:43], a[136:139], a[16:19], v[40:43]
    ds_read_b64_tr_b16 a[178:179], v10 offset:32352
    v_mfma_f32_16x16x32_bf16 v[108:111], a[136:139], a[20:23], v[108:111]
    s_waitcnt lgkmcnt(14)
    ds_read_b64_tr_b16 a[180:181], v10 offset:27776
    v_mfma_f32_16x16x32_bf16 v[44:47], a[140:143], a[16:19], v[44:47]
    ds_read_b64_tr_b16 a[182:183], v10 offset:32384
    ds_read_b64_tr_b16 a[184:185], v10 offset:27808
    v_mfma_f32_16x16x32_bf16 v[112:115], a[140:143], a[20:23], v[112:115]
    ds_read_b64_tr_b16 a[186:187], v10 offset:32416
    v_mfma_f32_16x16x32_bf16 v[48:51], a[144:147], a[16:19], v[48:51]
    ds_read_b64_tr_b16 a[188:189], v10 offset:27840
    ds_read_b64_tr_b16 a[190:191], v10 offset:32448
    v_mfma_f32_16x16x32_bf16 v[116:119], a[144:147], a[20:23], v[116:119]
    ds_read_b64_tr_b16 a[192:193], v10 offset:27872
    ds_read_b64_tr_b16 a[194:195], v10 offset:32480
    v_mfma_f32_16x16x32_bf16 v[52:55], a[148:151], a[16:19], v[52:55]
    ds_read_b64_tr_b16 a[196:197], v10 offset:27904
    v_mfma_f32_16x16x32_bf16 v[200:203], a[148:151], a[20:23], v[200:203]
    s_waitcnt lgkmcnt(15)
    ds_read_b64_tr_b16 a[198:199], v10 offset:32512
    v_mfma_f32_16x16x32_bf16 v[56:59], a[152:155], a[16:19], v[56:59]
    v_mfma_f32_16x16x32_bf16 v[204:207], a[152:155], a[20:23], v[204:207]
    v_mfma_f32_16x16x32_bf16 v[60:63], a[156:159], a[16:19], v[60:63]
    v_mfma_f32_16x16x32_bf16 v[208:211], a[156:159], a[20:23], v[208:211]
    v_mfma_f32_16x16x32_bf16 v[96:99], a[160:163], a[16:19], v[96:99]
    v_mfma_f32_16x16x32_bf16 v[212:215], a[160:163], a[20:23], v[212:215]
    s_waitcnt vmcnt(2) lgkmcnt(0)
    v_mfma_f32_16x16x32_bf16 v[32:35], a[164:167], a[24:27], v[32:35]
    s_barrier
    v_mfma_f32_16x16x32_bf16 v[100:103], a[164:167], a[28:31], v[100:103]
    ds_read_b64_tr_b16 a[128:129], v11 offset:0
    v_mfma_f32_16x16x32_bf16 v[36:39], a[168:171], a[24:27], v[36:39]
    ds_read_b64_tr_b16 a[130:131], v11 offset:4608
    v_mfma_f32_16x16x32_bf16 v[104:107], a[168:171], a[28:31], v[104:107]
    ds_read_b64_tr_b16 a[132:133], v11 offset:32
    v_mfma_f32_16x16x32_bf16 v[40:43], a[172:175], a[24:27], v[40:43]
    ds_read_b64_tr_b16 a[134:135], v11 offset:4640
    ds_read_b64_tr_b16 a[136:137], v11 offset:64
    v_mfma_f32_16x16x32_bf16 v[108:111], a[172:175], a[28:31], v[108:111]
    ds_read_b64_tr_b16 a[138:139], v11 offset:4672
    v_mfma_f32_16x16x32_bf16 v[44:47], a[176:179], a[24:27], v[44:47]
    ds_read_b64_tr_b16 a[140:141], v11 offset:96
    v_mfma_f32_16x16x32_bf16 v[112:115], a[176:179], a[28:31], v[112:115]
    ds_read_b64_tr_b16 a[142:143], v11 offset:4704
    v_mfma_f32_16x16x32_bf16 v[48:51], a[180:183], a[24:27], v[48:51]
    ds_read_b64_tr_b16 a[144:145], v11 offset:128
    v_mfma_f32_16x16x32_bf16 v[116:119], a[180:183], a[28:31], v[116:119]
    ds_read_b64_tr_b16 a[146:147], v11 offset:4736
    v_mfma_f32_16x16x32_bf16 v[52:55], a[184:187], a[24:27], v[52:55]
    ds_read_b64_tr_b16 a[148:149], v11 offset:160
    v_mfma_f32_16x16x32_bf16 v[200:203], a[184:187], a[28:31], v[200:203]
    ds_read_b64_tr_b16 a[150:151], v11 offset:4768
    v_mfma_f32_16x16x32_bf16 v[56:59], a[188:191], a[24:27], v[56:59]
    ds_read_b64_tr_b16 a[152:153], v11 offset:192
    ds_read_b64_tr_b16 a[154:155], v11 offset:4800
    v_mfma_f32_16x16x32_bf16 v[204:207], a[188:191], a[28:31], v[204:207]
    ds_read_b64_tr_b16 a[156:157], v11 offset:224
    v_mfma_f32_16x16x32_bf16 v[60:63], a[192:195], a[24:27], v[60:63]
    ds_read_b64_tr_b16 a[158:159], v11 offset:4832
    v_mfma_f32_16x16x32_bf16 v[208:211], a[192:195], a[28:31], v[208:211]
    ds_read_b64_tr_b16 a[160:161], v11 offset:256
    v_mfma_f32_16x16x32_bf16 v[96:99], a[196:199], a[24:27], v[96:99]
    ds_read_b64_tr_b16 a[162:163], v11 offset:4864
    v_mfma_f32_16x16x32_bf16 v[212:215], a[196:199], a[28:31], v[212:215]
    s_waitcnt vmcnt(0) lgkmcnt(12)
    v_mfma_f32_16x16x32_bf16 v[32:35], a[128:131], a[32:35], v[32:35]
    v_mfma_f32_16x16x32_bf16 v[100:103], a[128:131], a[36:39], v[100:103]
    v_mfma_f32_16x16x32_bf16 v[36:39], a[132:135], a[32:35], v[36:39]
    v_mfma_f32_16x16x32_bf16 v[104:107], a[132:135], a[36:39], v[104:107]
    v_mfma_f32_16x16x32_bf16 v[40:43], a[136:139], a[32:35], v[40:43]
    v_mfma_f32_16x16x32_bf16 v[108:111], a[136:139], a[36:39], v[108:111]
    s_waitcnt lgkmcnt(6)
    v_mfma_f32_16x16x32_bf16 v[44:47], a[140:143], a[32:35], v[44:47]
    v_mfma_f32_16x16x32_bf16 v[112:115], a[140:143], a[36:39], v[112:115]
    v_mfma_f32_16x16x32_bf16 v[48:51], a[144:147], a[32:35], v[48:51]
    v_mfma_f32_16x16x32_bf16 v[116:119], a[144:147], a[36:39], v[116:119]
    v_mfma_f32_16x16x32_bf16 v[52:55], a[148:151], a[32:35], v[52:55]
    v_mfma_f32_16x16x32_bf16 v[200:203], a[148:151], a[36:39], v[200:203]
    s_waitcnt lgkmcnt(0)
    v_mfma_f32_16x16x32_bf16 v[56:59], a[152:155], a[32:35], v[56:59]
    v_mfma_f32_16x16x32_bf16 v[204:207], a[152:155], a[36:39], v[204:207]
    v_mfma_f32_16x16x32_bf16 v[60:63], a[156:159], a[32:35], v[60:63]
    v_mfma_f32_16x16x32_bf16 v[208:211], a[156:159], a[36:39], v[208:211]
    v_mfma_f32_16x16x32_bf16 v[96:99], a[160:163], a[32:35], v[96:99]
    v_mfma_f32_16x16x32_bf16 v[212:215], a[160:163], a[36:39], v[212:215]
    s_lshl_b32 s74, s67, 4
    s_lshl_b32 s23, s22, 2
    s_add_u32 s75, s74, s23
    s_add_u32 s75, s75, s66
    s_mul_i32 s24, s75, 9216
    s_add_u32 s75, s75, 256
    s_lshl_b32 s75, s75, 7
    s_barrier
    s_cmp_eq_u32 s22, s66
    s_cbranch_scc1 f1_own
    v_cvt_pk_bf16_f32 v160, v32, v33
    v_cvt_pk_bf16_f32 v161, v34, v35
    v_cvt_pk_bf16_f32 v162, v100, v101
    v_cvt_pk_bf16_f32 v163, v102, v103
    buffer_store_dwordx4 v[160:163], v29, s[44:47], s24 offen offset:0 sc1
    v_cvt_pk_bf16_f32 v164, v36, v37
    v_cvt_pk_bf16_f32 v165, v38, v39
    v_cvt_pk_bf16_f32 v166, v104, v105
    v_cvt_pk_bf16_f32 v167, v106, v107
    buffer_store_dwordx4 v[164:167], v29, s[44:47], s24 offen offset:1024 sc1
    v_cvt_pk_bf16_f32 v168, v40, v41
    v_cvt_pk_bf16_f32 v169, v42, v43
    v_cvt_pk_bf16_f32 v170, v108, v109
    v_cvt_pk_bf16_f32 v171, v110, v111
    buffer_store_dwordx4 v[168:171], v29, s[44:47], s24 offen offset:2048 sc1
    v_cvt_pk_bf16_f32 v172, v44, v45
    v_cvt_pk_bf16_f32 v173, v46, v47
    v_cvt_pk_bf16_f32 v174, v112, v113
    v_cvt_pk_bf16_f32 v175, v114, v115
    buffer_store_dwordx4 v[172:175], v29, s[44:47], s24 offen offset:3072 sc1
    v_cvt_pk_bf16_f32 v176, v48, v49
    v_cvt_pk_bf16_f32 v177, v50, v51
    v_cvt_pk_bf16_f32 v178, v116, v117
    v_cvt_pk_bf16_f32 v179, v118, v119
    s_add_u32 s24, s24, 4096
    buffer_store_dwordx4 v[176:179], v29, s[44:47], s24 offen offset:0 sc1
    v_cvt_pk_bf16_f32 v180, v52, v53
    v_cvt_pk_bf16_f32 v181, v54, v55
    v_cvt_pk_bf16_f32 v182, v200, v201
    v_cvt_pk_bf16_f32 v183, v202, v203
    buffer_store_dwordx4 v[180:183], v29, s[44:47], s24 offen offset:1024 sc1
    v_cvt_pk_bf16_f32 v184, v56, v57
    v_cvt_pk_bf16_f32 v185, v58, v59
    v_cvt_pk_bf16_f32 v186, v204, v205
    v_cvt_pk_bf16_f32 v187, v206, v207
    buffer_store_dwordx4 v[184:187], v29, s[44:47], s24 offen offset:2048 sc1
    v_cvt_pk_bf16_f32 v188, v60, v61
    v_cvt_pk_bf16_f32 v189, v62, v63
    v_cvt_pk_bf16_f32 v190, v208, v209
    v_cvt_pk_bf16_f32 v191, v210, v211
    buffer_store_dwordx4 v[188:191], v29, s[44:47], s24 offen offset:3072 sc1
    v_cvt_pk_bf16_f32 v192, v96, v97
    v_cvt_pk_bf16_f32 v193, v98, v99
    v_cvt_pk_bf16_f32 v194, v212, v213
    v_cvt_pk_bf16_f32 v195, v214, v215
    s_add_u32 s24, s24, 4096
    buffer_store_dwordx4 v[192:195], v29, s[44:47], s24 offen offset:0 sc1
    s_waitcnt vmcnt(0)
    s_mov_b64 exec, 1
    v_mov_b32 v20, 1
    buffer_store_dword v20, off, s[60:63], s75 sc1
    s_mov_b64 exec, -1
    s_branch f1_join
f1_own:
    ds_write_b128 v29, v[32:35] offset:0
    ds_write_b128 v29, v[36:39] offset:1024
    ds_write_b128 v29, v[40:43] offset:2048
    ds_write_b128 v29, v[44:47] offset:3072
    ds_write_b128 v29, v[48:51] offset:4096
    ds_write_b128 v29, v[52:55] offset:5120
    ds_write_b128 v29, v[56:59] offset:6144
    ds_write_b128 v29, v[60:63] offset:7168
    ds_write_b128 v29, v[96:99] offset:8192
    ds_write_b128 v29, v[100:103] offset:9216
    ds_write_b128 v29, v[104:107] offset:10240
    ds_write_b128 v29, v[108:111] offset:11264
    ds_write_b128 v29, v[112:115] offset:12288
    ds_write_b128 v29, v[116:119] offset:13312
    ds_write_b128 v29, v[200:203] offset:14336
    ds_write_b128 v29, v[204:207] offset:15360
    ds_write_b128 v29, v[208:211] offset:16384
    ds_write_b128 v29, v[212:215] offset:17408
    s_waitcnt lgkmcnt(0)
f1_join:
    s_lshl_b32 s23, s66, 2
    s_add_u32 s74, s74, s23
    v_and_b32 v27, 3, v1
    v_min_u32 v27, 2, v27
    s_add_u32 s23, s66, 1
    v_add_u32 v27, s23, v27
    v_and_b32 v27, 3, v27
    v_lshlrev_b32 v27, 7, v27
    s_add_u32 s75, s74, 256
    s_lshl_b32 s75, s75, 7
    s_lshl_b32 s77, s22, 10
    v_add_u32 v26, s77, v29
    v_and_b32 v16, 15, v1
    v_mul_u32_u24 v16, 1152, v16
    v_lshrrev_b32 v17, 4, v1
    v_lshl_add_u32 v25, v17, 3, v16
    v_add_u32 v24, 18432, v25
    s_lshl_b32 s76, s27, 7
    s_lshl_b32 s23, s66, 5
    s_add_u32 s76, s76, s23
    s_mul_i32 s76, s76, 1152
    s_mul_i32 s23, s31, 288
    s_add_u32 s76, s76, s23
    s_lshl_b32 s23, s22, 5
    s_add_u32 s76, s76, s23
    s_mov_b32 s81, 0xffff0000
    s_add_u32 s23, s66, 1
    s_and_b32 s23, s23, 3
    s_add_u32 s23, s23, s74
    s_mul_i32 s78, s23, 9216
    s_add_u32 s78, s78, s77
    s_add_u32 s23, s66, 2
    s_and_b32 s23, s23, 3
    s_add_u32 s23, s23, s74
    s_mul_i32 s79, s23, 9216
    s_add_u32 s79, s79, s77
    s_add_u32 s23, s66, 3
    s_and_b32 s23, s23, 3
    s_add_u32 s23, s23, s74
    s_mul_i32 s80, s23, 9216
    s_add_u32 s80, s80, s77
    s_cmp_eq_u32 s22, 0
    s_cselect_b32 s25, 256, 0x40000000
    s_add_u32 s25, s25, s76
    s_barrier
    ds_read_b128 v[64:67], v26 offset:0
    ds_read_b128 v[68:71], v26 offset:9216
    ds_read_b128 v[88:91], v26 offset:4096
    ds_read_b128 v[92:95], v26 offset:13312
    ds_read_b128 v[112:115], v26 offset:8192
    ds_read_b128 v[116:119], v26 offset:17408
    s_mov_b32 s26, 0x10000
f1_pr:
    buffer_load_dword v28, v27, s[60:63], s75 offen sc1
    s_waitcnt vmcnt(0)
    v_cmp_lt_u32 vcc, 0, v28
    s_nop 0
    s_cmp_eq_u64 vcc, -1
    s_cbranch_scc1 f1_pr_r
    s_sub_u32 s26, s26, 1
    s_cmp_lg_u32 s26, 0
    s_cbranch_scc1 f1_pr
f1_pr_r:
    buffer_load_dwordx4 v[72:75], v29, s[44:47], s78 offen sc1
    buffer_load_dwordx4 v[76:79], v29, s[44:47], s79 offen sc1
    buffer_load_dwordx4 v[80:83], v29, s[44:47], s80 offen sc1
    s_add_u32 s78, s78, 4096
    buffer_load_dwordx4 v[96:99], v29, s[44:47], s78 offen sc1
    s_add_u32 s79, s79, 4096
    buffer_load_dwordx4 v[100:103], v29, s[44:47], s79 offen sc1
    s_add_u32 s80, s80, 4096
    buffer_load_dwordx4 v[104:107], v29, s[44:47], s80 offen sc1
    s_add_u32 s78, s78, 4096
    buffer_load_dwordx4 v[120:123], v29, s[44:47], s78 offen sc1
    s_add_u32 s79, s79, 4096
    buffer_load_dwordx4 v[124:127], v29, s[44:47], s79 offen sc1
    s_add_u32 s80, s80, 4096
    buffer_load_dwordx4 v[128:131], v29, s[44:47], s80 offen sc1
    s_waitcnt vmcnt(6) lgkmcnt(4)
    v_lshlrev_b32 v84, 16, v72
    v_and_b32 v85, s81, v72
    v_pk_add_f32 v[64:65], v[64:65], v[84:85]
    v_lshlrev_b32 v84, 16, v73
    v_and_b32 v85, s81, v73
    v_pk_add_f32 v[66:67], v[66:67], v[84:85]
    v_lshlrev_b32 v84, 16, v74
    v_and_b32 v85, s81, v74
    v_pk_add_f32 v[68:69], v[68:69], v[84:85]
    v_lshlrev_b32 v84, 16, v75
    v_and_b32 v85, s81, v75
    v_pk_add_f32 v[70:71], v[70:71], v[84:85]
    v_lshlrev_b32 v84, 16, v76
    v_and_b32 v85, s81, v76
    v_pk_add_f32 v[64:65], v[64:65], v[84:85]
    v_lshlrev_b32 v84, 16, v77
    v_and_b32 v85, s81, v77
    v_pk_add_f32 v[66:67], v[66:67], v[84:85]
    v_lshlrev_b32 v84, 16, v78
    v_and_b32 v85, s81, v78
    v_pk_add_f32 v[68:69], v[68:69], v[84:85]
    v_lshlrev_b32 v84, 16, v79
    v_and_b32 v85, s81, v79
    v_pk_add_f32 v[70:71], v[70:71], v[84:85]
    v_lshlrev_b32 v84, 16, v80
    v_and_b32 v85, s81, v80
    v_pk_add_f32 v[64:65], v[64:65], v[84:85]
    v_lshlrev_b32 v84, 16, v81
    v_and_b32 v85, s81, v81
    v_pk_add_f32 v[66:67], v[66:67], v[84:85]
    v_lshlrev_b32 v84, 16, v82
    v_and_b32 v85, s81, v82
    v_pk_add_f32 v[68:69], v[68:69], v[84:85]
    v_lshlrev_b32 v84, 16, v83
    v_and_b32 v85, s81, v83
    v_pk_add_f32 v[70:71], v[70:71], v[84:85]
    v_cvt_pk_bf16_f32 v64, v64, v65
    v_cvt_pk_bf16_f32 v65, v66, v67
    buffer_store_dwordx2 v[64:65], v25, s[36:39], s76 offen offset:0
    v_cvt_pk_bf16_f32 v68, v68, v69
    v_cvt_pk_bf16_f32 v69, v70, v71
    buffer_store_dwordx2 v[68:69], v24, s[36:39], s76 offen offset:0
    s_waitcnt vmcnt(5) lgkmcnt(2)
    v_lshlrev_b32 v108, 16, v96
    v_and_b32 v109, s81, v96
    v_pk_add_f32 v[88:89], v[88:89], v[108:109]
    v_lshlrev_b32 v108, 16, v97
    v_and_b32 v109, s81, v97
    v_pk_add_f32 v[90:91], v[90:91], v[108:109]
    v_lshlrev_b32 v108, 16, v98
    v_and_b32 v109, s81, v98
    v_pk_add_f32 v[92:93], v[92:93], v[108:109]
    v_lshlrev_b32 v108, 16, v99
    v_and_b32 v109, s81, v99
    v_pk_add_f32 v[94:95], v[94:95], v[108:109]
    v_lshlrev_b32 v108, 16, v100
    v_and_b32 v109, s81, v100
    v_pk_add_f32 v[88:89], v[88:89], v[108:109]
    v_lshlrev_b32 v108, 16, v101
    v_and_b32 v109, s81, v101
    v_pk_add_f32 v[90:91], v[90:91], v[108:109]
    v_lshlrev_b32 v108, 16, v102
    v_and_b32 v109, s81, v102
    v_pk_add_f32 v[92:93], v[92:93], v[108:109]
    v_lshlrev_b32 v108, 16, v103
    v_and_b32 v109, s81, v103
    v_pk_add_f32 v[94:95], v[94:95], v[108:109]
    v_lshlrev_b32 v108, 16, v104
    v_and_b32 v109, s81, v104
    v_pk_add_f32 v[88:89], v[88:89], v[108:109]
    v_lshlrev_b32 v108, 16, v105
    v_and_b32 v109, s81, v105
    v_pk_add_f32 v[90:91], v[90:91], v[108:109]
    v_lshlrev_b32 v108, 16, v106
    v_and_b32 v109, s81, v106
    v_pk_add_f32 v[92:93], v[92:93], v[108:109]
    v_lshlrev_b32 v108, 16, v107
    v_and_b32 v109, s81, v107
    v_pk_add_f32 v[94:95], v[94:95], v[108:109]
    v_cvt_pk_bf16_f32 v88, v88, v89
    v_cvt_pk_bf16_f32 v89, v90, v91
    buffer_store_dwordx2 v[88:89], v25, s[36:39], s76 offen offset:128
    v_cvt_pk_bf16_f32 v92, v92, v93
    v_cvt_pk_bf16_f32 v93, v94, v95
    buffer_store_dwordx2 v[92:93], v24, s[36:39], s76 offen offset:128
    s_waitcnt vmcnt(4) lgkmcnt(0)
    v_lshlrev_b32 v132, 16, v120
    v_and_b32 v133, s81, v120
    v_pk_add_f32 v[112:113], v[112:113], v[132:133]
    v_lshlrev_b32 v132, 16, v121
    v_and_b32 v133, s81, v121
    v_pk_add_f32 v[114:115], v[114:115], v[132:133]
    v_lshlrev_b32 v132, 16, v122
    v_and_b32 v133, s81, v122
    v_pk_add_f32 v[116:117], v[116:117], v[132:133]
    v_lshlrev_b32 v132, 16, v123
    v_and_b32 v133, s81, v123
    v_pk_add_f32 v[118:119], v[118:119], v[132:133]
    v_lshlrev_b32 v132, 16, v124
    v_and_b32 v133, s81, v124
    v_pk_add_f32 v[112:113], v[112:113], v[132:133]
    v_lshlrev_b32 v132, 16, v125
    v_and_b32 v133, s81, v125
    v_pk_add_f32 v[114:115], v[114:115], v[132:133]
    v_lshlrev_b32 v132, 16, v126
    v_and_b32 v133, s81, v126
    v_pk_add_f32 v[116:117], v[116:117], v[132:133]
    v_lshlrev_b32 v132, 16, v127
    v_and_b32 v133, s81, v127
    v_pk_add_f32 v[118:119], v[118:119], v[132:133]
    v_lshlrev_b32 v132, 16, v128
    v_and_b32 v133, s81, v128
    v_pk_add_f32 v[112:113], v[112:113], v[132:133]
    v_lshlrev_b32 v132, 16, v129
    v_and_b32 v133, s81, v129
    v_pk_add_f32 v[114:115], v[114:115], v[132:133]
    v_lshlrev_b32 v132, 16, v130
    v_and_b32 v133, s81, v130
    v_pk_add_f32 v[116:117], v[116:117], v[132:133]
    v_lshlrev_b32 v132, 16, v131
    v_and_b32 v133, s81, v131
    v_pk_add_f32 v[118:119], v[118:119], v[132:133]
    v_cvt_pk_bf16_f32 v112, v112, v113
    v_cvt_pk_bf16_f32 v113, v114, v115
    buffer_store_dwordx2 v[112:113], v25, s[36:39], s25 offen offset:0
    v_cvt_pk_bf16_f32 v116, v116, v117
    v_cvt_pk_bf16_f32 v117, v118, v119
    buffer_store_dwordx2 v[116:117], v24, s[36:39], s25 offen offset:0
f1_end:
    s_endpgm
f1_sgw2_wb:
    buffer_wbl2 sc1
    s_waitcnt vmcnt(0)
    s_branch f1_sgw2_wb_r
f1_pwb:
    s_mov_b32 s26, 0x10000
f1_pwb_l:
    buffer_load_dword v55, off, s[56:59], s83 sc1
    s_waitcnt vmcnt(0)
    v_readfirstlane_b32 s25, v55
    s_nop 0
    s_lshr_b32 s25, s25, s15
    s_bfe_u32 s25, s25, 262152
    s_cmp_ge_u32 s25, 8
    s_cbranch_scc1 f1_pwb_r
    s_sub_u32 s26, s26, 1
    s_cmp_lg_u32 s26, 0
    s_cbranch_scc1 f1_pwb_l
    s_branch f1_pwb_r
f1_sg0_wb:
    buffer_wbl2 sc1
    s_waitcnt vmcnt(0)
    s_branch f1_sg0_wb_r
f1_pk:
    s_mov_b32 s26, 0x10000
f1_pk_l:
    buffer_load_dword v22, off, s[56:59], s17 sc1
    s_waitcnt vmcnt(0)
    v_readfirstlane_b32 s25, v22
    s_nop 0
    s_cmp_ge_u32 s25, 32
    s_cbranch_scc1 f1_pk_r
    s_sub_u32 s26, s26, 1
    s_cmp_lg_u32 s26, 0
    s_cbranch_scc1 f1_pk_l
    s_branch f1_pk_r
f1_p_mask:
    s_nop 7
    v_cmp_lt_i32 s[40:41], v3, 0
    v_cmp_lt_i32 s[42:43], v3, 1
    v_cmp_lt_i32 s[60:61], v3, 2
    v_cmp_lt_i32 s[62:63], v3, 3
    v_cndmask_b32 v32, v32, v5, s[40:41]
    v_cndmask_b32 v33, v33, v5, s[42:43]
    v_cndmask_b32 v34, v34, v5, s[60:61]
    v_cndmask_b32 v35, v35, v5, s[62:63]
    v_cmp_lt_i32 s[40:41], v3, 16
    v_cmp_lt_i32 s[42:43], v3, 17
    v_cmp_lt_i32 s[60:61], v3, 18
    v_cmp_lt_i32 s[62:63], v3, 19
    v_cndmask_b32 v36, v36, v5, s[40:41]
    v_cndmask_b32 v37, v37, v5, s[42:43]
    v_cndmask_b32 v38, v38, v5, s[60:61]
    v_cndmask_b32 v39, v39, v5, s[62:63]
    v_cmp_lt_i32 s[40:41], v3, 32
    v_cmp_lt_i32 s[42:43], v3, 33
    v_cmp_lt_i32 s[60:61], v3, 34
    v_cmp_lt_i32 s[62:63], v3, 35
    v_cndmask_b32 v40, v40, v5, s[40:41]
    v_cndmask_b32 v41, v41, v5, s[42:43]
    v_cndmask_b32 v42, v42, v5, s[60:61]
    v_cndmask_b32 v43, v43, v5, s[62:63]
    v_cmp_lt_i32 s[40:41], v3, 48
    v_cmp_lt_i32 s[42:43], v3, 49
    v_cmp_lt_i32 s[60:61], v3, 50
    v_cmp_lt_i32 s[62:63], v3, 51
    v_cndmask_b32 v44, v44, v5, s[40:41]
    v_cndmask_b32 v45, v45, v5, s[42:43]
    v_cndmask_b32 v46, v46, v5, s[60:61]
    v_cndmask_b32 v47, v47, v5, s[62:63]
    s_branch f1_p_mask_r
f1_sg1_wb:
    buffer_wbl2 sc1
    s_waitcnt vmcnt(0)
    s_branch f1_sg1_wb_r
f1_dd0_rare:
    s_nop 7
    v_max3_f32 v20, v32, v33, v34
    v_max3_f32 v20, v20, v35, v36
    v_max3_f32 v20, v20, v37, v38
    v_max3_f32 v20, v20, v39, v40
    v_max3_f32 v20, v20, v41, v42
    v_max3_f32 v20, v20, v43, v44
    v_max3_f32 v20, v20, v45, v46
    v_max_f32 v20, v20, v47
    v_mov_b32 v21, v20
    s_nop 1
    v_permlane32_swap_b32 v20, v21
    v_max_f32 v20, v20, v21
    v_mov_b32 v21, v20
    s_nop 1
    v_permlane16_swap_b32 v20, v21
    v_max_f32 v20, v20, v21
    v_max_f32 v20, 0, v20
    v_exp_f32 v22, -v20
    s_nop 0
    v_mul_f32 v13, v13, v22
    v_accvgpr_read_b32 v24, a0
    v_mul_f32 v24, v24, v22
    v_accvgpr_write_b32 a0, v24
    v_accvgpr_read_b32 v25, a1
    v_mul_f32 v25, v25, v22
    v_accvgpr_write_b32 a1, v25
    v_accvgpr_read_b32 v26, a2
    v_mul_f32 v26, v26, v22
    v_accvgpr_write_b32 a2, v26
    v_accvgpr_read_b32 v27, a3
    v_mul_f32 v27, v27, v22
    v_accvgpr_write_b32 a3, v27
    v_accvgpr_read_b32 v24, a4
    v_mul_f32 v24, v24, v22
    v_accvgpr_write_b32 a4, v24
    v_accvgpr_read_b32 v25, a5
    v_mul_f32 v25, v25, v22
    v_accvgpr_write_b32 a5, v25
    v_accvgpr_read_b32 v26, a6
    v_mul_f32 v26, v26, v22
    v_accvgpr_write_b32 a6, v26
    v_accvgpr_read_b32 v27, a7
    v_mul_f32 v27, v27, v22
    v_accvgpr_write_b32 a7, v27
    v_accvgpr_read_b32 v24, a8
    v_mul_f32 v24, v24, v22
    v_accvgpr_write_b32 a8, v24
    v_accvgpr_read_b32 v25, a9
    v_mul_f32 v25, v25, v22
    v_accvgpr_write_b32 a9, v25
    v_accvgpr_read_b32 v26, a10
    v_mul_f32 v26, v26, v22
    v_accvgpr_write_b32 a10, v26
    v_accvgpr_read_b32 v27, a11
    v_mul_f32 v27, v27, v22
    v_accvgpr_write_b32 a11, v27
    v_accvgpr_read_b32 v24, a12
    v_mul_f32 v24, v24, v22
    v_accvgpr_write_b32 a12, v24
    v_accvgpr_read_b32 v25, a13
    v_mul_f32 v25, v25, v22
    v_accvgpr_write_b32 a13, v25
    v_accvgpr_read_b32 v26, a14
    v_mul_f32 v26, v26, v22
    v_accvgpr_write_b32 a14, v26
    v_accvgpr_read_b32 v27, a15
    v_mul_f32 v27, v27, v22
    v_accvgpr_write_b32 a15, v27
    v_accvgpr_read_b32 v24, a16
    v_mul_f32 v24, v24, v22
    v_accvgpr_write_b32 a16, v24
    v_accvgpr_read_b32 v25, a17
    v_mul_f32 v25, v25, v22
    v_accvgpr_write_b32 a17, v25
    v_accvgpr_read_b32 v26, a18
    v_mul_f32 v26, v26, v22
    v_accvgpr_write_b32 a18, v26
    v_accvgpr_read_b32 v27, a19
    v_mul_f32 v27, v27, v22
    v_accvgpr_write_b32 a19, v27
    v_accvgpr_read_b32 v24, a20
    v_mul_f32 v24, v24, v22
    v_accvgpr_write_b32 a20, v24
    v_accvgpr_read_b32 v25, a21
    v_mul_f32 v25, v25, v22
    v_accvgpr_write_b32 a21, v25
    v_accvgpr_read_b32 v26, a22
    v_mul_f32 v26, v26, v22
    v_accvgpr_write_b32 a22, v26
    v_accvgpr_read_b32 v27, a23
    v_mul_f32 v27, v27, v22
    v_accvgpr_write_b32 a23, v27
    v_accvgpr_read_b32 v24, a24
    v_mul_f32 v24, v24, v22
    v_accvgpr_write_b32 a24, v24
    v_accvgpr_read_b32 v25, a25
    v_mul_f32 v25, v25, v22
    v_accvgpr_write_b32 a25, v25
    v_accvgpr_read_b32 v26, a26
    v_mul_f32 v26, v26, v22
    v_accvgpr_write_b32 a26, v26
    v_accvgpr_read_b32 v27, a27
    v_mul_f32 v27, v27, v22
    v_accvgpr_write_b32 a27, v27
    v_accvgpr_read_b32 v24, a28
    v_mul_f32 v24, v24, v22
    v_accvgpr_write_b32 a28, v24
    v_accvgpr_read_b32 v25, a29
    v_mul_f32 v25, v25, v22
    v_accvgpr_write_b32 a29, v25
    v_accvgpr_read_b32 v26, a30
    v_mul_f32 v26, v26, v22
    v_accvgpr_write_b32 a30, v26
    v_accvgpr_read_b32 v27, a31
    v_mul_f32 v27, v27, v22
    v_accvgpr_write_b32 a31, v27
    v_sub_f32 v224, v224, v20
    v_sub_f32 v225, v225, v20
    v_sub_f32 v226, v226, v20
    v_sub_f32 v227, v227, v20
    v_sub_f32 v32, v32, v20
    v_sub_f32 v33, v33, v20
    v_sub_f32 v34, v34, v20
    v_sub_f32 v35, v35, v20
    v_sub_f32 v36, v36, v20
    v_sub_f32 v37, v37, v20
    v_sub_f32 v38, v38, v20
    v_sub_f32 v39, v39, v20
    v_sub_f32 v40, v40, v20
    v_sub_f32 v41, v41, v20
    v_sub_f32 v42, v42, v20
    v_sub_f32 v43, v43, v20
    v_sub_f32 v44, v44, v20
    v_sub_f32 v45, v45, v20
    v_sub_f32 v46, v46, v20
    v_sub_f32 v47, v47, v20
    v_sub_f32 v96, v96, v20
    v_sub_f32 v97, v97, v20
    v_sub_f32 v98, v98, v20
    v_sub_f32 v99, v99, v20
    v_sub_f32 v100, v100, v20
    v_sub_f32 v101, v101, v20
    v_sub_f32 v102, v102, v20
    v_sub_f32 v103, v103, v20
    v_sub_f32 v104, v104, v20
    v_sub_f32 v105, v105, v20
    v_sub_f32 v106, v106, v20
    v_sub_f32 v107, v107, v20
    v_sub_f32 v108, v108, v20
    v_sub_f32 v109, v109, v20
    v_sub_f32 v110, v110, v20
    v_sub_f32 v111, v111, v20
    v_exp_f32 v240, v32
    v_exp_f32 v241, v33
    v_exp_f32 v242, v34
    v_exp_f32 v243, v35
    v_exp_f32 v244, v36
    v_cvt_pk_bf16_f32 v160, v240, v241
    v_exp_f32 v245, v37
    v_exp_f32 v246, v38
    v_cvt_pk_bf16_f32 v161, v242, v243
    v_exp_f32 v247, v39
    v_cvt_pk_bf16_f32 v162, v244, v245
    v_cvt_pk_bf16_f32 v163, v246, v247
    s_nop 1
    v_mfma_f32_16x16x32_bf16 v[212:215], v[208:211], v[160:163], 0
    v_exp_f32 v240, v40
    v_exp_f32 v241, v41
    v_exp_f32 v242, v42
    v_exp_f32 v243, v43
    v_exp_f32 v244, v44
    v_cvt_pk_bf16_f32 v192, v240, v241
    v_exp_f32 v245, v45
    v_exp_f32 v246, v46
    v_cvt_pk_bf16_f32 v193, v242, v243
    v_exp_f32 v247, v47
    v_cvt_pk_bf16_f32 v194, v244, v245
    v_cvt_pk_bf16_f32 v195, v246, v247
    s_nop 1
    v_mfma_f32_16x16x32_bf16 v[212:215], v[208:211], v[192:195], v[212:215]
    v_max3_f32 v20, v48, v49, v50
    v_max3_f32 v20, v20, v51, v52
    v_max3_f32 v20, v20, v53, v54
    v_max3_f32 v20, v20, v55, v56
    v_max3_f32 v20, v20, v57, v58
    v_max3_f32 v20, v20, v59, v60
    v_max3_f32 v20, v20, v61, v62
    v_max_f32 v20, v20, v63
    v_mov_b32 v21, v20
    s_nop 1
    v_permlane32_swap_b32 v20, v21
    v_max_f32 v20, v20, v21
    v_mov_b32 v21, v20
    s_nop 1
    v_permlane16_swap_b32 v20, v21
    v_max_f32 v20, v20, v21
    v_max_f32 v20, 0, v20
    v_exp_f32 v22, -v20
    s_nop 0
    v_mul_f32 v14, v14, v22
    v_accvgpr_read_b32 v24, a32
    v_mul_f32 v24, v24, v22
    v_accvgpr_write_b32 a32, v24
    v_accvgpr_read_b32 v25, a33
    v_mul_f32 v25, v25, v22
    v_accvgpr_write_b32 a33, v25
    v_accvgpr_read_b32 v26, a34
    v_mul_f32 v26, v26, v22
    v_accvgpr_write_b32 a34, v26
    v_accvgpr_read_b32 v27, a35
    v_mul_f32 v27, v27, v22
    v_accvgpr_write_b32 a35, v27
    v_accvgpr_read_b32 v24, a36
    v_mul_f32 v24, v24, v22
    v_accvgpr_write_b32 a36, v24
    v_accvgpr_read_b32 v25, a37
    v_mul_f32 v25, v25, v22
    v_accvgpr_write_b32 a37, v25
    v_accvgpr_read_b32 v26, a38
    v_mul_f32 v26, v26, v22
    v_accvgpr_write_b32 a38, v26
    v_accvgpr_read_b32 v27, a39
    v_mul_f32 v27, v27, v22
    v_accvgpr_write_b32 a39, v27
    v_accvgpr_read_b32 v24, a40
    v_mul_f32 v24, v24, v22
    v_accvgpr_write_b32 a40, v24
    v_accvgpr_read_b32 v25, a41
    v_mul_f32 v25, v25, v22
    v_accvgpr_write_b32 a41, v25
    v_accvgpr_read_b32 v26, a42
    v_mul_f32 v26, v26, v22
    v_accvgpr_write_b32 a42, v26
    v_accvgpr_read_b32 v27, a43
    v_mul_f32 v27, v27, v22
    v_accvgpr_write_b32 a43, v27
    v_accvgpr_read_b32 v24, a44
    v_mul_f32 v24, v24, v22
    v_accvgpr_write_b32 a44, v24
    v_accvgpr_read_b32 v25, a45
    v_mul_f32 v25, v25, v22
    v_accvgpr_write_b32 a45, v25
    v_accvgpr_read_b32 v26, a46
    v_mul_f32 v26, v26, v22
    v_accvgpr_write_b32 a46, v26
    v_accvgpr_read_b32 v27, a47
    v_mul_f32 v27, v27, v22
    v_accvgpr_write_b32 a47, v27
    v_accvgpr_read_b32 v24, a48
    v_mul_f32 v24, v24, v22
    v_accvgpr_write_b32 a48, v24
    v_accvgpr_read_b32 v25, a49
    v_mul_f32 v25, v25, v22
    v_accvgpr_write_b32 a49, v25
    v_accvgpr_read_b32 v26, a50
    v_mul_f32 v26, v26, v22
    v_accvgpr_write_b32 a50, v26
    v_accvgpr_read_b32 v27, a51
    v_mul_f32 v27, v27, v22
    v_accvgpr_write_b32 a51, v27
    v_accvgpr_read_b32 v24, a52
    v_mul_f32 v24, v24, v22
    v_accvgpr_write_b32 a52, v24
    v_accvgpr_read_b32 v25, a53
    v_mul_f32 v25, v25, v22
    v_accvgpr_write_b32 a53, v25
    v_accvgpr_read_b32 v26, a54
    v_mul_f32 v26, v26, v22
    v_accvgpr_write_b32 a54, v26
    v_accvgpr_read_b32 v27, a55
    v_mul_f32 v27, v27, v22
    v_accvgpr_write_b32 a55, v27
    v_accvgpr_read_b32 v24, a56
    v_mul_f32 v24, v24, v22
    v_accvgpr_write_b32 a56, v24
    v_accvgpr_read_b32 v25, a57
    v_mul_f32 v25, v25, v22
    v_accvgpr_write_b32 a57, v25
    v_accvgpr_read_b32 v26, a58
    v_mul_f32 v26, v26, v22
    v_accvgpr_write_b32 a58, v26
    v_accvgpr_read_b32 v27, a59
    v_mul_f32 v27, v27, v22
    v_accvgpr_write_b32 a59, v27
    v_accvgpr_read_b32 v24, a60
    v_mul_f32 v24, v24, v22
    v_accvgpr_write_b32 a60, v24
    v_accvgpr_read_b32 v25, a61
    v_mul_f32 v25, v25, v22
    v_accvgpr_write_b32 a61, v25
    v_accvgpr_read_b32 v26, a62
    v_mul_f32 v26, v26, v22
    v_accvgpr_write_b32 a62, v26
    v_accvgpr_read_b32 v27, a63
    v_mul_f32 v27, v27, v22
    v_accvgpr_write_b32 a63, v27
    v_sub_f32 v228, v228, v20
    v_sub_f32 v229, v229, v20
    v_sub_f32 v230, v230, v20
    v_sub_f32 v231, v231, v20
    v_sub_f32 v48, v48, v20
    v_sub_f32 v49, v49, v20
    v_sub_f32 v50, v50, v20
    v_sub_f32 v51, v51, v20
    v_sub_f32 v52, v52, v20
    v_sub_f32 v53, v53, v20
    v_sub_f32 v54, v54, v20
    v_sub_f32 v55, v55, v20
    v_sub_f32 v56, v56, v20
    v_sub_f32 v57, v57, v20
    v_sub_f32 v58, v58, v20
    v_sub_f32 v59, v59, v20
    v_sub_f32 v60, v60, v20
    v_sub_f32 v61, v61, v20
    v_sub_f32 v62, v62, v20
    v_sub_f32 v63, v63, v20
    v_sub_f32 v112, v112, v20
    v_sub_f32 v113, v113, v20
    v_sub_f32 v114, v114, v20
    v_sub_f32 v115, v115, v20
    v_sub_f32 v116, v116, v20
    v_sub_f32 v117, v117, v20
    v_sub_f32 v118, v118, v20
    v_sub_f32 v119, v119, v20
    v_sub_f32 v120, v120, v20
    v_sub_f32 v121, v121, v20
    v_sub_f32 v122, v122, v20
    v_sub_f32 v123, v123, v20
    v_sub_f32 v124, v124, v20
    v_sub_f32 v125, v125, v20
    v_sub_f32 v126, v126, v20
    v_sub_f32 v127, v127, v20
    v_exp_f32 v240, v48
    v_exp_f32 v241, v49
    v_exp_f32 v242, v50
    v_exp_f32 v243, v51
    v_exp_f32 v244, v52
    v_cvt_pk_bf16_f32 v164, v240, v241
    v_exp_f32 v245, v53
    v_exp_f32 v246, v54
    v_cvt_pk_bf16_f32 v165, v242, v243
    v_exp_f32 v247, v55
    v_cvt_pk_bf16_f32 v166, v244, v245
    v_cvt_pk_bf16_f32 v167, v246, v247
    s_nop 1
    v_mfma_f32_16x16x32_bf16 v[216:219], v[208:211], v[164:167], 0
    v_exp_f32 v240, v56
    v_exp_f32 v241, v57
    v_exp_f32 v242, v58
    v_exp_f32 v243, v59
    v_exp_f32 v244, v60
    v_cvt_pk_bf16_f32 v196, v240, v241
    v_exp_f32 v245, v61
    v_exp_f32 v246, v62
    v_cvt_pk_bf16_f32 v197, v242, v243
    v_exp_f32 v247, v63
    v_cvt_pk_bf16_f32 v198, v244, v245
    v_cvt_pk_bf16_f32 v199, v246, v247
    s_nop 1
    v_mfma_f32_16x16x32_bf16 v[216:219], v[208:211], v[196:199], v[216:219]
    v_max3_f32 v20, v64, v65, v66
    v_max3_f32 v20, v20, v67, v68
    v_max3_f32 v20, v20, v69, v70
    v_max3_f32 v20, v20, v71, v72
    v_max3_f32 v20, v20, v73, v74
    v_max3_f32 v20, v20, v75, v76
    v_max3_f32 v20, v20, v77, v78
    v_max_f32 v20, v20, v79
    v_mov_b32 v21, v20
    s_nop 1
    v_permlane32_swap_b32 v20, v21
    v_max_f32 v20, v20, v21
    v_mov_b32 v21, v20
    s_nop 1
    v_permlane16_swap_b32 v20, v21
    v_max_f32 v20, v20, v21
    v_max_f32 v20, 0, v20
    v_exp_f32 v22, -v20
    s_nop 0
    v_mul_f32 v15, v15, v22
    v_accvgpr_read_b32 v24, a64
    v_mul_f32 v24, v24, v22
    v_accvgpr_write_b32 a64, v24
    v_accvgpr_read_b32 v25, a65
    v_mul_f32 v25, v25, v22
    v_accvgpr_write_b32 a65, v25
    v_accvgpr_read_b32 v26, a66
    v_mul_f32 v26, v26, v22
    v_accvgpr_write_b32 a66, v26
    v_accvgpr_read_b32 v27, a67
    v_mul_f32 v27, v27, v22
    v_accvgpr_write_b32 a67, v27
    v_accvgpr_read_b32 v24, a68
    v_mul_f32 v24, v24, v22
    v_accvgpr_write_b32 a68, v24
    v_accvgpr_read_b32 v25, a69
    v_mul_f32 v25, v25, v22
    v_accvgpr_write_b32 a69, v25
    v_accvgpr_read_b32 v26, a70
    v_mul_f32 v26, v26, v22
    v_accvgpr_write_b32 a70, v26
    v_accvgpr_read_b32 v27, a71
    v_mul_f32 v27, v27, v22
    v_accvgpr_write_b32 a71, v27
    v_accvgpr_read_b32 v24, a72
    v_mul_f32 v24, v24, v22
    v_accvgpr_write_b32 a72, v24
    v_accvgpr_read_b32 v25, a73
    v_mul_f32 v25, v25, v22
    v_accvgpr_write_b32 a73, v25
    v_accvgpr_read_b32 v26, a74
    v_mul_f32 v26, v26, v22
    v_accvgpr_write_b32 a74, v26
    v_accvgpr_read_b32 v27, a75
    v_mul_f32 v27, v27, v22
    v_accvgpr_write_b32 a75, v27
    v_accvgpr_read_b32 v24, a76
    v_mul_f32 v24, v24, v22
    v_accvgpr_write_b32 a76, v24
    v_accvgpr_read_b32 v25, a77
    v_mul_f32 v25, v25, v22
    v_accvgpr_write_b32 a77, v25
    v_accvgpr_read_b32 v26, a78
    v_mul_f32 v26, v26, v22
    v_accvgpr_write_b32 a78, v26
    v_accvgpr_read_b32 v27, a79
    v_mul_f32 v27, v27, v22
    v_accvgpr_write_b32 a79, v27
    v_accvgpr_read_b32 v24, a80
    v_mul_f32 v24, v24, v22
    v_accvgpr_write_b32 a80, v24
    v_accvgpr_read_b32 v25, a81
    v_mul_f32 v25, v25, v22
    v_accvgpr_write_b32 a81, v25
    v_accvgpr_read_b32 v26, a82
    v_mul_f32 v26, v26, v22
    v_accvgpr_write_b32 a82, v26
    v_accvgpr_read_b32 v27, a83
    v_mul_f32 v27, v27, v22
    v_accvgpr_write_b32 a83, v27
    v_accvgpr_read_b32 v24, a84
    v_mul_f32 v24, v24, v22
    v_accvgpr_write_b32 a84, v24
    v_accvgpr_read_b32 v25, a85
    v_mul_f32 v25, v25, v22
    v_accvgpr_write_b32 a85, v25
    v_accvgpr_read_b32 v26, a86
    v_mul_f32 v26, v26, v22
    v_accvgpr_write_b32 a86, v26
    v_accvgpr_read_b32 v27, a87
    v_mul_f32 v27, v27, v22
    v_accvgpr_write_b32 a87, v27
    v_accvgpr_read_b32 v24, a88
    v_mul_f32 v24, v24, v22
    v_accvgpr_write_b32 a88, v24
    v_accvgpr_read_b32 v25, a89
    v_mul_f32 v25, v25, v22
    v_accvgpr_write_b32 a89, v25
    v_accvgpr_read_b32 v26, a90
    v_mul_f32 v26, v26, v22
    v_accvgpr_write_b32 a90, v26
    v_accvgpr_read_b32 v27, a91
    v_mul_f32 v27, v27, v22
    v_accvgpr_write_b32 a91, v27
    v_accvgpr_read_b32 v24, a92
    v_mul_f32 v24, v24, v22
    v_accvgpr_write_b32 a92, v24
    v_accvgpr_read_b32 v25, a93
    v_mul_f32 v25, v25, v22
    v_accvgpr_write_b32 a93, v25
    v_accvgpr_read_b32 v26, a94
    v_mul_f32 v26, v26, v22
    v_accvgpr_write_b32 a94, v26
    v_accvgpr_read_b32 v27, a95
    v_mul_f32 v27, v27, v22
    v_accvgpr_write_b32 a95, v27
    v_sub_f32 v232, v232, v20
    v_sub_f32 v233, v233, v20
    v_sub_f32 v234, v234, v20
    v_sub_f32 v235, v235, v20
    v_sub_f32 v64, v64, v20
    v_sub_f32 v65, v65, v20
    v_sub_f32 v66, v66, v20
    v_sub_f32 v67, v67, v20
    v_sub_f32 v68, v68, v20
    v_sub_f32 v69, v69, v20
    v_sub_f32 v70, v70, v20
    v_sub_f32 v71, v71, v20
    v_sub_f32 v72, v72, v20
    v_sub_f32 v73, v73, v20
    v_sub_f32 v74, v74, v20
    v_sub_f32 v75, v75, v20
    v_sub_f32 v76, v76, v20
    v_sub_f32 v77, v77, v20
    v_sub_f32 v78, v78, v20
    v_sub_f32 v79, v79, v20
    v_sub_f32 v128, v128, v20
    v_sub_f32 v129, v129, v20
    v_sub_f32 v130, v130, v20
    v_sub_f32 v131, v131, v20
    v_sub_f32 v132, v132, v20
    v_sub_f32 v133, v133, v20
    v_sub_f32 v134, v134, v20
    v_sub_f32 v135, v135, v20
    v_sub_f32 v136, v136, v20
    v_sub_f32 v137, v137, v20
    v_sub_f32 v138, v138, v20
    v_sub_f32 v139, v139, v20
    v_sub_f32 v140, v140, v20
    v_sub_f32 v141, v141, v20
    v_sub_f32 v142, v142, v20
    v_sub_f32 v143, v143, v20
    v_exp_f32 v240, v64
    v_exp_f32 v241, v65
    v_exp_f32 v242, v66
    v_exp_f32 v243, v67
    v_exp_f32 v244, v68
    v_cvt_pk_bf16_f32 v168, v240, v241
    v_exp_f32 v245, v69
    v_exp_f32 v246, v70
    v_cvt_pk_bf16_f32 v169, v242, v243
    v_exp_f32 v247, v71
    v_cvt_pk_bf16_f32 v170, v244, v245
    v_cvt_pk_bf16_f32 v171, v246, v247
    s_nop 1
    v_mfma_f32_16x16x32_bf16 v[248:251], v[208:211], v[168:171], 0
    v_exp_f32 v240, v72
    v_exp_f32 v241, v73
    v_exp_f32 v242, v74
    v_exp_f32 v243, v75
    v_exp_f32 v244, v76
    v_cvt_pk_bf16_f32 v200, v240, v241
    v_exp_f32 v245, v77
    v_exp_f32 v246, v78
    v_cvt_pk_bf16_f32 v201, v242, v243
    v_exp_f32 v247, v79
    v_cvt_pk_bf16_f32 v202, v244, v245
    v_cvt_pk_bf16_f32 v203, v246, v247
    s_nop 1
    v_mfma_f32_16x16x32_bf16 v[248:251], v[208:211], v[200:203], v[248:251]
    v_max3_f32 v20, v80, v81, v82
    v_max3_f32 v20, v20, v83, v84
    v_max3_f32 v20, v20, v85, v86
    v_max3_f32 v20, v20, v87, v88
    v_max3_f32 v20, v20, v89, v90
    v_max3_f32 v20, v20, v91, v92
    v_max3_f32 v20, v20, v93, v94
    v_max_f32 v20, v20, v95
    v_mov_b32 v21, v20
    s_nop 1
    v_permlane32_swap_b32 v20, v21
    v_max_f32 v20, v20, v21
    v_mov_b32 v21, v20
    s_nop 1
    v_permlane16_swap_b32 v20, v21
    v_max_f32 v20, v20, v21
    v_max_f32 v20, 0, v20
    v_exp_f32 v22, -v20
    s_nop 0
    v_mul_f32 v30, v30, v22
    v_accvgpr_read_b32 v24, a96
    v_mul_f32 v24, v24, v22
    v_accvgpr_write_b32 a96, v24
    v_accvgpr_read_b32 v25, a97
    v_mul_f32 v25, v25, v22
    v_accvgpr_write_b32 a97, v25
    v_accvgpr_read_b32 v26, a98
    v_mul_f32 v26, v26, v22
    v_accvgpr_write_b32 a98, v26
    v_accvgpr_read_b32 v27, a99
    v_mul_f32 v27, v27, v22
    v_accvgpr_write_b32 a99, v27
    v_accvgpr_read_b32 v24, a100
    v_mul_f32 v24, v24, v22
    v_accvgpr_write_b32 a100, v24
    v_accvgpr_read_b32 v25, a101
    v_mul_f32 v25, v25, v22
    v_accvgpr_write_b32 a101, v25
    v_accvgpr_read_b32 v26, a102
    v_mul_f32 v26, v26, v22
    v_accvgpr_write_b32 a102, v26
    v_accvgpr_read_b32 v27, a103
    v_mul_f32 v27, v27, v22
    v_accvgpr_write_b32 a103, v27
    v_accvgpr_read_b32 v24, a104
    v_mul_f32 v24, v24, v22
    v_accvgpr_write_b32 a104, v24
    v_accvgpr_read_b32 v25, a105
    v_mul_f32 v25, v25, v22
    v_accvgpr_write_b32 a105, v25
    v_accvgpr_read_b32 v26, a106
    v_mul_f32 v26, v26, v22
    v_accvgpr_write_b32 a106, v26
    v_accvgpr_read_b32 v27, a107
    v_mul_f32 v27, v27, v22
    v_accvgpr_write_b32 a107, v27
    v_accvgpr_read_b32 v24, a108
    v_mul_f32 v24, v24, v22
    v_accvgpr_write_b32 a108, v24
    v_accvgpr_read_b32 v25, a109
    v_mul_f32 v25, v25, v22
    v_accvgpr_write_b32 a109, v25
    v_accvgpr_read_b32 v26, a110
    v_mul_f32 v26, v26, v22
    v_accvgpr_write_b32 a110, v26
    v_accvgpr_read_b32 v27, a111
    v_mul_f32 v27, v27, v22
    v_accvgpr_write_b32 a111, v27
    v_accvgpr_read_b32 v24, a112
    v_mul_f32 v24, v24, v22
    v_accvgpr_write_b32 a112, v24
    v_accvgpr_read_b32 v25, a113
    v_mul_f32 v25, v25, v22
    v_accvgpr_write_b32 a113, v25
    v_accvgpr_read_b32 v26, a114
    v_mul_f32 v26, v26, v22
    v_accvgpr_write_b32 a114, v26
    v_accvgpr_read_b32 v27, a115
    v_mul_f32 v27, v27, v22
    v_accvgpr_write_b32 a115, v27
    v_accvgpr_read_b32 v24, a116
    v_mul_f32 v24, v24, v22
    v_accvgpr_write_b32 a116, v24
    v_accvgpr_read_b32 v25, a117
    v_mul_f32 v25, v25, v22
    v_accvgpr_write_b32 a117, v25
    v_accvgpr_read_b32 v26, a118
    v_mul_f32 v26, v26, v22
    v_accvgpr_write_b32 a118, v26
    v_accvgpr_read_b32 v27, a119
    v_mul_f32 v27, v27, v22
    v_accvgpr_write_b32 a119, v27
    v_accvgpr_read_b32 v24, a120
    v_mul_f32 v24, v24, v22
    v_accvgpr_write_b32 a120, v24
    v_accvgpr_read_b32 v25, a121
    v_mul_f32 v25, v25, v22
    v_accvgpr_write_b32 a121, v25
    v_accvgpr_read_b32 v26, a122
    v_mul_f32 v26, v26, v22
    v_accvgpr_write_b32 a122, v26
    v_accvgpr_read_b32 v27, a123
    v_mul_f32 v27, v27, v22
    v_accvgpr_write_b32 a123, v27
    v_accvgpr_read_b32 v24, a124
    v_mul_f32 v24, v24, v22
    v_accvgpr_write_b32 a124, v24
    v_accvgpr_read_b32 v25, a125
    v_mul_f32 v25, v25, v22
    v_accvgpr_write_b32 a125, v25
    v_accvgpr_read_b32 v26, a126
    v_mul_f32 v26, v26, v22
    v_accvgpr_write_b32 a126, v26
    v_accvgpr_read_b32 v27, a127
    v_mul_f32 v27, v27, v22
    v_accvgpr_write_b32 a127, v27
    v_sub_f32 v236, v236, v20
    v_sub_f32 v237, v237, v20
    v_sub_f32 v238, v238, v20
    v_sub_f32 v239, v239, v20
    v_sub_f32 v80, v80, v20
    v_sub_f32 v81, v81, v20
    v_sub_f32 v82, v82, v20
    v_sub_f32 v83, v83, v20
    v_sub_f32 v84, v84, v20
    v_sub_f32 v85, v85, v20
    v_sub_f32 v86, v86, v20
    v_sub_f32 v87, v87, v20
    v_sub_f32 v88, v88, v20
    v_sub_f32 v89, v89, v20
    v_sub_f32 v90, v90, v20
    v_sub_f32 v91, v91, v20
    v_sub_f32 v92, v92, v20
    v_sub_f32 v93, v93, v20
    v_sub_f32 v94, v94, v20
    v_sub_f32 v95, v95, v20
    v_sub_f32 v144, v144, v20
    v_sub_f32 v145, v145, v20
    v_sub_f32 v146, v146, v20
    v_sub_f32 v147, v147, v20
    v_sub_f32 v148, v148, v20
    v_sub_f32 v149, v149, v20
    v_sub_f32 v150, v150, v20
    v_sub_f32 v151, v151, v20
    v_sub_f32 v152, v152, v20
    v_sub_f32 v153, v153, v20
    v_sub_f32 v154, v154, v20
    v_sub_f32 v155, v155, v20
    v_sub_f32 v156, v156, v20
    v_sub_f32 v157, v157, v20
    v_sub_f32 v158, v158, v20
    v_sub_f32 v159, v159, v20
    v_exp_f32 v240, v80
    v_exp_f32 v241, v81
    v_exp_f32 v242, v82
    v_exp_f32 v243, v83
    v_exp_f32 v244, v84
    v_cvt_pk_bf16_f32 v172, v240, v241
    v_exp_f32 v245, v85
    v_exp_f32 v246, v86
    v_cvt_pk_bf16_f32 v173, v242, v243
    v_exp_f32 v247, v87
    v_cvt_pk_bf16_f32 v174, v244, v245
    v_cvt_pk_bf16_f32 v175, v246, v247
    s_nop 1
    v_mfma_f32_16x16x32_bf16 v[252:255], v[208:211], v[172:175], 0
    v_exp_f32 v240, v88
    v_exp_f32 v241, v89
    v_exp_f32 v242, v90
    v_exp_f32 v243, v91
    v_exp_f32 v244, v92
    v_cvt_pk_bf16_f32 v204, v240, v241
    v_exp_f32 v245, v93
    v_exp_f32 v246, v94
    v_cvt_pk_bf16_f32 v205, v242, v243
    v_exp_f32 v247, v95
    v_cvt_pk_bf16_f32 v206, v244, v245
    v_cvt_pk_bf16_f32 v207, v246, v247
    s_nop 1
    v_mfma_f32_16x16x32_bf16 v[252:255], v[208:211], v[204:207], v[252:255]
    s_nop 7
    s_branch f1_dd0_rare_r
f1_dd0_mask:
    s_nop 7
    v_cmp_lt_i32 s[40:41], v3, 0
    v_cmp_lt_i32 s[42:43], v3, 1
    v_cmp_lt_i32 s[60:61], v3, 2
    v_cmp_lt_i32 s[62:63], v3, 3
    v_cndmask_b32 v112, v112, v5, s[40:41]
    v_cndmask_b32 v113, v113, v5, s[42:43]
    v_cndmask_b32 v114, v114, v5, s[60:61]
    v_cndmask_b32 v115, v115, v5, s[62:63]
    v_cmp_lt_i32 s[40:41], v3, 16
    v_cmp_lt_i32 s[42:43], v3, 17
    v_cmp_lt_i32 s[60:61], v3, 18
    v_cmp_lt_i32 s[62:63], v3, 19
    v_cndmask_b32 v116, v116, v5, s[40:41]
    v_cndmask_b32 v117, v117, v5, s[42:43]
    v_cndmask_b32 v118, v118, v5, s[60:61]
    v_cndmask_b32 v119, v119, v5, s[62:63]
    v_cmp_lt_i32 s[40:41], v3, 32
    v_cmp_lt_i32 s[42:43], v3, 33
    v_cmp_lt_i32 s[60:61], v3, 34
    v_cmp_lt_i32 s[62:63], v3, 35
    v_cndmask_b32 v120, v120, v5, s[40:41]
    v_cndmask_b32 v121, v121, v5, s[42:43]
    v_cndmask_b32 v122, v122, v5, s[60:61]
    v_cndmask_b32 v123, v123, v5, s[62:63]
    v_cmp_lt_i32 s[40:41], v3, 48
    v_cmp_lt_i32 s[42:43], v3, 49
    v_cmp_lt_i32 s[60:61], v3, 50
    v_cmp_lt_i32 s[62:63], v3, 51
    v_cndmask_b32 v124, v124, v5, s[40:41]
    v_cndmask_b32 v125, v125, v5, s[42:43]
    v_cndmask_b32 v126, v126, v5, s[60:61]
    v_cndmask_b32 v127, v127, v5, s[62:63]
    s_branch f1_dd0_mask_r
f1_dde_rare:
    s_nop 7
    v_max3_f32 v20, v32, v33, v34
    v_max3_f32 v20, v20, v35, v36
    v_max3_f32 v20, v20, v37, v38
    v_max3_f32 v20, v20, v39, v40
    v_max3_f32 v20, v20, v41, v42
    v_max3_f32 v20, v20, v43, v44
    v_max3_f32 v20, v20, v45, v46
    v_max_f32 v20, v20, v47
    v_mov_b32 v21, v20
    s_nop 1
    v_permlane32_swap_b32 v20, v21
    v_max_f32 v20, v20, v21
    v_mov_b32 v21, v20
    s_nop 1
    v_permlane16_swap_b32 v20, v21
    v_max_f32 v20, v20, v21
    v_max_f32 v20, 0, v20
    v_exp_f32 v22, -v20
    s_nop 0
    v_mul_f32 v13, v13, v22
    v_accvgpr_read_b32 v24, a0
    v_mul_f32 v24, v24, v22
    v_accvgpr_write_b32 a0, v24
    v_accvgpr_read_b32 v25, a1
    v_mul_f32 v25, v25, v22
    v_accvgpr_write_b32 a1, v25
    v_accvgpr_read_b32 v26, a2
    v_mul_f32 v26, v26, v22
    v_accvgpr_write_b32 a2, v26
    v_accvgpr_read_b32 v27, a3
    v_mul_f32 v27, v27, v22
    v_accvgpr_write_b32 a3, v27
    v_accvgpr_read_b32 v24, a4
    v_mul_f32 v24, v24, v22
    v_accvgpr_write_b32 a4, v24
    v_accvgpr_read_b32 v25, a5
    v_mul_f32 v25, v25, v22
    v_accvgpr_write_b32 a5, v25
    v_accvgpr_read_b32 v26, a6
    v_mul_f32 v26, v26, v22
    v_accvgpr_write_b32 a6, v26
    v_accvgpr_read_b32 v27, a7
    v_mul_f32 v27, v27, v22
    v_accvgpr_write_b32 a7, v27
    v_accvgpr_read_b32 v24, a8
    v_mul_f32 v24, v24, v22
    v_accvgpr_write_b32 a8, v24
    v_accvgpr_read_b32 v25, a9
    v_mul_f32 v25, v25, v22
    v_accvgpr_write_b32 a9, v25
    v_accvgpr_read_b32 v26, a10
    v_mul_f32 v26, v26, v22
    v_accvgpr_write_b32 a10, v26
    v_accvgpr_read_b32 v27, a11
    v_mul_f32 v27, v27, v22
    v_accvgpr_write_b32 a11, v27
    v_accvgpr_read_b32 v24, a12
    v_mul_f32 v24, v24, v22
    v_accvgpr_write_b32 a12, v24
    v_accvgpr_read_b32 v25, a13
    v_mul_f32 v25, v25, v22
    v_accvgpr_write_b32 a13, v25
    v_accvgpr_read_b32 v26, a14
    v_mul_f32 v26, v26, v22
    v_accvgpr_write_b32 a14, v26
    v_accvgpr_read_b32 v27, a15
    v_mul_f32 v27, v27, v22
    v_accvgpr_write_b32 a15, v27
    v_accvgpr_read_b32 v24, a16
    v_mul_f32 v24, v24, v22
    v_accvgpr_write_b32 a16, v24
    v_accvgpr_read_b32 v25, a17
    v_mul_f32 v25, v25, v22
    v_accvgpr_write_b32 a17, v25
    v_accvgpr_read_b32 v26, a18
    v_mul_f32 v26, v26, v22
    v_accvgpr_write_b32 a18, v26
    v_accvgpr_read_b32 v27, a19
    v_mul_f32 v27, v27, v22
    v_accvgpr_write_b32 a19, v27
    v_accvgpr_read_b32 v24, a20
    v_mul_f32 v24, v24, v22
    v_accvgpr_write_b32 a20, v24
    v_accvgpr_read_b32 v25, a21
    v_mul_f32 v25, v25, v22
    v_accvgpr_write_b32 a21, v25
    v_accvgpr_read_b32 v26, a22
    v_mul_f32 v26, v26, v22
    v_accvgpr_write_b32 a22, v26
    v_accvgpr_read_b32 v27, a23
    v_mul_f32 v27, v27, v22
    v_accvgpr_write_b32 a23, v27
    v_accvgpr_read_b32 v24, a24
    v_mul_f32 v24, v24, v22
    v_accvgpr_write_b32 a24, v24
    v_accvgpr_read_b32 v25, a25
    v_mul_f32 v25, v25, v22
    v_accvgpr_write_b32 a25, v25
    v_accvgpr_read_b32 v26, a26
    v_mul_f32 v26, v26, v22
    v_accvgpr_write_b32 a26, v26
    v_accvgpr_read_b32 v27, a27
    v_mul_f32 v27, v27, v22
    v_accvgpr_write_b32 a27, v27
    v_accvgpr_read_b32 v24, a28
    v_mul_f32 v24, v24, v22
    v_accvgpr_write_b32 a28, v24
    v_accvgpr_read_b32 v25, a29
    v_mul_f32 v25, v25, v22
    v_accvgpr_write_b32 a29, v25
    v_accvgpr_read_b32 v26, a30
    v_mul_f32 v26, v26, v22
    v_accvgpr_write_b32 a30, v26
    v_accvgpr_read_b32 v27, a31
    v_mul_f32 v27, v27, v22
    v_accvgpr_write_b32 a31, v27
    v_sub_f32 v224, v224, v20
    v_sub_f32 v225, v225, v20
    v_sub_f32 v226, v226, v20
    v_sub_f32 v227, v227, v20
    v_sub_f32 v32, v32, v20
    v_sub_f32 v33, v33, v20
    v_sub_f32 v34, v34, v20
    v_sub_f32 v35, v35, v20
    v_sub_f32 v36, v36, v20
    v_sub_f32 v37, v37, v20
    v_sub_f32 v38, v38, v20
    v_sub_f32 v39, v39, v20
    v_sub_f32 v40, v40, v20
    v_sub_f32 v41, v41, v20
    v_sub_f32 v42, v42, v20
    v_sub_f32 v43, v43, v20
    v_sub_f32 v44, v44, v20
    v_sub_f32 v45, v45, v20
    v_sub_f32 v46, v46, v20
    v_sub_f32 v47, v47, v20
    v_sub_f32 v96, v96, v20
    v_sub_f32 v97, v97, v20
    v_sub_f32 v98, v98, v20
    v_sub_f32 v99, v99, v20
    v_sub_f32 v100, v100, v20
    v_sub_f32 v101, v101, v20
    v_sub_f32 v102, v102, v20
    v_sub_f32 v103, v103, v20
    v_sub_f32 v104, v104, v20
    v_sub_f32 v105, v105, v20
    v_sub_f32 v106, v106, v20
    v_sub_f32 v107, v107, v20
    v_sub_f32 v108, v108, v20
    v_sub_f32 v109, v109, v20
    v_sub_f32 v110, v110, v20
    v_sub_f32 v111, v111, v20
    v_exp_f32 v240, v32
    v_exp_f32 v241, v33
    v_exp_f32 v242, v34
    v_exp_f32 v243, v35
    v_exp_f32 v244, v36
    v_cvt_pk_bf16_f32 v160, v240, v241
    v_exp_f32 v245, v37
    v_exp_f32 v246, v38
    v_cvt_pk_bf16_f32 v161, v242, v243
    v_exp_f32 v247, v39
    v_cvt_pk_bf16_f32 v162, v244, v245
    v_cvt_pk_bf16_f32 v163, v246, v247
    s_nop 1
    v_mfma_f32_16x16x32_bf16 v[212:215], v[208:211], v[160:163], 0
    v_exp_f32 v240, v40
    v_exp_f32 v241, v41
    v_exp_f32 v242, v42
    v_exp_f32 v243, v43
    v_exp_f32 v244, v44
    v_cvt_pk_bf16_f32 v192, v240, v241
    v_exp_f32 v245, v45
    v_exp_f32 v246, v46
    v_cvt_pk_bf16_f32 v193, v242, v243
    v_exp_f32 v247, v47
    v_cvt_pk_bf16_f32 v194, v244, v245
    v_cvt_pk_bf16_f32 v195, v246, v247
    s_nop 1
    v_mfma_f32_16x16x32_bf16 v[212:215], v[208:211], v[192:195], v[212:215]
    v_max3_f32 v20, v48, v49, v50
    v_max3_f32 v20, v20, v51, v52
    v_max3_f32 v20, v20, v53, v54
    v_max3_f32 v20, v20, v55, v56
    v_max3_f32 v20, v20, v57, v58
    v_max3_f32 v20, v20, v59, v60
    v_max3_f32 v20, v20, v61, v62
    v_max_f32 v20, v20, v63
    v_mov_b32 v21, v20
    s_nop 1
    v_permlane32_swap_b32 v20, v21
    v_max_f32 v20, v20, v21
    v_mov_b32 v21, v20
    s_nop 1
    v_permlane16_swap_b32 v20, v21
    v_max_f32 v20, v20, v21
    v_max_f32 v20, 0, v20
    v_exp_f32 v22, -v20
    s_nop 0
    v_mul_f32 v14, v14, v22
    v_accvgpr_read_b32 v24, a32
    v_mul_f32 v24, v24, v22
    v_accvgpr_write_b32 a32, v24
    v_accvgpr_read_b32 v25, a33
    v_mul_f32 v25, v25, v22
    v_accvgpr_write_b32 a33, v25
    v_accvgpr_read_b32 v26, a34
    v_mul_f32 v26, v26, v22
    v_accvgpr_write_b32 a34, v26
    v_accvgpr_read_b32 v27, a35
    v_mul_f32 v27, v27, v22
    v_accvgpr_write_b32 a35, v27
    v_accvgpr_read_b32 v24, a36
    v_mul_f32 v24, v24, v22
    v_accvgpr_write_b32 a36, v24
    v_accvgpr_read_b32 v25, a37
    v_mul_f32 v25, v25, v22
    v_accvgpr_write_b32 a37, v25
    v_accvgpr_read_b32 v26, a38
    v_mul_f32 v26, v26, v22
    v_accvgpr_write_b32 a38, v26
    v_accvgpr_read_b32 v27, a39
    v_mul_f32 v27, v27, v22
    v_accvgpr_write_b32 a39, v27
    v_accvgpr_read_b32 v24, a40
    v_mul_f32 v24, v24, v22
    v_accvgpr_write_b32 a40, v24
    v_accvgpr_read_b32 v25, a41
    v_mul_f32 v25, v25, v22
    v_accvgpr_write_b32 a41, v25
    v_accvgpr_read_b32 v26, a42
    v_mul_f32 v26, v26, v22
    v_accvgpr_write_b32 a42, v26
    v_accvgpr_read_b32 v27, a43
    v_mul_f32 v27, v27, v22
    v_accvgpr_write_b32 a43, v27
    v_accvgpr_read_b32 v24, a44
    v_mul_f32 v24, v24, v22
    v_accvgpr_write_b32 a44, v24
    v_accvgpr_read_b32 v25, a45
    v_mul_f32 v25, v25, v22
    v_accvgpr_write_b32 a45, v25
    v_accvgpr_read_b32 v26, a46
    v_mul_f32 v26, v26, v22
    v_accvgpr_write_b32 a46, v26
    v_accvgpr_read_b32 v27, a47
    v_mul_f32 v27, v27, v22
    v_accvgpr_write_b32 a47, v27
    v_accvgpr_read_b32 v24, a48
    v_mul_f32 v24, v24, v22
    v_accvgpr_write_b32 a48, v24
    v_accvgpr_read_b32 v25, a49
    v_mul_f32 v25, v25, v22
    v_accvgpr_write_b32 a49, v25
    v_accvgpr_read_b32 v26, a50
    v_mul_f32 v26, v26, v22
    v_accvgpr_write_b32 a50, v26
    v_accvgpr_read_b32 v27, a51
    v_mul_f32 v27, v27, v22
    v_accvgpr_write_b32 a51, v27
    v_accvgpr_read_b32 v24, a52
    v_mul_f32 v24, v24, v22
    v_accvgpr_write_b32 a52, v24
    v_accvgpr_read_b32 v25, a53
    v_mul_f32 v25, v25, v22
    v_accvgpr_write_b32 a53, v25
    v_accvgpr_read_b32 v26, a54
    v_mul_f32 v26, v26, v22
    v_accvgpr_write_b32 a54, v26
    v_accvgpr_read_b32 v27, a55
    v_mul_f32 v27, v27, v22
    v_accvgpr_write_b32 a55, v27
    v_accvgpr_read_b32 v24, a56
    v_mul_f32 v24, v24, v22
    v_accvgpr_write_b32 a56, v24
    v_accvgpr_read_b32 v25, a57
    v_mul_f32 v25, v25, v22
    v_accvgpr_write_b32 a57, v25
    v_accvgpr_read_b32 v26, a58
    v_mul_f32 v26, v26, v22
    v_accvgpr_write_b32 a58, v26
    v_accvgpr_read_b32 v27, a59
    v_mul_f32 v27, v27, v22
    v_accvgpr_write_b32 a59, v27
    v_accvgpr_read_b32 v24, a60
    v_mul_f32 v24, v24, v22
    v_accvgpr_write_b32 a60, v24
    v_accvgpr_read_b32 v25, a61
    v_mul_f32 v25, v25, v22
    v_accvgpr_write_b32 a61, v25
    v_accvgpr_read_b32 v26, a62
    v_mul_f32 v26, v26, v22
    v_accvgpr_write_b32 a62, v26
    v_accvgpr_read_b32 v27, a63
    v_mul_f32 v27, v27, v22
    v_accvgpr_write_b32 a63, v27
    v_sub_f32 v228, v228, v20
    v_sub_f32 v229, v229, v20
    v_sub_f32 v230, v230, v20
    v_sub_f32 v231, v231, v20
    v_sub_f32 v48, v48, v20
    v_sub_f32 v49, v49, v20
    v_sub_f32 v50, v50, v20
    v_sub_f32 v51, v51, v20
    v_sub_f32 v52, v52, v20
    v_sub_f32 v53, v53, v20
    v_sub_f32 v54, v54, v20
    v_sub_f32 v55, v55, v20
    v_sub_f32 v56, v56, v20
    v_sub_f32 v57, v57, v20
    v_sub_f32 v58, v58, v20
    v_sub_f32 v59, v59, v20
    v_sub_f32 v60, v60, v20
    v_sub_f32 v61, v61, v20
    v_sub_f32 v62, v62, v20
    v_sub_f32 v63, v63, v20
    v_sub_f32 v112, v112, v20
    v_sub_f32 v113, v113, v20
    v_sub_f32 v114, v114, v20
    v_sub_f32 v115, v115, v20
    v_sub_f32 v116, v116, v20
    v_sub_f32 v117, v117, v20
    v_sub_f32 v118, v118, v20
    v_sub_f32 v119, v119, v20
    v_sub_f32 v120, v120, v20
    v_sub_f32 v121, v121, v20
    v_sub_f32 v122, v122, v20
    v_sub_f32 v123, v123, v20
    v_sub_f32 v124, v124, v20
    v_sub_f32 v125, v125, v20
    v_sub_f32 v126, v126, v20
    v_sub_f32 v127, v127, v20
    v_exp_f32 v240, v48
    v_exp_f32 v241, v49
    v_exp_f32 v242, v50
    v_exp_f32 v243, v51
    v_exp_f32 v244, v52
    v_cvt_pk_bf16_f32 v164, v240, v241
    v_exp_f32 v245, v53
    v_exp_f32 v246, v54
    v_cvt_pk_bf16_f32 v165, v242, v243
    v_exp_f32 v247, v55
    v_cvt_pk_bf16_f32 v166, v244, v245
    v_cvt_pk_bf16_f32 v167, v246, v247
    s_nop 1
    v_mfma_f32_16x16x32_bf16 v[216:219], v[208:211], v[164:167], 0
    v_exp_f32 v240, v56
    v_exp_f32 v241, v57
    v_exp_f32 v242, v58
    v_exp_f32 v243, v59
    v_exp_f32 v244, v60
    v_cvt_pk_bf16_f32 v196, v240, v241
    v_exp_f32 v245, v61
    v_exp_f32 v246, v62
    v_cvt_pk_bf16_f32 v197, v242, v243
    v_exp_f32 v247, v63
    v_cvt_pk_bf16_f32 v198, v244, v245
    v_cvt_pk_bf16_f32 v199, v246, v247
    s_nop 1
    v_mfma_f32_16x16x32_bf16 v[216:219], v[208:211], v[196:199], v[216:219]
    v_max3_f32 v20, v64, v65, v66
    v_max3_f32 v20, v20, v67, v68
    v_max3_f32 v20, v20, v69, v70
    v_max3_f32 v20, v20, v71, v72
    v_max3_f32 v20, v20, v73, v74
    v_max3_f32 v20, v20, v75, v76
    v_max3_f32 v20, v20, v77, v78
    v_max_f32 v20, v20, v79
    v_mov_b32 v21, v20
    s_nop 1
    v_permlane32_swap_b32 v20, v21
    v_max_f32 v20, v20, v21
    v_mov_b32 v21, v20
    s_nop 1
    v_permlane16_swap_b32 v20, v21
    v_max_f32 v20, v20, v21
    v_max_f32 v20, 0, v20
    v_exp_f32 v22, -v20
    s_nop 0
    v_mul_f32 v15, v15, v22
    v_accvgpr_read_b32 v24, a64
    v_mul_f32 v24, v24, v22
    v_accvgpr_write_b32 a64, v24
    v_accvgpr_read_b32 v25, a65
    v_mul_f32 v25, v25, v22
    v_accvgpr_write_b32 a65, v25
    v_accvgpr_read_b32 v26, a66
    v_mul_f32 v26, v26, v22
    v_accvgpr_write_b32 a66, v26
    v_accvgpr_read_b32 v27, a67
    v_mul_f32 v27, v27, v22
    v_accvgpr_write_b32 a67, v27
    v_accvgpr_read_b32 v24, a68
    v_mul_f32 v24, v24, v22
    v_accvgpr_write_b32 a68, v24
    v_accvgpr_read_b32 v25, a69
    v_mul_f32 v25, v25, v22
    v_accvgpr_write_b32 a69, v25
    v_accvgpr_read_b32 v26, a70
    v_mul_f32 v26, v26, v22
    v_accvgpr_write_b32 a70, v26
    v_accvgpr_read_b32 v27, a71
    v_mul_f32 v27, v27, v22
    v_accvgpr_write_b32 a71, v27
    v_accvgpr_read_b32 v24, a72
    v_mul_f32 v24, v24, v22
    v_accvgpr_write_b32 a72, v24
    v_accvgpr_read_b32 v25, a73
    v_mul_f32 v25, v25, v22
    v_accvgpr_write_b32 a73, v25
    v_accvgpr_read_b32 v26, a74
    v_mul_f32 v26, v26, v22
    v_accvgpr_write_b32 a74, v26
    v_accvgpr_read_b32 v27, a75
    v_mul_f32 v27, v27, v22
    v_accvgpr_write_b32 a75, v27
    v_accvgpr_read_b32 v24, a76
    v_mul_f32 v24, v24, v22
    v_accvgpr_write_b32 a76, v24
    v_accvgpr_read_b32 v25, a77
    v_mul_f32 v25, v25, v22
    v_accvgpr_write_b32 a77, v25
    v_accvgpr_read_b32 v26, a78
    v_mul_f32 v26, v26, v22
    v_accvgpr_write_b32 a78, v26
    v_accvgpr_read_b32 v27, a79
    v_mul_f32 v27, v27, v22
    v_accvgpr_write_b32 a79, v27
    v_accvgpr_read_b32 v24, a80
    v_mul_f32 v24, v24, v22
    v_accvgpr_write_b32 a80, v24
    v_accvgpr_read_b32 v25, a81
    v_mul_f32 v25, v25, v22
    v_accvgpr_write_b32 a81, v25
    v_accvgpr_read_b32 v26, a82
    v_mul_f32 v26, v26, v22
    v_accvgpr_write_b32 a82, v26
    v_accvgpr_read_b32 v27, a83
    v_mul_f32 v27, v27, v22
    v_accvgpr_write_b32 a83, v27
    v_accvgpr_read_b32 v24, a84
    v_mul_f32 v24, v24, v22
    v_accvgpr_write_b32 a84, v24
    v_accvgpr_read_b32 v25, a85
    v_mul_f32 v25, v25, v22
    v_accvgpr_write_b32 a85, v25
    v_accvgpr_read_b32 v26, a86
    v_mul_f32 v26, v26, v22
    v_accvgpr_write_b32 a86, v26
    v_accvgpr_read_b32 v27, a87
    v_mul_f32 v27, v27, v22
    v_accvgpr_write_b32 a87, v27
    v_accvgpr_read_b32 v24, a88
    v_mul_f32 v24, v24, v22
    v_accvgpr_write_b32 a88, v24
    v_accvgpr_read_b32 v25, a89
    v_mul_f32 v25, v25, v22
    v_accvgpr_write_b32 a89, v25
    v_accvgpr_read_b32 v26, a90
    v_mul_f32 v26, v26, v22
    v_accvgpr_write_b32 a90, v26
    v_accvgpr_read_b32 v27, a91
    v_mul_f32 v27, v27, v22
    v_accvgpr_write_b32 a91, v27
    v_accvgpr_read_b32 v24, a92
    v_mul_f32 v24, v24, v22
    v_accvgpr_write_b32 a92, v24
    v_accvgpr_read_b32 v25, a93
    v_mul_f32 v25, v25, v22
    v_accvgpr_write_b32 a93, v25
    v_accvgpr_read_b32 v26, a94
    v_mul_f32 v26, v26, v22
    v_accvgpr_write_b32 a94, v26
    v_accvgpr_read_b32 v27, a95
    v_mul_f32 v27, v27, v22
    v_accvgpr_write_b32 a95, v27
    v_sub_f32 v232, v232, v20
    v_sub_f32 v233, v233, v20
    v_sub_f32 v234, v234, v20
    v_sub_f32 v235, v235, v20
    v_sub_f32 v64, v64, v20
    v_sub_f32 v65, v65, v20
    v_sub_f32 v66, v66, v20
    v_sub_f32 v67, v67, v20
    v_sub_f32 v68, v68, v20
    v_sub_f32 v69, v69, v20
    v_sub_f32 v70, v70, v20
    v_sub_f32 v71, v71, v20
    v_sub_f32 v72, v72, v20
    v_sub_f32 v73, v73, v20
    v_sub_f32 v74, v74, v20
    v_sub_f32 v75, v75, v20
    v_sub_f32 v76, v76, v20
    v_sub_f32 v77, v77, v20
    v_sub_f32 v78, v78, v20
    v_sub_f32 v79, v79, v20
    v_sub_f32 v128, v128, v20
    v_sub_f32 v129, v129, v20
    v_sub_f32 v130, v130, v20
    v_sub_f32 v131, v131, v20
    v_sub_f32 v132, v132, v20
    v_sub_f32 v133, v133, v20
    v_sub_f32 v134, v134, v20
    v_sub_f32 v135, v135, v20
    v_sub_f32 v136, v136, v20
    v_sub_f32 v137, v137, v20
    v_sub_f32 v138, v138, v20
    v_sub_f32 v139, v139, v20
    v_sub_f32 v140, v140, v20
    v_sub_f32 v141, v141, v20
    v_sub_f32 v142, v142, v20
    v_sub_f32 v143, v143, v20
    v_exp_f32 v240, v64
    v_exp_f32 v241, v65
    v_exp_f32 v242, v66
    v_exp_f32 v243, v67
    v_exp_f32 v244, v68
    v_cvt_pk_bf16_f32 v168, v240, v241
    v_exp_f32 v245, v69
    v_exp_f32 v246, v70
    v_cvt_pk_bf16_f32 v169, v242, v243
    v_exp_f32 v247, v71
    v_cvt_pk_bf16_f32 v170, v244, v245
    v_cvt_pk_bf16_f32 v171, v246, v247
    s_nop 1
    v_mfma_f32_16x16x32_bf16 v[248:251], v[208:211], v[168:171], 0
    v_exp_f32 v240, v72
    v_exp_f32 v241, v73
    v_exp_f32 v242, v74
    v_exp_f32 v243, v75
    v_exp_f32 v244, v76
    v_cvt_pk_bf16_f32 v200, v240, v241
    v_exp_f32 v245, v77
    v_exp_f32 v246, v78
    v_cvt_pk_bf16_f32 v201, v242, v243
    v_exp_f32 v247, v79
    v_cvt_pk_bf16_f32 v202, v244, v245
    v_cvt_pk_bf16_f32 v203, v246, v247
    s_nop 1
    v_mfma_f32_16x16x32_bf16 v[248:251], v[208:211], v[200:203], v[248:251]
    v_max3_f32 v20, v80, v81, v82
    v_max3_f32 v20, v20, v83, v84
    v_max3_f32 v20, v20, v85, v86
    v_max3_f32 v20, v20, v87, v88
    v_max3_f32 v20, v20, v89, v90
    v_max3_f32 v20, v20, v91, v92
    v_max3_f32 v20, v20, v93, v94
    v_max_f32 v20, v20, v95
    v_mov_b32 v21, v20
    s_nop 1
    v_permlane32_swap_b32 v20, v21
    v_max_f32 v20, v20, v21
    v_mov_b32 v21, v20
    s_nop 1
    v_permlane16_swap_b32 v20, v21
    v_max_f32 v20, v20, v21
    v_max_f32 v20, 0, v20
    v_exp_f32 v22, -v20
    s_nop 0
    v_mul_f32 v30, v30, v22
    v_accvgpr_read_b32 v24, a96
    v_mul_f32 v24, v24, v22
    v_accvgpr_write_b32 a96, v24
    v_accvgpr_read_b32 v25, a97
    v_mul_f32 v25, v25, v22
    v_accvgpr_write_b32 a97, v25
    v_accvgpr_read_b32 v26, a98
    v_mul_f32 v26, v26, v22
    v_accvgpr_write_b32 a98, v26
    v_accvgpr_read_b32 v27, a99
    v_mul_f32 v27, v27, v22
    v_accvgpr_write_b32 a99, v27
    v_accvgpr_read_b32 v24, a100
    v_mul_f32 v24, v24, v22
    v_accvgpr_write_b32 a100, v24
    v_accvgpr_read_b32 v25, a101
    v_mul_f32 v25, v25, v22
    v_accvgpr_write_b32 a101, v25
    v_accvgpr_read_b32 v26, a102
    v_mul_f32 v26, v26, v22
    v_accvgpr_write_b32 a102, v26
    v_accvgpr_read_b32 v27, a103
    v_mul_f32 v27, v27, v22
    v_accvgpr_write_b32 a103, v27
    v_accvgpr_read_b32 v24, a104
    v_mul_f32 v24, v24, v22
    v_accvgpr_write_b32 a104, v24
    v_accvgpr_read_b32 v25, a105
    v_mul_f32 v25, v25, v22
    v_accvgpr_write_b32 a105, v25
    v_accvgpr_read_b32 v26, a106
    v_mul_f32 v26, v26, v22
    v_accvgpr_write_b32 a106, v26
    v_accvgpr_read_b32 v27, a107
    v_mul_f32 v27, v27, v22
    v_accvgpr_write_b32 a107, v27
    v_accvgpr_read_b32 v24, a108
    v_mul_f32 v24, v24, v22
    v_accvgpr_write_b32 a108, v24
    v_accvgpr_read_b32 v25, a109
    v_mul_f32 v25, v25, v22
    v_accvgpr_write_b32 a109, v25
    v_accvgpr_read_b32 v26, a110
    v_mul_f32 v26, v26, v22
    v_accvgpr_write_b32 a110, v26
    v_accvgpr_read_b32 v27, a111
    v_mul_f32 v27, v27, v22
    v_accvgpr_write_b32 a111, v27
    v_accvgpr_read_b32 v24, a112
    v_mul_f32 v24, v24, v22
    v_accvgpr_write_b32 a112, v24
    v_accvgpr_read_b32 v25, a113
    v_mul_f32 v25, v25, v22
    v_accvgpr_write_b32 a113, v25
    v_accvgpr_read_b32 v26, a114
    v_mul_f32 v26, v26, v22
    v_accvgpr_write_b32 a114, v26
    v_accvgpr_read_b32 v27, a115
    v_mul_f32 v27, v27, v22
    v_accvgpr_write_b32 a115, v27
    v_accvgpr_read_b32 v24, a116
    v_mul_f32 v24, v24, v22
    v_accvgpr_write_b32 a116, v24
    v_accvgpr_read_b32 v25, a117
    v_mul_f32 v25, v25, v22
    v_accvgpr_write_b32 a117, v25
    v_accvgpr_read_b32 v26, a118
    v_mul_f32 v26, v26, v22
    v_accvgpr_write_b32 a118, v26
    v_accvgpr_read_b32 v27, a119
    v_mul_f32 v27, v27, v22
    v_accvgpr_write_b32 a119, v27
    v_accvgpr_read_b32 v24, a120
    v_mul_f32 v24, v24, v22
    v_accvgpr_write_b32 a120, v24
    v_accvgpr_read_b32 v25, a121
    v_mul_f32 v25, v25, v22
    v_accvgpr_write_b32 a121, v25
    v_accvgpr_read_b32 v26, a122
    v_mul_f32 v26, v26, v22
    v_accvgpr_write_b32 a122, v26
    v_accvgpr_read_b32 v27, a123
    v_mul_f32 v27, v27, v22
    v_accvgpr_write_b32 a123, v27
    v_accvgpr_read_b32 v24, a124
    v_mul_f32 v24, v24, v22
    v_accvgpr_write_b32 a124, v24
    v_accvgpr_read_b32 v25, a125
    v_mul_f32 v25, v25, v22
    v_accvgpr_write_b32 a125, v25
    v_accvgpr_read_b32 v26, a126
    v_mul_f32 v26, v26, v22
    v_accvgpr_write_b32 a126, v26
    v_accvgpr_read_b32 v27, a127
    v_mul_f32 v27, v27, v22
    v_accvgpr_write_b32 a127, v27
    v_sub_f32 v236, v236, v20
    v_sub_f32 v237, v237, v20
    v_sub_f32 v238, v238, v20
    v_sub_f32 v239, v239, v20
    v_sub_f32 v80, v80, v20
    v_sub_f32 v81, v81, v20
    v_sub_f32 v82, v82, v20
    v_sub_f32 v83, v83, v20
    v_sub_f32 v84, v84, v20
    v_sub_f32 v85, v85, v20
    v_sub_f32 v86, v86, v20
    v_sub_f32 v87, v87, v20
    v_sub_f32 v88, v88, v20
    v_sub_f32 v89, v89, v20
    v_sub_f32 v90, v90, v20
    v_sub_f32 v91, v91, v20
    v_sub_f32 v92, v92, v20
    v_sub_f32 v93, v93, v20
    v_sub_f32 v94, v94, v20
    v_sub_f32 v95, v95, v20
    v_sub_f32 v144, v144, v20
    v_sub_f32 v145, v145, v20
    v_sub_f32 v146, v146, v20
    v_sub_f32 v147, v147, v20
    v_sub_f32 v148, v148, v20
    v_sub_f32 v149, v149, v20
    v_sub_f32 v150, v150, v20
    v_sub_f32 v151, v151, v20
    v_sub_f32 v152, v152, v20
    v_sub_f32 v153, v153, v20
    v_sub_f32 v154, v154, v20
    v_sub_f32 v155, v155, v20
    v_sub_f32 v156, v156, v20
    v_sub_f32 v157, v157, v20
    v_sub_f32 v158, v158, v20
    v_sub_f32 v159, v159, v20
    v_exp_f32 v240, v80
    v_exp_f32 v241, v81
    v_exp_f32 v242, v82
    v_exp_f32 v243, v83
    v_exp_f32 v244, v84
    v_cvt_pk_bf16_f32 v172, v240, v241
    v_exp_f32 v245, v85
    v_exp_f32 v246, v86
    v_cvt_pk_bf16_f32 v173, v242, v243
    v_exp_f32 v247, v87
    v_cvt_pk_bf16_f32 v174, v244, v245
    v_cvt_pk_bf16_f32 v175, v246, v247
    s_nop 1
    v_mfma_f32_16x16x32_bf16 v[252:255], v[208:211], v[172:175], 0
    v_exp_f32 v240, v88
    v_exp_f32 v241, v89
    v_exp_f32 v242, v90
    v_exp_f32 v243, v91
    v_exp_f32 v244, v92
    v_cvt_pk_bf16_f32 v204, v240, v241
    v_exp_f32 v245, v93
    v_exp_f32 v246, v94
    v_cvt_pk_bf16_f32 v205, v242, v243
    v_exp_f32 v247, v95
    v_cvt_pk_bf16_f32 v206, v244, v245
    v_cvt_pk_bf16_f32 v207, v246, v247
    s_nop 1
    v_mfma_f32_16x16x32_bf16 v[252:255], v[208:211], v[204:207], v[252:255]
    s_nop 7
    s_branch f1_dde_rare_r
f1_dde_mask:
    s_nop 7
    v_cmp_lt_i32 s[40:41], v3, 0
    v_cmp_lt_i32 s[42:43], v3, 1
    v_cmp_lt_i32 s[60:61], v3, 2
    v_cmp_lt_i32 s[62:63], v3, 3
    v_cndmask_b32 v112, v112, v5, s[40:41]
    v_cndmask_b32 v113, v113, v5, s[42:43]
    v_cndmask_b32 v114, v114, v5, s[60:61]
    v_cndmask_b32 v115, v115, v5, s[62:63]
    v_cmp_lt_i32 s[40:41], v3, 16
    v_cmp_lt_i32 s[42:43], v3, 17
    v_cmp_lt_i32 s[60:61], v3, 18
    v_cmp_lt_i32 s[62:63], v3, 19
    v_cndmask_b32 v116, v116, v5, s[40:41]
    v_cndmask_b32 v117, v117, v5, s[42:43]
    v_cndmask_b32 v118, v118, v5, s[60:61]
    v_cndmask_b32 v119, v119, v5, s[62:63]
    v_cmp_lt_i32 s[40:41], v3, 32
    v_cmp_lt_i32 s[42:43], v3, 33
    v_cmp_lt_i32 s[60:61], v3, 34
    v_cmp_lt_i32 s[62:63], v3, 35
    v_cndmask_b32 v120, v120, v5, s[40:41]
    v_cndmask_b32 v121, v121, v5, s[42:43]
    v_cndmask_b32 v122, v122, v5, s[60:61]
    v_cndmask_b32 v123, v123, v5, s[62:63]
    v_cmp_lt_i32 s[40:41], v3, 48
    v_cmp_lt_i32 s[42:43], v3, 49
    v_cmp_lt_i32 s[60:61], v3, 50
    v_cmp_lt_i32 s[62:63], v3, 51
    v_cndmask_b32 v124, v124, v5, s[40:41]
    v_cndmask_b32 v125, v125, v5, s[42:43]
    v_cndmask_b32 v126, v126, v5, s[60:61]
    v_cndmask_b32 v127, v127, v5, s[62:63]
    s_branch f1_dde_mask_r
f1_ddo_rare:
    s_nop 7
    v_max3_f32 v20, v96, v97, v98
    v_max3_f32 v20, v20, v99, v100
    v_max3_f32 v20, v20, v101, v102
    v_max3_f32 v20, v20, v103, v104
    v_max3_f32 v20, v20, v105, v106
    v_max3_f32 v20, v20, v107, v108
    v_max3_f32 v20, v20, v109, v110
    v_max_f32 v20, v20, v111
    v_mov_b32 v21, v20
    s_nop 1
    v_permlane32_swap_b32 v20, v21
    v_max_f32 v20, v20, v21
    v_mov_b32 v21, v20
    s_nop 1
    v_permlane16_swap_b32 v20, v21
    v_max_f32 v20, v20, v21
    v_max_f32 v20, 0, v20
    v_exp_f32 v22, -v20
    s_nop 0
    v_mul_f32 v13, v13, v22
    v_accvgpr_read_b32 v24, a0
    v_mul_f32 v24, v24, v22
    v_accvgpr_write_b32 a0, v24
    v_accvgpr_read_b32 v25, a1
    v_mul_f32 v25, v25, v22
    v_accvgpr_write_b32 a1, v25
    v_accvgpr_read_b32 v26, a2
    v_mul_f32 v26, v26, v22
    v_accvgpr_write_b32 a2, v26
    v_accvgpr_read_b32 v27, a3
    v_mul_f32 v27, v27, v22
    v_accvgpr_write_b32 a3, v27
    v_accvgpr_read_b32 v24, a4
    v_mul_f32 v24, v24, v22
    v_accvgpr_write_b32 a4, v24
    v_accvgpr_read_b32 v25, a5
    v_mul_f32 v25, v25, v22
    v_accvgpr_write_b32 a5, v25
    v_accvgpr_read_b32 v26, a6
    v_mul_f32 v26, v26, v22
    v_accvgpr_write_b32 a6, v26
    v_accvgpr_read_b32 v27, a7
    v_mul_f32 v27, v27, v22
    v_accvgpr_write_b32 a7, v27
    v_accvgpr_read_b32 v24, a8
    v_mul_f32 v24, v24, v22
    v_accvgpr_write_b32 a8, v24
    v_accvgpr_read_b32 v25, a9
    v_mul_f32 v25, v25, v22
    v_accvgpr_write_b32 a9, v25
    v_accvgpr_read_b32 v26, a10
    v_mul_f32 v26, v26, v22
    v_accvgpr_write_b32 a10, v26
    v_accvgpr_read_b32 v27, a11
    v_mul_f32 v27, v27, v22
    v_accvgpr_write_b32 a11, v27
    v_accvgpr_read_b32 v24, a12
    v_mul_f32 v24, v24, v22
    v_accvgpr_write_b32 a12, v24
    v_accvgpr_read_b32 v25, a13
    v_mul_f32 v25, v25, v22
    v_accvgpr_write_b32 a13, v25
    v_accvgpr_read_b32 v26, a14
    v_mul_f32 v26, v26, v22
    v_accvgpr_write_b32 a14, v26
    v_accvgpr_read_b32 v27, a15
    v_mul_f32 v27, v27, v22
    v_accvgpr_write_b32 a15, v27
    v_accvgpr_read_b32 v24, a16
    v_mul_f32 v24, v24, v22
    v_accvgpr_write_b32 a16, v24
    v_accvgpr_read_b32 v25, a17
    v_mul_f32 v25, v25, v22
    v_accvgpr_write_b32 a17, v25
    v_accvgpr_read_b32 v26, a18
    v_mul_f32 v26, v26, v22
    v_accvgpr_write_b32 a18, v26
    v_accvgpr_read_b32 v27, a19
    v_mul_f32 v27, v27, v22
    v_accvgpr_write_b32 a19, v27
    v_accvgpr_read_b32 v24, a20
    v_mul_f32 v24, v24, v22
    v_accvgpr_write_b32 a20, v24
    v_accvgpr_read_b32 v25, a21
    v_mul_f32 v25, v25, v22
    v_accvgpr_write_b32 a21, v25
    v_accvgpr_read_b32 v26, a22
    v_mul_f32 v26, v26, v22
    v_accvgpr_write_b32 a22, v26
    v_accvgpr_read_b32 v27, a23
    v_mul_f32 v27, v27, v22
    v_accvgpr_write_b32 a23, v27
    v_accvgpr_read_b32 v24, a24
    v_mul_f32 v24, v24, v22
    v_accvgpr_write_b32 a24, v24
    v_accvgpr_read_b32 v25, a25
    v_mul_f32 v25, v25, v22
    v_accvgpr_write_b32 a25, v25
    v_accvgpr_read_b32 v26, a26
    v_mul_f32 v26, v26, v22
    v_accvgpr_write_b32 a26, v26
    v_accvgpr_read_b32 v27, a27
    v_mul_f32 v27, v27, v22
    v_accvgpr_write_b32 a27, v27
    v_accvgpr_read_b32 v24, a28
    v_mul_f32 v24, v24, v22
    v_accvgpr_write_b32 a28, v24
    v_accvgpr_read_b32 v25, a29
    v_mul_f32 v25, v25, v22
    v_accvgpr_write_b32 a29, v25
    v_accvgpr_read_b32 v26, a30
    v_mul_f32 v26, v26, v22
    v_accvgpr_write_b32 a30, v26
    v_accvgpr_read_b32 v27, a31
    v_mul_f32 v27, v27, v22
    v_accvgpr_write_b32 a31, v27
    v_sub_f32 v224, v224, v20
    v_sub_f32 v225, v225, v20
    v_sub_f32 v226, v226, v20
    v_sub_f32 v227, v227, v20
    v_sub_f32 v96, v96, v20
    v_sub_f32 v97, v97, v20
    v_sub_f32 v98, v98, v20
    v_sub_f32 v99, v99, v20
    v_sub_f32 v100, v100, v20
    v_sub_f32 v101, v101, v20
    v_sub_f32 v102, v102, v20
    v_sub_f32 v103, v103, v20
    v_sub_f32 v104, v104, v20
    v_sub_f32 v105, v105, v20
    v_sub_f32 v106, v106, v20
    v_sub_f32 v107, v107, v20
    v_sub_f32 v108, v108, v20
    v_sub_f32 v109, v109, v20
    v_sub_f32 v110, v110, v20
    v_sub_f32 v111, v111, v20
    v_sub_f32 v32, v32, v20
    v_sub_f32 v33, v33, v20
    v_sub_f32 v34, v34, v20
    v_sub_f32 v35, v35, v20
    v_sub_f32 v36, v36, v20
    v_sub_f32 v37, v37, v20
    v_sub_f32 v38, v38, v20
    v_sub_f32 v39, v39, v20
    v_sub_f32 v40, v40, v20
    v_sub_f32 v41, v41, v20
    v_sub_f32 v42, v42, v20
    v_sub_f32 v43, v43, v20
    v_sub_f32 v44, v44, v20
    v_sub_f32 v45, v45, v20
    v_sub_f32 v46, v46, v20
    v_sub_f32 v47, v47, v20
    v_exp_f32 v240, v96
    v_exp_f32 v241, v97
    v_exp_f32 v242, v98
    v_exp_f32 v243, v99
    v_exp_f32 v244, v100
    v_cvt_pk_bf16_f32 v176, v240, v241
    v_exp_f32 v245, v101
    v_exp_f32 v246, v102
    v_cvt_pk_bf16_f32 v177, v242, v243
    v_exp_f32 v247, v103
    v_cvt_pk_bf16_f32 v178, v244, v245
    v_cvt_pk_bf16_f32 v179, v246, v247
    s_nop 1
    v_mfma_f32_16x16x32_bf16 v[212:215], v[208:211], v[176:179], 0
    v_exp_f32 v240, v104
    v_exp_f32 v241, v105
    v_exp_f32 v242, v106
    v_exp_f32 v243, v107
    v_exp_f32 v244, v108
    v_cvt_pk_bf16_f32 v192, v240, v241
    v_exp_f32 v245, v109
    v_exp_f32 v246, v110
    v_cvt_pk_bf16_f32 v193, v242, v243
    v_exp_f32 v247, v111
    v_cvt_pk_bf16_f32 v194, v244, v245
    v_cvt_pk_bf16_f32 v195, v246, v247
    s_nop 1
    v_mfma_f32_16x16x32_bf16 v[212:215], v[208:211], v[192:195], v[212:215]
    v_max3_f32 v20, v112, v113, v114
    v_max3_f32 v20, v20, v115, v116
    v_max3_f32 v20, v20, v117, v118
    v_max3_f32 v20, v20, v119, v120
    v_max3_f32 v20, v20, v121, v122
    v_max3_f32 v20, v20, v123, v124
    v_max3_f32 v20, v20, v125, v126
    v_max_f32 v20, v20, v127
    v_mov_b32 v21, v20
    s_nop 1
    v_permlane32_swap_b32 v20, v21
    v_max_f32 v20, v20, v21
    v_mov_b32 v21, v20
    s_nop 1
    v_permlane16_swap_b32 v20, v21
    v_max_f32 v20, v20, v21
    v_max_f32 v20, 0, v20
    v_exp_f32 v22, -v20
    s_nop 0
    v_mul_f32 v14, v14, v22
    v_accvgpr_read_b32 v24, a32
    v_mul_f32 v24, v24, v22
    v_accvgpr_write_b32 a32, v24
    v_accvgpr_read_b32 v25, a33
    v_mul_f32 v25, v25, v22
    v_accvgpr_write_b32 a33, v25
    v_accvgpr_read_b32 v26, a34
    v_mul_f32 v26, v26, v22
    v_accvgpr_write_b32 a34, v26
    v_accvgpr_read_b32 v27, a35
    v_mul_f32 v27, v27, v22
    v_accvgpr_write_b32 a35, v27
    v_accvgpr_read_b32 v24, a36
    v_mul_f32 v24, v24, v22
    v_accvgpr_write_b32 a36, v24
    v_accvgpr_read_b32 v25, a37
    v_mul_f32 v25, v25, v22
    v_accvgpr_write_b32 a37, v25
    v_accvgpr_read_b32 v26, a38
    v_mul_f32 v26, v26, v22
    v_accvgpr_write_b32 a38, v26
    v_accvgpr_read_b32 v27, a39
    v_mul_f32 v27, v27, v22
    v_accvgpr_write_b32 a39, v27
    v_accvgpr_read_b32 v24, a40
    v_mul_f32 v24, v24, v22
    v_accvgpr_write_b32 a40, v24
    v_accvgpr_read_b32 v25, a41
    v_mul_f32 v25, v25, v22
    v_accvgpr_write_b32 a41, v25
    v_accvgpr_read_b32 v26, a42
    v_mul_f32 v26, v26, v22
    v_accvgpr_write_b32 a42, v26
    v_accvgpr_read_b32 v27, a43
    v_mul_f32 v27, v27, v22
    v_accvgpr_write_b32 a43, v27
    v_accvgpr_read_b32 v24, a44
    v_mul_f32 v24, v24, v22
    v_accvgpr_write_b32 a44, v24
    v_accvgpr_read_b32 v25, a45
    v_mul_f32 v25, v25, v22
    v_accvgpr_write_b32 a45, v25
    v_accvgpr_read_b32 v26, a46
    v_mul_f32 v26, v26, v22
    v_accvgpr_write_b32 a46, v26
    v_accvgpr_read_b32 v27, a47
    v_mul_f32 v27, v27, v22
    v_accvgpr_write_b32 a47, v27
    v_accvgpr_read_b32 v24, a48
    v_mul_f32 v24, v24, v22
    v_accvgpr_write_b32 a48, v24
    v_accvgpr_read_b32 v25, a49
    v_mul_f32 v25, v25, v22
    v_accvgpr_write_b32 a49, v25
    v_accvgpr_read_b32 v26, a50
    v_mul_f32 v26, v26, v22
    v_accvgpr_write_b32 a50, v26
    v_accvgpr_read_b32 v27, a51
    v_mul_f32 v27, v27, v22
    v_accvgpr_write_b32 a51, v27
    v_accvgpr_read_b32 v24, a52
    v_mul_f32 v24, v24, v22
    v_accvgpr_write_b32 a52, v24
    v_accvgpr_read_b32 v25, a53
    v_mul_f32 v25, v25, v22
    v_accvgpr_write_b32 a53, v25
    v_accvgpr_read_b32 v26, a54
    v_mul_f32 v26, v26, v22
    v_accvgpr_write_b32 a54, v26
    v_accvgpr_read_b32 v27, a55
    v_mul_f32 v27, v27, v22
    v_accvgpr_write_b32 a55, v27
    v_accvgpr_read_b32 v24, a56
    v_mul_f32 v24, v24, v22
    v_accvgpr_write_b32 a56, v24
    v_accvgpr_read_b32 v25, a57
    v_mul_f32 v25, v25, v22
    v_accvgpr_write_b32 a57, v25
    v_accvgpr_read_b32 v26, a58
    v_mul_f32 v26, v26, v22
    v_accvgpr_write_b32 a58, v26
    v_accvgpr_read_b32 v27, a59
    v_mul_f32 v27, v27, v22
    v_accvgpr_write_b32 a59, v27
    v_accvgpr_read_b32 v24, a60
    v_mul_f32 v24, v24, v22
    v_accvgpr_write_b32 a60, v24
    v_accvgpr_read_b32 v25, a61
    v_mul_f32 v25, v25, v22
    v_accvgpr_write_b32 a61, v25
    v_accvgpr_read_b32 v26, a62
    v_mul_f32 v26, v26, v22
    v_accvgpr_write_b32 a62, v26
    v_accvgpr_read_b32 v27, a63
    v_mul_f32 v27, v27, v22
    v_accvgpr_write_b32 a63, v27
    v_sub_f32 v228, v228, v20
    v_sub_f32 v229, v229, v20
    v_sub_f32 v230, v230, v20
    v_sub_f32 v231, v231, v20
    v_sub_f32 v112, v112, v20
    v_sub_f32 v113, v113, v20
    v_sub_f32 v114, v114, v20
    v_sub_f32 v115, v115, v20
    v_sub_f32 v116, v116, v20
    v_sub_f32 v117, v117, v20
    v_sub_f32 v118, v118, v20
    v_sub_f32 v119, v119, v20
    v_sub_f32 v120, v120, v20
    v_sub_f32 v121, v121, v20
    v_sub_f32 v122, v122, v20
    v_sub_f32 v123, v123, v20
    v_sub_f32 v124, v124, v20
    v_sub_f32 v125, v125, v20
    v_sub_f32 v126, v126, v20
    v_sub_f32 v127, v127, v20
    v_sub_f32 v48, v48, v20
    v_sub_f32 v49, v49, v20
    v_sub_f32 v50, v50, v20
    v_sub_f32 v51, v51, v20
    v_sub_f32 v52, v52, v20
    v_sub_f32 v53, v53, v20
    v_sub_f32 v54, v54, v20
    v_sub_f32 v55, v55, v20
    v_sub_f32 v56, v56, v20
    v_sub_f32 v57, v57, v20
    v_sub_f32 v58, v58, v20
    v_sub_f32 v59, v59, v20
    v_sub_f32 v60, v60, v20
    v_sub_f32 v61, v61, v20
    v_sub_f32 v62, v62, v20
    v_sub_f32 v63, v63, v20
    v_exp_f32 v240, v112
    v_exp_f32 v241, v113
    v_exp_f32 v242, v114
    v_exp_f32 v243, v115
    v_exp_f32 v244, v116
    v_cvt_pk_bf16_f32 v180, v240, v241
    v_exp_f32 v245, v117
    v_exp_f32 v246, v118
    v_cvt_pk_bf16_f32 v181, v242, v243
    v_exp_f32 v247, v119
    v_cvt_pk_bf16_f32 v182, v244, v245
    v_cvt_pk_bf16_f32 v183, v246, v247
    s_nop 1
    v_mfma_f32_16x16x32_bf16 v[216:219], v[208:211], v[180:183], 0
    v_exp_f32 v240, v120
    v_exp_f32 v241, v121
    v_exp_f32 v242, v122
    v_exp_f32 v243, v123
    v_exp_f32 v244, v124
    v_cvt_pk_bf16_f32 v196, v240, v241
    v_exp_f32 v245, v125
    v_exp_f32 v246, v126
    v_cvt_pk_bf16_f32 v197, v242, v243
    v_exp_f32 v247, v127
    v_cvt_pk_bf16_f32 v198, v244, v245
    v_cvt_pk_bf16_f32 v199, v246, v247
    s_nop 1
    v_mfma_f32_16x16x32_bf16 v[216:219], v[208:211], v[196:199], v[216:219]
    v_max3_f32 v20, v128, v129, v130
    v_max3_f32 v20, v20, v131, v132
    v_max3_f32 v20, v20, v133, v134
    v_max3_f32 v20, v20, v135, v136
    v_max3_f32 v20, v20, v137, v138
    v_max3_f32 v20, v20, v139, v140
    v_max3_f32 v20, v20, v141, v142
    v_max_f32 v20, v20, v143
    v_mov_b32 v21, v20
    s_nop 1
    v_permlane32_swap_b32 v20, v21
    v_max_f32 v20, v20, v21
    v_mov_b32 v21, v20
    s_nop 1
    v_permlane16_swap_b32 v20, v21
    v_max_f32 v20, v20, v21
    v_max_f32 v20, 0, v20
    v_exp_f32 v22, -v20
    s_nop 0
    v_mul_f32 v15, v15, v22
    v_accvgpr_read_b32 v24, a64
    v_mul_f32 v24, v24, v22
    v_accvgpr_write_b32 a64, v24
    v_accvgpr_read_b32 v25, a65
    v_mul_f32 v25, v25, v22
    v_accvgpr_write_b32 a65, v25
    v_accvgpr_read_b32 v26, a66
    v_mul_f32 v26, v26, v22
    v_accvgpr_write_b32 a66, v26
    v_accvgpr_read_b32 v27, a67
    v_mul_f32 v27, v27, v22
    v_accvgpr_write_b32 a67, v27
    v_accvgpr_read_b32 v24, a68
    v_mul_f32 v24, v24, v22
    v_accvgpr_write_b32 a68, v24
    v_accvgpr_read_b32 v25, a69
    v_mul_f32 v25, v25, v22
    v_accvgpr_write_b32 a69, v25
    v_accvgpr_read_b32 v26, a70
    v_mul_f32 v26, v26, v22
    v_accvgpr_write_b32 a70, v26
    v_accvgpr_read_b32 v27, a71
    v_mul_f32 v27, v27, v22
    v_accvgpr_write_b32 a71, v27
    v_accvgpr_read_b32 v24, a72
    v_mul_f32 v24, v24, v22
    v_accvgpr_write_b32 a72, v24
    v_accvgpr_read_b32 v25, a73
    v_mul_f32 v25, v25, v22
    v_accvgpr_write_b32 a73, v25
    v_accvgpr_read_b32 v26, a74
    v_mul_f32 v26, v26, v22
    v_accvgpr_write_b32 a74, v26
    v_accvgpr_read_b32 v27, a75
    v_mul_f32 v27, v27, v22
    v_accvgpr_write_b32 a75, v27
    v_accvgpr_read_b32 v24, a76
    v_mul_f32 v24, v24, v22
    v_accvgpr_write_b32 a76, v24
    v_accvgpr_read_b32 v25, a77
    v_mul_f32 v25, v25, v22
    v_accvgpr_write_b32 a77, v25
    v_accvgpr_read_b32 v26, a78
    v_mul_f32 v26, v26, v22
    v_accvgpr_write_b32 a78, v26
    v_accvgpr_read_b32 v27, a79
    v_mul_f32 v27, v27, v22
    v_accvgpr_write_b32 a79, v27
    v_accvgpr_read_b32 v24, a80
    v_mul_f32 v24, v24, v22
    v_accvgpr_write_b32 a80, v24
    v_accvgpr_read_b32 v25, a81
    v_mul_f32 v25, v25, v22
    v_accvgpr_write_b32 a81, v25
    v_accvgpr_read_b32 v26, a82
    v_mul_f32 v26, v26, v22
    v_accvgpr_write_b32 a82, v26
    v_accvgpr_read_b32 v27, a83
    v_mul_f32 v27, v27, v22
    v_accvgpr_write_b32 a83, v27
    v_accvgpr_read_b32 v24, a84
    v_mul_f32 v24, v24, v22
    v_accvgpr_write_b32 a84, v24
    v_accvgpr_read_b32 v25, a85
    v_mul_f32 v25, v25, v22
    v_accvgpr_write_b32 a85, v25
    v_accvgpr_read_b32 v26, a86
    v_mul_f32 v26, v26, v22
    v_accvgpr_write_b32 a86, v26
    v_accvgpr_read_b32 v27, a87
    v_mul_f32 v27, v27, v22
    v_accvgpr_write_b32 a87, v27
    v_accvgpr_read_b32 v24, a88
    v_mul_f32 v24, v24, v22
    v_accvgpr_write_b32 a88, v24
    v_accvgpr_read_b32 v25, a89
    v_mul_f32 v25, v25, v22
    v_accvgpr_write_b32 a89, v25
    v_accvgpr_read_b32 v26, a90
    v_mul_f32 v26, v26, v22
    v_accvgpr_write_b32 a90, v26
    v_accvgpr_read_b32 v27, a91
    v_mul_f32 v27, v27, v22
    v_accvgpr_write_b32 a91, v27
    v_accvgpr_read_b32 v24, a92
    v_mul_f32 v24, v24, v22
    v_accvgpr_write_b32 a92, v24
    v_accvgpr_read_b32 v25, a93
    v_mul_f32 v25, v25, v22
    v_accvgpr_write_b32 a93, v25
    v_accvgpr_read_b32 v26, a94
    v_mul_f32 v26, v26, v22
    v_accvgpr_write_b32 a94, v26
    v_accvgpr_read_b32 v27, a95
    v_mul_f32 v27, v27, v22
    v_accvgpr_write_b32 a95, v27
    v_sub_f32 v232, v232, v20
    v_sub_f32 v233, v233, v20
    v_sub_f32 v234, v234, v20
    v_sub_f32 v235, v235, v20
    v_sub_f32 v128, v128, v20
    v_sub_f32 v129, v129, v20
    v_sub_f32 v130, v130, v20
    v_sub_f32 v131, v131, v20
    v_sub_f32 v132, v132, v20
    v_sub_f32 v133, v133, v20
    v_sub_f32 v134, v134, v20
    v_sub_f32 v135, v135, v20
    v_sub_f32 v136, v136, v20
    v_sub_f32 v137, v137, v20
    v_sub_f32 v138, v138, v20
    v_sub_f32 v139, v139, v20
    v_sub_f32 v140, v140, v20
    v_sub_f32 v141, v141, v20
    v_sub_f32 v142, v142, v20
    v_sub_f32 v143, v143, v20
    v_sub_f32 v64, v64, v20
    v_sub_f32 v65, v65, v20
    v_sub_f32 v66, v66, v20
    v_sub_f32 v67, v67, v20
    v_sub_f32 v68, v68, v20
    v_sub_f32 v69, v69, v20
    v_sub_f32 v70, v70, v20
    v_sub_f32 v71, v71, v20
    v_sub_f32 v72, v72, v20
    v_sub_f32 v73, v73, v20
    v_sub_f32 v74, v74, v20
    v_sub_f32 v75, v75, v20
    v_sub_f32 v76, v76, v20
    v_sub_f32 v77, v77, v20
    v_sub_f32 v78, v78, v20
    v_sub_f32 v79, v79, v20
    v_exp_f32 v240, v128
    v_exp_f32 v241, v129
    v_exp_f32 v242, v130
    v_exp_f32 v243, v131
    v_exp_f32 v244, v132
    v_cvt_pk_bf16_f32 v184, v240, v241
    v_exp_f32 v245, v133
    v_exp_f32 v246, v134
    v_cvt_pk_bf16_f32 v185, v242, v243
    v_exp_f32 v247, v135
    v_cvt_pk_bf16_f32 v186, v244, v245
    v_cvt_pk_bf16_f32 v187, v246, v247
    s_nop 1
    v_mfma_f32_16x16x32_bf16 v[248:251], v[208:211], v[184:187], 0
    v_exp_f32 v240, v136
    v_exp_f32 v241, v137
    v_exp_f32 v242, v138
    v_exp_f32 v243, v139
    v_exp_f32 v244, v140
    v_cvt_pk_bf16_f32 v200, v240, v241
    v_exp_f32 v245, v141
    v_exp_f32 v246, v142
    v_cvt_pk_bf16_f32 v201, v242, v243
    v_exp_f32 v247, v143
    v_cvt_pk_bf16_f32 v202, v244, v245
    v_cvt_pk_bf16_f32 v203, v246, v247
    s_nop 1
    v_mfma_f32_16x16x32_bf16 v[248:251], v[208:211], v[200:203], v[248:251]
    v_max3_f32 v20, v144, v145, v146
    v_max3_f32 v20, v20, v147, v148
    v_max3_f32 v20, v20, v149, v150
    v_max3_f32 v20, v20, v151, v152
    v_max3_f32 v20, v20, v153, v154
    v_max3_f32 v20, v20, v155, v156
    v_max3_f32 v20, v20, v157, v158
    v_max_f32 v20, v20, v159
    v_mov_b32 v21, v20
    s_nop 1
    v_permlane32_swap_b32 v20, v21
    v_max_f32 v20, v20, v21
    v_mov_b32 v21, v20
    s_nop 1
    v_permlane16_swap_b32 v20, v21
    v_max_f32 v20, v20, v21
    v_max_f32 v20, 0, v20
    v_exp_f32 v22, -v20
    s_nop 0
    v_mul_f32 v30, v30, v22
    v_accvgpr_read_b32 v24, a96
    v_mul_f32 v24, v24, v22
    v_accvgpr_write_b32 a96, v24
    v_accvgpr_read_b32 v25, a97
    v_mul_f32 v25, v25, v22
    v_accvgpr_write_b32 a97, v25
    v_accvgpr_read_b32 v26, a98
    v_mul_f32 v26, v26, v22
    v_accvgpr_write_b32 a98, v26
    v_accvgpr_read_b32 v27, a99
    v_mul_f32 v27, v27, v22
    v_accvgpr_write_b32 a99, v27
    v_accvgpr_read_b32 v24, a100
    v_mul_f32 v24, v24, v22
    v_accvgpr_write_b32 a100, v24
    v_accvgpr_read_b32 v25, a101
    v_mul_f32 v25, v25, v22
    v_accvgpr_write_b32 a101, v25
    v_accvgpr_read_b32 v26, a102
    v_mul_f32 v26, v26, v22
    v_accvgpr_write_b32 a102, v26
    v_accvgpr_read_b32 v27, a103
    v_mul_f32 v27, v27, v22
    v_accvgpr_write_b32 a103, v27
    v_accvgpr_read_b32 v24, a104
    v_mul_f32 v24, v24, v22
    v_accvgpr_write_b32 a104, v24
    v_accvgpr_read_b32 v25, a105
    v_mul_f32 v25, v25, v22
    v_accvgpr_write_b32 a105, v25
    v_accvgpr_read_b32 v26, a106
    v_mul_f32 v26, v26, v22
    v_accvgpr_write_b32 a106, v26
    v_accvgpr_read_b32 v27, a107
    v_mul_f32 v27, v27, v22
    v_accvgpr_write_b32 a107, v27
    v_accvgpr_read_b32 v24, a108
    v_mul_f32 v24, v24, v22
    v_accvgpr_write_b32 a108, v24
    v_accvgpr_read_b32 v25, a109
    v_mul_f32 v25, v25, v22
    v_accvgpr_write_b32 a109, v25
    v_accvgpr_read_b32 v26, a110
    v_mul_f32 v26, v26, v22
    v_accvgpr_write_b32 a110, v26
    v_accvgpr_read_b32 v27, a111
    v_mul_f32 v27, v27, v22
    v_accvgpr_write_b32 a111, v27
    v_accvgpr_read_b32 v24, a112
    v_mul_f32 v24, v24, v22
    v_accvgpr_write_b32 a112, v24
    v_accvgpr_read_b32 v25, a113
    v_mul_f32 v25, v25, v22
    v_accvgpr_write_b32 a113, v25
    v_accvgpr_read_b32 v26, a114
    v_mul_f32 v26, v26, v22
    v_accvgpr_write_b32 a114, v26
    v_accvgpr_read_b32 v27, a115
    v_mul_f32 v27, v27, v22
    v_accvgpr_write_b32 a115, v27
    v_accvgpr_read_b32 v24, a116
    v_mul_f32 v24, v24, v22
    v_accvgpr_write_b32 a116, v24
    v_accvgpr_read_b32 v25, a117
    v_mul_f32 v25, v25, v22
    v_accvgpr_write_b32 a117, v25
    v_accvgpr_read_b32 v26, a118
    v_mul_f32 v26, v26, v22
    v_accvgpr_write_b32 a118, v26
    v_accvgpr_read_b32 v27, a119
    v_mul_f32 v27, v27, v22
    v_accvgpr_write_b32 a119, v27
    v_accvgpr_read_b32 v24, a120
    v_mul_f32 v24, v24, v22
    v_accvgpr_write_b32 a120, v24
    v_accvgpr_read_b32 v25, a121
    v_mul_f32 v25, v25, v22
    v_accvgpr_write_b32 a121, v25
    v_accvgpr_read_b32 v26, a122
    v_mul_f32 v26, v26, v22
    v_accvgpr_write_b32 a122, v26
    v_accvgpr_read_b32 v27, a123
    v_mul_f32 v27, v27, v22
    v_accvgpr_write_b32 a123, v27
    v_accvgpr_read_b32 v24, a124
    v_mul_f32 v24, v24, v22
    v_accvgpr_write_b32 a124, v24
    v_accvgpr_read_b32 v25, a125
    v_mul_f32 v25, v25, v22
    v_accvgpr_write_b32 a125, v25
    v_accvgpr_read_b32 v26, a126
    v_mul_f32 v26, v26, v22
    v_accvgpr_write_b32 a126, v26
    v_accvgpr_read_b32 v27, a127
    v_mul_f32 v27, v27, v22
    v_accvgpr_write_b32 a127, v27
    v_sub_f32 v236, v236, v20
    v_sub_f32 v237, v237, v20
    v_sub_f32 v238, v238, v20
    v_sub_f32 v239, v239, v20
    v_sub_f32 v144, v144, v20
    v_sub_f32 v145, v145, v20
    v_sub_f32 v146, v146, v20
    v_sub_f32 v147, v147, v20
    v_sub_f32 v148, v148, v20
    v_sub_f32 v149, v149, v20
    v_sub_f32 v150, v150, v20
    v_sub_f32 v151, v151, v20
    v_sub_f32 v152, v152, v20
    v_sub_f32 v153, v153, v20
    v_sub_f32 v154, v154, v20
    v_sub_f32 v155, v155, v20
    v_sub_f32 v156, v156, v20
    v_sub_f32 v157, v157, v20
    v_sub_f32 v158, v158, v20
    v_sub_f32 v159, v159, v20
    v_sub_f32 v80, v80, v20
    v_sub_f32 v81, v81, v20
    v_sub_f32 v82, v82, v20
    v_sub_f32 v83, v83, v20
    v_sub_f32 v84, v84, v20
    v_sub_f32 v85, v85, v20
    v_sub_f32 v86, v86, v20
    v_sub_f32 v87, v87, v20
    v_sub_f32 v88, v88, v20
    v_sub_f32 v89, v89, v20
    v_sub_f32 v90, v90, v20
    v_sub_f32 v91, v91, v20
    v_sub_f32 v92, v92, v20
    v_sub_f32 v93, v93, v20
    v_sub_f32 v94, v94, v20
    v_sub_f32 v95, v95, v20
    v_exp_f32 v240, v144
    v_exp_f32 v241, v145
    v_exp_f32 v242, v146
    v_exp_f32 v243, v147
    v_exp_f32 v244, v148
    v_cvt_pk_bf16_f32 v188, v240, v241
    v_exp_f32 v245, v149
    v_exp_f32 v246, v150
    v_cvt_pk_bf16_f32 v189, v242, v243
    v_exp_f32 v247, v151
    v_cvt_pk_bf16_f32 v190, v244, v245
    v_cvt_pk_bf16_f32 v191, v246, v247
    s_nop 1
    v_mfma_f32_16x16x32_bf16 v[252:255], v[208:211], v[188:191], 0
    v_exp_f32 v240, v152
    v_exp_f32 v241, v153
    v_exp_f32 v242, v154
    v_exp_f32 v243, v155
    v_exp_f32 v244, v156
    v_cvt_pk_bf16_f32 v204, v240, v241
    v_exp_f32 v245, v157
    v_exp_f32 v246, v158
    v_cvt_pk_bf16_f32 v205, v242, v243
    v_exp_f32 v247, v159
    v_cvt_pk_bf16_f32 v206, v244, v245
    v_cvt_pk_bf16_f32 v207, v246, v247
    s_nop 1
    v_mfma_f32_16x16x32_bf16 v[252:255], v[208:211], v[204:207], v[252:255]
    s_nop 7
    s_branch f1_ddo_rare_r
f1_ddo_mask:
    s_nop 7
    v_cmp_lt_i32 s[40:41], v3, 0
    v_cmp_lt_i32 s[42:43], v3, 1
    v_cmp_lt_i32 s[60:61], v3, 2
    v_cmp_lt_i32 s[62:63], v3, 3
    v_cndmask_b32 v32, v32, v5, s[40:41]
    v_cndmask_b32 v33, v33, v5, s[42:43]
    v_cndmask_b32 v34, v34, v5, s[60:61]
    v_cndmask_b32 v35, v35, v5, s[62:63]
    v_cmp_lt_i32 s[40:41], v3, 16
    v_cmp_lt_i32 s[42:43], v3, 17
    v_cmp_lt_i32 s[60:61], v3, 18
    v_cmp_lt_i32 s[62:63], v3, 19
    v_cndmask_b32 v36, v36, v5, s[40:41]
    v_cndmask_b32 v37, v37, v5, s[42:43]
    v_cndmask_b32 v38, v38, v5, s[60:61]
    v_cndmask_b32 v39, v39, v5, s[62:63]
    v_cmp_lt_i32 s[40:41], v3, 32
    v_cmp_lt_i32 s[42:43], v3, 33
    v_cmp_lt_i32 s[60:61], v3, 34
    v_cmp_lt_i32 s[62:63], v3, 35
    v_cndmask_b32 v40, v40, v5, s[40:41]
    v_cndmask_b32 v41, v41, v5, s[42:43]
    v_cndmask_b32 v42, v42, v5, s[60:61]
    v_cndmask_b32 v43, v43, v5, s[62:63]
    v_cmp_lt_i32 s[40:41], v3, 48
    v_cmp_lt_i32 s[42:43], v3, 49
    v_cmp_lt_i32 s[60:61], v3, 50
    v_cmp_lt_i32 s[62:63], v3, 51
    v_cndmask_b32 v44, v44, v5, s[40:41]
    v_cndmask_b32 v45, v45, v5, s[42:43]
    v_cndmask_b32 v46, v46, v5, s[60:61]
    v_cndmask_b32 v47, v47, v5, s[62:63]
    s_branch f1_ddo_mask_r
f1_dso_rare:
    s_nop 7
    v_max3_f32 v20, v112, v113, v114
    v_max3_f32 v20, v20, v115, v116
    v_max3_f32 v20, v20, v117, v118
    v_max3_f32 v20, v20, v119, v120
    v_max3_f32 v20, v20, v121, v122
    v_max3_f32 v20, v20, v123, v124
    v_max3_f32 v20, v20, v125, v126
    v_max_f32 v20, v20, v127
    v_mov_b32 v21, v20
    s_nop 1
    v_permlane32_swap_b32 v20, v21
    v_max_f32 v20, v20, v21
    v_mov_b32 v21, v20
    s_nop 1
    v_permlane16_swap_b32 v20, v21
    v_max_f32 v20, v20, v21
    v_max_f32 v20, 0, v20
    v_exp_f32 v22, -v20
    s_nop 0
    v_mul_f32 v14, v14, v22
    v_accvgpr_read_b32 v24, a32
    v_mul_f32 v24, v24, v22
    v_accvgpr_write_b32 a32, v24
    v_accvgpr_read_b32 v25, a33
    v_mul_f32 v25, v25, v22
    v_accvgpr_write_b32 a33, v25
    v_accvgpr_read_b32 v26, a34
    v_mul_f32 v26, v26, v22
    v_accvgpr_write_b32 a34, v26
    v_accvgpr_read_b32 v27, a35
    v_mul_f32 v27, v27, v22
    v_accvgpr_write_b32 a35, v27
    v_accvgpr_read_b32 v24, a36
    v_mul_f32 v24, v24, v22
    v_accvgpr_write_b32 a36, v24
    v_accvgpr_read_b32 v25, a37
    v_mul_f32 v25, v25, v22
    v_accvgpr_write_b32 a37, v25
    v_accvgpr_read_b32 v26, a38
    v_mul_f32 v26, v26, v22
    v_accvgpr_write_b32 a38, v26
    v_accvgpr_read_b32 v27, a39
    v_mul_f32 v27, v27, v22
    v_accvgpr_write_b32 a39, v27
    v_accvgpr_read_b32 v24, a40
    v_mul_f32 v24, v24, v22
    v_accvgpr_write_b32 a40, v24
    v_accvgpr_read_b32 v25, a41
    v_mul_f32 v25, v25, v22
    v_accvgpr_write_b32 a41, v25
    v_accvgpr_read_b32 v26, a42
    v_mul_f32 v26, v26, v22
    v_accvgpr_write_b32 a42, v26
    v_accvgpr_read_b32 v27, a43
    v_mul_f32 v27, v27, v22
    v_accvgpr_write_b32 a43, v27
    v_accvgpr_read_b32 v24, a44
    v_mul_f32 v24, v24, v22
    v_accvgpr_write_b32 a44, v24
    v_accvgpr_read_b32 v25, a45
    v_mul_f32 v25, v25, v22
    v_accvgpr_write_b32 a45, v25
    v_accvgpr_read_b32 v26, a46
    v_mul_f32 v26, v26, v22
    v_accvgpr_write_b32 a46, v26
    v_accvgpr_read_b32 v27, a47
    v_mul_f32 v27, v27, v22
    v_accvgpr_write_b32 a47, v27
    v_accvgpr_read_b32 v24, a48
    v_mul_f32 v24, v24, v22
    v_accvgpr_write_b32 a48, v24
    v_accvgpr_read_b32 v25, a49
    v_mul_f32 v25, v25, v22
    v_accvgpr_write_b32 a49, v25
    v_accvgpr_read_b32 v26, a50
    v_mul_f32 v26, v26, v22
    v_accvgpr_write_b32 a50, v26
    v_accvgpr_read_b32 v27, a51
    v_mul_f32 v27, v27, v22
    v_accvgpr_write_b32 a51, v27
    v_accvgpr_read_b32 v24, a52
    v_mul_f32 v24, v24, v22
    v_accvgpr_write_b32 a52, v24
    v_accvgpr_read_b32 v25, a53
    v_mul_f32 v25, v25, v22
    v_accvgpr_write_b32 a53, v25
    v_accvgpr_read_b32 v26, a54
    v_mul_f32 v26, v26, v22
    v_accvgpr_write_b32 a54, v26
    v_accvgpr_read_b32 v27, a55
    v_mul_f32 v27, v27, v22
    v_accvgpr_write_b32 a55, v27
    v_accvgpr_read_b32 v24, a56
    v_mul_f32 v24, v24, v22
    v_accvgpr_write_b32 a56, v24
    v_accvgpr_read_b32 v25, a57
    v_mul_f32 v25, v25, v22
    v_accvgpr_write_b32 a57, v25
    v_accvgpr_read_b32 v26, a58
    v_mul_f32 v26, v26, v22
    v_accvgpr_write_b32 a58, v26
    v_accvgpr_read_b32 v27, a59
    v_mul_f32 v27, v27, v22
    v_accvgpr_write_b32 a59, v27
    v_accvgpr_read_b32 v24, a60
    v_mul_f32 v24, v24, v22
    v_accvgpr_write_b32 a60, v24
    v_accvgpr_read_b32 v25, a61
    v_mul_f32 v25, v25, v22
    v_accvgpr_write_b32 a61, v25
    v_accvgpr_read_b32 v26, a62
    v_mul_f32 v26, v26, v22
    v_accvgpr_write_b32 a62, v26
    v_accvgpr_read_b32 v27, a63
    v_mul_f32 v27, v27, v22
    v_accvgpr_write_b32 a63, v27
    v_sub_f32 v228, v228, v20
    v_sub_f32 v229, v229, v20
    v_sub_f32 v230, v230, v20
    v_sub_f32 v231, v231, v20
    v_sub_f32 v112, v112, v20
    v_sub_f32 v113, v113, v20
    v_sub_f32 v114, v114, v20
    v_sub_f32 v115, v115, v20
    v_sub_f32 v116, v116, v20
    v_sub_f32 v117, v117, v20
    v_sub_f32 v118, v118, v20
    v_sub_f32 v119, v119, v20
    v_sub_f32 v120, v120, v20
    v_sub_f32 v121, v121, v20
    v_sub_f32 v122, v122, v20
    v_sub_f32 v123, v123, v20
    v_sub_f32 v124, v124, v20
    v_sub_f32 v125, v125, v20
    v_sub_f32 v126, v126, v20
    v_sub_f32 v127, v127, v20
    v_exp_f32 v240, v112
    v_exp_f32 v241, v113
    v_exp_f32 v242, v114
    v_exp_f32 v243, v115
    v_exp_f32 v244, v116
    v_cvt_pk_bf16_f32 v180, v240, v241
    v_exp_f32 v245, v117
    v_exp_f32 v246, v118
    v_cvt_pk_bf16_f32 v181, v242, v243
    v_exp_f32 v247, v119
    v_cvt_pk_bf16_f32 v182, v244, v245
    v_cvt_pk_bf16_f32 v183, v246, v247
    s_nop 1
    v_mfma_f32_16x16x32_bf16 v[216:219], v[208:211], v[180:183], 0
    v_exp_f32 v240, v120
    v_exp_f32 v241, v121
    v_exp_f32 v242, v122
    v_exp_f32 v243, v123
    v_exp_f32 v244, v124
    v_cvt_pk_bf16_f32 v196, v240, v241
    v_exp_f32 v245, v125
    v_exp_f32 v246, v126
    v_cvt_pk_bf16_f32 v197, v242, v243
    v_exp_f32 v247, v127
    v_cvt_pk_bf16_f32 v198, v244, v245
    v_cvt_pk_bf16_f32 v199, v246, v247
    s_nop 1
    v_mfma_f32_16x16x32_bf16 v[216:219], v[208:211], v[196:199], v[216:219]
    v_max3_f32 v20, v128, v129, v130
    v_max3_f32 v20, v20, v131, v132
    v_max3_f32 v20, v20, v133, v134
    v_max3_f32 v20, v20, v135, v136
    v_max3_f32 v20, v20, v137, v138
    v_max3_f32 v20, v20, v139, v140
    v_max3_f32 v20, v20, v141, v142
    v_max_f32 v20, v20, v143
    v_mov_b32 v21, v20
    s_nop 1
    v_permlane32_swap_b32 v20, v21
    v_max_f32 v20, v20, v21
    v_mov_b32 v21, v20
    s_nop 1
    v_permlane16_swap_b32 v20, v21
    v_max_f32 v20, v20, v21
    v_max_f32 v20, 0, v20
    v_exp_f32 v22, -v20
    s_nop 0
    v_mul_f32 v15, v15, v22
    v_accvgpr_read_b32 v24, a64
    v_mul_f32 v24, v24, v22
    v_accvgpr_write_b32 a64, v24
    v_accvgpr_read_b32 v25, a65
    v_mul_f32 v25, v25, v22
    v_accvgpr_write_b32 a65, v25
    v_accvgpr_read_b32 v26, a66
    v_mul_f32 v26, v26, v22
    v_accvgpr_write_b32 a66, v26
    v_accvgpr_read_b32 v27, a67
    v_mul_f32 v27, v27, v22
    v_accvgpr_write_b32 a67, v27
    v_accvgpr_read_b32 v24, a68
    v_mul_f32 v24, v24, v22
    v_accvgpr_write_b32 a68, v24
    v_accvgpr_read_b32 v25, a69
    v_mul_f32 v25, v25, v22
    v_accvgpr_write_b32 a69, v25
    v_accvgpr_read_b32 v26, a70
    v_mul_f32 v26, v26, v22
    v_accvgpr_write_b32 a70, v26
    v_accvgpr_read_b32 v27, a71
    v_mul_f32 v27, v27, v22
    v_accvgpr_write_b32 a71, v27
    v_accvgpr_read_b32 v24, a72
    v_mul_f32 v24, v24, v22
    v_accvgpr_write_b32 a72, v24
    v_accvgpr_read_b32 v25, a73
    v_mul_f32 v25, v25, v22
    v_accvgpr_write_b32 a73, v25
    v_accvgpr_read_b32 v26, a74
    v_mul_f32 v26, v26, v22
    v_accvgpr_write_b32 a74, v26
    v_accvgpr_read_b32 v27, a75
    v_mul_f32 v27, v27, v22
    v_accvgpr_write_b32 a75, v27
    v_accvgpr_read_b32 v24, a76
    v_mul_f32 v24, v24, v22
    v_accvgpr_write_b32 a76, v24
    v_accvgpr_read_b32 v25, a77
    v_mul_f32 v25, v25, v22
    v_accvgpr_write_b32 a77, v25
    v_accvgpr_read_b32 v26, a78
    v_mul_f32 v26, v26, v22
    v_accvgpr_write_b32 a78, v26
    v_accvgpr_read_b32 v27, a79
    v_mul_f32 v27, v27, v22
    v_accvgpr_write_b32 a79, v27
    v_accvgpr_read_b32 v24, a80
    v_mul_f32 v24, v24, v22
    v_accvgpr_write_b32 a80, v24
    v_accvgpr_read_b32 v25, a81
    v_mul_f32 v25, v25, v22
    v_accvgpr_write_b32 a81, v25
    v_accvgpr_read_b32 v26, a82
    v_mul_f32 v26, v26, v22
    v_accvgpr_write_b32 a82, v26
    v_accvgpr_read_b32 v27, a83
    v_mul_f32 v27, v27, v22
    v_accvgpr_write_b32 a83, v27
    v_accvgpr_read_b32 v24, a84
    v_mul_f32 v24, v24, v22
    v_accvgpr_write_b32 a84, v24
    v_accvgpr_read_b32 v25, a85
    v_mul_f32 v25, v25, v22
    v_accvgpr_write_b32 a85, v25
    v_accvgpr_read_b32 v26, a86
    v_mul_f32 v26, v26, v22
    v_accvgpr_write_b32 a86, v26
    v_accvgpr_read_b32 v27, a87
    v_mul_f32 v27, v27, v22
    v_accvgpr_write_b32 a87, v27
    v_accvgpr_read_b32 v24, a88
    v_mul_f32 v24, v24, v22
    v_accvgpr_write_b32 a88, v24
    v_accvgpr_read_b32 v25, a89
    v_mul_f32 v25, v25, v22
    v_accvgpr_write_b32 a89, v25
    v_accvgpr_read_b32 v26, a90
    v_mul_f32 v26, v26, v22
    v_accvgpr_write_b32 a90, v26
    v_accvgpr_read_b32 v27, a91
    v_mul_f32 v27, v27, v22
    v_accvgpr_write_b32 a91, v27
    v_accvgpr_read_b32 v24, a92
    v_mul_f32 v24, v24, v22
    v_accvgpr_write_b32 a92, v24
    v_accvgpr_read_b32 v25, a93
    v_mul_f32 v25, v25, v22
    v_accvgpr_write_b32 a93, v25
    v_accvgpr_read_b32 v26, a94
    v_mul_f32 v26, v26, v22
    v_accvgpr_write_b32 a94, v26
    v_accvgpr_read_b32 v27, a95
    v_mul_f32 v27, v27, v22
    v_accvgpr_write_b32 a95, v27
    v_sub_f32 v232, v232, v20
    v_sub_f32 v233, v233, v20
    v_sub_f32 v234, v234, v20
    v_sub_f32 v235, v235, v20
    v_sub_f32 v128, v128, v20
    v_sub_f32 v129, v129, v20
    v_sub_f32 v130, v130, v20
    v_sub_f32 v131, v131, v20
    v_sub_f32 v132, v132, v20
    v_sub_f32 v133, v133, v20
    v_sub_f32 v134, v134, v20
    v_sub_f32 v135, v135, v20
    v_sub_f32 v136, v136, v20
    v_sub_f32 v137, v137, v20
    v_sub_f32 v138, v138, v20
    v_sub_f32 v139, v139, v20
    v_sub_f32 v140, v140, v20
    v_sub_f32 v141, v141, v20
    v_sub_f32 v142, v142, v20
    v_sub_f32 v143, v143, v20
    v_sub_f32 v64, v64, v20
    v_sub_f32 v65, v65, v20
    v_sub_f32 v66, v66, v20
    v_sub_f32 v67, v67, v20
    v_sub_f32 v68, v68, v20
    v_sub_f32 v69, v69, v20
    v_sub_f32 v70, v70, v20
    v_sub_f32 v71, v71, v20
    v_sub_f32 v72, v72, v20
    v_sub_f32 v73, v73, v20
    v_sub_f32 v74, v74, v20
    v_sub_f32 v75, v75, v20
    v_sub_f32 v76, v76, v20
    v_sub_f32 v77, v77, v20
    v_sub_f32 v78, v78, v20
    v_sub_f32 v79, v79, v20
    v_exp_f32 v240, v128
    v_exp_f32 v241, v129
    v_exp_f32 v242, v130
    v_exp_f32 v243, v131
    v_exp_f32 v244, v132
    v_cvt_pk_bf16_f32 v184, v240, v241
    v_exp_f32 v245, v133
    v_exp_f32 v246, v134
    v_cvt_pk_bf16_f32 v185, v242, v243
    v_exp_f32 v247, v135
    v_cvt_pk_bf16_f32 v186, v244, v245
    v_cvt_pk_bf16_f32 v187, v246, v247
    s_nop 1
    v_mfma_f32_16x16x32_bf16 v[248:251], v[208:211], v[184:187], 0
    v_exp_f32 v240, v136
    v_exp_f32 v241, v137
    v_exp_f32 v242, v138
    v_exp_f32 v243, v139
    v_exp_f32 v244, v140
    v_cvt_pk_bf16_f32 v200, v240, v241
    v_exp_f32 v245, v141
    v_exp_f32 v246, v142
    v_cvt_pk_bf16_f32 v201, v242, v243
    v_exp_f32 v247, v143
    v_cvt_pk_bf16_f32 v202, v244, v245
    v_cvt_pk_bf16_f32 v203, v246, v247
    s_nop 1
    v_mfma_f32_16x16x32_bf16 v[248:251], v[208:211], v[200:203], v[248:251]
    v_max3_f32 v20, v144, v145, v146
    v_max3_f32 v20, v20, v147, v148
    v_max3_f32 v20, v20, v149, v150
    v_max3_f32 v20, v20, v151, v152
    v_max3_f32 v20, v20, v153, v154
    v_max3_f32 v20, v20, v155, v156
    v_max3_f32 v20, v20, v157, v158
    v_max_f32 v20, v20, v159
    v_mov_b32 v21, v20
    s_nop 1
    v_permlane32_swap_b32 v20, v21
    v_max_f32 v20, v20, v21
    v_mov_b32 v21, v20
    s_nop 1
    v_permlane16_swap_b32 v20, v21
    v_max_f32 v20, v20, v21
    v_max_f32 v20, 0, v20
    v_exp_f32 v22, -v20
    s_nop 0
    v_mul_f32 v30, v30, v22
    v_accvgpr_read_b32 v24, a96
    v_mul_f32 v24, v24, v22
    v_accvgpr_write_b32 a96, v24
    v_accvgpr_read_b32 v25, a97
    v_mul_f32 v25, v25, v22
    v_accvgpr_write_b32 a97, v25
    v_accvgpr_read_b32 v26, a98
    v_mul_f32 v26, v26, v22
    v_accvgpr_write_b32 a98, v26
    v_accvgpr_read_b32 v27, a99
    v_mul_f32 v27, v27, v22
    v_accvgpr_write_b32 a99, v27
    v_accvgpr_read_b32 v24, a100
    v_mul_f32 v24, v24, v22
    v_accvgpr_write_b32 a100, v24
    v_accvgpr_read_b32 v25, a101
    v_mul_f32 v25, v25, v22
    v_accvgpr_write_b32 a101, v25
    v_accvgpr_read_b32 v26, a102
    v_mul_f32 v26, v26, v22
    v_accvgpr_write_b32 a102, v26
    v_accvgpr_read_b32 v27, a103
    v_mul_f32 v27, v27, v22
    v_accvgpr_write_b32 a103, v27
    v_accvgpr_read_b32 v24, a104
    v_mul_f32 v24, v24, v22
    v_accvgpr_write_b32 a104, v24
    v_accvgpr_read_b32 v25, a105
    v_mul_f32 v25, v25, v22
    v_accvgpr_write_b32 a105, v25
    v_accvgpr_read_b32 v26, a106
    v_mul_f32 v26, v26, v22
    v_accvgpr_write_b32 a106, v26
    v_accvgpr_read_b32 v27, a107
    v_mul_f32 v27, v27, v22
    v_accvgpr_write_b32 a107, v27
    v_accvgpr_read_b32 v24, a108
    v_mul_f32 v24, v24, v22
    v_accvgpr_write_b32 a108, v24
    v_accvgpr_read_b32 v25, a109
    v_mul_f32 v25, v25, v22
    v_accvgpr_write_b32 a109, v25
    v_accvgpr_read_b32 v26, a110
    v_mul_f32 v26, v26, v22
    v_accvgpr_write_b32 a110, v26
    v_accvgpr_read_b32 v27, a111
    v_mul_f32 v27, v27, v22
    v_accvgpr_write_b32 a111, v27
    v_accvgpr_read_b32 v24, a112
    v_mul_f32 v24, v24, v22
    v_accvgpr_write_b32 a112, v24
    v_accvgpr_read_b32 v25, a113
    v_mul_f32 v25, v25, v22
    v_accvgpr_write_b32 a113, v25
    v_accvgpr_read_b32 v26, a114
    v_mul_f32 v26, v26, v22
    v_accvgpr_write_b32 a114, v26
    v_accvgpr_read_b32 v27, a115
    v_mul_f32 v27, v27, v22
    v_accvgpr_write_b32 a115, v27
    v_accvgpr_read_b32 v24, a116
    v_mul_f32 v24, v24, v22
    v_accvgpr_write_b32 a116, v24
    v_accvgpr_read_b32 v25, a117
    v_mul_f32 v25, v25, v22
    v_accvgpr_write_b32 a117, v25
    v_accvgpr_read_b32 v26, a118
    v_mul_f32 v26, v26, v22
    v_accvgpr_write_b32 a118, v26
    v_accvgpr_read_b32 v27, a119
    v_mul_f32 v27, v27, v22
    v_accvgpr_write_b32 a119, v27
    v_accvgpr_read_b32 v24, a120
    v_mul_f32 v24, v24, v22
    v_accvgpr_write_b32 a120, v24
    v_accvgpr_read_b32 v25, a121
    v_mul_f32 v25, v25, v22
    v_accvgpr_write_b32 a121, v25
    v_accvgpr_read_b32 v26, a122
    v_mul_f32 v26, v26, v22
    v_accvgpr_write_b32 a122, v26
    v_accvgpr_read_b32 v27, a123
    v_mul_f32 v27, v27, v22
    v_accvgpr_write_b32 a123, v27
    v_accvgpr_read_b32 v24, a124
    v_mul_f32 v24, v24, v22
    v_accvgpr_write_b32 a124, v24
    v_accvgpr_read_b32 v25, a125
    v_mul_f32 v25, v25, v22
    v_accvgpr_write_b32 a125, v25
    v_accvgpr_read_b32 v26, a126
    v_mul_f32 v26, v26, v22
    v_accvgpr_write_b32 a126, v26
    v_accvgpr_read_b32 v27, a127
    v_mul_f32 v27, v27, v22
    v_accvgpr_write_b32 a127, v27
    v_sub_f32 v236, v236, v20
    v_sub_f32 v237, v237, v20
    v_sub_f32 v238, v238, v20
    v_sub_f32 v239, v239, v20
    v_sub_f32 v144, v144, v20
    v_sub_f32 v145, v145, v20
    v_sub_f32 v146, v146, v20
    v_sub_f32 v147, v147, v20
    v_sub_f32 v148, v148, v20
    v_sub_f32 v149, v149, v20
    v_sub_f32 v150, v150, v20
    v_sub_f32 v151, v151, v20
    v_sub_f32 v152, v152, v20
    v_sub_f32 v153, v153, v20
    v_sub_f32 v154, v154, v20
    v_sub_f32 v155, v155, v20
    v_sub_f32 v156, v156, v20
    v_sub_f32 v157, v157, v20
    v_sub_f32 v158, v158, v20
    v_sub_f32 v159, v159, v20
    v_sub_f32 v80, v80, v20
    v_sub_f32 v81, v81, v20
    v_sub_f32 v82, v82, v20
    v_sub_f32 v83, v83, v20
    v_sub_f32 v84, v84, v20
    v_sub_f32 v85, v85, v20
    v_sub_f32 v86, v86, v20
    v_sub_f32 v87, v87, v20
    v_sub_f32 v88, v88, v20
    v_sub_f32 v89, v89, v20
    v_sub_f32 v90, v90, v20
    v_sub_f32 v91, v91, v20
    v_sub_f32 v92, v92, v20
    v_sub_f32 v93, v93, v20
    v_sub_f32 v94, v94, v20
    v_sub_f32 v95, v95, v20
    v_exp_f32 v240, v144
    v_exp_f32 v241, v145
    v_exp_f32 v242, v146
    v_exp_f32 v243, v147
    v_exp_f32 v244, v148
    v_cvt_pk_bf16_f32 v188, v240, v241
    v_exp_f32 v245, v149
    v_exp_f32 v246, v150
    v_cvt_pk_bf16_f32 v189, v242, v243
    v_exp_f32 v247, v151
    v_cvt_pk_bf16_f32 v190, v244, v245
    v_cvt_pk_bf16_f32 v191, v246, v247
    s_nop 1
    v_mfma_f32_16x16x32_bf16 v[252:255], v[208:211], v[188:191], 0
    v_exp_f32 v240, v152
    v_exp_f32 v241, v153
    v_exp_f32 v242, v154
    v_exp_f32 v243, v155
    v_exp_f32 v244, v156
    v_cvt_pk_bf16_f32 v204, v240, v241
    v_exp_f32 v245, v157
    v_exp_f32 v246, v158
    v_cvt_pk_bf16_f32 v205, v242, v243
    v_exp_f32 v247, v159
    v_cvt_pk_bf16_f32 v206, v244, v245
    v_cvt_pk_bf16_f32 v207, v246, v247
    s_nop 1
    v_mfma_f32_16x16x32_bf16 v[252:255], v[208:211], v[204:207], v[252:255]
    s_nop 7
    s_branch f1_dso_rare_r
f1_dso_mask:
    s_nop 7
    v_cmp_lt_i32 s[40:41], v3, 0
    v_cmp_lt_i32 s[42:43], v3, 1
    v_cmp_lt_i32 s[60:61], v3, 2
    v_cmp_lt_i32 s[62:63], v3, 3
    v_cndmask_b32 v64, v64, v5, s[40:41]
    v_cndmask_b32 v65, v65, v5, s[42:43]
    v_cndmask_b32 v66, v66, v5, s[60:61]
    v_cndmask_b32 v67, v67, v5, s[62:63]
    v_cmp_lt_i32 s[40:41], v3, 16
    v_cmp_lt_i32 s[42:43], v3, 17
    v_cmp_lt_i32 s[60:61], v3, 18
    v_cmp_lt_i32 s[62:63], v3, 19
    v_cndmask_b32 v68, v68, v5, s[40:41]
    v_cndmask_b32 v69, v69, v5, s[42:43]
    v_cndmask_b32 v70, v70, v5, s[60:61]
    v_cndmask_b32 v71, v71, v5, s[62:63]
    v_cmp_lt_i32 s[40:41], v3, 32
    v_cmp_lt_i32 s[42:43], v3, 33
    v_cmp_lt_i32 s[60:61], v3, 34
    v_cmp_lt_i32 s[62:63], v3, 35
    v_cndmask_b32 v72, v72, v5, s[40:41]
    v_cndmask_b32 v73, v73, v5, s[42:43]
    v_cndmask_b32 v74, v74, v5, s[60:61]
    v_cndmask_b32 v75, v75, v5, s[62:63]
    v_cmp_lt_i32 s[40:41], v3, 48
    v_cmp_lt_i32 s[42:43], v3, 49
    v_cmp_lt_i32 s[60:61], v3, 50
    v_cmp_lt_i32 s[62:63], v3, 51
    v_cndmask_b32 v76, v76, v5, s[40:41]
    v_cndmask_b32 v77, v77, v5, s[42:43]
    v_cndmask_b32 v78, v78, v5, s[60:61]
    v_cndmask_b32 v79, v79, v5, s[62:63]
    s_branch f1_dso_mask_r
f1_sse_rare:
    s_nop 7
    v_max3_f32 v20, v64, v65, v66
    v_max3_f32 v20, v20, v67, v68
    v_max3_f32 v20, v20, v69, v70
    v_max3_f32 v20, v20, v71, v72
    v_max3_f32 v20, v20, v73, v74
    v_max3_f32 v20, v20, v75, v76
    v_max3_f32 v20, v20, v77, v78
    v_max_f32 v20, v20, v79
    v_mov_b32 v21, v20
    s_nop 1
    v_permlane32_swap_b32 v20, v21
    v_max_f32 v20, v20, v21
    v_mov_b32 v21, v20
    s_nop 1
    v_permlane16_swap_b32 v20, v21
    v_max_f32 v20, v20, v21
    v_max_f32 v20, 0, v20
    v_exp_f32 v22, -v20
    s_nop 0
    v_mul_f32 v15, v15, v22
    v_accvgpr_read_b32 v24, a64
    v_mul_f32 v24, v24, v22
    v_accvgpr_write_b32 a64, v24
    v_accvgpr_read_b32 v25, a65
    v_mul_f32 v25, v25, v22
    v_accvgpr_write_b32 a65, v25
    v_accvgpr_read_b32 v26, a66
    v_mul_f32 v26, v26, v22
    v_accvgpr_write_b32 a66, v26
    v_accvgpr_read_b32 v27, a67
    v_mul_f32 v27, v27, v22
    v_accvgpr_write_b32 a67, v27
    v_accvgpr_read_b32 v24, a68
    v_mul_f32 v24, v24, v22
    v_accvgpr_write_b32 a68, v24
    v_accvgpr_read_b32 v25, a69
    v_mul_f32 v25, v25, v22
    v_accvgpr_write_b32 a69, v25
    v_accvgpr_read_b32 v26, a70
    v_mul_f32 v26, v26, v22
    v_accvgpr_write_b32 a70, v26
    v_accvgpr_read_b32 v27, a71
    v_mul_f32 v27, v27, v22
    v_accvgpr_write_b32 a71, v27
    v_accvgpr_read_b32 v24, a72
    v_mul_f32 v24, v24, v22
    v_accvgpr_write_b32 a72, v24
    v_accvgpr_read_b32 v25, a73
    v_mul_f32 v25, v25, v22
    v_accvgpr_write_b32 a73, v25
    v_accvgpr_read_b32 v26, a74
    v_mul_f32 v26, v26, v22
    v_accvgpr_write_b32 a74, v26
    v_accvgpr_read_b32 v27, a75
    v_mul_f32 v27, v27, v22
    v_accvgpr_write_b32 a75, v27
    v_accvgpr_read_b32 v24, a76
    v_mul_f32 v24, v24, v22
    v_accvgpr_write_b32 a76, v24
    v_accvgpr_read_b32 v25, a77
    v_mul_f32 v25, v25, v22
    v_accvgpr_write_b32 a77, v25
    v_accvgpr_read_b32 v26, a78
    v_mul_f32 v26, v26, v22
    v_accvgpr_write_b32 a78, v26
    v_accvgpr_read_b32 v27, a79
    v_mul_f32 v27, v27, v22
    v_accvgpr_write_b32 a79, v27
    v_accvgpr_read_b32 v24, a80
    v_mul_f32 v24, v24, v22
    v_accvgpr_write_b32 a80, v24
    v_accvgpr_read_b32 v25, a81
    v_mul_f32 v25, v25, v22
    v_accvgpr_write_b32 a81, v25
    v_accvgpr_read_b32 v26, a82
    v_mul_f32 v26, v26, v22
    v_accvgpr_write_b32 a82, v26
    v_accvgpr_read_b32 v27, a83
    v_mul_f32 v27, v27, v22
    v_accvgpr_write_b32 a83, v27
    v_accvgpr_read_b32 v24, a84
    v_mul_f32 v24, v24, v22
    v_accvgpr_write_b32 a84, v24
    v_accvgpr_read_b32 v25, a85
    v_mul_f32 v25, v25, v22
    v_accvgpr_write_b32 a85, v25
    v_accvgpr_read_b32 v26, a86
    v_mul_f32 v26, v26, v22
    v_accvgpr_write_b32 a86, v26
    v_accvgpr_read_b32 v27, a87
    v_mul_f32 v27, v27, v22
    v_accvgpr_write_b32 a87, v27
    v_accvgpr_read_b32 v24, a88
    v_mul_f32 v24, v24, v22
    v_accvgpr_write_b32 a88, v24
    v_accvgpr_read_b32 v25, a89
    v_mul_f32 v25, v25, v22
    v_accvgpr_write_b32 a89, v25
    v_accvgpr_read_b32 v26, a90
    v_mul_f32 v26, v26, v22
    v_accvgpr_write_b32 a90, v26
    v_accvgpr_read_b32 v27, a91
    v_mul_f32 v27, v27, v22
    v_accvgpr_write_b32 a91, v27
    v_accvgpr_read_b32 v24, a92
    v_mul_f32 v24, v24, v22
    v_accvgpr_write_b32 a92, v24
    v_accvgpr_read_b32 v25, a93
    v_mul_f32 v25, v25, v22
    v_accvgpr_write_b32 a93, v25
    v_accvgpr_read_b32 v26, a94
    v_mul_f32 v26, v26, v22
    v_accvgpr_write_b32 a94, v26
    v_accvgpr_read_b32 v27, a95
    v_mul_f32 v27, v27, v22
    v_accvgpr_write_b32 a95, v27
    v_sub_f32 v232, v232, v20
    v_sub_f32 v233, v233, v20
    v_sub_f32 v234, v234, v20
    v_sub_f32 v235, v235, v20
    v_sub_f32 v64, v64, v20
    v_sub_f32 v65, v65, v20
    v_sub_f32 v66, v66, v20
    v_sub_f32 v67, v67, v20
    v_sub_f32 v68, v68, v20
    v_sub_f32 v69, v69, v20
    v_sub_f32 v70, v70, v20
    v_sub_f32 v71, v71, v20
    v_sub_f32 v72, v72, v20
    v_sub_f32 v73, v73, v20
    v_sub_f32 v74, v74, v20
    v_sub_f32 v75, v75, v20
    v_sub_f32 v76, v76, v20
    v_sub_f32 v77, v77, v20
    v_sub_f32 v78, v78, v20
    v_sub_f32 v79, v79, v20
    v_sub_f32 v128, v128, v20
    v_sub_f32 v129, v129, v20
    v_sub_f32 v130, v130, v20
    v_sub_f32 v131, v131, v20
    v_sub_f32 v132, v132, v20
    v_sub_f32 v133, v133, v20
    v_sub_f32 v134, v134, v20
    v_sub_f32 v135, v135, v20
    v_sub_f32 v136, v136, v20
    v_sub_f32 v137, v137, v20
    v_sub_f32 v138, v138, v20
    v_sub_f32 v139, v139, v20
    v_sub_f32 v140, v140, v20
    v_sub_f32 v141, v141, v20
    v_sub_f32 v142, v142, v20
    v_sub_f32 v143, v143, v20
    v_exp_f32 v240, v64
    v_exp_f32 v241, v65
    v_exp_f32 v242, v66
    v_exp_f32 v243, v67
    v_exp_f32 v244, v68
    v_cvt_pk_bf16_f32 v168, v240, v241
    v_exp_f32 v245, v69
    v_exp_f32 v246, v70
    v_cvt_pk_bf16_f32 v169, v242, v243
    v_exp_f32 v247, v71
    v_cvt_pk_bf16_f32 v170, v244, v245
    v_cvt_pk_bf16_f32 v171, v246, v247
    s_nop 1
    v_mfma_f32_16x16x32_bf16 v[248:251], v[208:211], v[168:171], 0
    v_exp_f32 v240, v72
    v_exp_f32 v241, v73
    v_exp_f32 v242, v74
    v_exp_f32 v243, v75
    v_exp_f32 v244, v76
    v_cvt_pk_bf16_f32 v200, v240, v241
    v_exp_f32 v245, v77
    v_exp_f32 v246, v78
    v_cvt_pk_bf16_f32 v201, v242, v243
    v_exp_f32 v247, v79
    v_cvt_pk_bf16_f32 v202, v244, v245
    v_cvt_pk_bf16_f32 v203, v246, v247
    s_nop 1
    v_mfma_f32_16x16x32_bf16 v[248:251], v[208:211], v[200:203], v[248:251]
    v_max3_f32 v20, v80, v81, v82
    v_max3_f32 v20, v20, v83, v84
    v_max3_f32 v20, v20, v85, v86
    v_max3_f32 v20, v20, v87, v88
    v_max3_f32 v20, v20, v89, v90
    v_max3_f32 v20, v20, v91, v92
    v_max3_f32 v20, v20, v93, v94
    v_max_f32 v20, v20, v95
    v_mov_b32 v21, v20
    s_nop 1
    v_permlane32_swap_b32 v20, v21
    v_max_f32 v20, v20, v21
    v_mov_b32 v21, v20
    s_nop 1
    v_permlane16_swap_b32 v20, v21
    v_max_f32 v20, v20, v21
    v_max_f32 v20, 0, v20
    v_exp_f32 v22, -v20
    s_nop 0
    v_mul_f32 v30, v30, v22
    v_accvgpr_read_b32 v24, a96
    v_mul_f32 v24, v24, v22
    v_accvgpr_write_b32 a96, v24
    v_accvgpr_read_b32 v25, a97
    v_mul_f32 v25, v25, v22
    v_accvgpr_write_b32 a97, v25
    v_accvgpr_read_b32 v26, a98
    v_mul_f32 v26, v26, v22
    v_accvgpr_write_b32 a98, v26
    v_accvgpr_read_b32 v27, a99
    v_mul_f32 v27, v27, v22
    v_accvgpr_write_b32 a99, v27
    v_accvgpr_read_b32 v24, a100
    v_mul_f32 v24, v24, v22
    v_accvgpr_write_b32 a100, v24
    v_accvgpr_read_b32 v25, a101
    v_mul_f32 v25, v25, v22
    v_accvgpr_write_b32 a101, v25
    v_accvgpr_read_b32 v26, a102
    v_mul_f32 v26, v26, v22
    v_accvgpr_write_b32 a102, v26
    v_accvgpr_read_b32 v27, a103
    v_mul_f32 v27, v27, v22
    v_accvgpr_write_b32 a103, v27
    v_accvgpr_read_b32 v24, a104
    v_mul_f32 v24, v24, v22
    v_accvgpr_write_b32 a104, v24
    v_accvgpr_read_b32 v25, a105
    v_mul_f32 v25, v25, v22
    v_accvgpr_write_b32 a105, v25
    v_accvgpr_read_b32 v26, a106
    v_mul_f32 v26, v26, v22
    v_accvgpr_write_b32 a106, v26
    v_accvgpr_read_b32 v27, a107
    v_mul_f32 v27, v27, v22
    v_accvgpr_write_b32 a107, v27
    v_accvgpr_read_b32 v24, a108
    v_mul_f32 v24, v24, v22
    v_accvgpr_write_b32 a108, v24
    v_accvgpr_read_b32 v25, a109
    v_mul_f32 v25, v25, v22
    v_accvgpr_write_b32 a109, v25
    v_accvgpr_read_b32 v26, a110
    v_mul_f32 v26, v26, v22
    v_accvgpr_write_b32 a110, v26
    v_accvgpr_read_b32 v27, a111
    v_mul_f32 v27, v27, v22
    v_accvgpr_write_b32 a111, v27
    v_accvgpr_read_b32 v24, a112
    v_mul_f32 v24, v24, v22
    v_accvgpr_write_b32 a112, v24
    v_accvgpr_read_b32 v25, a113
    v_mul_f32 v25, v25, v22
    v_accvgpr_write_b32 a113, v25
    v_accvgpr_read_b32 v26, a114
    v_mul_f32 v26, v26, v22
    v_accvgpr_write_b32 a114, v26
    v_accvgpr_read_b32 v27, a115
    v_mul_f32 v27, v27, v22
    v_accvgpr_write_b32 a115, v27
    v_accvgpr_read_b32 v24, a116
    v_mul_f32 v24, v24, v22
    v_accvgpr_write_b32 a116, v24
    v_accvgpr_read_b32 v25, a117
    v_mul_f32 v25, v25, v22
    v_accvgpr_write_b32 a117, v25
    v_accvgpr_read_b32 v26, a118
    v_mul_f32 v26, v26, v22
    v_accvgpr_write_b32 a118, v26
    v_accvgpr_read_b32 v27, a119
    v_mul_f32 v27, v27, v22
    v_accvgpr_write_b32 a119, v27
    v_accvgpr_read_b32 v24, a120
    v_mul_f32 v24, v24, v22
    v_accvgpr_write_b32 a120, v24
    v_accvgpr_read_b32 v25, a121
    v_mul_f32 v25, v25, v22
    v_accvgpr_write_b32 a121, v25
    v_accvgpr_read_b32 v26, a122
    v_mul_f32 v26, v26, v22
    v_accvgpr_write_b32 a122, v26
    v_accvgpr_read_b32 v27, a123
    v_mul_f32 v27, v27, v22
    v_accvgpr_write_b32 a123, v27
    v_accvgpr_read_b32 v24, a124
    v_mul_f32 v24, v24, v22
    v_accvgpr_write_b32 a124, v24
    v_accvgpr_read_b32 v25, a125
    v_mul_f32 v25, v25, v22
    v_accvgpr_write_b32 a125, v25
    v_accvgpr_read_b32 v26, a126
    v_mul_f32 v26, v26, v22
    v_accvgpr_write_b32 a126, v26
    v_accvgpr_read_b32 v27, a127
    v_mul_f32 v27, v27, v22
    v_accvgpr_write_b32 a127, v27
    v_sub_f32 v236, v236, v20
    v_sub_f32 v237, v237, v20
    v_sub_f32 v238, v238, v20
    v_sub_f32 v239, v239, v20
    v_sub_f32 v80, v80, v20
    v_sub_f32 v81, v81, v20
    v_sub_f32 v82, v82, v20
    v_sub_f32 v83, v83, v20
    v_sub_f32 v84, v84, v20
    v_sub_f32 v85, v85, v20
    v_sub_f32 v86, v86, v20
    v_sub_f32 v87, v87, v20
    v_sub_f32 v88, v88, v20
    v_sub_f32 v89, v89, v20
    v_sub_f32 v90, v90, v20
    v_sub_f32 v91, v91, v20
    v_sub_f32 v92, v92, v20
    v_sub_f32 v93, v93, v20
    v_sub_f32 v94, v94, v20
    v_sub_f32 v95, v95, v20
    v_sub_f32 v144, v144, v20
    v_sub_f32 v145, v145, v20
    v_sub_f32 v146, v146, v20
    v_sub_f32 v147, v147, v20
    v_sub_f32 v148, v148, v20
    v_sub_f32 v149, v149, v20
    v_sub_f32 v150, v150, v20
    v_sub_f32 v151, v151, v20
    v_sub_f32 v152, v152, v20
    v_sub_f32 v153, v153, v20
    v_sub_f32 v154, v154, v20
    v_sub_f32 v155, v155, v20
    v_sub_f32 v156, v156, v20
    v_sub_f32 v157, v157, v20
    v_sub_f32 v158, v158, v20
    v_sub_f32 v159, v159, v20
    v_exp_f32 v240, v80
    v_exp_f32 v241, v81
    v_exp_f32 v242, v82
    v_exp_f32 v243, v83
    v_exp_f32 v244, v84
    v_cvt_pk_bf16_f32 v172, v240, v241
    v_exp_f32 v245, v85
    v_exp_f32 v246, v86
    v_cvt_pk_bf16_f32 v173, v242, v243
    v_exp_f32 v247, v87
    v_cvt_pk_bf16_f32 v174, v244, v245
    v_cvt_pk_bf16_f32 v175, v246, v247
    s_nop 1
    v_mfma_f32_16x16x32_bf16 v[252:255], v[208:211], v[172:175], 0
    v_exp_f32 v240, v88
    v_exp_f32 v241, v89
    v_exp_f32 v242, v90
    v_exp_f32 v243, v91
    v_exp_f32 v244, v92
    v_cvt_pk_bf16_f32 v204, v240, v241
    v_exp_f32 v245, v93
    v_exp_f32 v246, v94
    v_cvt_pk_bf16_f32 v205, v242, v243
    v_exp_f32 v247, v95
    v_cvt_pk_bf16_f32 v206, v244, v245
    v_cvt_pk_bf16_f32 v207, v246, v247
    s_nop 1
    v_mfma_f32_16x16x32_bf16 v[252:255], v[208:211], v[204:207], v[252:255]
    s_nop 7
    s_branch f1_sse_rare_r
f1_sso_rare:
    s_nop 7
    v_max3_f32 v20, v128, v129, v130
    v_max3_f32 v20, v20, v131, v132
    v_max3_f32 v20, v20, v133, v134
    v_max3_f32 v20, v20, v135, v136
    v_max3_f32 v20, v20, v137, v138
    v_max3_f32 v20, v20, v139, v140
    v_max3_f32 v20, v20, v141, v142
    v_max_f32 v20, v20, v143
    v_mov_b32 v21, v20
    s_nop 1
    v_permlane32_swap_b32 v20, v21
    v_max_f32 v20, v20, v21
    v_mov_b32 v21, v20
    s_nop 1
    v_permlane16_swap_b32 v20, v21
    v_max_f32 v20, v20, v21
    v_max_f32 v20, 0, v20
    v_exp_f32 v22, -v20
    s_nop 0
    v_mul_f32 v15, v15, v22
    v_accvgpr_read_b32 v24, a64
    v_mul_f32 v24, v24, v22
    v_accvgpr_write_b32 a64, v24
    v_accvgpr_read_b32 v25, a65
    v_mul_f32 v25, v25, v22
    v_accvgpr_write_b32 a65, v25
    v_accvgpr_read_b32 v26, a66
    v_mul_f32 v26, v26, v22
    v_accvgpr_write_b32 a66, v26
    v_accvgpr_read_b32 v27, a67
    v_mul_f32 v27, v27, v22
    v_accvgpr_write_b32 a67, v27
    v_accvgpr_read_b32 v24, a68
    v_mul_f32 v24, v24, v22
    v_accvgpr_write_b32 a68, v24
    v_accvgpr_read_b32 v25, a69
    v_mul_f32 v25, v25, v22
    v_accvgpr_write_b32 a69, v25
    v_accvgpr_read_b32 v26, a70
    v_mul_f32 v26, v26, v22
    v_accvgpr_write_b32 a70, v26
    v_accvgpr_read_b32 v27, a71
    v_mul_f32 v27, v27, v22
    v_accvgpr_write_b32 a71, v27
    v_accvgpr_read_b32 v24, a72
    v_mul_f32 v24, v24, v22
    v_accvgpr_write_b32 a72, v24
    v_accvgpr_read_b32 v25, a73
    v_mul_f32 v25, v25, v22
    v_accvgpr_write_b32 a73, v25
    v_accvgpr_read_b32 v26, a74
    v_mul_f32 v26, v26, v22
    v_accvgpr_write_b32 a74, v26
    v_accvgpr_read_b32 v27, a75
    v_mul_f32 v27, v27, v22
    v_accvgpr_write_b32 a75, v27
    v_accvgpr_read_b32 v24, a76
    v_mul_f32 v24, v24, v22
    v_accvgpr_write_b32 a76, v24
    v_accvgpr_read_b32 v25, a77
    v_mul_f32 v25, v25, v22
    v_accvgpr_write_b32 a77, v25
    v_accvgpr_read_b32 v26, a78
    v_mul_f32 v26, v26, v22
    v_accvgpr_write_b32 a78, v26
    v_accvgpr_read_b32 v27, a79
    v_mul_f32 v27, v27, v22
    v_accvgpr_write_b32 a79, v27
    v_accvgpr_read_b32 v24, a80
    v_mul_f32 v24, v24, v22
    v_accvgpr_write_b32 a80, v24
    v_accvgpr_read_b32 v25, a81
    v_mul_f32 v25, v25, v22
    v_accvgpr_write_b32 a81, v25
    v_accvgpr_read_b32 v26, a82
    v_mul_f32 v26, v26, v22
    v_accvgpr_write_b32 a82, v26
    v_accvgpr_read_b32 v27, a83
    v_mul_f32 v27, v27, v22
    v_accvgpr_write_b32 a83, v27
    v_accvgpr_read_b32 v24, a84
    v_mul_f32 v24, v24, v22
    v_accvgpr_write_b32 a84, v24
    v_accvgpr_read_b32 v25, a85
    v_mul_f32 v25, v25, v22
    v_accvgpr_write_b32 a85, v25
    v_accvgpr_read_b32 v26, a86
    v_mul_f32 v26, v26, v22
    v_accvgpr_write_b32 a86, v26
    v_accvgpr_read_b32 v27, a87
    v_mul_f32 v27, v27, v22
    v_accvgpr_write_b32 a87, v27
    v_accvgpr_read_b32 v24, a88
    v_mul_f32 v24, v24, v22
    v_accvgpr_write_b32 a88, v24
    v_accvgpr_read_b32 v25, a89
    v_mul_f32 v25, v25, v22
    v_accvgpr_write_b32 a89, v25
    v_accvgpr_read_b32 v26, a90
    v_mul_f32 v26, v26, v22
    v_accvgpr_write_b32 a90, v26
    v_accvgpr_read_b32 v27, a91
    v_mul_f32 v27, v27, v22
    v_accvgpr_write_b32 a91, v27
    v_accvgpr_read_b32 v24, a92
    v_mul_f32 v24, v24, v22
    v_accvgpr_write_b32 a92, v24
    v_accvgpr_read_b32 v25, a93
    v_mul_f32 v25, v25, v22
    v_accvgpr_write_b32 a93, v25
    v_accvgpr_read_b32 v26, a94
    v_mul_f32 v26, v26, v22
    v_accvgpr_write_b32 a94, v26
    v_accvgpr_read_b32 v27, a95
    v_mul_f32 v27, v27, v22
    v_accvgpr_write_b32 a95, v27
    v_sub_f32 v232, v232, v20
    v_sub_f32 v233, v233, v20
    v_sub_f32 v234, v234, v20
    v_sub_f32 v235, v235, v20
    v_sub_f32 v128, v128, v20
    v_sub_f32 v129, v129, v20
    v_sub_f32 v130, v130, v20
    v_sub_f32 v131, v131, v20
    v_sub_f32 v132, v132, v20
    v_sub_f32 v133, v133, v20
    v_sub_f32 v134, v134, v20
    v_sub_f32 v135, v135, v20
    v_sub_f32 v136, v136, v20
    v_sub_f32 v137, v137, v20
    v_sub_f32 v138, v138, v20
    v_sub_f32 v139, v139, v20
    v_sub_f32 v140, v140, v20
    v_sub_f32 v141, v141, v20
    v_sub_f32 v142, v142, v20
    v_sub_f32 v143, v143, v20
    v_sub_f32 v64, v64, v20
    v_sub_f32 v65, v65, v20
    v_sub_f32 v66, v66, v20
    v_sub_f32 v67, v67, v20
    v_sub_f32 v68, v68, v20
    v_sub_f32 v69, v69, v20
    v_sub_f32 v70, v70, v20
    v_sub_f32 v71, v71, v20
    v_sub_f32 v72, v72, v20
    v_sub_f32 v73, v73, v20
    v_sub_f32 v74, v74, v20
    v_sub_f32 v75, v75, v20
    v_sub_f32 v76, v76, v20
    v_sub_f32 v77, v77, v20
    v_sub_f32 v78, v78, v20
    v_sub_f32 v79, v79, v20
    v_exp_f32 v240, v128
    v_exp_f32 v241, v129
    v_exp_f32 v242, v130
    v_exp_f32 v243, v131
    v_exp_f32 v244, v132
    v_cvt_pk_bf16_f32 v184, v240, v241
    v_exp_f32 v245, v133
    v_exp_f32 v246, v134
    v_cvt_pk_bf16_f32 v185, v242, v243
    v_exp_f32 v247, v135
    v_cvt_pk_bf16_f32 v186, v244, v245
    v_cvt_pk_bf16_f32 v187, v246, v247
    s_nop 1
    v_mfma_f32_16x16x32_bf16 v[248:251], v[208:211], v[184:187], 0
    v_exp_f32 v240, v136
    v_exp_f32 v241, v137
    v_exp_f32 v242, v138
    v_exp_f32 v243, v139
    v_exp_f32 v244, v140
    v_cvt_pk_bf16_f32 v200, v240, v241
    v_exp_f32 v245, v141
    v_exp_f32 v246, v142
    v_cvt_pk_bf16_f32 v201, v242, v243
    v_exp_f32 v247, v143
    v_cvt_pk_bf16_f32 v202, v244, v245
    v_cvt_pk_bf16_f32 v203, v246, v247
    s_nop 1
    v_mfma_f32_16x16x32_bf16 v[248:251], v[208:211], v[200:203], v[248:251]
    v_max3_f32 v20, v144, v145, v146
    v_max3_f32 v20, v20, v147, v148
    v_max3_f32 v20, v20, v149, v150
    v_max3_f32 v20, v20, v151, v152
    v_max3_f32 v20, v20, v153, v154
    v_max3_f32 v20, v20, v155, v156
    v_max3_f32 v20, v20, v157, v158
    v_max_f32 v20, v20, v159
    v_mov_b32 v21, v20
    s_nop 1
    v_permlane32_swap_b32 v20, v21
    v_max_f32 v20, v20, v21
    v_mov_b32 v21, v20
    s_nop 1
    v_permlane16_swap_b32 v20, v21
    v_max_f32 v20, v20, v21
    v_max_f32 v20, 0, v20
    v_exp_f32 v22, -v20
    s_nop 0
    v_mul_f32 v30, v30, v22
    v_accvgpr_read_b32 v24, a96
    v_mul_f32 v24, v24, v22
    v_accvgpr_write_b32 a96, v24
    v_accvgpr_read_b32 v25, a97
    v_mul_f32 v25, v25, v22
    v_accvgpr_write_b32 a97, v25
    v_accvgpr_read_b32 v26, a98
    v_mul_f32 v26, v26, v22
    v_accvgpr_write_b32 a98, v26
    v_accvgpr_read_b32 v27, a99
    v_mul_f32 v27, v27, v22
    v_accvgpr_write_b32 a99, v27
    v_accvgpr_read_b32 v24, a100
    v_mul_f32 v24, v24, v22
    v_accvgpr_write_b32 a100, v24
    v_accvgpr_read_b32 v25, a101
    v_mul_f32 v25, v25, v22
    v_accvgpr_write_b32 a101, v25
    v_accvgpr_read_b32 v26, a102
    v_mul_f32 v26, v26, v22
    v_accvgpr_write_b32 a102, v26
    v_accvgpr_read_b32 v27, a103
    v_mul_f32 v27, v27, v22
    v_accvgpr_write_b32 a103, v27
    v_accvgpr_read_b32 v24, a104
    v_mul_f32 v24, v24, v22
    v_accvgpr_write_b32 a104, v24
    v_accvgpr_read_b32 v25, a105
    v_mul_f32 v25, v25, v22
    v_accvgpr_write_b32 a105, v25
    v_accvgpr_read_b32 v26, a106
    v_mul_f32 v26, v26, v22
    v_accvgpr_write_b32 a106, v26
    v_accvgpr_read_b32 v27, a107
    v_mul_f32 v27, v27, v22
    v_accvgpr_write_b32 a107, v27
    v_accvgpr_read_b32 v24, a108
    v_mul_f32 v24, v24, v22
    v_accvgpr_write_b32 a108, v24
    v_accvgpr_read_b32 v25, a109
    v_mul_f32 v25, v25, v22
    v_accvgpr_write_b32 a109, v25
    v_accvgpr_read_b32 v26, a110
    v_mul_f32 v26, v26, v22
    v_accvgpr_write_b32 a110, v26
    v_accvgpr_read_b32 v27, a111
    v_mul_f32 v27, v27, v22
    v_accvgpr_write_b32 a111, v27
    v_accvgpr_read_b32 v24, a112
    v_mul_f32 v24, v24, v22
    v_accvgpr_write_b32 a112, v24
    v_accvgpr_read_b32 v25, a113
    v_mul_f32 v25, v25, v22
    v_accvgpr_write_b32 a113, v25
    v_accvgpr_read_b32 v26, a114
    v_mul_f32 v26, v26, v22
    v_accvgpr_write_b32 a114, v26
    v_accvgpr_read_b32 v27, a115
    v_mul_f32 v27, v27, v22
    v_accvgpr_write_b32 a115, v27
    v_accvgpr_read_b32 v24, a116
    v_mul_f32 v24, v24, v22
    v_accvgpr_write_b32 a116, v24
    v_accvgpr_read_b32 v25, a117
    v_mul_f32 v25, v25, v22
    v_accvgpr_write_b32 a117, v25
    v_accvgpr_read_b32 v26, a118
    v_mul_f32 v26, v26, v22
    v_accvgpr_write_b32 a118, v26
    v_accvgpr_read_b32 v27, a119
    v_mul_f32 v27, v27, v22
    v_accvgpr_write_b32 a119, v27
    v_accvgpr_read_b32 v24, a120
    v_mul_f32 v24, v24, v22
    v_accvgpr_write_b32 a120, v24
    v_accvgpr_read_b32 v25, a121
    v_mul_f32 v25, v25, v22
    v_accvgpr_write_b32 a121, v25
    v_accvgpr_read_b32 v26, a122
    v_mul_f32 v26, v26, v22
    v_accvgpr_write_b32 a122, v26
    v_accvgpr_read_b32 v27, a123
    v_mul_f32 v27, v27, v22
    v_accvgpr_write_b32 a123, v27
    v_accvgpr_read_b32 v24, a124
    v_mul_f32 v24, v24, v22
    v_accvgpr_write_b32 a124, v24
    v_accvgpr_read_b32 v25, a125
    v_mul_f32 v25, v25, v22
    v_accvgpr_write_b32 a125, v25
    v_accvgpr_read_b32 v26, a126
    v_mul_f32 v26, v26, v22
    v_accvgpr_write_b32 a126, v26
    v_accvgpr_read_b32 v27, a127
    v_mul_f32 v27, v27, v22
    v_accvgpr_write_b32 a127, v27
    v_sub_f32 v236, v236, v20
    v_sub_f32 v237, v237, v20
    v_sub_f32 v238, v238, v20
    v_sub_f32 v239, v239, v20
    v_sub_f32 v144, v144, v20
    v_sub_f32 v145, v145, v20
    v_sub_f32 v146, v146, v20
    v_sub_f32 v147, v147, v20
    v_sub_f32 v148, v148, v20
    v_sub_f32 v149, v149, v20
    v_sub_f32 v150, v150, v20
    v_sub_f32 v151, v151, v20
    v_sub_f32 v152, v152, v20
    v_sub_f32 v153, v153, v20
    v_sub_f32 v154, v154, v20
    v_sub_f32 v155, v155, v20
    v_sub_f32 v156, v156, v20
    v_sub_f32 v157, v157, v20
    v_sub_f32 v158, v158, v20
    v_sub_f32 v159, v159, v20
    v_sub_f32 v80, v80, v20
    v_sub_f32 v81, v81, v20
    v_sub_f32 v82, v82, v20
    v_sub_f32 v83, v83, v20
    v_sub_f32 v84, v84, v20
    v_sub_f32 v85, v85, v20
    v_sub_f32 v86, v86, v20
    v_sub_f32 v87, v87, v20
    v_sub_f32 v88, v88, v20
    v_sub_f32 v89, v89, v20
    v_sub_f32 v90, v90, v20
    v_sub_f32 v91, v91, v20
    v_sub_f32 v92, v92, v20
    v_sub_f32 v93, v93, v20
    v_sub_f32 v94, v94, v20
    v_sub_f32 v95, v95, v20
    v_exp_f32 v240, v144
    v_exp_f32 v241, v145
    v_exp_f32 v242, v146
    v_exp_f32 v243, v147
    v_exp_f32 v244, v148
    v_cvt_pk_bf16_f32 v188, v240, v241
    v_exp_f32 v245, v149
    v_exp_f32 v246, v150
    v_cvt_pk_bf16_f32 v189, v242, v243
    v_exp_f32 v247, v151
    v_cvt_pk_bf16_f32 v190, v244, v245
    v_cvt_pk_bf16_f32 v191, v246, v247
    s_nop 1
    v_mfma_f32_16x16x32_bf16 v[252:255], v[208:211], v[188:191], 0
    v_exp_f32 v240, v152
    v_exp_f32 v241, v153
    v_exp_f32 v242, v154
    v_exp_f32 v243, v155
    v_exp_f32 v244, v156
    v_cvt_pk_bf16_f32 v204, v240, v241
    v_exp_f32 v245, v157
    v_exp_f32 v246, v158
    v_cvt_pk_bf16_f32 v205, v242, v243
    v_exp_f32 v247, v159
    v_cvt_pk_bf16_f32 v206, v244, v245
    v_cvt_pk_bf16_f32 v207, v246, v247
    s_nop 1
    v_mfma_f32_16x16x32_bf16 v[252:255], v[208:211], v[204:207], v[252:255]
    s_nop 7
    s_branch f1_sso_rare_r
f1_ssol_rare:
    s_nop 7
    v_max3_f32 v20, v128, v129, v130
    v_max3_f32 v20, v20, v131, v132
    v_max3_f32 v20, v20, v133, v134
    v_max3_f32 v20, v20, v135, v136
    v_max3_f32 v20, v20, v137, v138
    v_max3_f32 v20, v20, v139, v140
    v_max3_f32 v20, v20, v141, v142
    v_max_f32 v20, v20, v143
    v_mov_b32 v21, v20
    s_nop 1
    v_permlane32_swap_b32 v20, v21
    v_max_f32 v20, v20, v21
    v_mov_b32 v21, v20
    s_nop 1
    v_permlane16_swap_b32 v20, v21
    v_max_f32 v20, v20, v21
    v_max_f32 v20, 0, v20
    v_exp_f32 v22, -v20
    s_nop 0
    v_mul_f32 v15, v15, v22
    v_accvgpr_read_b32 v24, a64
    v_mul_f32 v24, v24, v22
    v_accvgpr_write_b32 a64, v24
    v_accvgpr_read_b32 v25, a65
    v_mul_f32 v25, v25, v22
    v_accvgpr_write_b32 a65, v25
    v_accvgpr_read_b32 v26, a66
    v_mul_f32 v26, v26, v22
    v_accvgpr_write_b32 a66, v26
    v_accvgpr_read_b32 v27, a67
    v_mul_f32 v27, v27, v22
    v_accvgpr_write_b32 a67, v27
    v_accvgpr_read_b32 v24, a68
    v_mul_f32 v24, v24, v22
    v_accvgpr_write_b32 a68, v24
    v_accvgpr_read_b32 v25, a69
    v_mul_f32 v25, v25, v22
    v_accvgpr_write_b32 a69, v25
    v_accvgpr_read_b32 v26, a70
    v_mul_f32 v26, v26, v22
    v_accvgpr_write_b32 a70, v26
    v_accvgpr_read_b32 v27, a71
    v_mul_f32 v27, v27, v22
    v_accvgpr_write_b32 a71, v27
    v_accvgpr_read_b32 v24, a72
    v_mul_f32 v24, v24, v22
    v_accvgpr_write_b32 a72, v24
    v_accvgpr_read_b32 v25, a73
    v_mul_f32 v25, v25, v22
    v_accvgpr_write_b32 a73, v25
    v_accvgpr_read_b32 v26, a74
    v_mul_f32 v26, v26, v22
    v_accvgpr_write_b32 a74, v26
    v_accvgpr_read_b32 v27, a75
    v_mul_f32 v27, v27, v22
    v_accvgpr_write_b32 a75, v27
    v_accvgpr_read_b32 v24, a76
    v_mul_f32 v24, v24, v22
    v_accvgpr_write_b32 a76, v24
    v_accvgpr_read_b32 v25, a77
    v_mul_f32 v25, v25, v22
    v_accvgpr_write_b32 a77, v25
    v_accvgpr_read_b32 v26, a78
    v_mul_f32 v26, v26, v22
    v_accvgpr_write_b32 a78, v26
    v_accvgpr_read_b32 v27, a79
    v_mul_f32 v27, v27, v22
    v_accvgpr_write_b32 a79, v27
    v_accvgpr_read_b32 v24, a80
    v_mul_f32 v24, v24, v22
    v_accvgpr_write_b32 a80, v24
    v_accvgpr_read_b32 v25, a81
    v_mul_f32 v25, v25, v22
    v_accvgpr_write_b32 a81, v25
    v_accvgpr_read_b32 v26, a82
    v_mul_f32 v26, v26, v22
    v_accvgpr_write_b32 a82, v26
    v_accvgpr_read_b32 v27, a83
    v_mul_f32 v27, v27, v22
    v_accvgpr_write_b32 a83, v27
    v_accvgpr_read_b32 v24, a84
    v_mul_f32 v24, v24, v22
    v_accvgpr_write_b32 a84, v24
    v_accvgpr_read_b32 v25, a85
    v_mul_f32 v25, v25, v22
    v_accvgpr_write_b32 a85, v25
    v_accvgpr_read_b32 v26, a86
    v_mul_f32 v26, v26, v22
    v_accvgpr_write_b32 a86, v26
    v_accvgpr_read_b32 v27, a87
    v_mul_f32 v27, v27, v22
    v_accvgpr_write_b32 a87, v27
    v_accvgpr_read_b32 v24, a88
    v_mul_f32 v24, v24, v22
    v_accvgpr_write_b32 a88, v24
    v_accvgpr_read_b32 v25, a89
    v_mul_f32 v25, v25, v22
    v_accvgpr_write_b32 a89, v25
    v_accvgpr_read_b32 v26, a90
    v_mul_f32 v26, v26, v22
    v_accvgpr_write_b32 a90, v26
    v_accvgpr_read_b32 v27, a91
    v_mul_f32 v27, v27, v22
    v_accvgpr_write_b32 a91, v27
    v_accvgpr_read_b32 v24, a92
    v_mul_f32 v24, v24, v22
    v_accvgpr_write_b32 a92, v24
    v_accvgpr_read_b32 v25, a93
    v_mul_f32 v25, v25, v22
    v_accvgpr_write_b32 a93, v25
    v_accvgpr_read_b32 v26, a94
    v_mul_f32 v26, v26, v22
    v_accvgpr_write_b32 a94, v26
    v_accvgpr_read_b32 v27, a95
    v_mul_f32 v27, v27, v22
    v_accvgpr_write_b32 a95, v27
    v_sub_f32 v232, v232, v20
    v_sub_f32 v233, v233, v20
    v_sub_f32 v234, v234, v20
    v_sub_f32 v235, v235, v20
    v_sub_f32 v128, v128, v20
    v_sub_f32 v129, v129, v20
    v_sub_f32 v130, v130, v20
    v_sub_f32 v131, v131, v20
    v_sub_f32 v132, v132, v20
    v_sub_f32 v133, v133, v20
    v_sub_f32 v134, v134, v20
    v_sub_f32 v135, v135, v20
    v_sub_f32 v136, v136, v20
    v_sub_f32 v137, v137, v20
    v_sub_f32 v138, v138, v20
    v_sub_f32 v139, v139, v20
    v_sub_f32 v140, v140, v20
    v_sub_f32 v141, v141, v20
    v_sub_f32 v142, v142, v20
    v_sub_f32 v143, v143, v20
    v_sub_f32 v64, v64, v20
    v_sub_f32 v65, v65, v20
    v_sub_f32 v66, v66, v20
    v_sub_f32 v67, v67, v20
    v_sub_f32 v68, v68, v20
    v_sub_f32 v69, v69, v20
    v_sub_f32 v70, v70, v20
    v_sub_f32 v71, v71, v20
    v_sub_f32 v72, v72, v20
    v_sub_f32 v73, v73, v20
    v_sub_f32 v74, v74, v20
    v_sub_f32 v75, v75, v20
    v_sub_f32 v76, v76, v20
    v_sub_f32 v77, v77, v20
    v_sub_f32 v78, v78, v20
    v_sub_f32 v79, v79, v20
    v_exp_f32 v240, v128
    v_exp_f32 v241, v129
    v_exp_f32 v242, v130
    v_exp_f32 v243, v131
    v_exp_f32 v244, v132
    v_cvt_pk_bf16_f32 v184, v240, v241
    v_exp_f32 v245, v133
    v_exp_f32 v246, v134
    v_cvt_pk_bf16_f32 v185, v242, v243
    v_exp_f32 v247, v135
    v_cvt_pk_bf16_f32 v186, v244, v245
    v_cvt_pk_bf16_f32 v187, v246, v247
    s_nop 1
    v_mfma_f32_16x16x32_bf16 v[248:251], v[208:211], v[184:187], 0
    v_exp_f32 v240, v136
    v_exp_f32 v241, v137
    v_exp_f32 v242, v138
    v_exp_f32 v243, v139
    v_exp_f32 v244, v140
    v_cvt_pk_bf16_f32 v200, v240, v241
    v_exp_f32 v245, v141
    v_exp_f32 v246, v142
    v_cvt_pk_bf16_f32 v201, v242, v243
    v_exp_f32 v247, v143
    v_cvt_pk_bf16_f32 v202, v244, v245
    v_cvt_pk_bf16_f32 v203, v246, v247
    s_nop 1
    v_mfma_f32_16x16x32_bf16 v[248:251], v[208:211], v[200:203], v[248:251]
    v_max3_f32 v20, v144, v145, v146
    v_max3_f32 v20, v20, v147, v148
    v_max3_f32 v20, v20, v149, v150
    v_max3_f32 v20, v20, v151, v152
    v_max3_f32 v20, v20, v153, v154
    v_max3_f32 v20, v20, v155, v156
    v_max3_f32 v20, v20, v157, v158
    v_max_f32 v20, v20, v159
    v_mov_b32 v21, v20
    s_nop 1
    v_permlane32_swap_b32 v20, v21
    v_max_f32 v20, v20, v21
    v_mov_b32 v21, v20
    s_nop 1
    v_permlane16_swap_b32 v20, v21
    v_max_f32 v20, v20, v21
    v_max_f32 v20, 0, v20
    v_exp_f32 v22, -v20
    s_nop 0
    v_mul_f32 v30, v30, v22
    v_accvgpr_read_b32 v24, a96
    v_mul_f32 v24, v24, v22
    v_accvgpr_write_b32 a96, v24
    v_accvgpr_read_b32 v25, a97
    v_mul_f32 v25, v25, v22
    v_accvgpr_write_b32 a97, v25
    v_accvgpr_read_b32 v26, a98
    v_mul_f32 v26, v26, v22
    v_accvgpr_write_b32 a98, v26
    v_accvgpr_read_b32 v27, a99
    v_mul_f32 v27, v27, v22
    v_accvgpr_write_b32 a99, v27
    v_accvgpr_read_b32 v24, a100
    v_mul_f32 v24, v24, v22
    v_accvgpr_write_b32 a100, v24
    v_accvgpr_read_b32 v25, a101
    v_mul_f32 v25, v25, v22
    v_accvgpr_write_b32 a101, v25
    v_accvgpr_read_b32 v26, a102
    v_mul_f32 v26, v26, v22
    v_accvgpr_write_b32 a102, v26
    v_accvgpr_read_b32 v27, a103
    v_mul_f32 v27, v27, v22
    v_accvgpr_write_b32 a103, v27
    v_accvgpr_read_b32 v24, a104
    v_mul_f32 v24, v24, v22
    v_accvgpr_write_b32 a104, v24
    v_accvgpr_read_b32 v25, a105
    v_mul_f32 v25, v25, v22
    v_accvgpr_write_b32 a105, v25
    v_accvgpr_read_b32 v26, a106
    v_mul_f32 v26, v26, v22
    v_accvgpr_write_b32 a106, v26
    v_accvgpr_read_b32 v27, a107
    v_mul_f32 v27, v27, v22
    v_accvgpr_write_b32 a107, v27
    v_accvgpr_read_b32 v24, a108
    v_mul_f32 v24, v24, v22
    v_accvgpr_write_b32 a108, v24
    v_accvgpr_read_b32 v25, a109
    v_mul_f32 v25, v25, v22
    v_accvgpr_write_b32 a109, v25
    v_accvgpr_read_b32 v26, a110
    v_mul_f32 v26, v26, v22
    v_accvgpr_write_b32 a110, v26
    v_accvgpr_read_b32 v27, a111
    v_mul_f32 v27, v27, v22
    v_accvgpr_write_b32 a111, v27
    v_accvgpr_read_b32 v24, a112
    v_mul_f32 v24, v24, v22
    v_accvgpr_write_b32 a112, v24
    v_accvgpr_read_b32 v25, a113
    v_mul_f32 v25, v25, v22
    v_accvgpr_write_b32 a113, v25
    v_accvgpr_read_b32 v26, a114
    v_mul_f32 v26, v26, v22
    v_accvgpr_write_b32 a114, v26
    v_accvgpr_read_b32 v27, a115
    v_mul_f32 v27, v27, v22
    v_accvgpr_write_b32 a115, v27
    v_accvgpr_read_b32 v24, a116
    v_mul_f32 v24, v24, v22
    v_accvgpr_write_b32 a116, v24
    v_accvgpr_read_b32 v25, a117
    v_mul_f32 v25, v25, v22
    v_accvgpr_write_b32 a117, v25
    v_accvgpr_read_b32 v26, a118
    v_mul_f32 v26, v26, v22
    v_accvgpr_write_b32 a118, v26
    v_accvgpr_read_b32 v27, a119
    v_mul_f32 v27, v27, v22
    v_accvgpr_write_b32 a119, v27
    v_accvgpr_read_b32 v24, a120
    v_mul_f32 v24, v24, v22
    v_accvgpr_write_b32 a120, v24
    v_accvgpr_read_b32 v25, a121
    v_mul_f32 v25, v25, v22
    v_accvgpr_write_b32 a121, v25
    v_accvgpr_read_b32 v26, a122
    v_mul_f32 v26, v26, v22
    v_accvgpr_write_b32 a122, v26
    v_accvgpr_read_b32 v27, a123
    v_mul_f32 v27, v27, v22
    v_accvgpr_write_b32 a123, v27
    v_accvgpr_read_b32 v24, a124
    v_mul_f32 v24, v24, v22
    v_accvgpr_write_b32 a124, v24
    v_accvgpr_read_b32 v25, a125
    v_mul_f32 v25, v25, v22
    v_accvgpr_write_b32 a125, v25
    v_accvgpr_read_b32 v26, a126
    v_mul_f32 v26, v26, v22
    v_accvgpr_write_b32 a126, v26
    v_accvgpr_read_b32 v27, a127
    v_mul_f32 v27, v27, v22
    v_accvgpr_write_b32 a127, v27
    v_sub_f32 v236, v236, v20
    v_sub_f32 v237, v237, v20
    v_sub_f32 v238, v238, v20
    v_sub_f32 v239, v239, v20
    v_sub_f32 v144, v144, v20
    v_sub_f32 v145, v145, v20
    v_sub_f32 v146, v146, v20
    v_sub_f32 v147, v147, v20
    v_sub_f32 v148, v148, v20
    v_sub_f32 v149, v149, v20
    v_sub_f32 v150, v150, v20
    v_sub_f32 v151, v151, v20
    v_sub_f32 v152, v152, v20
    v_sub_f32 v153, v153, v20
    v_sub_f32 v154, v154, v20
    v_sub_f32 v155, v155, v20
    v_sub_f32 v156, v156, v20
    v_sub_f32 v157, v157, v20
    v_sub_f32 v158, v158, v20
    v_sub_f32 v159, v159, v20
    v_sub_f32 v80, v80, v20
    v_sub_f32 v81, v81, v20
    v_sub_f32 v82, v82, v20
    v_sub_f32 v83, v83, v20
    v_sub_f32 v84, v84, v20
    v_sub_f32 v85, v85, v20
    v_sub_f32 v86, v86, v20
    v_sub_f32 v87, v87, v20
    v_sub_f32 v88, v88, v20
    v_sub_f32 v89, v89, v20
    v_sub_f32 v90, v90, v20
    v_sub_f32 v91, v91, v20
    v_sub_f32 v92, v92, v20
    v_sub_f32 v93, v93, v20
    v_sub_f32 v94, v94, v20
    v_sub_f32 v95, v95, v20
    v_exp_f32 v240, v144
    v_exp_f32 v241, v145
    v_exp_f32 v242, v146
    v_exp_f32 v243, v147
    v_exp_f32 v244, v148
    v_cvt_pk_bf16_f32 v188, v240, v241
    v_exp_f32 v245, v149
    v_exp_f32 v246, v150
    v_cvt_pk_bf16_f32 v189, v242, v243
    v_exp_f32 v247, v151
    v_cvt_pk_bf16_f32 v190, v244, v245
    v_cvt_pk_bf16_f32 v191, v246, v247
    s_nop 1
    v_mfma_f32_16x16x32_bf16 v[252:255], v[208:211], v[188:191], 0
    v_exp_f32 v240, v152
    v_exp_f32 v241, v153
    v_exp_f32 v242, v154
    v_exp_f32 v243, v155
    v_exp_f32 v244, v156
    v_cvt_pk_bf16_f32 v204, v240, v241
    v_exp_f32 v245, v157
    v_exp_f32 v246, v158
    v_cvt_pk_bf16_f32 v205, v242, v243
    v_exp_f32 v247, v159
    v_cvt_pk_bf16_f32 v206, v244, v245
    v_cvt_pk_bf16_f32 v207, v246, v247
    s_nop 1
    v_mfma_f32_16x16x32_bf16 v[252:255], v[208:211], v[204:207], v[252:255]
    s_nop 7
    s_branch f1_ssol_rare_r
f1_ssol_mask:
    s_nop 7
    v_cmp_lt_i32 s[40:41], v3, 0
    v_cmp_lt_i32 s[42:43], v3, 1
    v_cmp_lt_i32 s[60:61], v3, 2
    v_cmp_lt_i32 s[62:63], v3, 3
    v_cndmask_b32 v64, v64, v5, s[40:41]
    v_cndmask_b32 v65, v65, v5, s[42:43]
    v_cndmask_b32 v66, v66, v5, s[60:61]
    v_cndmask_b32 v67, v67, v5, s[62:63]
    v_cmp_lt_i32 s[40:41], v3, 16
    v_cmp_lt_i32 s[42:43], v3, 17
    v_cmp_lt_i32 s[60:61], v3, 18
    v_cmp_lt_i32 s[62:63], v3, 19
    v_cndmask_b32 v68, v68, v5, s[40:41]
    v_cndmask_b32 v69, v69, v5, s[42:43]
    v_cndmask_b32 v70, v70, v5, s[60:61]
    v_cndmask_b32 v71, v71, v5, s[62:63]
    v_cmp_lt_i32 s[40:41], v3, 32
    v_cmp_lt_i32 s[42:43], v3, 33
    v_cmp_lt_i32 s[60:61], v3, 34
    v_cmp_lt_i32 s[62:63], v3, 35
    v_cndmask_b32 v72, v72, v5, s[40:41]
    v_cndmask_b32 v73, v73, v5, s[42:43]
    v_cndmask_b32 v74, v74, v5, s[60:61]
    v_cndmask_b32 v75, v75, v5, s[62:63]
    v_cmp_lt_i32 s[40:41], v3, 48
    v_cmp_lt_i32 s[42:43], v3, 49
    v_cmp_lt_i32 s[60:61], v3, 50
    v_cmp_lt_i32 s[62:63], v3, 51
    v_cndmask_b32 v76, v76, v5, s[40:41]
    v_cndmask_b32 v77, v77, v5, s[42:43]
    v_cndmask_b32 v78, v78, v5, s[60:61]
    v_cndmask_b32 v79, v79, v5, s[62:63]
    s_branch f1_ssol_mask_r
f1_ssel_rare:
    s_nop 7
    v_max3_f32 v20, v64, v65, v66
    v_max3_f32 v20, v20, v67, v68
    v_max3_f32 v20, v20, v69, v70
    v_max3_f32 v20, v20, v71, v72
    v_max3_f32 v20, v20, v73, v74
    v_max3_f32 v20, v20, v75, v76
    v_max3_f32 v20, v20, v77, v78
    v_max_f32 v20, v20, v79
    v_mov_b32 v21, v20
    s_nop 1
    v_permlane32_swap_b32 v20, v21
    v_max_f32 v20, v20, v21
    v_mov_b32 v21, v20
    s_nop 1
    v_permlane16_swap_b32 v20, v21
    v_max_f32 v20, v20, v21
    v_max_f32 v20, 0, v20
    v_exp_f32 v22, -v20
    s_nop 0
    v_mul_f32 v15, v15, v22
    v_accvgpr_read_b32 v24, a64
    v_mul_f32 v24, v24, v22
    v_accvgpr_write_b32 a64, v24
    v_accvgpr_read_b32 v25, a65
    v_mul_f32 v25, v25, v22
    v_accvgpr_write_b32 a65, v25
    v_accvgpr_read_b32 v26, a66
    v_mul_f32 v26, v26, v22
    v_accvgpr_write_b32 a66, v26
    v_accvgpr_read_b32 v27, a67
    v_mul_f32 v27, v27, v22
    v_accvgpr_write_b32 a67, v27
    v_accvgpr_read_b32 v24, a68
    v_mul_f32 v24, v24, v22
    v_accvgpr_write_b32 a68, v24
    v_accvgpr_read_b32 v25, a69
    v_mul_f32 v25, v25, v22
    v_accvgpr_write_b32 a69, v25
    v_accvgpr_read_b32 v26, a70
    v_mul_f32 v26, v26, v22
    v_accvgpr_write_b32 a70, v26
    v_accvgpr_read_b32 v27, a71
    v_mul_f32 v27, v27, v22
    v_accvgpr_write_b32 a71, v27
    v_accvgpr_read_b32 v24, a72
    v_mul_f32 v24, v24, v22
    v_accvgpr_write_b32 a72, v24
    v_accvgpr_read_b32 v25, a73
    v_mul_f32 v25, v25, v22
    v_accvgpr_write_b32 a73, v25
    v_accvgpr_read_b32 v26, a74
    v_mul_f32 v26, v26, v22
    v_accvgpr_write_b32 a74, v26
    v_accvgpr_read_b32 v27, a75
    v_mul_f32 v27, v27, v22
    v_accvgpr_write_b32 a75, v27
    v_accvgpr_read_b32 v24, a76
    v_mul_f32 v24, v24, v22
    v_accvgpr_write_b32 a76, v24
    v_accvgpr_read_b32 v25, a77
    v_mul_f32 v25, v25, v22
    v_accvgpr_write_b32 a77, v25
    v_accvgpr_read_b32 v26, a78
    v_mul_f32 v26, v26, v22
    v_accvgpr_write_b32 a78, v26
    v_accvgpr_read_b32 v27, a79
    v_mul_f32 v27, v27, v22
    v_accvgpr_write_b32 a79, v27
    v_accvgpr_read_b32 v24, a80
    v_mul_f32 v24, v24, v22
    v_accvgpr_write_b32 a80, v24
    v_accvgpr_read_b32 v25, a81
    v_mul_f32 v25, v25, v22
    v_accvgpr_write_b32 a81, v25
    v_accvgpr_read_b32 v26, a82
    v_mul_f32 v26, v26, v22
    v_accvgpr_write_b32 a82, v26
    v_accvgpr_read_b32 v27, a83
    v_mul_f32 v27, v27, v22
    v_accvgpr_write_b32 a83, v27
    v_accvgpr_read_b32 v24, a84
    v_mul_f32 v24, v24, v22
    v_accvgpr_write_b32 a84, v24
    v_accvgpr_read_b32 v25, a85
    v_mul_f32 v25, v25, v22
    v_accvgpr_write_b32 a85, v25
    v_accvgpr_read_b32 v26, a86
    v_mul_f32 v26, v26, v22
    v_accvgpr_write_b32 a86, v26
    v_accvgpr_read_b32 v27, a87
    v_mul_f32 v27, v27, v22
    v_accvgpr_write_b32 a87, v27
    v_accvgpr_read_b32 v24, a88
    v_mul_f32 v24, v24, v22
    v_accvgpr_write_b32 a88, v24
    v_accvgpr_read_b32 v25, a89
    v_mul_f32 v25, v25, v22
    v_accvgpr_write_b32 a89, v25
    v_accvgpr_read_b32 v26, a90
    v_mul_f32 v26, v26, v22
    v_accvgpr_write_b32 a90, v26
    v_accvgpr_read_b32 v27, a91
    v_mul_f32 v27, v27, v22
    v_accvgpr_write_b32 a91, v27
    v_accvgpr_read_b32 v24, a92
    v_mul_f32 v24, v24, v22
    v_accvgpr_write_b32 a92, v24
    v_accvgpr_read_b32 v25, a93
    v_mul_f32 v25, v25, v22
    v_accvgpr_write_b32 a93, v25
    v_accvgpr_read_b32 v26, a94
    v_mul_f32 v26, v26, v22
    v_accvgpr_write_b32 a94, v26
    v_accvgpr_read_b32 v27, a95
    v_mul_f32 v27, v27, v22
    v_accvgpr_write_b32 a95, v27
    v_sub_f32 v232, v232, v20
    v_sub_f32 v233, v233, v20
    v_sub_f32 v234, v234, v20
    v_sub_f32 v235, v235, v20
    v_sub_f32 v64, v64, v20
    v_sub_f32 v65, v65, v20
    v_sub_f32 v66, v66, v20
    v_sub_f32 v67, v67, v20
    v_sub_f32 v68, v68, v20
    v_sub_f32 v69, v69, v20
    v_sub_f32 v70, v70, v20
    v_sub_f32 v71, v71, v20
    v_sub_f32 v72, v72, v20
    v_sub_f32 v73, v73, v20
    v_sub_f32 v74, v74, v20
    v_sub_f32 v75, v75, v20
    v_sub_f32 v76, v76, v20
    v_sub_f32 v77, v77, v20
    v_sub_f32 v78, v78, v20
    v_sub_f32 v79, v79, v20
    v_exp_f32 v240, v64
    v_exp_f32 v241, v65
    v_exp_f32 v242, v66
    v_exp_f32 v243, v67
    v_exp_f32 v244, v68
    v_cvt_pk_bf16_f32 v168, v240, v241
    v_exp_f32 v245, v69
    v_exp_f32 v246, v70
    v_cvt_pk_bf16_f32 v169, v242, v243
    v_exp_f32 v247, v71
    v_cvt_pk_bf16_f32 v170, v244, v245
    v_cvt_pk_bf16_f32 v171, v246, v247
    s_nop 1
    v_mfma_f32_16x16x32_bf16 v[248:251], v[208:211], v[168:171], 0
    v_exp_f32 v240, v72
    v_exp_f32 v241, v73
    v_exp_f32 v242, v74
    v_exp_f32 v243, v75
    v_exp_f32 v244, v76
    v_cvt_pk_bf16_f32 v200, v240, v241
    v_exp_f32 v245, v77
    v_exp_f32 v246, v78
    v_cvt_pk_bf16_f32 v201, v242, v243
    v_exp_f32 v247, v79
    v_cvt_pk_bf16_f32 v202, v244, v245
    v_cvt_pk_bf16_f32 v203, v246, v247
    s_nop 1
    v_mfma_f32_16x16x32_bf16 v[248:251], v[208:211], v[200:203], v[248:251]
    v_max3_f32 v20, v80, v81, v82
    v_max3_f32 v20, v20, v83, v84
    v_max3_f32 v20, v20, v85, v86
    v_max3_f32 v20, v20, v87, v88
    v_max3_f32 v20, v20, v89, v90
    v_max3_f32 v20, v20, v91, v92
    v_max3_f32 v20, v20, v93, v94
    v_max_f32 v20, v20, v95
    v_mov_b32 v21, v20
    s_nop 1
    v_permlane32_swap_b32 v20, v21
    v_max_f32 v20, v20, v21
    v_mov_b32 v21, v20
    s_nop 1
    v_permlane16_swap_b32 v20, v21
    v_max_f32 v20, v20, v21
    v_max_f32 v20, 0, v20
    v_exp_f32 v22, -v20
    s_nop 0
    v_mul_f32 v30, v30, v22
    v_accvgpr_read_b32 v24, a96
    v_mul_f32 v24, v24, v22
    v_accvgpr_write_b32 a96, v24
    v_accvgpr_read_b32 v25, a97
    v_mul_f32 v25, v25, v22
    v_accvgpr_write_b32 a97, v25
    v_accvgpr_read_b32 v26, a98
    v_mul_f32 v26, v26, v22
    v_accvgpr_write_b32 a98, v26
    v_accvgpr_read_b32 v27, a99
    v_mul_f32 v27, v27, v22
    v_accvgpr_write_b32 a99, v27
    v_accvgpr_read_b32 v24, a100
    v_mul_f32 v24, v24, v22
    v_accvgpr_write_b32 a100, v24
    v_accvgpr_read_b32 v25, a101
    v_mul_f32 v25, v25, v22
    v_accvgpr_write_b32 a101, v25
    v_accvgpr_read_b32 v26, a102
    v_mul_f32 v26, v26, v22
    v_accvgpr_write_b32 a102, v26
    v_accvgpr_read_b32 v27, a103
    v_mul_f32 v27, v27, v22
    v_accvgpr_write_b32 a103, v27
    v_accvgpr_read_b32 v24, a104
    v_mul_f32 v24, v24, v22
    v_accvgpr_write_b32 a104, v24
    v_accvgpr_read_b32 v25, a105
    v_mul_f32 v25, v25, v22
    v_accvgpr_write_b32 a105, v25
    v_accvgpr_read_b32 v26, a106
    v_mul_f32 v26, v26, v22
    v_accvgpr_write_b32 a106, v26
    v_accvgpr_read_b32 v27, a107
    v_mul_f32 v27, v27, v22
    v_accvgpr_write_b32 a107, v27
    v_accvgpr_read_b32 v24, a108
    v_mul_f32 v24, v24, v22
    v_accvgpr_write_b32 a108, v24
    v_accvgpr_read_b32 v25, a109
    v_mul_f32 v25, v25, v22
    v_accvgpr_write_b32 a109, v25
    v_accvgpr_read_b32 v26, a110
    v_mul_f32 v26, v26, v22
    v_accvgpr_write_b32 a110, v26
    v_accvgpr_read_b32 v27, a111
    v_mul_f32 v27, v27, v22
    v_accvgpr_write_b32 a111, v27
    v_accvgpr_read_b32 v24, a112
    v_mul_f32 v24, v24, v22
    v_accvgpr_write_b32 a112, v24
    v_accvgpr_read_b32 v25, a113
    v_mul_f32 v25, v25, v22
    v_accvgpr_write_b32 a113, v25
    v_accvgpr_read_b32 v26, a114
    v_mul_f32 v26, v26, v22
    v_accvgpr_write_b32 a114, v26
    v_accvgpr_read_b32 v27, a115
    v_mul_f32 v27, v27, v22
    v_accvgpr_write_b32 a115, v27
    v_accvgpr_read_b32 v24, a116
    v_mul_f32 v24, v24, v22
    v_accvgpr_write_b32 a116, v24
    v_accvgpr_read_b32 v25, a117
    v_mul_f32 v25, v25, v22
    v_accvgpr_write_b32 a117, v25
    v_accvgpr_read_b32 v26, a118
    v_mul_f32 v26, v26, v22
    v_accvgpr_write_b32 a118, v26
    v_accvgpr_read_b32 v27, a119
    v_mul_f32 v27, v27, v22
    v_accvgpr_write_b32 a119, v27
    v_accvgpr_read_b32 v24, a120
    v_mul_f32 v24, v24, v22
    v_accvgpr_write_b32 a120, v24
    v_accvgpr_read_b32 v25, a121
    v_mul_f32 v25, v25, v22
    v_accvgpr_write_b32 a121, v25
    v_accvgpr_read_b32 v26, a122
    v_mul_f32 v26, v26, v22
    v_accvgpr_write_b32 a122, v26
    v_accvgpr_read_b32 v27, a123
    v_mul_f32 v27, v27, v22
    v_accvgpr_write_b32 a123, v27
    v_accvgpr_read_b32 v24, a124
    v_mul_f32 v24, v24, v22
    v_accvgpr_write_b32 a124, v24
    v_accvgpr_read_b32 v25, a125
    v_mul_f32 v25, v25, v22
    v_accvgpr_write_b32 a125, v25
    v_accvgpr_read_b32 v26, a126
    v_mul_f32 v26, v26, v22
    v_accvgpr_write_b32 a126, v26
    v_accvgpr_read_b32 v27, a127
    v_mul_f32 v27, v27, v22
    v_accvgpr_write_b32 a127, v27
    v_sub_f32 v236, v236, v20
    v_sub_f32 v237, v237, v20
    v_sub_f32 v238, v238, v20
    v_sub_f32 v239, v239, v20
    v_sub_f32 v80, v80, v20
    v_sub_f32 v81, v81, v20
    v_sub_f32 v82, v82, v20
    v_sub_f32 v83, v83, v20
    v_sub_f32 v84, v84, v20
    v_sub_f32 v85, v85, v20
    v_sub_f32 v86, v86, v20
    v_sub_f32 v87, v87, v20
    v_sub_f32 v88, v88, v20
    v_sub_f32 v89, v89, v20
    v_sub_f32 v90, v90, v20
    v_sub_f32 v91, v91, v20
    v_sub_f32 v92, v92, v20
    v_sub_f32 v93, v93, v20
    v_sub_f32 v94, v94, v20
    v_sub_f32 v95, v95, v20
    v_sub_f32 v144, v144, v20
    v_sub_f32 v145, v145, v20
    v_sub_f32 v146, v146, v20
    v_sub_f32 v147, v147, v20
    v_sub_f32 v148, v148, v20
    v_sub_f32 v149, v149, v20
    v_sub_f32 v150, v150, v20
    v_sub_f32 v151, v151, v20
    v_sub_f32 v152, v152, v20
    v_sub_f32 v153, v153, v20
    v_sub_f32 v154, v154, v20
    v_sub_f32 v155, v155, v20
    v_sub_f32 v156, v156, v20
    v_sub_f32 v157, v157, v20
    v_sub_f32 v158, v158, v20
    v_sub_f32 v159, v159, v20
    v_exp_f32 v240, v80
    v_exp_f32 v241, v81
    v_exp_f32 v242, v82
    v_exp_f32 v243, v83
    v_exp_f32 v244, v84
    v_cvt_pk_bf16_f32 v172, v240, v241
    v_exp_f32 v245, v85
    v_exp_f32 v246, v86
    v_cvt_pk_bf16_f32 v173, v242, v243
    v_exp_f32 v247, v87
    v_cvt_pk_bf16_f32 v174, v244, v245
    v_cvt_pk_bf16_f32 v175, v246, v247
    s_nop 1
    v_mfma_f32_16x16x32_bf16 v[252:255], v[208:211], v[172:175], 0
    v_exp_f32 v240, v88
    v_exp_f32 v241, v89
    v_exp_f32 v242, v90
    v_exp_f32 v243, v91
    v_exp_f32 v244, v92
    v_cvt_pk_bf16_f32 v204, v240, v241
    v_exp_f32 v245, v93
    v_exp_f32 v246, v94
    v_cvt_pk_bf16_f32 v205, v242, v243
    v_exp_f32 v247, v95
    v_cvt_pk_bf16_f32 v206, v244, v245
    v_cvt_pk_bf16_f32 v207, v246, v247
    s_nop 1
    v_mfma_f32_16x16x32_bf16 v[252:255], v[208:211], v[204:207], v[252:255]
    s_nop 7
    s_branch f1_ssel_rare_r
f1_ssel_mask:
    s_nop 7
    v_cmp_lt_i32 s[40:41], v3, 0
    v_cmp_lt_i32 s[42:43], v3, 1
    v_cmp_lt_i32 s[60:61], v3, 2
    v_cmp_lt_i32 s[62:63], v3, 3
    v_cndmask_b32 v144, v144, v5, s[40:41]
    v_cndmask_b32 v145, v145, v5, s[42:43]
    v_cndmask_b32 v146, v146, v5, s[60:61]
    v_cndmask_b32 v147, v147, v5, s[62:63]
    v_cmp_lt_i32 s[40:41], v3, 16
    v_cmp_lt_i32 s[42:43], v3, 17
    v_cmp_lt_i32 s[60:61], v3, 18
    v_cmp_lt_i32 s[62:63], v3, 19
    v_cndmask_b32 v148, v148, v5, s[40:41]
    v_cndmask_b32 v149, v149, v5, s[42:43]
    v_cndmask_b32 v150, v150, v5, s[60:61]
    v_cndmask_b32 v151, v151, v5, s[62:63]
    v_cmp_lt_i32 s[40:41], v3, 32
    v_cmp_lt_i32 s[42:43], v3, 33
    v_cmp_lt_i32 s[60:61], v3, 34
    v_cmp_lt_i32 s[62:63], v3, 35
    v_cndmask_b32 v152, v152, v5, s[40:41]
    v_cndmask_b32 v153, v153, v5, s[42:43]
    v_cndmask_b32 v154, v154, v5, s[60:61]
    v_cndmask_b32 v155, v155, v5, s[62:63]
    v_cmp_lt_i32 s[40:41], v3, 48
    v_cmp_lt_i32 s[42:43], v3, 49
    v_cmp_lt_i32 s[60:61], v3, 50
    v_cmp_lt_i32 s[62:63], v3, 51
    v_cndmask_b32 v156, v156, v5, s[40:41]
    v_cndmask_b32 v157, v157, v5, s[42:43]
    v_cndmask_b32 v158, v158, v5, s[60:61]
    v_cndmask_b32 v159, v159, v5, s[62:63]
    s_branch f1_ssel_mask_r
f1_sse1_rare:
    s_nop 7
    v_max3_f32 v20, v64, v65, v66
    v_max3_f32 v20, v20, v67, v68
    v_max3_f32 v20, v20, v69, v70
    v_max3_f32 v20, v20, v71, v72
    v_max3_f32 v20, v20, v73, v74
    v_max3_f32 v20, v20, v75, v76
    v_max3_f32 v20, v20, v77, v78
    v_max_f32 v20, v20, v79
    v_mov_b32 v21, v20
    s_nop 1
    v_permlane32_swap_b32 v20, v21
    v_max_f32 v20, v20, v21
    v_mov_b32 v21, v20
    s_nop 1
    v_permlane16_swap_b32 v20, v21
    v_max_f32 v20, v20, v21
    v_max_f32 v20, 0, v20
    v_exp_f32 v22, -v20
    s_nop 0
    v_mul_f32 v15, v15, v22
    v_accvgpr_read_b32 v24, a64
    v_mul_f32 v24, v24, v22
    v_accvgpr_write_b32 a64, v24
    v_accvgpr_read_b32 v25, a65
    v_mul_f32 v25, v25, v22
    v_accvgpr_write_b32 a65, v25
    v_accvgpr_read_b32 v26, a66
    v_mul_f32 v26, v26, v22
    v_accvgpr_write_b32 a66, v26
    v_accvgpr_read_b32 v27, a67
    v_mul_f32 v27, v27, v22
    v_accvgpr_write_b32 a67, v27
    v_accvgpr_read_b32 v24, a68
    v_mul_f32 v24, v24, v22
    v_accvgpr_write_b32 a68, v24
    v_accvgpr_read_b32 v25, a69
    v_mul_f32 v25, v25, v22
    v_accvgpr_write_b32 a69, v25
    v_accvgpr_read_b32 v26, a70
    v_mul_f32 v26, v26, v22
    v_accvgpr_write_b32 a70, v26
    v_accvgpr_read_b32 v27, a71
    v_mul_f32 v27, v27, v22
    v_accvgpr_write_b32 a71, v27
    v_accvgpr_read_b32 v24, a72
    v_mul_f32 v24, v24, v22
    v_accvgpr_write_b32 a72, v24
    v_accvgpr_read_b32 v25, a73
    v_mul_f32 v25, v25, v22
    v_accvgpr_write_b32 a73, v25
    v_accvgpr_read_b32 v26, a74
    v_mul_f32 v26, v26, v22
    v_accvgpr_write_b32 a74, v26
    v_accvgpr_read_b32 v27, a75
    v_mul_f32 v27, v27, v22
    v_accvgpr_write_b32 a75, v27
    v_accvgpr_read_b32 v24, a76
    v_mul_f32 v24, v24, v22
    v_accvgpr_write_b32 a76, v24
    v_accvgpr_read_b32 v25, a77
    v_mul_f32 v25, v25, v22
    v_accvgpr_write_b32 a77, v25
    v_accvgpr_read_b32 v26, a78
    v_mul_f32 v26, v26, v22
    v_accvgpr_write_b32 a78, v26
    v_accvgpr_read_b32 v27, a79
    v_mul_f32 v27, v27, v22
    v_accvgpr_write_b32 a79, v27
    v_accvgpr_read_b32 v24, a80
    v_mul_f32 v24, v24, v22
    v_accvgpr_write_b32 a80, v24
    v_accvgpr_read_b32 v25, a81
    v_mul_f32 v25, v25, v22
    v_accvgpr_write_b32 a81, v25
    v_accvgpr_read_b32 v26, a82
    v_mul_f32 v26, v26, v22
    v_accvgpr_write_b32 a82, v26
    v_accvgpr_read_b32 v27, a83
    v_mul_f32 v27, v27, v22
    v_accvgpr_write_b32 a83, v27
    v_accvgpr_read_b32 v24, a84
    v_mul_f32 v24, v24, v22
    v_accvgpr_write_b32 a84, v24
    v_accvgpr_read_b32 v25, a85
    v_mul_f32 v25, v25, v22
    v_accvgpr_write_b32 a85, v25
    v_accvgpr_read_b32 v26, a86
    v_mul_f32 v26, v26, v22
    v_accvgpr_write_b32 a86, v26
    v_accvgpr_read_b32 v27, a87
    v_mul_f32 v27, v27, v22
    v_accvgpr_write_b32 a87, v27
    v_accvgpr_read_b32 v24, a88
    v_mul_f32 v24, v24, v22
    v_accvgpr_write_b32 a88, v24
    v_accvgpr_read_b32 v25, a89
    v_mul_f32 v25, v25, v22
    v_accvgpr_write_b32 a89, v25
    v_accvgpr_read_b32 v26, a90
    v_mul_f32 v26, v26, v22
    v_accvgpr_write_b32 a90, v26
    v_accvgpr_read_b32 v27, a91
    v_mul_f32 v27, v27, v22
    v_accvgpr_write_b32 a91, v27
    v_accvgpr_read_b32 v24, a92
    v_mul_f32 v24, v24, v22
    v_accvgpr_write_b32 a92, v24
    v_accvgpr_read_b32 v25, a93
    v_mul_f32 v25, v25, v22
    v_accvgpr_write_b32 a93, v25
    v_accvgpr_read_b32 v26, a94
    v_mul_f32 v26, v26, v22
    v_accvgpr_write_b32 a94, v26
    v_accvgpr_read_b32 v27, a95
    v_mul_f32 v27, v27, v22
    v_accvgpr_write_b32 a95, v27
    v_sub_f32 v232, v232, v20
    v_sub_f32 v233, v233, v20
    v_sub_f32 v234, v234, v20
    v_sub_f32 v235, v235, v20
    v_sub_f32 v64, v64, v20
    v_sub_f32 v65, v65, v20
    v_sub_f32 v66, v66, v20
    v_sub_f32 v67, v67, v20
    v_sub_f32 v68, v68, v20
    v_sub_f32 v69, v69, v20
    v_sub_f32 v70, v70, v20
    v_sub_f32 v71, v71, v20
    v_sub_f32 v72, v72, v20
    v_sub_f32 v73, v73, v20
    v_sub_f32 v74, v74, v20
    v_sub_f32 v75, v75, v20
    v_sub_f32 v76, v76, v20
    v_sub_f32 v77, v77, v20
    v_sub_f32 v78, v78, v20
    v_sub_f32 v79, v79, v20
    v_sub_f32 v128, v128, v20
    v_sub_f32 v129, v129, v20
    v_sub_f32 v130, v130, v20
    v_sub_f32 v131, v131, v20
    v_sub_f32 v132, v132, v20
    v_sub_f32 v133, v133, v20
    v_sub_f32 v134, v134, v20
    v_sub_f32 v135, v135, v20
    v_sub_f32 v136, v136, v20
    v_sub_f32 v137, v137, v20
    v_sub_f32 v138, v138, v20
    v_sub_f32 v139, v139, v20
    v_sub_f32 v140, v140, v20
    v_sub_f32 v141, v141, v20
    v_sub_f32 v142, v142, v20
    v_sub_f32 v143, v143, v20
    v_exp_f32 v240, v64
    v_exp_f32 v241, v65
    v_exp_f32 v242, v66
    v_exp_f32 v243, v67
    v_exp_f32 v244, v68
    v_cvt_pk_bf16_f32 v168, v240, v241
    v_exp_f32 v245, v69
    v_exp_f32 v246, v70
    v_cvt_pk_bf16_f32 v169, v242, v243
    v_exp_f32 v247, v71
    v_cvt_pk_bf16_f32 v170, v244, v245
    v_cvt_pk_bf16_f32 v171, v246, v247
    s_nop 1
    v_mfma_f32_16x16x32_bf16 v[248:251], v[208:211], v[168:171], 0
    v_exp_f32 v240, v72
    v_exp_f32 v241, v73
    v_exp_f32 v242, v74
    v_exp_f32 v243, v75
    v_exp_f32 v244, v76
    v_cvt_pk_bf16_f32 v200, v240, v241
    v_exp_f32 v245, v77
    v_exp_f32 v246, v78
    v_cvt_pk_bf16_f32 v201, v242, v243
    v_exp_f32 v247, v79
    v_cvt_pk_bf16_f32 v202, v244, v245
    v_cvt_pk_bf16_f32 v203, v246, v247
    s_nop 1
    v_mfma_f32_16x16x32_bf16 v[248:251], v[208:211], v[200:203], v[248:251]
    v_max3_f32 v20, v80, v81, v82
    v_max3_f32 v20, v20, v83, v84
    v_max3_f32 v20, v20, v85, v86
    v_max3_f32 v20, v20, v87, v88
    v_max3_f32 v20, v20, v89, v90
    v_max3_f32 v20, v20, v91, v92
    v_max3_f32 v20, v20, v93, v94
    v_max_f32 v20, v20, v95
    v_mov_b32 v21, v20
    s_nop 1
    v_permlane32_swap_b32 v20, v21
    v_max_f32 v20, v20, v21
    v_mov_b32 v21, v20
    s_nop 1
    v_permlane16_swap_b32 v20, v21
    v_max_f32 v20, v20, v21
    v_max_f32 v20, 0, v20
    v_exp_f32 v22, -v20
    s_nop 0
    v_mul_f32 v30, v30, v22
    v_accvgpr_read_b32 v24, a96
    v_mul_f32 v24, v24, v22
    v_accvgpr_write_b32 a96, v24
    v_accvgpr_read_b32 v25, a97
    v_mul_f32 v25, v25, v22
    v_accvgpr_write_b32 a97, v25
    v_accvgpr_read_b32 v26, a98
    v_mul_f32 v26, v26, v22
    v_accvgpr_write_b32 a98, v26
    v_accvgpr_read_b32 v27, a99
    v_mul_f32 v27, v27, v22
    v_accvgpr_write_b32 a99, v27
    v_accvgpr_read_b32 v24, a100
    v_mul_f32 v24, v24, v22
    v_accvgpr_write_b32 a100, v24
    v_accvgpr_read_b32 v25, a101
    v_mul_f32 v25, v25, v22
    v_accvgpr_write_b32 a101, v25
    v_accvgpr_read_b32 v26, a102
    v_mul_f32 v26, v26, v22
    v_accvgpr_write_b32 a102, v26
    v_accvgpr_read_b32 v27, a103
    v_mul_f32 v27, v27, v22
    v_accvgpr_write_b32 a103, v27
    v_accvgpr_read_b32 v24, a104
    v_mul_f32 v24, v24, v22
    v_accvgpr_write_b32 a104, v24
    v_accvgpr_read_b32 v25, a105
    v_mul_f32 v25, v25, v22
    v_accvgpr_write_b32 a105, v25
    v_accvgpr_read_b32 v26, a106
    v_mul_f32 v26, v26, v22
    v_accvgpr_write_b32 a106, v26
    v_accvgpr_read_b32 v27, a107
    v_mul_f32 v27, v27, v22
    v_accvgpr_write_b32 a107, v27
    v_accvgpr_read_b32 v24, a108
    v_mul_f32 v24, v24, v22
    v_accvgpr_write_b32 a108, v24
    v_accvgpr_read_b32 v25, a109
    v_mul_f32 v25, v25, v22
    v_accvgpr_write_b32 a109, v25
    v_accvgpr_read_b32 v26, a110
    v_mul_f32 v26, v26, v22
    v_accvgpr_write_b32 a110, v26
    v_accvgpr_read_b32 v27, a111
    v_mul_f32 v27, v27, v22
    v_accvgpr_write_b32 a111, v27
    v_accvgpr_read_b32 v24, a112
    v_mul_f32 v24, v24, v22
    v_accvgpr_write_b32 a112, v24
    v_accvgpr_read_b32 v25, a113
    v_mul_f32 v25, v25, v22
    v_accvgpr_write_b32 a113, v25
    v_accvgpr_read_b32 v26, a114
    v_mul_f32 v26, v26, v22
    v_accvgpr_write_b32 a114, v26
    v_accvgpr_read_b32 v27, a115
    v_mul_f32 v27, v27, v22
    v_accvgpr_write_b32 a115, v27
    v_accvgpr_read_b32 v24, a116
    v_mul_f32 v24, v24, v22
    v_accvgpr_write_b32 a116, v24
    v_accvgpr_read_b32 v25, a117
    v_mul_f32 v25, v25, v22
    v_accvgpr_write_b32 a117, v25
    v_accvgpr_read_b32 v26, a118
    v_mul_f32 v26, v26, v22
    v_accvgpr_write_b32 a118, v26
    v_accvgpr_read_b32 v27, a119
    v_mul_f32 v27, v27, v22
    v_accvgpr_write_b32 a119, v27
    v_accvgpr_read_b32 v24, a120
    v_mul_f32 v24, v24, v22
    v_accvgpr_write_b32 a120, v24
    v_accvgpr_read_b32 v25, a121
    v_mul_f32 v25, v25, v22
    v_accvgpr_write_b32 a121, v25
    v_accvgpr_read_b32 v26, a122
    v_mul_f32 v26, v26, v22
    v_accvgpr_write_b32 a122, v26
    v_accvgpr_read_b32 v27, a123
    v_mul_f32 v27, v27, v22
    v_accvgpr_write_b32 a123, v27
    v_accvgpr_read_b32 v24, a124
    v_mul_f32 v24, v24, v22
    v_accvgpr_write_b32 a124, v24
    v_accvgpr_read_b32 v25, a125
    v_mul_f32 v25, v25, v22
    v_accvgpr_write_b32 a125, v25
    v_accvgpr_read_b32 v26, a126
    v_mul_f32 v26, v26, v22
    v_accvgpr_write_b32 a126, v26
    v_accvgpr_read_b32 v27, a127
    v_mul_f32 v27, v27, v22
    v_accvgpr_write_b32 a127, v27
    v_sub_f32 v236, v236, v20
    v_sub_f32 v237, v237, v20
    v_sub_f32 v238, v238, v20
    v_sub_f32 v239, v239, v20
    v_sub_f32 v80, v80, v20
    v_sub_f32 v81, v81, v20
    v_sub_f32 v82, v82, v20
    v_sub_f32 v83, v83, v20
    v_sub_f32 v84, v84, v20
    v_sub_f32 v85, v85, v20
    v_sub_f32 v86, v86, v20
    v_sub_f32 v87, v87, v20
    v_sub_f32 v88, v88, v20
    v_sub_f32 v89, v89, v20
    v_sub_f32 v90, v90, v20
    v_sub_f32 v91, v91, v20
    v_sub_f32 v92, v92, v20
    v_sub_f32 v93, v93, v20
    v_sub_f32 v94, v94, v20
    v_sub_f32 v95, v95, v20
    v_sub_f32 v144, v144, v20
    v_sub_f32 v145, v145, v20
    v_sub_f32 v146, v146, v20
    v_sub_f32 v147, v147, v20
    v_sub_f32 v148, v148, v20
    v_sub_f32 v149, v149, v20
    v_sub_f32 v150, v150, v20
    v_sub_f32 v151, v151, v20
    v_sub_f32 v152, v152, v20
    v_sub_f32 v153, v153, v20
    v_sub_f32 v154, v154, v20
    v_sub_f32 v155, v155, v20
    v_sub_f32 v156, v156, v20
    v_sub_f32 v157, v157, v20
    v_sub_f32 v158, v158, v20
    v_sub_f32 v159, v159, v20
    v_exp_f32 v240, v80
    v_exp_f32 v241, v81
    v_exp_f32 v242, v82
    v_exp_f32 v243, v83
    v_exp_f32 v244, v84
    v_cvt_pk_bf16_f32 v172, v240, v241
    v_exp_f32 v245, v85
    v_exp_f32 v246, v86
    v_cvt_pk_bf16_f32 v173, v242, v243
    v_exp_f32 v247, v87
    v_cvt_pk_bf16_f32 v174, v244, v245
    v_cvt_pk_bf16_f32 v175, v246, v247
    s_nop 1
    v_mfma_f32_16x16x32_bf16 v[252:255], v[208:211], v[172:175], 0
    v_exp_f32 v240, v88
    v_exp_f32 v241, v89
    v_exp_f32 v242, v90
    v_exp_f32 v243, v91
    v_exp_f32 v244, v92
    v_cvt_pk_bf16_f32 v204, v240, v241
    v_exp_f32 v245, v93
    v_exp_f32 v246, v94
    v_cvt_pk_bf16_f32 v205, v242, v243
    v_exp_f32 v247, v95
    v_cvt_pk_bf16_f32 v206, v244, v245
    v_cvt_pk_bf16_f32 v207, v246, v247
    s_nop 1
    v_mfma_f32_16x16x32_bf16 v[252:255], v[208:211], v[204:207], v[252:255]
    s_nop 7
    s_branch f1_sse1_rare_r
f1_sse1_mask:
    s_nop 7
    v_cmp_lt_i32 s[40:41], v3, 0
    v_cmp_lt_i32 s[42:43], v3, 1
    v_cmp_lt_i32 s[60:61], v3, 2
    v_cmp_lt_i32 s[62:63], v3, 3
    v_cndmask_b32 v144, v144, v5, s[40:41]
    v_cndmask_b32 v145, v145, v5, s[42:43]
    v_cndmask_b32 v146, v146, v5, s[60:61]
    v_cndmask_b32 v147, v147, v5, s[62:63]
    v_cmp_lt_i32 s[40:41], v3, 16
    v_cmp_lt_i32 s[42:43], v3, 17
    v_cmp_lt_i32 s[60:61], v3, 18
    v_cmp_lt_i32 s[62:63], v3, 19
    v_cndmask_b32 v148, v148, v5, s[40:41]
    v_cndmask_b32 v149, v149, v5, s[42:43]
    v_cndmask_b32 v150, v150, v5, s[60:61]
    v_cndmask_b32 v151, v151, v5, s[62:63]
    v_cmp_lt_i32 s[40:41], v3, 32
    v_cmp_lt_i32 s[42:43], v3, 33
    v_cmp_lt_i32 s[60:61], v3, 34
    v_cmp_lt_i32 s[62:63], v3, 35
    v_cndmask_b32 v152, v152, v5, s[40:41]
    v_cndmask_b32 v153, v153, v5, s[42:43]
    v_cndmask_b32 v154, v154, v5, s[60:61]
    v_cndmask_b32 v155, v155, v5, s[62:63]
    v_cmp_lt_i32 s[40:41], v3, 48
    v_cmp_lt_i32 s[42:43], v3, 49
    v_cmp_lt_i32 s[60:61], v3, 50
    v_cmp_lt_i32 s[62:63], v3, 51
    v_cndmask_b32 v156, v156, v5, s[40:41]
    v_cndmask_b32 v157, v157, v5, s[42:43]
    v_cndmask_b32 v158, v158, v5, s[60:61]
    v_cndmask_b32 v159, v159, v5, s[62:63]
    s_branch f1_sse1_mask_r
f1_sso1_rare:
    s_nop 7
    v_max3_f32 v20, v128, v129, v130
    v_max3_f32 v20, v20, v131, v132
    v_max3_f32 v20, v20, v133, v134
    v_max3_f32 v20, v20, v135, v136
    v_max3_f32 v20, v20, v137, v138
    v_max3_f32 v20, v20, v139, v140
    v_max3_f32 v20, v20, v141, v142
    v_max_f32 v20, v20, v143
    v_mov_b32 v21, v20
    s_nop 1
    v_permlane32_swap_b32 v20, v21
    v_max_f32 v20, v20, v21
    v_mov_b32 v21, v20
    s_nop 1
    v_permlane16_swap_b32 v20, v21
    v_max_f32 v20, v20, v21
    v_max_f32 v20, 0, v20
    v_exp_f32 v22, -v20
    s_nop 0
    v_mul_f32 v15, v15, v22
    v_accvgpr_read_b32 v24, a64
    v_mul_f32 v24, v24, v22
    v_accvgpr_write_b32 a64, v24
    v_accvgpr_read_b32 v25, a65
    v_mul_f32 v25, v25, v22
    v_accvgpr_write_b32 a65, v25
    v_accvgpr_read_b32 v26, a66
    v_mul_f32 v26, v26, v22
    v_accvgpr_write_b32 a66, v26
    v_accvgpr_read_b32 v27, a67
    v_mul_f32 v27, v27, v22
    v_accvgpr_write_b32 a67, v27
    v_accvgpr_read_b32 v24, a68
    v_mul_f32 v24, v24, v22
    v_accvgpr_write_b32 a68, v24
    v_accvgpr_read_b32 v25, a69
    v_mul_f32 v25, v25, v22
    v_accvgpr_write_b32 a69, v25
    v_accvgpr_read_b32 v26, a70
    v_mul_f32 v26, v26, v22
    v_accvgpr_write_b32 a70, v26
    v_accvgpr_read_b32 v27, a71
    v_mul_f32 v27, v27, v22
    v_accvgpr_write_b32 a71, v27
    v_accvgpr_read_b32 v24, a72
    v_mul_f32 v24, v24, v22
    v_accvgpr_write_b32 a72, v24
    v_accvgpr_read_b32 v25, a73
    v_mul_f32 v25, v25, v22
    v_accvgpr_write_b32 a73, v25
    v_accvgpr_read_b32 v26, a74
    v_mul_f32 v26, v26, v22
    v_accvgpr_write_b32 a74, v26
    v_accvgpr_read_b32 v27, a75
    v_mul_f32 v27, v27, v22
    v_accvgpr_write_b32 a75, v27
    v_accvgpr_read_b32 v24, a76
    v_mul_f32 v24, v24, v22
    v_accvgpr_write_b32 a76, v24
    v_accvgpr_read_b32 v25, a77
    v_mul_f32 v25, v25, v22
    v_accvgpr_write_b32 a77, v25
    v_accvgpr_read_b32 v26, a78
    v_mul_f32 v26, v26, v22
    v_accvgpr_write_b32 a78, v26
    v_accvgpr_read_b32 v27, a79
    v_mul_f32 v27, v27, v22
    v_accvgpr_write_b32 a79, v27
    v_accvgpr_read_b32 v24, a80
    v_mul_f32 v24, v24, v22
    v_accvgpr_write_b32 a80, v24
    v_accvgpr_read_b32 v25, a81
    v_mul_f32 v25, v25, v22
    v_accvgpr_write_b32 a81, v25
    v_accvgpr_read_b32 v26, a82
    v_mul_f32 v26, v26, v22
    v_accvgpr_write_b32 a82, v26
    v_accvgpr_read_b32 v27, a83
    v_mul_f32 v27, v27, v22
    v_accvgpr_write_b32 a83, v27
    v_accvgpr_read_b32 v24, a84
    v_mul_f32 v24, v24, v22
    v_accvgpr_write_b32 a84, v24
    v_accvgpr_read_b32 v25, a85
    v_mul_f32 v25, v25, v22
    v_accvgpr_write_b32 a85, v25
    v_accvgpr_read_b32 v26, a86
    v_mul_f32 v26, v26, v22
    v_accvgpr_write_b32 a86, v26
    v_accvgpr_read_b32 v27, a87
    v_mul_f32 v27, v27, v22
    v_accvgpr_write_b32 a87, v27
    v_accvgpr_read_b32 v24, a88
    v_mul_f32 v24, v24, v22
    v_accvgpr_write_b32 a88, v24
    v_accvgpr_read_b32 v25, a89
    v_mul_f32 v25, v25, v22
    v_accvgpr_write_b32 a89, v25
    v_accvgpr_read_b32 v26, a90
    v_mul_f32 v26, v26, v22
    v_accvgpr_write_b32 a90, v26
    v_accvgpr_read_b32 v27, a91
    v_mul_f32 v27, v27, v22
    v_accvgpr_write_b32 a91, v27
    v_accvgpr_read_b32 v24, a92
    v_mul_f32 v24, v24, v22
    v_accvgpr_write_b32 a92, v24
    v_accvgpr_read_b32 v25, a93
    v_mul_f32 v25, v25, v22
    v_accvgpr_write_b32 a93, v25
    v_accvgpr_read_b32 v26, a94
    v_mul_f32 v26, v26, v22
    v_accvgpr_write_b32 a94, v26
    v_accvgpr_read_b32 v27, a95
    v_mul_f32 v27, v27, v22
    v_accvgpr_write_b32 a95, v27
    v_sub_f32 v232, v232, v20
    v_sub_f32 v233, v233, v20
    v_sub_f32 v234, v234, v20
    v_sub_f32 v235, v235, v20
    v_sub_f32 v128, v128, v20
    v_sub_f32 v129, v129, v20
    v_sub_f32 v130, v130, v20
    v_sub_f32 v131, v131, v20
    v_sub_f32 v132, v132, v20
    v_sub_f32 v133, v133, v20
    v_sub_f32 v134, v134, v20
    v_sub_f32 v135, v135, v20
    v_sub_f32 v136, v136, v20
    v_sub_f32 v137, v137, v20
    v_sub_f32 v138, v138, v20
    v_sub_f32 v139, v139, v20
    v_sub_f32 v140, v140, v20
    v_sub_f32 v141, v141, v20
    v_sub_f32 v142, v142, v20
    v_sub_f32 v143, v143, v20
    v_sub_f32 v64, v64, v20
    v_sub_f32 v65, v65, v20
    v_sub_f32 v66, v66, v20
    v_sub_f32 v67, v67, v20
    v_sub_f32 v68, v68, v20
    v_sub_f32 v69, v69, v20
    v_sub_f32 v70, v70, v20
    v_sub_f32 v71, v71, v20
    v_sub_f32 v72, v72, v20
    v_sub_f32 v73, v73, v20
    v_sub_f32 v74, v74, v20
    v_sub_f32 v75, v75, v20
    v_sub_f32 v76, v76, v20
    v_sub_f32 v77, v77, v20
    v_sub_f32 v78, v78, v20
    v_sub_f32 v79, v79, v20
    v_exp_f32 v240, v128
    v_exp_f32 v241, v129
    v_exp_f32 v242, v130
    v_exp_f32 v243, v131
    v_exp_f32 v244, v132
    v_cvt_pk_bf16_f32 v184, v240, v241
    v_exp_f32 v245, v133
    v_exp_f32 v246, v134
    v_cvt_pk_bf16_f32 v185, v242, v243
    v_exp_f32 v247, v135
    v_cvt_pk_bf16_f32 v186, v244, v245
    v_cvt_pk_bf16_f32 v187, v246, v247
    s_nop 1
    v_mfma_f32_16x16x32_bf16 v[248:251], v[208:211], v[184:187], 0
    v_exp_f32 v240, v136
    v_exp_f32 v241, v137
    v_exp_f32 v242, v138
    v_exp_f32 v243, v139
    v_exp_f32 v244, v140
    v_cvt_pk_bf16_f32 v200, v240, v241
    v_exp_f32 v245, v141
    v_exp_f32 v246, v142
    v_cvt_pk_bf16_f32 v201, v242, v243
    v_exp_f32 v247, v143
    v_cvt_pk_bf16_f32 v202, v244, v245
    v_cvt_pk_bf16_f32 v203, v246, v247
    s_nop 1
    v_mfma_f32_16x16x32_bf16 v[248:251], v[208:211], v[200:203], v[248:251]
    v_max3_f32 v20, v144, v145, v146
    v_max3_f32 v20, v20, v147, v148
    v_max3_f32 v20, v20, v149, v150
    v_max3_f32 v20, v20, v151, v152
    v_max3_f32 v20, v20, v153, v154
    v_max3_f32 v20, v20, v155, v156
    v_max3_f32 v20, v20, v157, v158
    v_max_f32 v20, v20, v159
    v_mov_b32 v21, v20
    s_nop 1
    v_permlane32_swap_b32 v20, v21
    v_max_f32 v20, v20, v21
    v_mov_b32 v21, v20
    s_nop 1
    v_permlane16_swap_b32 v20, v21
    v_max_f32 v20, v20, v21
    v_max_f32 v20, 0, v20
    v_exp_f32 v22, -v20
    s_nop 0
    v_mul_f32 v30, v30, v22
    v_accvgpr_read_b32 v24, a96
    v_mul_f32 v24, v24, v22
    v_accvgpr_write_b32 a96, v24
    v_accvgpr_read_b32 v25, a97
    v_mul_f32 v25, v25, v22
    v_accvgpr_write_b32 a97, v25
    v_accvgpr_read_b32 v26, a98
    v_mul_f32 v26, v26, v22
    v_accvgpr_write_b32 a98, v26
    v_accvgpr_read_b32 v27, a99
    v_mul_f32 v27, v27, v22
    v_accvgpr_write_b32 a99, v27
    v_accvgpr_read_b32 v24, a100
    v_mul_f32 v24, v24, v22
    v_accvgpr_write_b32 a100, v24
    v_accvgpr_read_b32 v25, a101
    v_mul_f32 v25, v25, v22
    v_accvgpr_write_b32 a101, v25
    v_accvgpr_read_b32 v26, a102
    v_mul_f32 v26, v26, v22
    v_accvgpr_write_b32 a102, v26
    v_accvgpr_read_b32 v27, a103
    v_mul_f32 v27, v27, v22
    v_accvgpr_write_b32 a103, v27
    v_accvgpr_read_b32 v24, a104
    v_mul_f32 v24, v24, v22
    v_accvgpr_write_b32 a104, v24
    v_accvgpr_read_b32 v25, a105
    v_mul_f32 v25, v25, v22
    v_accvgpr_write_b32 a105, v25
    v_accvgpr_read_b32 v26, a106
    v_mul_f32 v26, v26, v22
    v_accvgpr_write_b32 a106, v26
    v_accvgpr_read_b32 v27, a107
    v_mul_f32 v27, v27, v22
    v_accvgpr_write_b32 a107, v27
    v_accvgpr_read_b32 v24, a108
    v_mul_f32 v24, v24, v22
    v_accvgpr_write_b32 a108, v24
    v_accvgpr_read_b32 v25, a109
    v_mul_f32 v25, v25, v22
    v_accvgpr_write_b32 a109, v25
    v_accvgpr_read_b32 v26, a110
    v_mul_f32 v26, v26, v22
    v_accvgpr_write_b32 a110, v26
    v_accvgpr_read_b32 v27, a111
    v_mul_f32 v27, v27, v22
    v_accvgpr_write_b32 a111, v27
    v_accvgpr_read_b32 v24, a112
    v_mul_f32 v24, v24, v22
    v_accvgpr_write_b32 a112, v24
    v_accvgpr_read_b32 v25, a113
    v_mul_f32 v25, v25, v22
    v_accvgpr_write_b32 a113, v25
    v_accvgpr_read_b32 v26, a114
    v_mul_f32 v26, v26, v22
    v_accvgpr_write_b32 a114, v26
    v_accvgpr_read_b32 v27, a115
    v_mul_f32 v27, v27, v22
    v_accvgpr_write_b32 a115, v27
    v_accvgpr_read_b32 v24, a116
    v_mul_f32 v24, v24, v22
    v_accvgpr_write_b32 a116, v24
    v_accvgpr_read_b32 v25, a117
    v_mul_f32 v25, v25, v22
    v_accvgpr_write_b32 a117, v25
    v_accvgpr_read_b32 v26, a118
    v_mul_f32 v26, v26, v22
    v_accvgpr_write_b32 a118, v26
    v_accvgpr_read_b32 v27, a119
    v_mul_f32 v27, v27, v22
    v_accvgpr_write_b32 a119, v27
    v_accvgpr_read_b32 v24, a120
    v_mul_f32 v24, v24, v22
    v_accvgpr_write_b32 a120, v24
    v_accvgpr_read_b32 v25, a121
    v_mul_f32 v25, v25, v22
    v_accvgpr_write_b32 a121, v25
    v_accvgpr_read_b32 v26, a122
    v_mul_f32 v26, v26, v22
    v_accvgpr_write_b32 a122, v26
    v_accvgpr_read_b32 v27, a123
    v_mul_f32 v27, v27, v22
    v_accvgpr_write_b32 a123, v27
    v_accvgpr_read_b32 v24, a124
    v_mul_f32 v24, v24, v22
    v_accvgpr_write_b32 a124, v24
    v_accvgpr_read_b32 v25, a125
    v_mul_f32 v25, v25, v22
    v_accvgpr_write_b32 a125, v25
    v_accvgpr_read_b32 v26, a126
    v_mul_f32 v26, v26, v22
    v_accvgpr_write_b32 a126, v26
    v_accvgpr_read_b32 v27, a127
    v_mul_f32 v27, v27, v22
    v_accvgpr_write_b32 a127, v27
    v_sub_f32 v236, v236, v20
    v_sub_f32 v237, v237, v20
    v_sub_f32 v238, v238, v20
    v_sub_f32 v239, v239, v20
    v_sub_f32 v144, v144, v20
    v_sub_f32 v145, v145, v20
    v_sub_f32 v146, v146, v20
    v_sub_f32 v147, v147, v20
    v_sub_f32 v148, v148, v20
    v_sub_f32 v149, v149, v20
    v_sub_f32 v150, v150, v20
    v_sub_f32 v151, v151, v20
    v_sub_f32 v152, v152, v20
    v_sub_f32 v153, v153, v20
    v_sub_f32 v154, v154, v20
    v_sub_f32 v155, v155, v20
    v_sub_f32 v156, v156, v20
    v_sub_f32 v157, v157, v20
    v_sub_f32 v158, v158, v20
    v_sub_f32 v159, v159, v20
    v_sub_f32 v80, v80, v20
    v_sub_f32 v81, v81, v20
    v_sub_f32 v82, v82, v20
    v_sub_f32 v83, v83, v20
    v_sub_f32 v84, v84, v20
    v_sub_f32 v85, v85, v20
    v_sub_f32 v86, v86, v20
    v_sub_f32 v87, v87, v20
    v_sub_f32 v88, v88, v20
    v_sub_f32 v89, v89, v20
    v_sub_f32 v90, v90, v20
    v_sub_f32 v91, v91, v20
    v_sub_f32 v92, v92, v20
    v_sub_f32 v93, v93, v20
    v_sub_f32 v94, v94, v20
    v_sub_f32 v95, v95, v20
    v_exp_f32 v240, v144
    v_exp_f32 v241, v145
    v_exp_f32 v242, v146
    v_exp_f32 v243, v147
    v_exp_f32 v244, v148
    v_cvt_pk_bf16_f32 v188, v240, v241
    v_exp_f32 v245, v149
    v_exp_f32 v246, v150
    v_cvt_pk_bf16_f32 v189, v242, v243
    v_exp_f32 v247, v151
    v_cvt_pk_bf16_f32 v190, v244, v245
    v_cvt_pk_bf16_f32 v191, v246, v247
    s_nop 1
    v_mfma_f32_16x16x32_bf16 v[252:255], v[208:211], v[188:191], 0
    v_exp_f32 v240, v152
    v_exp_f32 v241, v153
    v_exp_f32 v242, v154
    v_exp_f32 v243, v155
    v_exp_f32 v244, v156
    v_cvt_pk_bf16_f32 v204, v240, v241
    v_exp_f32 v245, v157
    v_exp_f32 v246, v158
    v_cvt_pk_bf16_f32 v205, v242, v243
    v_exp_f32 v247, v159
    v_cvt_pk_bf16_f32 v206, v244, v245
    v_cvt_pk_bf16_f32 v207, v246, v247
    s_nop 1
    v_mfma_f32_16x16x32_bf16 v[252:255], v[208:211], v[204:207], v[252:255]
    s_nop 7
    s_branch f1_sso1_rare_r
f1_seo_rare:
    s_nop 7
    v_max3_f32 v20, v144, v145, v146
    v_max3_f32 v20, v20, v147, v148
    v_max3_f32 v20, v20, v149, v150
    v_max3_f32 v20, v20, v151, v152
    v_max3_f32 v20, v20, v153, v154
    v_max3_f32 v20, v20, v155, v156
    v_max3_f32 v20, v20, v157, v158
    v_max_f32 v20, v20, v159
    v_mov_b32 v21, v20
    s_nop 1
    v_permlane32_swap_b32 v20, v21
    v_max_f32 v20, v20, v21
    v_mov_b32 v21, v20
    s_nop 1
    v_permlane16_swap_b32 v20, v21
    v_max_f32 v20, v20, v21
    v_max_f32 v20, 0, v20
    v_exp_f32 v22, -v20
    s_nop 0
    v_mul_f32 v30, v30, v22
    v_accvgpr_read_b32 v24, a96
    v_mul_f32 v24, v24, v22
    v_accvgpr_write_b32 a96, v24
    v_accvgpr_read_b32 v25, a97
    v_mul_f32 v25, v25, v22
    v_accvgpr_write_b32 a97, v25
    v_accvgpr_read_b32 v26, a98
    v_mul_f32 v26, v26, v22
    v_accvgpr_write_b32 a98, v26
    v_accvgpr_read_b32 v27, a99
    v_mul_f32 v27, v27, v22
    v_accvgpr_write_b32 a99, v27
    v_accvgpr_read_b32 v24, a100
    v_mul_f32 v24, v24, v22
    v_accvgpr_write_b32 a100, v24
    v_accvgpr_read_b32 v25, a101
    v_mul_f32 v25, v25, v22
    v_accvgpr_write_b32 a101, v25
    v_accvgpr_read_b32 v26, a102
    v_mul_f32 v26, v26, v22
    v_accvgpr_write_b32 a102, v26
    v_accvgpr_read_b32 v27, a103
    v_mul_f32 v27, v27, v22
    v_accvgpr_write_b32 a103, v27
    v_accvgpr_read_b32 v24, a104
    v_mul_f32 v24, v24, v22
    v_accvgpr_write_b32 a104, v24
    v_accvgpr_read_b32 v25, a105
    v_mul_f32 v25, v25, v22
    v_accvgpr_write_b32 a105, v25
    v_accvgpr_read_b32 v26, a106
    v_mul_f32 v26, v26, v22
    v_accvgpr_write_b32 a106, v26
    v_accvgpr_read_b32 v27, a107
    v_mul_f32 v27, v27, v22
    v_accvgpr_write_b32 a107, v27
    v_accvgpr_read_b32 v24, a108
    v_mul_f32 v24, v24, v22
    v_accvgpr_write_b32 a108, v24
    v_accvgpr_read_b32 v25, a109
    v_mul_f32 v25, v25, v22
    v_accvgpr_write_b32 a109, v25
    v_accvgpr_read_b32 v26, a110
    v_mul_f32 v26, v26, v22
    v_accvgpr_write_b32 a110, v26
    v_accvgpr_read_b32 v27, a111
    v_mul_f32 v27, v27, v22
    v_accvgpr_write_b32 a111, v27
    v_accvgpr_read_b32 v24, a112
    v_mul_f32 v24, v24, v22
    v_accvgpr_write_b32 a112, v24
    v_accvgpr_read_b32 v25, a113
    v_mul_f32 v25, v25, v22
    v_accvgpr_write_b32 a113, v25
    v_accvgpr_read_b32 v26, a114
    v_mul_f32 v26, v26, v22
    v_accvgpr_write_b32 a114, v26
    v_accvgpr_read_b32 v27, a115
    v_mul_f32 v27, v27, v22
    v_accvgpr_write_b32 a115, v27
    v_accvgpr_read_b32 v24, a116
    v_mul_f32 v24, v24, v22
    v_accvgpr_write_b32 a116, v24
    v_accvgpr_read_b32 v25, a117
    v_mul_f32 v25, v25, v22
    v_accvgpr_write_b32 a117, v25
    v_accvgpr_read_b32 v26, a118
    v_mul_f32 v26, v26, v22
    v_accvgpr_write_b32 a118, v26
    v_accvgpr_read_b32 v27, a119
    v_mul_f32 v27, v27, v22
    v_accvgpr_write_b32 a119, v27
    v_accvgpr_read_b32 v24, a120
    v_mul_f32 v24, v24, v22
    v_accvgpr_write_b32 a120, v24
    v_accvgpr_read_b32 v25, a121
    v_mul_f32 v25, v25, v22
    v_accvgpr_write_b32 a121, v25
    v_accvgpr_read_b32 v26, a122
    v_mul_f32 v26, v26, v22
    v_accvgpr_write_b32 a122, v26
    v_accvgpr_read_b32 v27, a123
    v_mul_f32 v27, v27, v22
    v_accvgpr_write_b32 a123, v27
    v_accvgpr_read_b32 v24, a124
    v_mul_f32 v24, v24, v22
    v_accvgpr_write_b32 a124, v24
    v_accvgpr_read_b32 v25, a125
    v_mul_f32 v25, v25, v22
    v_accvgpr_write_b32 a125, v25
    v_accvgpr_read_b32 v26, a126
    v_mul_f32 v26, v26, v22
    v_accvgpr_write_b32 a126, v26
    v_accvgpr_read_b32 v27, a127
    v_mul_f32 v27, v27, v22
    v_accvgpr_write_b32 a127, v27
    v_sub_f32 v236, v236, v20
    v_sub_f32 v237, v237, v20
    v_sub_f32 v238, v238, v20
    v_sub_f32 v239, v239, v20
    v_sub_f32 v144, v144, v20
    v_sub_f32 v145, v145, v20
    v_sub_f32 v146, v146, v20
    v_sub_f32 v147, v147, v20
    v_sub_f32 v148, v148, v20
    v_sub_f32 v149, v149, v20
    v_sub_f32 v150, v150, v20
    v_sub_f32 v151, v151, v20
    v_sub_f32 v152, v152, v20
    v_sub_f32 v153, v153, v20
    v_sub_f32 v154, v154, v20
    v_sub_f32 v155, v155, v20
    v_sub_f32 v156, v156, v20
    v_sub_f32 v157, v157, v20
    v_sub_f32 v158, v158, v20
    v_sub_f32 v159, v159, v20
    v_exp_f32 v240, v144
    v_exp_f32 v241, v145
    v_exp_f32 v242, v146
    v_exp_f32 v243, v147
    v_exp_f32 v244, v148
    v_cvt_pk_bf16_f32 v188, v240, v241
    v_exp_f32 v245, v149
    v_exp_f32 v246, v150
    v_cvt_pk_bf16_f32 v189, v242, v243
    v_exp_f32 v247, v151
    v_cvt_pk_bf16_f32 v190, v244, v245
    v_cvt_pk_bf16_f32 v191, v246, v247
    s_nop 1
    v_mfma_f32_16x16x32_bf16 v[252:255], v[208:211], v[188:191], 0
    v_exp_f32 v240, v152
    v_exp_f32 v241, v153
    v_exp_f32 v242, v154
    v_exp_f32 v243, v155
    v_exp_f32 v244, v156
    v_cvt_pk_bf16_f32 v204, v240, v241
    v_exp_f32 v245, v157
    v_exp_f32 v246, v158
    v_cvt_pk_bf16_f32 v205, v242, v243
    v_exp_f32 v247, v159
    v_cvt_pk_bf16_f32 v206, v244, v245
    v_cvt_pk_bf16_f32 v207, v246, v247
    s_nop 1
    v_mfma_f32_16x16x32_bf16 v[252:255], v[208:211], v[204:207], v[252:255]
    s_nop 7
    s_branch f1_seo_rare_r
f1_pp:
    s_mov_b32 s26, 0x10000
f1_pp_l:
    buffer_load_dword v28, off, s[56:59], s83 sc1
    s_waitcnt vmcnt(0)
    v_readfirstlane_b32 s25, v28
    s_nop 0
    s_lshr_b32 s25, s25, s15
    s_bfe_u32 s25, s25, 262148
    s_cmp_ge_u32 s25, 8
    s_cbranch_scc1 f1_pp_r
    s_sub_u32 s26, s26, 1
    s_cmp_lg_u32 s26, 0
    s_cbranch_scc1 f1_pp_l
    s_branch f1_pp_r
f1_pw:
    s_mov_b32 s26, 0x10000
f1_pw_l:
    buffer_load_dword v28, off, s[56:59], s75 sc1
    s_waitcnt vmcnt(0)
    v_readfirstlane_b32 s25, v28
    s_nop 0
    s_cmp_ge_u32 s25, 256
    s_cbranch_scc1 f1_pw_r
    s_sub_u32 s26, s26, 1
    s_cmp_lg_u32 s26, 0
    s_cbranch_scc1 f1_pw_l
    s_branch f1_pw_r
f1_pd_e:
    s_mov_b32 s26, 0x10000
f1_pd:
    buffer_load_dword v28, v15, s[60:63], s74 offen sc1
    s_waitcnt vmcnt(0)
    v_cmp_lt_u32 vcc, 0, v28
    s_nop 0
    s_cmp_eq_u64 vcc, -1
    s_cbranch_scc1 f1_pd_r
    s_sub_u32 s26, s26, 1
    s_cmp_lg_u32 s26, 0
    s_cbranch_scc1 f1_pd
    s_branch f1_pd_r
f1_pe_e:
    s_mov_b32 s26, 0x10000
f1_pe:
    buffer_load_dword v28, v15, s[60:63], s74 offen sc1
    s_waitcnt vmcnt(0)
    v_cmp_lt_u32 vcc, 1, v28
    s_nop 0
    s_cmp_eq_u64 vcc, -1
    s_cbranch_scc1 f1_pe_r
    s_sub_u32 s26, s26, 1
    s_cmp_lg_u32 s26, 0
    s_cbranch_scc1 f1_pe
    s_branch f1_pe_r
f1_last:
    s_endpgm
.section .rodata,"a"
.p2align 6
.amdhsa_kernel gated_mix__compressed_kv_cla__linear_kernel_hedgehog__prompt_kernel
  .amdhsa_next_free_vgpr 512
  .amdhsa_next_free_sgpr 102
  .amdhsa_accum_offset 256
  .amdhsa_group_segment_fixed_size 0
  .amdhsa_kernarg_size 112
  .amdhsa_user_sgpr_count 2
  .amdhsa_user_sgpr_kernarg_segment_ptr 1
  .amdhsa_system_sgpr_workgroup_id_x 1
.end_amdhsa_kernel
```
